```python
import torch

def _softmax(x, axis=-1):
    return torch.softmax(x, dim=axis)
def _gelu(x):
    return torch.nn.functional.gelu(x, approximate="tanh")
def _silu(x):
    return torch.nn.functional.silu(x)
def _sigmoid(x):
    return torch.sigmoid(x)
def _layernorm(x, axis=-1, eps=1e-5):
    m = x.mean(dim=axis, keepdim=True)
    v = x.var(dim=axis, keepdim=True, unbiased=False)
    return (x - m) / torch.sqrt(v + eps)
def _scatter_add(tgt, idx, src, axis=0):
    return tgt.clone().index_add_(axis, idx, src)
def _segment_sum(src, seg, n):
    out = torch.zeros((n,) + src.shape[1:], dtype=src.dtype)
    return out.index_add_(0, seg, src)
def _pad(x, pw):
    flat = tuple(v for pair in reversed(pw) for v in pair)
    return torch.nn.functional.pad(x, flat)

kernel_name = 'sequential_preLN__spectral_gfnet__geglu_ffn__prompt'

def setup_inputs():

    _w = (lambda a: (lambda t: t.to(torch.bfloat16) if t.is_floating_point() else t)(torch.as_tensor(a)))
    def _A_setup():
        B, S, D = 1, 2048, 576
        Df = D // 2 + 1
        return {
            "x": _w((lambda *s: torch.randn(*s, dtype=torch.bfloat16) * 0.05)(B, S, D)),
            "w_r": _w((lambda *s: torch.randn(*s, dtype=torch.bfloat16) * 0.4)(S, Df) * 0.02),
            "w_i": _w((lambda *s: torch.randn(*s, dtype=torch.bfloat16) * 0.4)(S, Df) * 0.02),
        }
    _A_in = _A_setup()

    def _B_setup():
        B, S, D, F = 1, 2048, 576, 4608
        return {
            "x": _w((lambda *s: torch.randn(*s, dtype=torch.bfloat16) * 0.05)(B, S, D)),
            "w_gate": _w((lambda *s: torch.randn(*s, dtype=torch.bfloat16) * 0.05)(D, F)),
            "w_up": _w((lambda *s: torch.randn(*s, dtype=torch.bfloat16) * 0.05)(D, F)),
            "w_down": _w((lambda *s: torch.randn(*s, dtype=torch.bfloat16) * 0.05)(F, D)),
        }
    _B_in = _B_setup()

    return {
        "A_x": _A_in["x"],
        "A_w_r": _A_in["w_r"],
        "A_w_i": _A_in["w_i"],
        "B_x": _B_in["x"],
        "B_w_gate": _B_in["w_gate"],
        "B_w_up": _B_in["w_up"],
        "B_w_down": _B_in["w_down"],
    }

def reference(A_x, A_w_r, A_w_i, B_x, B_w_gate, B_w_up, B_w_down):
    def _A_ref(x, w_r, w_i):
        B, S, D = x.shape
        X = (lambda x, axes=(-2,-1): torch.fft.rfft2(x.float(), dim=axes))(x, axes=(-2, -1))
        W = w_r + 1j * w_i
        X = X * W
        y = (lambda x, s, axes=(-2,-1): torch.fft.irfft2(x, s=s, dim=axes).to(torch.bfloat16))(X, (S, D), axes=(-2, -1))
        return y

    def _B_ref(x, w_gate, w_up, w_down):
        return (_gelu(x @ w_gate) * (x @ w_up)) @ w_down

    x = A_x
    h = x + _A_ref(_layernorm(x, axis=-1), A_w_r, A_w_i)
    h2 = h + _B_ref(_layernorm(h, axis=-1), B_w_gate, B_w_up, B_w_down)
    return h2
```

```asm
; @launch grid=(256,1,1) block=(256,1,1) lds=159744
.amdgcn_target "amdgcn-amd-amdhsa--gfx950"
.text
L_text_begin:
.globl sequential_preLN__spectral_gfnet__geglu_ffn__prompt_kernel
.p2align 8
.type sequential_preLN__spectral_gfnet__geglu_ffn__prompt_kernel,@function
sequential_preLN__spectral_gfnet__geglu_ffn__prompt_kernel:
    s_cmp_ge_u32 s2, 256
    s_cbranch_scc1 L_sequential_preLN__spectral_gfnet__geglu_ffn__prompt_kernel_end
    s_bfe_u32 s3, s2, 0x20003
    s_lshr_b32 s16, s2, 5
    s_mul_i32 s17, s16, 3
    s_add_u32 s17, s17, s3
    s_add_u32 s17, s17, 8
    s_cmp_eq_u32 s3, 3
    s_cselect_b32 s16, s16, s17
    s_lshl_b32 s16, s16, 3
    s_and_b32 s2, s2, 7
    s_or_b32 s2, s2, s16
    s_load_dwordx2 s[4:5], s[0:1], 0
    s_load_dwordx2 s[6:7], s[0:1], 72
    s_load_dwordx2 s[96:97], s[0:1], 64
    v_lshrrev_b32 v1, 6, v0
    v_and_b32 v2, 63, v0
    v_readfirstlane_b32 s20, v1
    s_bfe_u32 s40, s2, 0x20003
    s_lshl_b32 s40, s40, 2
    s_add_u32 s40, s40, s20
    s_getpc_b64 s[32:33]
L_sequential_preLN__spectral_gfnet__geglu_ffn__prompt_kernel_pc0:
    s_add_u32 s32, s32, L_text_begin-L_sequential_preLN__spectral_gfnet__geglu_ffn__prompt_kernel_pc0
    s_addc_u32 s33, s33, (L_text_begin-L_sequential_preLN__spectral_gfnet__geglu_ffn__prompt_kernel_pc0)>>32
    s_and_b32 s33, s33, 0xffff
    s_mov_b32 s34, L_text_end-L_text_begin
    s_mov_b32 s35, 0x20000
    v_lshlrev_b32 v3, 7, v2
    s_mul_i32 s36, s40, 8192
    buffer_load_dword v1, v3, s[32:35], s36 offen
    s_sub_u32 s3, s2, 64
    s_cmp_ge_u32 s3, 192
    s_cbranch_scc1 L_sequential_preLN__spectral_gfnet__geglu_ffn__prompt_kernel_wt
    v_mov_b32 v0, v2
    s_load_dwordx4 s[52:55], s[0:1], 32
    s_load_dwordx2 s[56:57], s[0:1], 48
    s_lshr_b32 s23, s3, 3
    s_mul_hi_u32 s24, s23, 0x55555556
    s_mul_i32 s22, s24, 3
    s_sub_u32 s22, s23, s22
    s_and_b32 s21, s2, 4
    s_lshl_b32 s21, s21, 1
    s_add_u32 s21, s21, s24
    s_lshl_b32 s21, s21, 2
    s_and_b32 s25, s2, 3
    s_add_u32 s21, s21, s25
    v_lshrrev_b32 v4, 3, v0
    v_lshrrev_b32 v5, 4, v0
    v_and_b32 v6, 7, v0
    v_xor_b32 v6, v6, v5
    v_lshlrev_b32 v6, 4, v6
    v_mul_u32_u24 v2, 73728, v4
    v_add_u32 v2, v2, v6
    s_and_b32 s26, s20, 1
    s_lshl_b32 s26, s26, 6
    v_xor_b32 v2, s26, v2
    s_mul_i32 s27, s20, 589824
    s_mul_i32 s25, s21, 1152
    s_add_u32 s27, s27, s25
    s_lshl_b32 s26, s20, 10
    s_waitcnt lgkmcnt(0)
    s_mov_b32 s8, s4
    s_and_b32 s9, s5, 0xffff
    s_mov_b32 s10, 2359296
    s_mov_b32 s11, 0x20000
    s_mov_b32 m0, s26
    s_nop 0
    buffer_load_dwordx4 v2, s[8:11], s27 offen offset:0 lds
    s_add_u32 m0, m0, 3968
    s_nop 0
    buffer_load_dwordx4 v2, s[8:11], s27 offen offset:128 lds
    s_add_u32 m0, m0, 3968
    s_nop 0
    buffer_load_dwordx4 v2, s[8:11], s27 offen offset:256 lds
    s_add_u32 m0, m0, 3968
    s_nop 0
    buffer_load_dwordx4 v2, s[8:11], s27 offen offset:384 lds
    s_add_u32 m0, m0, 3968
    s_nop 0
    buffer_load_dwordx4 v2, s[8:11], s27 offen offset:512 lds
    s_add_u32 m0, m0, 3968
    s_nop 0
    buffer_load_dwordx4 v2, s[8:11], s27 offen offset:640 lds
    s_add_u32 m0, m0, 3968
    s_nop 0
    buffer_load_dwordx4 v2, s[8:11], s27 offen offset:768 lds
    s_add_u32 m0, m0, 3968
    s_nop 0
    buffer_load_dwordx4 v2, s[8:11], s27 offen offset:896 lds
    s_add_u32 m0, m0, 3968
    s_nop 0
    buffer_load_dwordx4 v2, s[8:11], s27 offen offset:1024 lds
    s_mul_i32 s19, s22, 3
    s_min_u32 s24, s22, 1
    s_add_u32 s19, s19, s24
    s_add_u32 s19, s19, s20
    s_mul_i32 s18, s24, s20
    v_lshlrev_b32 v34, 4, v0
    s_lshl_b32 s51, s23, 2
    s_add_u32 s51, s51, s20
    s_and_b32 s59, s2, 3
    s_lshl_b32 s59, s59, 1
    s_bfe_u32 s58, s2, 0x10002
    s_add_u32 s59, s59, s58
    s_add_u32 s58, s51, 0
    s_mul_i32 s72, s59, 1152
    s_cmp_lt_u32 s51, 81
    s_cselect_b32 s72, s72, 0x40000000
    s_lshl_b32 s58, s58, 6
    s_and_b32 s58, s58, 0x3fff
    v_add_u32 v224, s58, v0
    v_mul_u32_u24 v225, 7282, v224
    v_lshrrev_b32 v225, 16, v225
    v_mul_u32_u24 v225, 8064, v225
    v_lshl_add_u32 v224, v224, 7, v225
    s_mov_b32 s60, s52
    s_and_b32 s61, s53, 0xffff
    s_mov_b32 s62, 5308416
    s_mov_b32 s63, 0x20000
    s_mov_b32 s12, s6
    s_and_b32 s13, s7, 0xffff
    s_mov_b32 s14, 48768000
    s_mov_b32 s15, 0x20000
    v_lshrrev_b32 v5, 5, v0
    v_and_b32 v35, 31, v0
    v_add_u32 v34, s26, v34
    v_cvt_f32_u32 v9, v5
    v_cvt_f32_u32 v10, v35
    v_mul_f32 v11, 0x3d000000, v10
    s_and_b32 s16, s20, 1
    s_lshl_b32 s16, s16, 10
    s_add_u32 s16, s16, s21
    v_cvt_f32_u32 v12, s16
    v_mul_f32 v12, 0x3c800000, v12
    v_fma_f32 v12, v9, 4.0, v12
    s_cmp_ge_u32 s20, 2
    s_cselect_b32 s16, 0x3e800000, 0
    v_fma_f32 v12, v12, v11, s16
    v_fmamk_f32 v136, v11, 0x00000000, v12
    v_fmamk_f32 v137, v11, 0x3f800000, v12
    v_fmamk_f32 v138, v11, 0x40000000, v12
    v_fmamk_f32 v139, v11, 0x40400000, v12
    v_fmamk_f32 v140, v11, 0x41000000, v12
    v_fmamk_f32 v141, v11, 0x41100000, v12
    v_fmamk_f32 v142, v11, 0x41200000, v12
    v_fmamk_f32 v143, v11, 0x41300000, v12
    v_cos_f32 v136, v136
    v_cos_f32 v137, v137
    v_cos_f32 v138, v138
    v_cos_f32 v139, v139
    v_cos_f32 v140, v140
    v_cos_f32 v141, v141
    v_cos_f32 v142, v142
    v_cos_f32 v143, v143
    v_cvt_pk_bf16_f32 v144, v136, v137
    v_cvt_pk_bf16_f32 v145, v138, v139
    v_cvt_pk_bf16_f32 v146, v140, v141
    v_cvt_pk_bf16_f32 v147, v142, v143
    ds_write_b128 v34, v[144:147] offset:37120
    s_lshl_b32 s30, s19, 6
    s_add_u32 s30, s30, s21
    s_lshl_b32 s30, s30, 7
    s_add_u32 s30, s30, 48529408
    s_cmp_eq_u32 s18, 3
    s_cselect_b32 s30, 0x40000000, s30
    v_lshlrev_b32 v32, 2, v0
    v_lshl_add_u32 v32, v5, 30, v32
    v_mov_b32 v33, 0
    buffer_store_dword v33, v32, s[12:15], s30 offen sc1
    s_mov_b32 s33, 0
    s_cmp_eq_u32 s18, 3
    s_cbranch_scc1 L_sequential_preLN__spectral_gfnet__geglu_ffn__prompt_kernel_hgen
    s_lshl_b32 s17, s19, 4
    v_bfe_u32 v4, v0, 1, 4
    v_add_u32 v4, s17, v4
    v_and_b32 v6, 1, v0
    v_cvt_f32_u32 v7, v4
    v_mul_f32 v7, 0x3b638e39, v7
    v_cvt_f32_u32 v8, v6
    v_mul_f32 v8, 0x3e800000, v8
    v_mul_f32 v10, 0x41000000, v9
    v_fma_f32 v10, v10, v7, v8
    v_add_f32 v11, v10, v7
    v_add_f32 v12, v11, v7
    v_add_f32 v13, v12, v7
    v_add_f32 v14, v13, v7
    v_add_f32 v15, v14, v7
    v_add_f32 v16, v15, v7
    v_add_f32 v17, v16, v7
    v_mul_f32 v8, 0x41800000, v7
    v_and_b32 v31, 1, v4
    v_mul_u32_u24 v31, 0x8000, v31
    v_lshl_or_b32 v31, v31, 16, v31
    v_mov_b32 v28, 0
    v_mov_b32 v3, 0x3f803f80
    v_cos_f32 v18, v10
    v_cos_f32 v19, v11
    v_cos_f32 v20, v12
    v_cos_f32 v21, v13
    v_cos_f32 v22, v14
    v_cos_f32 v23, v15
    v_cos_f32 v24, v16
    v_cos_f32 v25, v17
    v_add_f32 v10, v8, v10
    v_add_f32 v11, v8, v11
    v_add_f32 v12, v8, v12
    v_add_f32 v13, v8, v13
    v_add_f32 v14, v8, v14
    v_add_f32 v15, v8, v15
    v_add_f32 v16, v8, v16
    v_add_f32 v17, v8, v17
    v_cvt_pk_bf16_f32 v40, v18, v19
    v_cvt_pk_bf16_f32 v41, v20, v21
    v_cvt_pk_bf16_f32 v42, v22, v23
    v_cvt_pk_bf16_f32 v43, v24, v25
    v_dot2c_f32_bf16 v28, v40, v3
    v_dot2c_f32_bf16 v28, v41, v3
    v_dot2c_f32_bf16 v28, v42, v3
    v_dot2c_f32_bf16 v28, v43, v3
    v_xor_b32 v76, v31, v40
    v_xor_b32 v77, v31, v41
    v_xor_b32 v78, v31, v42
    v_xor_b32 v79, v31, v43
    buffer_load_dword v1, v224, s[60:63], s72 offen
    v_cos_f32 v18, v10
    v_cos_f32 v19, v11
    v_cos_f32 v20, v12
    v_cos_f32 v21, v13
    v_cos_f32 v22, v14
    v_cos_f32 v23, v15
    v_cos_f32 v24, v16
    v_cos_f32 v25, v17
    v_add_f32 v10, v8, v10
    v_add_f32 v11, v8, v11
    v_add_f32 v12, v8, v12
    v_add_f32 v13, v8, v13
    v_add_f32 v14, v8, v14
    v_add_f32 v15, v8, v15
    v_add_f32 v16, v8, v16
    v_add_f32 v17, v8, v17
    v_cvt_pk_bf16_f32 v44, v18, v19
    v_cvt_pk_bf16_f32 v45, v20, v21
    v_cvt_pk_bf16_f32 v46, v22, v23
    v_cvt_pk_bf16_f32 v47, v24, v25
    v_dot2c_f32_bf16 v28, v44, v3
    v_dot2c_f32_bf16 v28, v45, v3
    v_dot2c_f32_bf16 v28, v46, v3
    v_dot2c_f32_bf16 v28, v47, v3
    v_xor_b32 v80, v31, v44
    v_xor_b32 v81, v31, v45
    v_xor_b32 v82, v31, v46
    v_xor_b32 v83, v31, v47
    v_cos_f32 v18, v10
    v_cos_f32 v19, v11
    v_cos_f32 v20, v12
    v_cos_f32 v21, v13
    v_cos_f32 v22, v14
    v_cos_f32 v23, v15
    v_cos_f32 v24, v16
    v_cos_f32 v25, v17
    v_add_f32 v10, v8, v10
    v_add_f32 v11, v8, v11
    v_add_f32 v12, v8, v12
    v_add_f32 v13, v8, v13
    v_add_f32 v14, v8, v14
    v_add_f32 v15, v8, v15
    v_add_f32 v16, v8, v16
    v_add_f32 v17, v8, v17
    v_cvt_pk_bf16_f32 v48, v18, v19
    v_cvt_pk_bf16_f32 v49, v20, v21
    v_cvt_pk_bf16_f32 v50, v22, v23
    v_cvt_pk_bf16_f32 v51, v24, v25
    v_dot2c_f32_bf16 v28, v48, v3
    v_dot2c_f32_bf16 v28, v49, v3
    v_dot2c_f32_bf16 v28, v50, v3
    v_dot2c_f32_bf16 v28, v51, v3
    v_xor_b32 v84, v31, v48
    v_xor_b32 v85, v31, v49
    v_xor_b32 v86, v31, v50
    v_xor_b32 v87, v31, v51
    v_cos_f32 v18, v10
    v_cos_f32 v19, v11
    v_cos_f32 v20, v12
    v_cos_f32 v21, v13
    v_cos_f32 v22, v14
    v_cos_f32 v23, v15
    v_cos_f32 v24, v16
    v_cos_f32 v25, v17
    v_add_f32 v10, v8, v10
    v_add_f32 v11, v8, v11
    v_add_f32 v12, v8, v12
    v_add_f32 v13, v8, v13
    v_add_f32 v14, v8, v14
    v_add_f32 v15, v8, v15
    v_add_f32 v16, v8, v16
    v_add_f32 v17, v8, v17
    v_cvt_pk_bf16_f32 v52, v18, v19
    v_cvt_pk_bf16_f32 v53, v20, v21
    v_cvt_pk_bf16_f32 v54, v22, v23
    v_cvt_pk_bf16_f32 v55, v24, v25
    v_dot2c_f32_bf16 v28, v52, v3
    v_dot2c_f32_bf16 v28, v53, v3
    v_dot2c_f32_bf16 v28, v54, v3
    v_dot2c_f32_bf16 v28, v55, v3
    v_xor_b32 v88, v31, v52
    v_xor_b32 v89, v31, v53
    v_xor_b32 v90, v31, v54
    v_xor_b32 v91, v31, v55
    v_cos_f32 v18, v10
    v_cos_f32 v19, v11
    v_cos_f32 v20, v12
    v_cos_f32 v21, v13
    v_cos_f32 v22, v14
    v_cos_f32 v23, v15
    v_cos_f32 v24, v16
    v_cos_f32 v25, v17
    v_add_f32 v10, v8, v10
    v_add_f32 v11, v8, v11
    v_add_f32 v12, v8, v12
    v_add_f32 v13, v8, v13
    v_add_f32 v14, v8, v14
    v_add_f32 v15, v8, v15
    v_add_f32 v16, v8, v16
    v_add_f32 v17, v8, v17
    v_cvt_pk_bf16_f32 v56, v18, v19
    v_cvt_pk_bf16_f32 v57, v20, v21
    v_cvt_pk_bf16_f32 v58, v22, v23
    v_cvt_pk_bf16_f32 v59, v24, v25
    v_dot2c_f32_bf16 v28, v56, v3
    v_dot2c_f32_bf16 v28, v57, v3
    v_dot2c_f32_bf16 v28, v58, v3
    v_dot2c_f32_bf16 v28, v59, v3
    v_xor_b32 v92, v31, v56
    v_xor_b32 v93, v31, v57
    v_xor_b32 v94, v31, v58
    v_xor_b32 v95, v31, v59
    v_cos_f32 v18, v10
    v_cos_f32 v19, v11
    v_cos_f32 v20, v12
    v_cos_f32 v21, v13
    v_cos_f32 v22, v14
    v_cos_f32 v23, v15
    v_cos_f32 v24, v16
    v_cos_f32 v25, v17
    v_add_f32 v10, v8, v10
    v_add_f32 v11, v8, v11
    v_add_f32 v12, v8, v12
    v_add_f32 v13, v8, v13
    v_add_f32 v14, v8, v14
    v_add_f32 v15, v8, v15
    v_add_f32 v16, v8, v16
    v_add_f32 v17, v8, v17
    v_cvt_pk_bf16_f32 v60, v18, v19
    v_cvt_pk_bf16_f32 v61, v20, v21
    v_cvt_pk_bf16_f32 v62, v22, v23
    v_cvt_pk_bf16_f32 v63, v24, v25
    v_dot2c_f32_bf16 v28, v60, v3
    v_dot2c_f32_bf16 v28, v61, v3
    v_dot2c_f32_bf16 v28, v62, v3
    v_dot2c_f32_bf16 v28, v63, v3
    v_xor_b32 v96, v31, v60
    v_xor_b32 v97, v31, v61
    v_xor_b32 v98, v31, v62
    v_xor_b32 v99, v31, v63
    v_cos_f32 v18, v10
    v_cos_f32 v19, v11
    v_cos_f32 v20, v12
    v_cos_f32 v21, v13
    v_cos_f32 v22, v14
    v_cos_f32 v23, v15
    v_cos_f32 v24, v16
    v_cos_f32 v25, v17
    v_add_f32 v10, v8, v10
    v_add_f32 v11, v8, v11
    v_add_f32 v12, v8, v12
    v_add_f32 v13, v8, v13
    v_add_f32 v14, v8, v14
    v_add_f32 v15, v8, v15
    v_add_f32 v16, v8, v16
    v_add_f32 v17, v8, v17
    v_cvt_pk_bf16_f32 v64, v18, v19
    v_cvt_pk_bf16_f32 v65, v20, v21
    v_cvt_pk_bf16_f32 v66, v22, v23
    v_cvt_pk_bf16_f32 v67, v24, v25
    v_dot2c_f32_bf16 v28, v64, v3
    v_dot2c_f32_bf16 v28, v65, v3
    v_dot2c_f32_bf16 v28, v66, v3
    v_dot2c_f32_bf16 v28, v67, v3
    v_xor_b32 v100, v31, v64
    v_xor_b32 v101, v31, v65
    v_xor_b32 v102, v31, v66
    v_xor_b32 v103, v31, v67
    v_cos_f32 v18, v10
    v_cos_f32 v19, v11
    v_cos_f32 v20, v12
    v_cos_f32 v21, v13
    v_cos_f32 v22, v14
    v_cos_f32 v23, v15
    v_cos_f32 v24, v16
    v_cos_f32 v25, v17
    v_add_f32 v10, v8, v10
    v_add_f32 v11, v8, v11
    v_add_f32 v12, v8, v12
    v_add_f32 v13, v8, v13
    v_add_f32 v14, v8, v14
    v_add_f32 v15, v8, v15
    v_add_f32 v16, v8, v16
    v_add_f32 v17, v8, v17
    v_cvt_pk_bf16_f32 v68, v18, v19
    v_cvt_pk_bf16_f32 v69, v20, v21
    v_cvt_pk_bf16_f32 v70, v22, v23
    v_cvt_pk_bf16_f32 v71, v24, v25
    v_dot2c_f32_bf16 v28, v68, v3
    v_dot2c_f32_bf16 v28, v69, v3
    v_dot2c_f32_bf16 v28, v70, v3
    v_dot2c_f32_bf16 v28, v71, v3
    v_xor_b32 v104, v31, v68
    v_xor_b32 v105, v31, v69
    v_xor_b32 v106, v31, v70
    v_xor_b32 v107, v31, v71
    v_cos_f32 v18, v10
    v_cos_f32 v19, v11
    v_cos_f32 v20, v12
    v_cos_f32 v21, v13
    v_cos_f32 v22, v14
    v_cos_f32 v23, v15
    v_cos_f32 v24, v16
    v_cos_f32 v25, v17
    v_cvt_pk_bf16_f32 v72, v18, v19
    v_cvt_pk_bf16_f32 v73, v20, v21
    v_cvt_pk_bf16_f32 v74, v22, v23
    v_cvt_pk_bf16_f32 v75, v24, v25
    v_dot2c_f32_bf16 v28, v72, v3
    v_dot2c_f32_bf16 v28, v73, v3
    v_dot2c_f32_bf16 v28, v74, v3
    v_dot2c_f32_bf16 v28, v75, v3
    v_xor_b32 v108, v31, v72
    v_xor_b32 v109, v31, v73
    v_xor_b32 v110, v31, v74
    v_xor_b32 v111, v31, v75
    v_mul_f32 v12, 0.5, v7
    v_lshlrev_b32 v13, 31, v6
    v_xor_b32 v12, v12, v13
    v_cos_f32 v29, v12
    v_sin_f32 v30, v12
    v_mov_b32 v11, v28
    v_and_b32 v13, 1, v4
    v_or_b32 v13, v13, v5
    v_permlane32_swap_b32 v28, v11
    v_cmp_eq_u32 vcc, 0, v13
    v_mov_b32 v113, 0
    v_mov_b32 v114, 0
    v_mov_b32 v115, 0
    v_mov_b32 v117, 0
    v_mov_b32 v118, 0
    v_mov_b32 v119, 0
    v_add_f32 v28, v28, v11
    v_mul_f32 v28, -2.0, v28
    v_cndmask_b32 v28, 0, v28, vcc
    v_cvt_pk_bf16_f32 v112, v28, v113
    v_bfe_u32 v10, v0, 1, 3
    v_lshlrev_b32 v11, 1, v5
    v_xor_b32 v10, v10, v11
    v_lshlrev_b32 v10, 4, v10
    v_lshl_add_u32 v36, v35, 7, v10
    v_xor_b32 v37, 16, v36
    v_xor_b32 v38, 64, v36
    v_xor_b32 v39, 80, v36
    s_mov_b32 s28, 0x05040100
    s_mov_b32 s29, 0x07060302
    v_lshlrev_b32 v26, 4, v5
    v_lshlrev_b32 v27, 2, v35
    s_lshr_b32 s24, s21, 3
    s_lshl_b32 s24, s24, 10
    s_bfe_u32 s25, s21, 0x10002
    s_lshl_b32 s25, s25, 9
    s_add_u32 s24, s24, s25
    s_and_b32 s25, s21, 1
    s_lshl_b32 s25, s25, 8
    s_add_u32 s24, s24, s25
    s_bfe_u32 s25, s21, 0x10001
    s_lshl_b32 s25, s25, 7
    s_add_u32 s24, s24, s25
    v_lshl_add_u32 v10, v35, 2, s24
    v_lshl_add_u32 v11, v5, 1, s17
    v_lshlrev_b32 v11, 13, v11
    v_add_u32 v24, v10, v11
    v_subrev_u32 v24, 8192, v24
    v_sub_u32 v25, v10, v11
    v_add_u32 v25, 1171456, v25
    s_add_u32 s44, s6, 0
    s_addc_u32 s45, s7, 0
    s_and_b32 s45, s45, 0xffff
    s_mov_b32 s46, 1179648
    s_mov_b32 s47, 0x20000
    s_add_u32 s48, s6, 1179648
    s_addc_u32 s49, s7, 0
    s_and_b32 s49, s49, 0xffff
    s_mov_b32 s50, 1179648
    s_mov_b32 s51, 0x20000
L_sequential_preLN__spectral_gfnet__geglu_ffn__prompt_kernel_nogen:
    s_waitcnt vmcnt(2)
    ds_read_b128 v[136:139], v34 offset:0
    ds_read_b128 v[140:143], v34 offset:4096
    ds_read_b128 v[144:147], v34 offset:8192
    ds_read_b128 v[148:151], v34 offset:12288
    ds_read_b128 v[152:155], v34 offset:16384
    ds_read_b128 v[156:159], v34 offset:20480
    ds_read_b128 v[160:163], v34 offset:24576
    ds_read_b128 v[164:167], v34 offset:28672
    ds_read_b128 v[168:171], v34 offset:32768
    s_barrier
    v_mov_b32 v18, 0
    v_mov_b32 v19, 0
    v_mov_b32 v20, 0
    v_mov_b32 v21, 0
    v_mov_b32 v22, 0x3f803f80
    v_lshrrev_b32 v23, 3, v0
    v_lshlrev_b32 v23, 2, v23
    s_lshl_b32 s24, s20, 5
    v_add_u32 v23, s24, v23
    s_cmp_eq_u32 s18, 3
    s_cbranch_scc1 L_sequential_preLN__spectral_gfnet__geglu_ffn__prompt_kernel_helper
    ds_read_b128 v[172:175], v36 offset:0
    ds_read_b128 v[176:179], v37 offset:0
    ds_read_b128 v[180:183], v38 offset:0
    ds_read_b128 v[184:187], v39 offset:0
    ds_read_b128 v[188:191], v36 offset:4096
    ds_read_b128 v[192:195], v37 offset:4096
    s_waitcnt lgkmcnt(14)
    v_dot2c_f32_bf16 v18, v136, v22
    v_dot2c_f32_bf16 v19, v136, v136
    v_dot2c_f32_bf16 v20, v137, v22
    v_dot2c_f32_bf16 v21, v137, v137
    v_dot2c_f32_bf16 v18, v138, v22
    v_dot2c_f32_bf16 v19, v138, v138
    v_dot2c_f32_bf16 v20, v139, v22
    v_dot2c_f32_bf16 v21, v139, v139
    s_waitcnt lgkmcnt(13)
    v_dot2c_f32_bf16 v18, v140, v22
    v_dot2c_f32_bf16 v19, v140, v140
    v_dot2c_f32_bf16 v20, v141, v22
    v_dot2c_f32_bf16 v21, v141, v141
    v_dot2c_f32_bf16 v18, v142, v22
    v_dot2c_f32_bf16 v19, v142, v142
    v_dot2c_f32_bf16 v20, v143, v22
    v_dot2c_f32_bf16 v21, v143, v143
    s_waitcnt lgkmcnt(12)
    v_dot2c_f32_bf16 v18, v144, v22
    v_dot2c_f32_bf16 v19, v144, v144
    v_dot2c_f32_bf16 v20, v145, v22
    v_dot2c_f32_bf16 v21, v145, v145
    v_dot2c_f32_bf16 v18, v146, v22
    v_dot2c_f32_bf16 v19, v146, v146
    v_dot2c_f32_bf16 v20, v147, v22
    v_dot2c_f32_bf16 v21, v147, v147
    s_waitcnt lgkmcnt(11)
    v_dot2c_f32_bf16 v18, v148, v22
    v_dot2c_f32_bf16 v19, v148, v148
    v_dot2c_f32_bf16 v20, v149, v22
    v_dot2c_f32_bf16 v21, v149, v149
    v_dot2c_f32_bf16 v18, v150, v22
    v_dot2c_f32_bf16 v19, v150, v150
    v_dot2c_f32_bf16 v20, v151, v22
    v_dot2c_f32_bf16 v21, v151, v151
    s_waitcnt lgkmcnt(10)
    v_dot2c_f32_bf16 v18, v152, v22
    v_dot2c_f32_bf16 v19, v152, v152
    v_dot2c_f32_bf16 v20, v153, v22
    v_dot2c_f32_bf16 v21, v153, v153
    v_dot2c_f32_bf16 v18, v154, v22
    v_dot2c_f32_bf16 v19, v154, v154
    v_dot2c_f32_bf16 v20, v155, v22
    v_dot2c_f32_bf16 v21, v155, v155
    s_waitcnt lgkmcnt(9)
    v_dot2c_f32_bf16 v18, v156, v22
    v_dot2c_f32_bf16 v19, v156, v156
    v_dot2c_f32_bf16 v20, v157, v22
    v_dot2c_f32_bf16 v21, v157, v157
    v_dot2c_f32_bf16 v18, v158, v22
    v_dot2c_f32_bf16 v19, v158, v158
    v_dot2c_f32_bf16 v20, v159, v22
    v_dot2c_f32_bf16 v21, v159, v159
    s_waitcnt lgkmcnt(8)
    v_dot2c_f32_bf16 v18, v160, v22
    v_dot2c_f32_bf16 v19, v160, v160
    v_dot2c_f32_bf16 v20, v161, v22
    v_dot2c_f32_bf16 v21, v161, v161
    v_dot2c_f32_bf16 v18, v162, v22
    v_dot2c_f32_bf16 v19, v162, v162
    v_dot2c_f32_bf16 v20, v163, v22
    v_dot2c_f32_bf16 v21, v163, v163
    s_waitcnt lgkmcnt(7)
    v_dot2c_f32_bf16 v18, v164, v22
    v_dot2c_f32_bf16 v19, v164, v164
    v_dot2c_f32_bf16 v20, v165, v22
    v_dot2c_f32_bf16 v21, v165, v165
    v_dot2c_f32_bf16 v18, v166, v22
    v_dot2c_f32_bf16 v19, v166, v166
    v_dot2c_f32_bf16 v20, v167, v22
    v_dot2c_f32_bf16 v21, v167, v167
    s_waitcnt lgkmcnt(6)
    v_dot2c_f32_bf16 v18, v168, v22
    v_dot2c_f32_bf16 v19, v168, v168
    v_dot2c_f32_bf16 v20, v169, v22
    v_dot2c_f32_bf16 v21, v169, v169
    v_dot2c_f32_bf16 v18, v170, v22
    v_dot2c_f32_bf16 v19, v170, v170
    v_dot2c_f32_bf16 v20, v171, v22
    v_dot2c_f32_bf16 v21, v171, v171
    s_waitcnt lgkmcnt(4)
    v_perm_b32 v8, v173, v172, s28
    v_perm_b32 v9, v175, v174, s28
    v_perm_b32 v10, v177, v176, s28
    v_perm_b32 v11, v179, v178, s28
    v_perm_b32 v12, v173, v172, s29
    v_perm_b32 v13, v175, v174, s29
    v_perm_b32 v14, v177, v176, s29
    v_perm_b32 v15, v179, v178, s29
    s_nop 0
    v_mfma_f32_32x32x16_bf16 v[136:151], v[8:11], v[40:43], 0
    s_waitcnt lgkmcnt(2)
    ds_read_b128 v[172:175], v38 offset:4096
    v_perm_b32 v200, v181, v180, s28
    v_perm_b32 v201, v183, v182, s28
    v_perm_b32 v202, v185, v184, s28
    v_perm_b32 v203, v187, v186, s28
    v_add_f32 v18, v18, v20
    v_add_f32 v19, v19, v21
    v_mfma_f32_32x32x16_bf16 v[152:167], v[12:15], v[40:43], 0
    ds_read_b128 v[176:179], v39 offset:4096
    v_perm_b32 v204, v181, v180, s29
    v_perm_b32 v205, v183, v182, s29
    v_perm_b32 v206, v185, v184, s29
    v_perm_b32 v207, v187, v186, s29
    v_add_f32_dpp v18, v18, v18 quad_perm:[1,0,3,2] row_mask:0xf bank_mask:0xf
    v_add_f32_dpp v19, v19, v19 quad_perm:[1,0,3,2] row_mask:0xf bank_mask:0xf
    v_mfma_f32_32x32x16_bf16 v[136:151], v[200:203], v[44:47], v[136:151]
    s_waitcnt lgkmcnt(2)
    ds_read_b128 v[180:183], v36 offset:8192
    v_perm_b32 v8, v189, v188, s28
    v_perm_b32 v9, v191, v190, s28
    v_perm_b32 v10, v193, v192, s28
    v_perm_b32 v11, v195, v194, s28
    v_add_f32_dpp v18, v18, v18 quad_perm:[2,3,0,1] row_mask:0xf bank_mask:0xf
    v_add_f32_dpp v19, v19, v19 quad_perm:[2,3,0,1] row_mask:0xf bank_mask:0xf
    v_mfma_f32_32x32x16_bf16 v[152:167], v[204:207], v[44:47], v[152:167]
    ds_read_b128 v[184:187], v37 offset:8192
    v_perm_b32 v12, v189, v188, s29
    v_perm_b32 v13, v191, v190, s29
    v_perm_b32 v14, v193, v192, s29
    v_perm_b32 v15, v195, v194, s29
    v_add_f32_dpp v18, v18, v18 row_half_mirror row_mask:0xf bank_mask:0xf
    v_add_f32_dpp v19, v19, v19 row_half_mirror row_mask:0xf bank_mask:0xf
    v_mfma_f32_32x32x16_bf16 v[136:151], v[8:11], v[48:51], v[136:151]
    s_waitcnt lgkmcnt(2)
    ds_read_b128 v[188:191], v38 offset:8192
    v_perm_b32 v200, v173, v172, s28
    v_perm_b32 v201, v175, v174, s28
    v_perm_b32 v202, v177, v176, s28
    v_perm_b32 v203, v179, v178, s28
    v_mul_f32 v18, 0x3ae38e39, v18
    v_mul_f32 v19, 0x3ae38e39, v19
    v_mfma_f32_32x32x16_bf16 v[152:167], v[12:15], v[48:51], v[152:167]
    ds_read_b128 v[192:195], v39 offset:8192
    v_perm_b32 v204, v173, v172, s29
    v_perm_b32 v205, v175, v174, s29
    v_perm_b32 v206, v177, v176, s29
    v_perm_b32 v207, v179, v178, s29
    v_fma_f32 v19, -v18, v18, v19
    v_max_f32 v19, 0, v19
    v_mfma_f32_32x32x16_bf16 v[136:151], v[200:203], v[52:55], v[136:151]
    s_waitcnt lgkmcnt(2)
    ds_read_b128 v[172:175], v36 offset:12288
    v_perm_b32 v8, v181, v180, s28
    v_perm_b32 v9, v183, v182, s28
    v_perm_b32 v10, v185, v184, s28
    v_perm_b32 v11, v187, v186, s28
    v_add_f32 v19, 0x3727c5ac, v19
    v_rsq_f32 v19, v19
    v_mfma_f32_32x32x16_bf16 v[152:167], v[204:207], v[52:55], v[152:167]
    ds_read_b128 v[176:179], v37 offset:12288
    v_perm_b32 v12, v181, v180, s29
    v_perm_b32 v13, v183, v182, s29
    v_perm_b32 v14, v185, v184, s29
    v_perm_b32 v15, v187, v186, s29
    ds_write_b32 v23, v18 offset:36992
    v_mul_f32 v19, 0x35e38e39, v19
    v_mfma_f32_32x32x16_bf16 v[136:151], v[8:11], v[56:59], v[136:151]
    s_waitcnt lgkmcnt(3)
    ds_read_b128 v[180:183], v38 offset:12288
    v_perm_b32 v200, v189, v188, s28
    v_perm_b32 v201, v191, v190, s28
    v_perm_b32 v202, v193, v192, s28
    v_perm_b32 v203, v195, v194, s28
    ds_write_b32 v23, v19 offset:36864
    v_mfma_f32_32x32x16_bf16 v[152:167], v[12:15], v[56:59], v[152:167]
    ds_read_b128 v[184:187], v39 offset:12288
    v_perm_b32 v204, v189, v188, s29
    v_perm_b32 v205, v191, v190, s29
    v_perm_b32 v206, v193, v192, s29
    v_perm_b32 v207, v195, v194, s29
    v_mfma_f32_32x32x16_bf16 v[136:151], v[200:203], v[60:63], v[136:151]
    s_waitcnt lgkmcnt(4)
    ds_read_b128 v[188:191], v36 offset:16384
    v_perm_b32 v8, v173, v172, s28
    v_perm_b32 v9, v175, v174, s28
    v_perm_b32 v10, v177, v176, s28
    v_perm_b32 v11, v179, v178, s28
    v_mfma_f32_32x32x16_bf16 v[152:167], v[204:207], v[60:63], v[152:167]
    ds_read_b128 v[192:195], v37 offset:16384
    v_perm_b32 v12, v173, v172, s29
    v_perm_b32 v13, v175, v174, s29
    v_perm_b32 v14, v177, v176, s29
    v_perm_b32 v15, v179, v178, s29
    v_mfma_f32_32x32x16_bf16 v[136:151], v[8:11], v[64:67], v[136:151]
    s_waitcnt lgkmcnt(2)
    ds_read_b128 v[172:175], v38 offset:16384
    v_perm_b32 v200, v181, v180, s28
    v_perm_b32 v201, v183, v182, s28
    v_perm_b32 v202, v185, v184, s28
    v_perm_b32 v203, v187, v186, s28
    v_mfma_f32_32x32x16_bf16 v[152:167], v[12:15], v[64:67], v[152:167]
    ds_read_b128 v[176:179], v39 offset:16384
    v_perm_b32 v204, v181, v180, s29
    v_perm_b32 v205, v183, v182, s29
    v_perm_b32 v206, v185, v184, s29
    v_perm_b32 v207, v187, v186, s29
    v_mfma_f32_32x32x16_bf16 v[136:151], v[200:203], v[68:71], v[136:151]
    s_waitcnt lgkmcnt(2)
    ds_read_b128 v[180:183], v36 offset:20480
    v_perm_b32 v8, v189, v188, s28
    v_perm_b32 v9, v191, v190, s28
    v_perm_b32 v10, v193, v192, s28
    v_perm_b32 v11, v195, v194, s28
    v_mfma_f32_32x32x16_bf16 v[152:167], v[204:207], v[68:71], v[152:167]
    ds_read_b128 v[184:187], v37 offset:20480
    v_perm_b32 v12, v189, v188, s29
    v_perm_b32 v13, v191, v190, s29
    v_perm_b32 v14, v193, v192, s29
    v_perm_b32 v15, v195, v194, s29
    v_mfma_f32_32x32x16_bf16 v[136:151], v[8:11], v[72:75], v[136:151]
    s_waitcnt lgkmcnt(2)
    ds_read_b128 v[188:191], v38 offset:20480
    v_perm_b32 v200, v173, v172, s28
    v_perm_b32 v201, v175, v174, s28
    v_perm_b32 v202, v177, v176, s28
    v_perm_b32 v203, v179, v178, s28
    v_mfma_f32_32x32x16_bf16 v[152:167], v[12:15], v[72:75], v[152:167]
    ds_read_b128 v[192:195], v39 offset:20480
    v_perm_b32 v204, v173, v172, s29
    v_perm_b32 v205, v175, v174, s29
    v_perm_b32 v206, v177, v176, s29
    v_perm_b32 v207, v179, v178, s29
    v_mfma_f32_32x32x16_bf16 v[136:151], v[200:203], v[76:79], v[136:151]
    s_waitcnt lgkmcnt(2)
    ds_read_b128 v[172:175], v36 offset:24576
    v_perm_b32 v8, v181, v180, s28
    v_perm_b32 v9, v183, v182, s28
    v_perm_b32 v10, v185, v184, s28
    v_perm_b32 v11, v187, v186, s28
    v_mfma_f32_32x32x16_bf16 v[152:167], v[204:207], v[76:79], v[152:167]
    ds_read_b128 v[176:179], v37 offset:24576
    v_perm_b32 v12, v181, v180, s29
    v_perm_b32 v13, v183, v182, s29
    v_perm_b32 v14, v185, v184, s29
    v_perm_b32 v15, v187, v186, s29
    v_mfma_f32_32x32x16_bf16 v[136:151], v[8:11], v[80:83], v[136:151]
    s_waitcnt lgkmcnt(2)
    ds_read_b128 v[180:183], v38 offset:24576
    v_perm_b32 v200, v189, v188, s28
    v_perm_b32 v201, v191, v190, s28
    v_perm_b32 v202, v193, v192, s28
    v_perm_b32 v203, v195, v194, s28
    v_mfma_f32_32x32x16_bf16 v[152:167], v[12:15], v[80:83], v[152:167]
    ds_read_b128 v[184:187], v39 offset:24576
    v_perm_b32 v204, v189, v188, s29
    v_perm_b32 v205, v191, v190, s29
    v_perm_b32 v206, v193, v192, s29
    v_perm_b32 v207, v195, v194, s29
    v_mfma_f32_32x32x16_bf16 v[136:151], v[200:203], v[84:87], v[136:151]
    s_waitcnt lgkmcnt(2)
    s_barrier
    ds_read_b128 v[188:191], v36 offset:28672
    v_perm_b32 v8, v173, v172, s28
    v_perm_b32 v9, v175, v174, s28
    v_perm_b32 v10, v177, v176, s28
    v_perm_b32 v11, v179, v178, s28
    v_mfma_f32_32x32x16_bf16 v[152:167], v[204:207], v[84:87], v[152:167]
    ds_read_b128 v[192:195], v37 offset:28672
    v_perm_b32 v12, v173, v172, s29
    v_perm_b32 v13, v175, v174, s29
    v_perm_b32 v14, v177, v176, s29
    v_perm_b32 v15, v179, v178, s29
    v_mfma_f32_32x32x16_bf16 v[136:151], v[8:11], v[88:91], v[136:151]
    s_waitcnt lgkmcnt(2)
    ds_read_b128 v[172:175], v38 offset:28672
    v_perm_b32 v200, v181, v180, s28
    v_perm_b32 v201, v183, v182, s28
    v_perm_b32 v202, v185, v184, s28
    v_perm_b32 v203, v187, v186, s28
    v_mfma_f32_32x32x16_bf16 v[152:167], v[12:15], v[88:91], v[152:167]
    ds_read_b128 v[176:179], v39 offset:28672
    v_perm_b32 v204, v181, v180, s29
    v_perm_b32 v205, v183, v182, s29
    v_perm_b32 v206, v185, v184, s29
    v_perm_b32 v207, v187, v186, s29
    v_mfma_f32_32x32x16_bf16 v[136:151], v[200:203], v[92:95], v[136:151]
    s_waitcnt lgkmcnt(2)
    ds_read_b128 v[180:183], v36 offset:32768
    v_perm_b32 v8, v189, v188, s28
    v_perm_b32 v9, v191, v190, s28
    v_perm_b32 v10, v193, v192, s28
    v_perm_b32 v11, v195, v194, s28
    v_mfma_f32_32x32x16_bf16 v[152:167], v[204:207], v[92:95], v[152:167]
    ds_read_b128 v[184:187], v37 offset:32768
    v_perm_b32 v12, v189, v188, s29
    v_perm_b32 v13, v191, v190, s29
    v_perm_b32 v14, v193, v192, s29
    v_perm_b32 v15, v195, v194, s29
    v_mfma_f32_32x32x16_bf16 v[136:151], v[8:11], v[96:99], v[136:151]
    s_waitcnt lgkmcnt(2)
    ds_read_b128 v[188:191], v38 offset:32768
    v_perm_b32 v200, v173, v172, s28
    v_perm_b32 v201, v175, v174, s28
    v_perm_b32 v202, v177, v176, s28
    v_perm_b32 v203, v179, v178, s28
    v_mfma_f32_32x32x16_bf16 v[152:167], v[12:15], v[96:99], v[152:167]
    ds_read_b128 v[192:195], v39 offset:32768
    v_lshlrev_b32 v17, 4, v0
    v_perm_b32 v204, v173, v172, s29
    v_perm_b32 v205, v175, v174, s29
    v_perm_b32 v206, v177, v176, s29
    v_perm_b32 v207, v179, v178, s29
    v_mfma_f32_32x32x16_bf16 v[136:151], v[200:203], v[100:103], v[136:151]
    s_waitcnt lgkmcnt(2)
    ds_read_b32 v16, v27 offset:36992
    ds_read_b128 v[208:211], v26 offset:36864
    v_perm_b32 v8, v181, v180, s28
    v_perm_b32 v9, v183, v182, s28
    v_perm_b32 v10, v185, v184, s28
    v_perm_b32 v11, v187, v186, s28
    v_mfma_f32_32x32x16_bf16 v[152:167], v[204:207], v[100:103], v[152:167]
    ds_read_b128 v[212:215], v26 offset:36896
    v_perm_b32 v12, v181, v180, s29
    v_perm_b32 v13, v183, v182, s29
    v_perm_b32 v14, v185, v184, s29
    v_perm_b32 v15, v187, v186, s29
    v_mfma_f32_32x32x16_bf16 v[136:151], v[8:11], v[104:107], v[136:151]
    s_waitcnt lgkmcnt(3)
    ds_read_b128 v[120:123], v17 offset:37120
    ds_read_b128 v[216:219], v26 offset:36928
    v_perm_b32 v200, v189, v188, s28
    v_perm_b32 v201, v191, v190, s28
    v_perm_b32 v202, v193, v192, s28
    v_perm_b32 v203, v195, v194, s28
    v_mfma_f32_32x32x16_bf16 v[152:167], v[12:15], v[104:107], v[152:167]
    ds_read_b128 v[124:127], v17 offset:38144
    ds_read_b128 v[220:223], v26 offset:36960
    v_perm_b32 v204, v189, v188, s29
    v_perm_b32 v205, v191, v190, s29
    v_perm_b32 v206, v193, v192, s29
    v_perm_b32 v207, v195, v194, s29
    v_mfma_f32_32x32x16_bf16 v[136:151], v[200:203], v[108:111], v[136:151]
    ds_read_b128 v[128:131], v17 offset:39168
    s_waitcnt lgkmcnt(7)
    v_cvt_pk_bf16_f32 v116, v16, v117
    s_lshl_b32 s24, s21, 7
    s_add_u32 s24, s24, 9768960
    v_mfma_f32_32x32x16_bf16 v[152:167], v[204:207], v[108:111], v[152:167]
    ds_read_b128 v[132:135], v17 offset:40192
    s_cmp_eq_u32 s19, 0
    s_cselect_b32 s24, s24, 0x40000000
    buffer_store_dword v16, v27, s[12:15], s24 offen sc1
    v_mfma_f32_32x32x16_bf16 v[152:167], v[116:119], v[112:115], v[152:167]
    v_mfma_f32_32x32x16_bf16 v[136:151], v[116:119], v[112:115], v[136:151]
    s_nop 10
    s_waitcnt lgkmcnt(0)
    v_mul_f32 v40, v29, v152
    v_mul_f32 v41, v29, v153
    v_mul_f32 v42, v29, v154
    v_mul_f32 v43, v29, v155
    v_mul_f32 v44, v29, v156
    v_mul_f32 v45, v29, v157
    v_mul_f32 v46, v29, v158
    v_mul_f32 v47, v29, v159
    v_mul_f32 v48, v29, v160
    v_mul_f32 v49, v29, v161
    v_mul_f32 v50, v29, v162
    v_mul_f32 v51, v29, v163
    v_mul_f32 v52, v29, v164
    v_mul_f32 v53, v29, v165
    v_mul_f32 v54, v29, v166
    v_mul_f32 v55, v29, v167
    v_fmac_f32_dpp v40, v152, v30 quad_perm:[1,0,3,2] row_mask:0xf bank_mask:0xf
    v_fmac_f32_dpp v41, v153, v30 quad_perm:[1,0,3,2] row_mask:0xf bank_mask:0xf
    v_fmac_f32_dpp v42, v154, v30 quad_perm:[1,0,3,2] row_mask:0xf bank_mask:0xf
    v_fmac_f32_dpp v43, v155, v30 quad_perm:[1,0,3,2] row_mask:0xf bank_mask:0xf
    v_fmac_f32_dpp v44, v156, v30 quad_perm:[1,0,3,2] row_mask:0xf bank_mask:0xf
    v_fmac_f32_dpp v45, v157, v30 quad_perm:[1,0,3,2] row_mask:0xf bank_mask:0xf
    v_fmac_f32_dpp v46, v158, v30 quad_perm:[1,0,3,2] row_mask:0xf bank_mask:0xf
    v_fmac_f32_dpp v47, v159, v30 quad_perm:[1,0,3,2] row_mask:0xf bank_mask:0xf
    v_fmac_f32_dpp v48, v160, v30 quad_perm:[1,0,3,2] row_mask:0xf bank_mask:0xf
    v_fmac_f32_dpp v49, v161, v30 quad_perm:[1,0,3,2] row_mask:0xf bank_mask:0xf
    v_fmac_f32_dpp v50, v162, v30 quad_perm:[1,0,3,2] row_mask:0xf bank_mask:0xf
    v_fmac_f32_dpp v51, v163, v30 quad_perm:[1,0,3,2] row_mask:0xf bank_mask:0xf
    v_fmac_f32_dpp v52, v164, v30 quad_perm:[1,0,3,2] row_mask:0xf bank_mask:0xf
    v_fmac_f32_dpp v53, v165, v30 quad_perm:[1,0,3,2] row_mask:0xf bank_mask:0xf
    v_fmac_f32_dpp v54, v166, v30 quad_perm:[1,0,3,2] row_mask:0xf bank_mask:0xf
    v_fmac_f32_dpp v55, v167, v30 quad_perm:[1,0,3,2] row_mask:0xf bank_mask:0xf
    v_mul_f32 v136, v136, v208
    v_mul_f32 v137, v137, v209
    v_mul_f32 v138, v138, v210
    v_mul_f32 v139, v139, v211
    v_mul_f32 v140, v140, v212
    v_mul_f32 v141, v141, v213
    v_mul_f32 v142, v142, v214
    v_mul_f32 v143, v143, v215
    v_mul_f32 v144, v144, v216
    v_mul_f32 v145, v145, v217
    v_mul_f32 v146, v146, v218
    v_mul_f32 v147, v147, v219
    v_mul_f32 v148, v148, v220
    v_mul_f32 v149, v149, v221
    v_mul_f32 v150, v150, v222
    v_mul_f32 v151, v151, v223
    v_fma_f32 v56, v40, v208, v136
    v_fma_f32 v57, v41, v209, v137
    v_fma_f32 v58, v42, v210, v138
    v_fma_f32 v59, v43, v211, v139
    v_fma_f32 v60, v44, v212, v140
    v_fma_f32 v61, v45, v213, v141
    v_fma_f32 v62, v46, v214, v142
    v_fma_f32 v63, v47, v215, v143
    v_fma_f32 v64, v48, v216, v144
    v_fma_f32 v65, v49, v217, v145
    v_fma_f32 v66, v50, v218, v146
    v_fma_f32 v67, v51, v219, v147
    v_fma_f32 v68, v52, v220, v148
    v_fma_f32 v69, v53, v221, v149
    v_fma_f32 v70, v54, v222, v150
    v_fma_f32 v71, v55, v223, v151
    v_cvt_pk_bf16_f32 v88, v56, v57
    v_cvt_pk_bf16_f32 v89, v58, v59
    v_cvt_pk_bf16_f32 v90, v60, v61
    v_cvt_pk_bf16_f32 v91, v62, v63
    v_cvt_pk_bf16_f32 v92, v64, v65
    v_cvt_pk_bf16_f32 v93, v66, v67
    v_cvt_pk_bf16_f32 v94, v68, v69
    v_cvt_pk_bf16_f32 v95, v70, v71
    v_fma_f32 v72, -v40, v208, v136
    v_fma_f32 v73, -v41, v209, v137
    v_mfma_f32_32x32x16_bf16 v[172:187], v[88:91], v[120:123], 0
    v_fma_f32 v74, -v42, v210, v138
    v_fma_f32 v75, -v43, v211, v139
    v_fma_f32 v76, -v44, v212, v140
    v_fma_f32 v77, -v45, v213, v141
    v_fma_f32 v78, -v46, v214, v142
    v_fma_f32 v79, -v47, v215, v143
    v_mfma_f32_32x32x16_bf16 v[152:167], v[88:91], v[128:131], 0
    v_fma_f32 v80, -v48, v216, v144
    v_fma_f32 v81, -v49, v217, v145
    v_fma_f32 v82, -v50, v218, v146
    v_fma_f32 v83, -v51, v219, v147
    v_fma_f32 v84, -v52, v220, v148
    v_fma_f32 v85, -v53, v221, v149
    v_mfma_f32_32x32x16_bf16 v[172:187], v[92:95], v[124:127], v[172:187]
    v_fma_f32 v86, -v54, v222, v150
    v_fma_f32 v87, -v55, v223, v151
    v_cvt_pk_bf16_f32 v96, v72, v73
    v_cvt_pk_bf16_f32 v97, v74, v75
    v_cvt_pk_bf16_f32 v98, v76, v77
    v_cvt_pk_bf16_f32 v99, v78, v79
    v_mfma_f32_32x32x16_bf16 v[152:167], v[92:95], v[132:135], v[152:167]
    v_cvt_pk_bf16_f32 v100, v80, v81
    v_cvt_pk_bf16_f32 v101, v82, v83
    v_cvt_pk_bf16_f32 v102, v84, v85
    v_cvt_pk_bf16_f32 v103, v86, v87
    s_nop 1
    v_mfma_f32_32x32x16_bf16 v[224:239], v[96:99], v[120:123], 0
    v_add_u32 v8, 0, v24
    v_add_u32 v9, 8192, v24
    v_add_u32 v10, 32768, v24
    v_add_u32 v11, 40960, v24
    v_add_u32 v12, 65536, v24
    v_add_u32 v13, 73728, v24
    v_mfma_f32_32x32x16_bf16 v[240:255], v[96:99], v[128:131], 0
    v_add_u32 v14, 98304, v24
    v_add_u32 v15, 106496, v24
    v_subrev_u32 v200, 0, v25
    v_subrev_u32 v201, 8192, v25
    v_subrev_u32 v202, 32768, v25
    v_subrev_u32 v203, 40960, v25
    v_mfma_f32_32x32x16_bf16 v[224:239], v[100:103], v[124:127], v[224:239]
    v_subrev_u32 v204, 65536, v25
    v_subrev_u32 v205, 73728, v25
    v_subrev_u32 v206, 98304, v25
    v_subrev_u32 v207, 106496, v25
    v_mfma_f32_32x32x16_bf16 v[240:255], v[100:103], v[132:135], v[240:255]
    v_sub_f32 v56, v172, v153
    v_add_f32 v57, v152, v173
    v_sub_f32 v58, v174, v155
    v_add_f32 v59, v154, v175
    v_sub_f32 v60, v176, v157
    v_add_f32 v61, v156, v177
    v_sub_f32 v62, v178, v159
    v_add_f32 v63, v158, v179
    v_sub_f32 v64, v180, v161
    v_add_f32 v65, v160, v181
    v_sub_f32 v66, v182, v163
    v_add_f32 v67, v162, v183
    v_sub_f32 v68, v184, v165
    v_add_f32 v69, v164, v185
    v_sub_f32 v70, v186, v167
    v_add_f32 v71, v166, v187
    v_cvt_pk_bf16_f32 v88, v56, v57
    v_cvt_pk_bf16_f32 v89, v58, v59
    v_cvt_pk_bf16_f32 v90, v60, v61
    v_cvt_pk_bf16_f32 v91, v62, v63
    v_cvt_pk_bf16_f32 v92, v64, v65
    v_cvt_pk_bf16_f32 v93, v66, v67
    v_cvt_pk_bf16_f32 v94, v68, v69
    v_cvt_pk_bf16_f32 v95, v70, v71
    buffer_store_dword v88, v8, s[44:47], 0 offen sc1
    buffer_store_dword v89, v9, s[44:47], 0 offen sc1
    buffer_store_dword v90, v10, s[44:47], 0 offen sc1
    buffer_store_dword v91, v11, s[44:47], 0 offen sc1
    buffer_store_dword v92, v12, s[44:47], 0 offen sc1
    buffer_store_dword v93, v13, s[44:47], 0 offen sc1
    buffer_store_dword v94, v14, s[44:47], 0 offen sc1
    buffer_store_dword v95, v15, s[44:47], 0 offen sc1
    v_add_f32 v72, v224, v241
    v_sub_f32 v73, v240, v225
    v_add_f32 v74, v226, v243
    v_sub_f32 v75, v242, v227
    v_add_f32 v76, v228, v245
    v_sub_f32 v77, v244, v229
    v_add_f32 v78, v230, v247
    v_sub_f32 v79, v246, v231
    v_add_f32 v80, v232, v249
    v_sub_f32 v81, v248, v233
    v_add_f32 v82, v234, v251
    v_sub_f32 v83, v250, v235
    v_add_f32 v84, v236, v253
    v_sub_f32 v85, v252, v237
    v_add_f32 v86, v238, v255
    v_sub_f32 v87, v254, v239
    v_cvt_pk_bf16_f32 v96, v72, v73
    v_cvt_pk_bf16_f32 v97, v74, v75
    v_cvt_pk_bf16_f32 v98, v76, v77
    v_cvt_pk_bf16_f32 v99, v78, v79
    v_cvt_pk_bf16_f32 v100, v80, v81
    v_cvt_pk_bf16_f32 v101, v82, v83
    v_cvt_pk_bf16_f32 v102, v84, v85
    v_cvt_pk_bf16_f32 v103, v86, v87
    buffer_store_dword v96, v200, s[48:51], 0 offen sc1
    buffer_store_dword v97, v201, s[48:51], 0 offen sc1
    buffer_store_dword v98, v202, s[48:51], 0 offen sc1
    buffer_store_dword v99, v203, s[48:51], 0 offen sc1
    buffer_store_dword v100, v204, s[48:51], 0 offen sc1
    buffer_store_dword v101, v205, s[48:51], 0 offen sc1
    buffer_store_dword v102, v206, s[48:51], 0 offen sc1
    buffer_store_dword v103, v207, s[48:51], 0 offen sc1
L_sequential_preLN__spectral_gfnet__geglu_ffn__prompt_kernel_s2:
    s_mov_b32 s12, s6
    s_and_b32 s13, s7, 0xffff
    s_mov_b32 s14, 48768000
    s_mov_b32 s15, 0x20000
    s_mov_b32 s36, s96
    s_and_b32 s37, s97, 0xffff
    s_mov_b32 s38, 256
    s_mov_b32 s39, 0x20000
    buffer_load_dword v197, off, s[36:39], 0 sc1
    s_add_u32 s101, s2, 32
    v_lshlrev_b32 v2, 4, v0
    v_lshrrev_b32 v5, 5, v0
    v_and_b32 v35, 31, v0
    v_lshlrev_b32 v3, 2, v35
    v_lshl_add_u32 v3, v5, 8, v3
    s_lshl_b32 s23, s101, 13
    s_lshl_b32 s26, s20, 11
    s_add_u32 s23, s23, s26
    s_add_u32 s24, s23, 0
    s_add_u32 s25, s23, 7077888
    s_add_u32 m0, s26, 41472
    v_bfe_u32 v4, v0, 1, 4
    s_lshl_b32 s27, s20, 4
    v_add_u32 v4, s27, v4
    v_and_b32 v6, 1, v0
    v_cvt_f32_u32 v7, v4
    v_mul_f32 v8, 0x3c800000, v7
    v_cvt_f32_u32 v9, v6
    v_mul_f32 v9, 0x3e800000, v9
    v_cvt_f32_u32 v36, v5
    v_add_f32 v10, v36, v36
    v_fma_f32 v9, v10, v8, v9
    v_fmamk_f32 v12, v8, 0x00000000, v9
    v_fmamk_f32 v13, v8, 0x3f800000, v9
    v_fmamk_f32 v14, v8, 0x40800000, v9
    v_fmamk_f32 v15, v8, 0x40a00000, v9
    v_fmamk_f32 v16, v8, 0x41000000, v9
    v_fmamk_f32 v17, v8, 0x41100000, v9
    v_fmamk_f32 v18, v8, 0x41400000, v9
    v_fmamk_f32 v19, v8, 0x41500000, v9
    v_cos_f32 v20, v12
    v_cos_f32 v21, v13
    v_cos_f32 v22, v14
    v_cos_f32 v23, v15
    v_cos_f32 v24, v16
    v_cos_f32 v25, v17
    v_cos_f32 v26, v18
    v_cos_f32 v27, v19
    v_sin_f32 v12, v12
    v_sin_f32 v13, v13
    v_sin_f32 v14, v14
    v_sin_f32 v15, v15
    v_sin_f32 v16, v16
    v_sin_f32 v17, v17
    v_sin_f32 v18, v18
    v_sin_f32 v19, v19
    v_cvt_pk_bf16_f32 v80, v20, v12
    v_cvt_pk_bf16_f32 v81, v21, v13
    v_cvt_pk_bf16_f32 v82, v22, v14
    v_cvt_pk_bf16_f32 v83, v23, v15
    v_cvt_pk_bf16_f32 v84, v24, v16
    v_cvt_pk_bf16_f32 v85, v25, v17
    v_cvt_pk_bf16_f32 v86, v26, v18
    v_cvt_pk_bf16_f32 v87, v27, v19
    s_load_dwordx4 s[52:55], s[0:1], 32
    s_load_dwordx2 s[56:57], s[0:1], 48
    s_lshr_b32 s51, s2, 3
    s_lshl_b32 s51, s51, 2
    s_add_u32 s51, s51, s20
    s_sub_u32 s51, s51, 16
    s_waitcnt lgkmcnt(0)
    s_and_b32 s59, s2, 3
    s_lshl_b32 s59, s59, 1
    s_bfe_u32 s58, s2, 0x10002
    s_add_u32 s59, s59, s58
    s_add_u32 s58, s51, 0
    s_mul_i32 s72, s59, 1152
    s_cmp_lt_u32 s51, 81
    s_cselect_b32 s72, s72, 0x40000000
    s_lshl_b32 s58, s58, 6
    s_and_b32 s58, s58, 0x3fff
    v_add_u32 v176, s58, v0
    v_mul_u32_u24 v177, 7282, v176
    v_lshrrev_b32 v177, 16, v177
    v_mul_u32_u24 v177, 8064, v177
    v_lshl_add_u32 v176, v176, 7, v177
    s_mov_b32 s64, s54
    s_and_b32 s65, s55, 0xffff
    s_mov_b32 s66, 5308416
    s_mov_b32 s67, 0x20000
    v_lshlrev_b32 v196, 2, v0
    v_lshl_add_u32 v196, v5, 30, v196
    s_mov_b32 s16, 200000
L_sequential_preLN__spectral_gfnet__geglu_ffn__prompt_kernel_nw:
    s_waitcnt vmcnt(0)
    v_readfirstlane_b32 s100, v197
    s_sub_u32 s16, s16, 1
    s_cmp_eq_u32 s16, 0
    s_cbranch_scc1 L_sequential_preLN__spectral_gfnet__geglu_ffn__prompt_kernel_ng
    s_cmp_lg_u32 s100, 0
    s_cbranch_scc1 L_sequential_preLN__spectral_gfnet__geglu_ffn__prompt_kernel_ng
    s_sleep 8
    buffer_load_dword v197, off, s[36:39], 0 sc1
    s_branch L_sequential_preLN__spectral_gfnet__geglu_ffn__prompt_kernel_nw
L_sequential_preLN__spectral_gfnet__geglu_ffn__prompt_kernel_ng:
    buffer_store_dword v197, v196, s[12:15], s30 offen sc1
    s_lshl_b32 s16, s20, 10
    s_add_u32 s16, s16, s2
    s_cmp_eq_u32 s16, 64
    s_cselect_b32 s16, 128, 0x40000000
    buffer_store_dword v197, v196, s[36:39], s16 offen sc1
    buffer_load_dword v1, v176, s[64:67], s72 offen
    s_cmp_ge_u32 s2, 64
    s_cbranch_scc1 L_sequential_preLN__spectral_gfnet__geglu_ffn__prompt_kernel_nw1
    s_load_dwordx2 s[40:41], s[0:1], 32
    s_lshr_b32 s44, s2, 3
    s_sub_u32 s45, s44, 8
    s_mul_hi_u32 s3, s45, 0x55555556
    s_add_u32 s45, s45, s3
    s_lshl_b32 s3, s44, 2
    s_add_u32 s3, s3, 3
    s_cmp_lt_u32 s44, 8
    s_cselect_b32 s45, s3, s45
    s_lshl_b32 s45, s45, 3
    s_and_b32 s3, s2, 7
    s_or_b32 s3, s3, s45
    s_lshr_b32 s46, s3, 3
    s_and_b32 s44, s46, 3
    s_lshr_b32 s45, s46, 2
    s_and_b32 s46, s3, 7
    s_and_b32 s47, s46, 3
    s_lshl_b32 s47, s47, 2
    s_add_u32 s44, s44, s47
    s_lshr_b32 s46, s46, 2
    s_lshl_b32 s46, s46, 3
    s_add_u32 s45, s45, s46
    v_lshrrev_b32 v184, 3, v0
    v_and_b32 v185, 7, v0
    v_and_b32 v186, 6, v184
    v_xor_b32 v185, v185, v186
    v_lshlrev_b32 v185, 4, v185
    v_mul_u32_u24 v184, 9216, v184
    v_add_u32 v184, v184, v185
    v_add_u32 v185, 72704, v184
    v_add_u32 v186, 145408, v184
    v_add_u32 v187, 218112, v184
    s_lshr_b32 s45, s44, 1
    s_and_b32 s44, s44, 1
    s_mul_i32 s45, s45, 1152
    s_mul_i32 s44, s44, 640
    s_add_u32 s44, s44, s45
    s_mul_i32 s45, s20, 663552
    s_add_u32 s44, s44, s45
    s_mul_i32 s45, s20, 9216
    s_waitcnt lgkmcnt(0)
    s_and_b32 s41, s41, 0xffff
    s_mov_b32 s42, 5308416
    s_mov_b32 s43, 0x20000
    s_add_u32 m0, s45, 73728
    s_add_u32 s46, s44, 0
    buffer_load_dwordx4 v184, s[40:43], s46 offen offset:0 lds
    buffer_load_dwordx4 v185, s[40:43], s46 offen offset:1024 lds
    buffer_load_dwordx4 v186, s[40:43], s46 offen offset:2048 lds
    buffer_load_dwordx4 v187, s[40:43], s46 offen offset:3072 lds
    s_add_u32 m0, s45, 77824
    s_add_u32 s46, s44, 294912
    buffer_load_dwordx4 v184, s[40:43], s46 offen offset:0 lds
    buffer_load_dwordx4 v185, s[40:43], s46 offen offset:1024 lds
    buffer_load_dwordx4 v186, s[40:43], s46 offen offset:2048 lds
    buffer_load_dwordx4 v187, s[40:43], s46 offen offset:3072 lds
    s_add_u32 m0, s45, 81920
    s_add_u32 s46, s44, 589824
    buffer_load_dwordx4 v184, s[40:43], s46 offen offset:0 lds
    s_add_u32 m0, s45, 110592
    s_add_u32 s46, s44, 2654208
    buffer_load_dwordx4 v184, s[40:43], s46 offen offset:0 lds
    buffer_load_dwordx4 v185, s[40:43], s46 offen offset:1024 lds
    buffer_load_dwordx4 v186, s[40:43], s46 offen offset:2048 lds
    buffer_load_dwordx4 v187, s[40:43], s46 offen offset:3072 lds
    s_add_u32 m0, s45, 114688
    s_add_u32 s46, s44, 2949120
    buffer_load_dwordx4 v184, s[40:43], s46 offen offset:0 lds
    buffer_load_dwordx4 v185, s[40:43], s46 offen offset:1024 lds
    buffer_load_dwordx4 v186, s[40:43], s46 offen offset:2048 lds
    buffer_load_dwordx4 v187, s[40:43], s46 offen offset:3072 lds
    s_add_u32 m0, s45, 118784
    s_add_u32 s46, s44, 3244032
    buffer_load_dwordx4 v184, s[40:43], s46 offen offset:0 lds
    s_add_u32 m0, s26, 41472
L_sequential_preLN__spectral_gfnet__geglu_ffn__prompt_kernel_nw1:
    v_fmamk_f32 v12, v8, 0x41800000, v9
    v_fmamk_f32 v13, v8, 0x41880000, v9
    v_fmamk_f32 v14, v8, 0x41a00000, v9
    v_fmamk_f32 v15, v8, 0x41a80000, v9
    v_fmamk_f32 v16, v8, 0x41c00000, v9
    v_fmamk_f32 v17, v8, 0x41c80000, v9
    v_fmamk_f32 v18, v8, 0x41e00000, v9
    v_fmamk_f32 v19, v8, 0x41e80000, v9
    v_cos_f32 v20, v12
    v_cos_f32 v21, v13
    v_cos_f32 v22, v14
    v_cos_f32 v23, v15
    v_cos_f32 v24, v16
    v_cos_f32 v25, v17
    v_cos_f32 v26, v18
    v_cos_f32 v27, v19
    v_sin_f32 v12, v12
    v_sin_f32 v13, v13
    v_sin_f32 v14, v14
    v_sin_f32 v15, v15
    v_sin_f32 v16, v16
    v_sin_f32 v17, v17
    v_sin_f32 v18, v18
    v_sin_f32 v19, v19
    v_cvt_pk_bf16_f32 v88, v20, v12
    v_cvt_pk_bf16_f32 v89, v21, v13
    v_cvt_pk_bf16_f32 v90, v22, v14
    v_cvt_pk_bf16_f32 v91, v23, v15
    v_cvt_pk_bf16_f32 v92, v24, v16
    v_cvt_pk_bf16_f32 v93, v25, v17
    v_cvt_pk_bf16_f32 v94, v26, v18
    v_cvt_pk_bf16_f32 v95, v27, v19
    v_and_b32 v10, 1, v4
    v_mul_u32_u24 v10, 0x8000, v10
    v_lshl_or_b32 v10, v10, 16, v10
    v_xor_b32 v96, v10, v80
    v_xor_b32 v97, v10, v81
    v_xor_b32 v98, v10, v82
    v_xor_b32 v99, v10, v83
    v_xor_b32 v100, v10, v84
    v_xor_b32 v101, v10, v85
    v_xor_b32 v102, v10, v86
    v_xor_b32 v103, v10, v87
    v_xor_b32 v104, v10, v88
    v_xor_b32 v105, v10, v89
    v_xor_b32 v106, v10, v90
    v_xor_b32 v107, v10, v91
    v_xor_b32 v108, v10, v92
    v_xor_b32 v109, v10, v93
    v_xor_b32 v110, v10, v94
    v_xor_b32 v111, v10, v95
    v_mul_f32 v8, 0x3a000000, v7
    v_lshlrev_b32 v10, 31, v6
    v_xor_b32 v8, v8, v10
    v_mul_f32 v9, 4.0, v36
    v_mul_f32 v9, v9, v8
    v_fmamk_f32 v128, v8, 0x00000000, v9
    v_fmamk_f32 v129, v8, 0x3f800000, v9
    v_fmamk_f32 v130, v8, 0x40000000, v9
    v_fmamk_f32 v131, v8, 0x40400000, v9
    v_fmamk_f32 v132, v8, 0x41000000, v9
    v_fmamk_f32 v133, v8, 0x41100000, v9
    v_fmamk_f32 v134, v8, 0x41200000, v9
    v_fmamk_f32 v135, v8, 0x41300000, v9
    v_fmamk_f32 v136, v8, 0x41800000, v9
    v_fmamk_f32 v137, v8, 0x41880000, v9
    v_fmamk_f32 v138, v8, 0x41900000, v9
    v_fmamk_f32 v139, v8, 0x41980000, v9
    v_fmamk_f32 v140, v8, 0x41c00000, v9
    v_fmamk_f32 v141, v8, 0x41c80000, v9
    v_fmamk_f32 v142, v8, 0x41d00000, v9
    v_fmamk_f32 v143, v8, 0x41d80000, v9
    v_cos_f32 v112, v128
    v_cos_f32 v113, v129
    v_cos_f32 v114, v130
    v_cos_f32 v115, v131
    v_cos_f32 v116, v132
    v_cos_f32 v117, v133
    v_cos_f32 v118, v134
    v_cos_f32 v119, v135
    v_cos_f32 v120, v136
    v_cos_f32 v121, v137
    v_cos_f32 v122, v138
    v_cos_f32 v123, v139
    v_cos_f32 v124, v140
    v_cos_f32 v125, v141
    v_cos_f32 v126, v142
    v_cos_f32 v127, v143
    v_sin_f32 v128, v128
    v_sin_f32 v129, v129
    v_sin_f32 v130, v130
    v_sin_f32 v131, v131
    v_sin_f32 v132, v132
    v_sin_f32 v133, v133
    v_sin_f32 v134, v134
    v_sin_f32 v135, v135
    v_sin_f32 v136, v136
    v_sin_f32 v137, v137
    v_sin_f32 v138, v138
    v_sin_f32 v139, v139
    v_sin_f32 v140, v140
    v_sin_f32 v141, v141
    v_sin_f32 v142, v142
    v_sin_f32 v143, v143
    v_lshlrev_b32 v34, 2, v0
    v_add_u32 v34, 41472, v34
    v_cvt_f32_u32 v10, v35
    v_mul_f32 v11, 0x3d000000, v10
    v_mul_f32 v32, 4.0, v36
    v_mul_f32 v32, v32, v11
    v_fmamk_f32 v14, v11, 0x00000000, v32
    v_fmamk_f32 v15, v11, 0x3f800000, v32
    v_fmamk_f32 v16, v11, 0x40000000, v32
    v_fmamk_f32 v17, v11, 0x40400000, v32
    v_fmamk_f32 v18, v11, 0x41000000, v32
    v_fmamk_f32 v19, v11, 0x41100000, v32
    v_fmamk_f32 v20, v11, 0x41200000, v32
    v_fmamk_f32 v21, v11, 0x41300000, v32
    v_cos_f32 v22, v14
    v_cos_f32 v23, v15
    v_cos_f32 v24, v16
    v_cos_f32 v25, v17
    v_cos_f32 v26, v18
    v_cos_f32 v27, v19
    v_cos_f32 v28, v20
    v_cos_f32 v29, v21
    v_sin_f32 v14, -v14
    v_sin_f32 v15, -v15
    v_sin_f32 v16, -v16
    v_sin_f32 v17, -v17
    v_sin_f32 v18, -v18
    v_sin_f32 v19, -v19
    v_sin_f32 v20, -v20
    v_sin_f32 v21, -v21
    v_and_b32 v10, 1, v0
    v_mul_u32_u24 v10, 0x8000, v10
    v_lshl_or_b32 v10, v10, 16, v10
    v_cvt_pk_bf16_f32 v144, v22, v23
    v_cvt_pk_bf16_f32 v152, v14, v15
    v_cvt_pk_bf16_f32 v145, v24, v25
    v_cvt_pk_bf16_f32 v153, v16, v17
    v_cvt_pk_bf16_f32 v146, v26, v27
    v_cvt_pk_bf16_f32 v154, v18, v19
    v_cvt_pk_bf16_f32 v147, v28, v29
    v_cvt_pk_bf16_f32 v155, v20, v21
    v_xor_b32 v148, v10, v144
    v_xor_b32 v156, v10, v152
    v_xor_b32 v149, v10, v145
    v_xor_b32 v157, v10, v153
    v_xor_b32 v150, v10, v146
    v_xor_b32 v158, v10, v154
    v_xor_b32 v151, v10, v147
    v_xor_b32 v159, v10, v155
    s_cmp_lg_u32 s101, 287
    s_cbranch_scc1 L_sequential_preLN__spectral_gfnet__geglu_ffn__prompt_kernel_nonyq
    v_mul_f32 v112, 0.5, v112
    v_mul_f32 v113, 0.5, v113
    v_mul_f32 v114, 0.5, v114
    v_mul_f32 v115, 0.5, v115
    v_mul_f32 v116, 0.5, v116
    v_mul_f32 v117, 0.5, v117
    v_mul_f32 v118, 0.5, v118
    v_mul_f32 v119, 0.5, v119
    v_mul_f32 v120, 0.5, v120
    v_mul_f32 v121, 0.5, v121
    v_mul_f32 v122, 0.5, v122
    v_mul_f32 v123, 0.5, v123
    v_mul_f32 v124, 0.5, v124
    v_mul_f32 v125, 0.5, v125
    v_mul_f32 v126, 0.5, v126
    v_mul_f32 v127, 0.5, v127
    v_mul_f32 v128, 0.5, v128
    v_mul_f32 v129, 0.5, v129
    v_mul_f32 v130, 0.5, v130
    v_mul_f32 v131, 0.5, v131
    v_mul_f32 v132, 0.5, v132
    v_mul_f32 v133, 0.5, v133
    v_mul_f32 v134, 0.5, v134
    v_mul_f32 v135, 0.5, v135
    v_mul_f32 v136, 0.5, v136
    v_mul_f32 v137, 0.5, v137
    v_mul_f32 v138, 0.5, v138
    v_mul_f32 v139, 0.5, v139
    v_mul_f32 v140, 0.5, v140
    v_mul_f32 v141, 0.5, v141
    v_mul_f32 v142, 0.5, v142
    v_mul_f32 v143, 0.5, v143
L_sequential_preLN__spectral_gfnet__geglu_ffn__prompt_kernel_nonyq:
    s_add_u32 s16, s101, 1
    s_sub_u32 s17, 287, s101
    s_cmp_lt_u32 s101, 144
    s_cselect_b32 s16, s16, s17
    s_lshr_b32 s16, s16, 4
    v_bfe_u32 v32, v0, 4, 1
    v_cmp_eq_u32 vcc, 0, v32
    s_add_u32 s17, s2, 1
    s_lshr_b32 s17, s17, 4
    s_cmp_lt_u32 s2, 32
    s_cselect_b32 s17, s17, s16
    s_sub_u32 s17, s17, s16
    v_mul_lo_u32 v33, v5, s17
    v_add_u32 v33, s16, v33
    v_and_b32 v32, 15, v0
    v_cndmask_b32 v33, 10, v33, vcc
    v_lshl_add_u32 v32, v33, 6, v32
    v_lshlrev_b32 v32, 7, v32
    s_add_u32 s17, s26, 48529408
    s_mov_b32 s16, 200000
    s_lshr_b32 s28, s2, 3
    s_sub_u32 s28, s28, 8
    s_lshl_b32 s29, s28, 13
    s_add_u32 s29, s29, 9437184
    s_lshl_b32 s27, s20, 8
    s_add_u32 s28, s28, s27
    s_cmp_lt_u32 s28, 21
    s_cselect_b32 s28, s29, 0x40000000
    v_lshlrev_b32 v192, 7, v0
    s_barrier
    s_cmp_eq_u32 s33, 0
    s_cbranch_scc1 L_sequential_preLN__spectral_gfnet__geglu_ffn__prompt_kernel_f0
L_sequential_preLN__spectral_gfnet__geglu_ffn__prompt_kernel_gw:
    buffer_load_dword v33, off, s[36:39], 0 offset:128 sc1
    s_sub_u32 s16, s16, 1
    s_waitcnt vmcnt(0)
    v_cmp_eq_u32 vcc, 0, v33
    s_cmp_eq_u32 s16, 0
    s_cbranch_scc1 L_sequential_preLN__spectral_gfnet__geglu_ffn__prompt_kernel_fg
    s_cbranch_vccz L_sequential_preLN__spectral_gfnet__geglu_ffn__prompt_kernel_f0
    s_sleep 4
    s_branch L_sequential_preLN__spectral_gfnet__geglu_ffn__prompt_kernel_gw
    s_branch L_sequential_preLN__spectral_gfnet__geglu_ffn__prompt_kernel_f0
L_sequential_preLN__spectral_gfnet__geglu_ffn__prompt_kernel_fw:
L_sequential_preLN__spectral_gfnet__geglu_ffn__prompt_kernel_f0:
    buffer_load_dword v33, v32, s[12:15], s17 offen sc1
    s_sub_u32 s16, s16, 1
    s_waitcnt vmcnt(0)
    v_cmp_ne_u32 vcc, s100, v33
    s_cmp_eq_u32 s16, 0
    s_cbranch_scc1 L_sequential_preLN__spectral_gfnet__geglu_ffn__prompt_kernel_fg
    s_cbranch_vccnz L_sequential_preLN__spectral_gfnet__geglu_ffn__prompt_kernel_fw
L_sequential_preLN__spectral_gfnet__geglu_ffn__prompt_kernel_fg:
    s_cmp_lt_u32 s2, 32
    s_cbranch_scc1 L_sequential_preLN__spectral_gfnet__geglu_ffn__prompt_kernel_dual
    buffer_load_dwordx4 v2, s[12:15], s24 offen offset:0 sc1 lds
    buffer_load_dwordx4 v2, s[12:15], s24 offen offset:1024 sc1 lds
    buffer_load_dword v72, v3, s[12:15], s25 offen offset:0 sc1
    buffer_load_dword v73, v3, s[12:15], s25 offen offset:128 sc1
    buffer_load_dword v74, v3, s[12:15], s25 offen offset:512 sc1
    buffer_load_dword v75, v3, s[12:15], s25 offen offset:640 sc1
    buffer_load_dword v76, v3, s[12:15], s25 offen offset:1024 sc1
    buffer_load_dword v77, v3, s[12:15], s25 offen offset:1152 sc1
    buffer_load_dword v78, v3, s[12:15], s25 offen offset:1536 sc1
    buffer_load_dword v79, v3, s[12:15], s25 offen offset:1664 sc1
    s_waitcnt vmcnt(8)
    s_barrier
    buffer_load_dword v1, v192, s[12:15], s28 offen sc1
    ds_read2st64_b32 v[40:41], v34 offset0:0 offset1:1
    ds_read2st64_b32 v[42:43], v34 offset0:2 offset1:3
    ds_read2st64_b32 v[44:45], v34 offset0:4 offset1:5
    ds_read2st64_b32 v[46:47], v34 offset0:6 offset1:7
    ds_read2st64_b32 v[48:49], v34 offset0:8 offset1:9
    ds_read2st64_b32 v[50:51], v34 offset0:10 offset1:11
    ds_read2st64_b32 v[52:53], v34 offset0:12 offset1:13
    ds_read2st64_b32 v[54:55], v34 offset0:14 offset1:15
    ds_read2st64_b32 v[56:57], v34 offset0:16 offset1:17
    ds_read2st64_b32 v[58:59], v34 offset0:18 offset1:19
    ds_read2st64_b32 v[60:61], v34 offset0:20 offset1:21
    ds_read2st64_b32 v[62:63], v34 offset0:22 offset1:23
    s_waitcnt lgkmcnt(10)
    v_mfma_f32_32x32x16_bf16 v[160:175], v[80:83], v[40:43], 0
    ds_read2st64_b32 v[64:65], v34 offset0:24 offset1:25
    ds_read2st64_b32 v[66:67], v34 offset0:26 offset1:27
    s_waitcnt lgkmcnt(10)
    v_mfma_f32_32x32x16_bf16 v[160:175], v[84:87], v[44:47], v[160:175]
    ds_read2st64_b32 v[68:69], v34 offset0:28 offset1:29
    ds_read2st64_b32 v[70:71], v34 offset0:30 offset1:31
    s_waitcnt lgkmcnt(10)
    v_mfma_f32_32x32x16_bf16 v[160:175], v[88:91], v[48:51], v[160:175]
    s_waitcnt lgkmcnt(8)
    v_mfma_f32_32x32x16_bf16 v[160:175], v[92:95], v[52:55], v[160:175]
    s_waitcnt lgkmcnt(6)
    v_mfma_f32_32x32x16_bf16 v[160:175], v[96:99], v[56:59], v[160:175]
    s_waitcnt lgkmcnt(4)
    v_mfma_f32_32x32x16_bf16 v[160:175], v[100:103], v[60:63], v[160:175]
    s_waitcnt vmcnt(1)
    v_lshlrev_b32 v12, 16, v72
    v_and_b32 v13, 0xffff0000, v72
    v_lshlrev_b32 v14, 16, v73
    v_and_b32 v15, 0xffff0000, v73
    s_waitcnt lgkmcnt(2)
    v_mfma_f32_32x32x16_bf16 v[160:175], v[104:107], v[64:67], v[160:175]
    v_lshlrev_b32 v16, 16, v74
    v_and_b32 v17, 0xffff0000, v74
    v_lshlrev_b32 v18, 16, v75
    v_and_b32 v19, 0xffff0000, v75
    s_waitcnt lgkmcnt(0)
    v_mfma_f32_32x32x16_bf16 v[160:175], v[108:111], v[68:71], v[160:175]
    v_lshlrev_b32 v20, 16, v76
    v_and_b32 v21, 0xffff0000, v76
    v_lshlrev_b32 v22, 16, v77
    v_and_b32 v23, 0xffff0000, v77
    v_lshlrev_b32 v24, 16, v78
    v_and_b32 v25, 0xffff0000, v78
    v_lshlrev_b32 v26, 16, v79
    v_and_b32 v27, 0xffff0000, v79
    v_add_u32 v30, s26, v2
    s_nop 2
    v_mul_f32 v176, v160, v12
    v_mul_f32 v177, v160, v13
    v_mul_f32 v178, v162, v14
    v_mul_f32 v179, v162, v15
    v_mul_f32 v180, v164, v16
    v_mul_f32 v181, v164, v17
    v_mul_f32 v182, v166, v18
    v_mul_f32 v183, v166, v19
    v_fma_f32 v176, -v161, v13, v176
    v_fma_f32 v177, -v161, v12, -v177
    v_fma_f32 v178, -v163, v15, v178
    v_fma_f32 v179, -v163, v14, -v179
    v_fma_f32 v180, -v165, v17, v180
    v_fma_f32 v181, -v165, v16, -v181
    v_fma_f32 v182, -v167, v19, v182
    v_fma_f32 v183, -v167, v18, -v183
    v_cvt_pk_bf16_f32 v72, v176, v177
    v_cvt_pk_bf16_f32 v73, v178, v179
    v_cvt_pk_bf16_f32 v74, v180, v181
    v_cvt_pk_bf16_f32 v75, v182, v183
    ds_write_b128 v30, v[72:75] offset:49664
    v_mul_f32 v184, v168, v20
    v_mul_f32 v185, v168, v21
    v_mul_f32 v186, v170, v22
    v_mul_f32 v187, v170, v23
    v_mul_f32 v188, v172, v24
    v_mul_f32 v189, v172, v25
    v_mul_f32 v190, v174, v26
    v_mul_f32 v191, v174, v27
    v_fma_f32 v184, -v169, v21, v184
    v_fma_f32 v185, -v169, v20, -v185
    v_fma_f32 v186, -v171, v23, v186
    v_fma_f32 v187, -v171, v22, -v187
    v_fma_f32 v188, -v173, v25, v188
    v_fma_f32 v189, -v173, v24, -v189
    v_fma_f32 v190, -v175, v27, v190
    v_fma_f32 v191, -v175, v26, -v191
    v_cvt_pk_bf16_f32 v76, v184, v185
    v_cvt_pk_bf16_f32 v77, v186, v187
    v_cvt_pk_bf16_f32 v78, v188, v189
    v_cvt_pk_bf16_f32 v79, v190, v191
    ds_write_b128 v30, v[76:79] offset:50688
    s_waitcnt lgkmcnt(0)
    s_barrier
    ds_read_b128 v[40:43], v2 offset:49664
    ds_read_b128 v[44:47], v2 offset:50688
    ds_read_b128 v[48:51], v2 offset:51712
    ds_read_b128 v[52:55], v2 offset:52736
    ds_read_b128 v[56:59], v2 offset:53760
    ds_read_b128 v[60:63], v2 offset:54784
    ds_read_b128 v[64:67], v2 offset:55808
    ds_read_b128 v[68:71], v2 offset:56832
    s_waitcnt lgkmcnt(7)
    v_mfma_f32_32x32x16_bf16 v[176:191], v[40:43], v[80:83], 0
    s_and_b32 s27, s101, 1
    s_mul_i32 s29, s27, 18432
    s_waitcnt lgkmcnt(6)
    v_mfma_f32_32x32x16_bf16 v[176:191], v[44:47], v[84:87], v[176:191]
    s_lshr_b32 s27, s101, 4
    s_lshl_b32 s27, s27, 10
    s_waitcnt lgkmcnt(5)
    v_mfma_f32_32x32x16_bf16 v[176:191], v[48:51], v[88:91], v[176:191]
    s_add_u32 s29, s29, s27
    s_bfe_u32 s27, s101, 0x20001
    s_waitcnt lgkmcnt(4)
    v_mfma_f32_32x32x16_bf16 v[176:191], v[52:55], v[92:95], v[176:191]
    s_lshl_b32 s27, s27, 8
    s_add_u32 s29, s29, s27
    s_waitcnt lgkmcnt(3)
    v_mfma_f32_32x32x16_bf16 v[176:191], v[56:59], v[96:99], v[176:191]
    s_bfe_u32 s27, s101, 0x10003
    s_lshl_b32 s27, s27, 7
    s_waitcnt lgkmcnt(2)
    v_mfma_f32_32x32x16_bf16 v[176:191], v[60:63], v[100:103], v[176:191]
    s_add_u32 s29, s29, s27
    s_mul_i32 s27, s20, 589824
    s_waitcnt lgkmcnt(1)
    v_mfma_f32_32x32x16_bf16 v[176:191], v[64:67], v[104:107], v[176:191]
    s_add_u32 s29, s29, s27
    s_add_u32 s29, s29, 2359296
    s_waitcnt lgkmcnt(0)
    v_mfma_f32_32x32x16_bf16 v[176:191], v[68:71], v[108:111], v[176:191]
    v_mul_u32_u24 v31, 73728, v5
    v_lshl_add_u32 v31, v35, 2, v31
    s_add_u32 s31, s29, 36864
    s_add_u32 s32, s29, 147456
    s_add_u32 s33, s29, 184320
    s_add_u32 s34, s29, 294912
    s_add_u32 s35, s29, 331776
    s_add_u32 s36, s29, 442368
    s_add_u32 s37, s29, 479232
    s_mov_b32 s30, s29
    s_nop 1
    v_mul_f32 v160, v176, v112
    v_mul_f32 v161, v177, v113
    v_mul_f32 v162, v178, v114
    v_mul_f32 v163, v179, v115
    v_mul_f32 v164, v180, v116
    v_mul_f32 v165, v181, v117
    v_mul_f32 v166, v182, v118
    v_mul_f32 v167, v183, v119
    v_fmac_f32_dpp v160, v176, v128 quad_perm:[1,0,3,2] row_mask:0xf bank_mask:0xf
    v_fmac_f32_dpp v161, v177, v129 quad_perm:[1,0,3,2] row_mask:0xf bank_mask:0xf
    v_fmac_f32_dpp v162, v178, v130 quad_perm:[1,0,3,2] row_mask:0xf bank_mask:0xf
    v_fmac_f32_dpp v163, v179, v131 quad_perm:[1,0,3,2] row_mask:0xf bank_mask:0xf
    v_fmac_f32_dpp v164, v180, v132 quad_perm:[1,0,3,2] row_mask:0xf bank_mask:0xf
    v_fmac_f32_dpp v165, v181, v133 quad_perm:[1,0,3,2] row_mask:0xf bank_mask:0xf
    v_fmac_f32_dpp v166, v182, v134 quad_perm:[1,0,3,2] row_mask:0xf bank_mask:0xf
    v_fmac_f32_dpp v167, v183, v135 quad_perm:[1,0,3,2] row_mask:0xf bank_mask:0xf
    v_cvt_pk_bf16_f32 v40, v160, v161
    v_cvt_pk_bf16_f32 v41, v162, v163
    v_cvt_pk_bf16_f32 v42, v164, v165
    v_cvt_pk_bf16_f32 v43, v166, v167
    s_nop 1
    v_mfma_f32_32x32x16_bf16 v[80:95], v[40:43], v[144:147], 0
    v_mfma_f32_32x32x16_bf16 v[96:111], v[40:43], v[152:155], 0
    v_mul_f32 v168, v184, v120
    v_mul_f32 v169, v185, v121
    v_mul_f32 v170, v186, v122
    v_mul_f32 v171, v187, v123
    v_mul_f32 v172, v188, v124
    v_mul_f32 v173, v189, v125
    v_mul_f32 v174, v190, v126
    v_mul_f32 v175, v191, v127
    v_fmac_f32_dpp v168, v184, v136 quad_perm:[1,0,3,2] row_mask:0xf bank_mask:0xf
    v_fmac_f32_dpp v169, v185, v137 quad_perm:[1,0,3,2] row_mask:0xf bank_mask:0xf
    v_fmac_f32_dpp v170, v186, v138 quad_perm:[1,0,3,2] row_mask:0xf bank_mask:0xf
    v_fmac_f32_dpp v171, v187, v139 quad_perm:[1,0,3,2] row_mask:0xf bank_mask:0xf
    v_fmac_f32_dpp v172, v188, v140 quad_perm:[1,0,3,2] row_mask:0xf bank_mask:0xf
    v_fmac_f32_dpp v173, v189, v141 quad_perm:[1,0,3,2] row_mask:0xf bank_mask:0xf
    v_fmac_f32_dpp v174, v190, v142 quad_perm:[1,0,3,2] row_mask:0xf bank_mask:0xf
    v_fmac_f32_dpp v175, v191, v143 quad_perm:[1,0,3,2] row_mask:0xf bank_mask:0xf
    v_cvt_pk_bf16_f32 v44, v168, v169
    v_cvt_pk_bf16_f32 v45, v170, v171
    v_cvt_pk_bf16_f32 v46, v172, v173
    v_cvt_pk_bf16_f32 v47, v174, v175
    s_nop 1
    v_mfma_f32_32x32x16_bf16 v[80:95], v[44:47], v[148:151], v[80:95]
    v_mfma_f32_32x32x16_bf16 v[96:111], v[44:47], v[156:159], v[96:111]
    s_nop 12
    v_sub_f32 v48, v80, v97
    v_add_f32 v49, v96, v81
    v_cvt_pk_bf16_f32 v40, v48, v49
    buffer_store_dword v40, v31, s[12:15], s30 offen sc1
    v_sub_f32 v50, v82, v99
    v_add_f32 v51, v98, v83
    v_cvt_pk_bf16_f32 v41, v50, v51
    buffer_store_dword v41, v31, s[12:15], s31 offen sc1
    v_sub_f32 v52, v84, v101
    v_add_f32 v53, v100, v85
    v_cvt_pk_bf16_f32 v42, v52, v53
    buffer_store_dword v42, v31, s[12:15], s32 offen sc1
    v_sub_f32 v54, v86, v103
    v_add_f32 v55, v102, v87
    v_cvt_pk_bf16_f32 v43, v54, v55
    buffer_store_dword v43, v31, s[12:15], s33 offen sc1
    v_sub_f32 v56, v88, v105
    v_add_f32 v57, v104, v89
    v_cvt_pk_bf16_f32 v44, v56, v57
    buffer_store_dword v44, v31, s[12:15], s34 offen sc1
    v_sub_f32 v58, v90, v107
    v_add_f32 v59, v106, v91
    v_cvt_pk_bf16_f32 v45, v58, v59
    buffer_store_dword v45, v31, s[12:15], s35 offen sc1
    v_sub_f32 v60, v92, v109
    v_add_f32 v61, v108, v93
    v_cvt_pk_bf16_f32 v46, v60, v61
    buffer_store_dword v46, v31, s[12:15], s36 offen sc1
    v_sub_f32 v62, v94, v111
    v_add_f32 v63, v110, v95
    v_cvt_pk_bf16_f32 v47, v62, v63
    buffer_store_dword v47, v31, s[12:15], s37 offen sc1
L_sequential_preLN__spectral_gfnet__geglu_ffn__prompt_kernel_st2:
    s_branch L_back
L_sequential_preLN__spectral_gfnet__geglu_ffn__prompt_kernel_dual:
    buffer_load_dwordx4 v2, s[12:15], s24 offen offset:0 sc1 lds
    buffer_load_dwordx4 v2, s[12:15], s24 offen offset:1024 sc1 lds
    s_mov_b32 m0, s26
    s_sub_u32 s24, s24, 262144
    buffer_load_dwordx4 v2, s[12:15], s24 offen offset:0 sc1 lds
    buffer_load_dwordx4 v2, s[12:15], s24 offen offset:1024 sc1 lds
    buffer_load_dword v72, v3, s[12:15], s25 offen offset:0 sc1
    buffer_load_dword v73, v3, s[12:15], s25 offen offset:128 sc1
    buffer_load_dword v74, v3, s[12:15], s25 offen offset:512 sc1
    buffer_load_dword v75, v3, s[12:15], s25 offen offset:640 sc1
    buffer_load_dword v76, v3, s[12:15], s25 offen offset:1024 sc1
    buffer_load_dword v77, v3, s[12:15], s25 offen offset:1152 sc1
    buffer_load_dword v78, v3, s[12:15], s25 offen offset:1536 sc1
    buffer_load_dword v79, v3, s[12:15], s25 offen offset:1664 sc1
    s_sub_u32 s25, s25, 262144
    buffer_load_dword v200, v3, s[12:15], s25 offen offset:0 sc1
    buffer_load_dword v201, v3, s[12:15], s25 offen offset:128 sc1
    buffer_load_dword v202, v3, s[12:15], s25 offen offset:512 sc1
    buffer_load_dword v203, v3, s[12:15], s25 offen offset:640 sc1
    buffer_load_dword v204, v3, s[12:15], s25 offen offset:1024 sc1
    buffer_load_dword v205, v3, s[12:15], s25 offen offset:1152 sc1
    buffer_load_dword v206, v3, s[12:15], s25 offen offset:1536 sc1
    buffer_load_dword v207, v3, s[12:15], s25 offen offset:1664 sc1
    v_add_u32 v30, s26, v2
    s_and_b32 s27, s101, 1
    s_mul_i32 s29, s27, 18432
    s_lshr_b32 s27, s101, 4
    s_lshl_b32 s27, s27, 10
    s_add_u32 s29, s29, s27
    s_bfe_u32 s27, s101, 0x20001
    s_lshl_b32 s27, s27, 8
    s_add_u32 s29, s29, s27
    s_bfe_u32 s27, s101, 0x10003
    s_lshl_b32 s27, s27, 7
    s_add_u32 s29, s29, s27
    s_mul_i32 s27, s20, 589824
    s_add_u32 s29, s29, s27
    s_add_u32 s29, s29, 2359296
    v_mul_u32_u24 v31, 73728, v5
    v_lshl_add_u32 v31, v35, 2, v31
    s_sub_u32 s29, s29, 2048
    s_add_u32 s31, s29, 36864
    s_add_u32 s32, s29, 147456
    s_add_u32 s33, s29, 184320
    s_add_u32 s34, s29, 294912
    s_add_u32 s35, s29, 331776
    s_add_u32 s36, s29, 442368
    s_add_u32 s37, s29, 479232
    s_mov_b32 s30, s29
    v_lshlrev_b32 v33, 2, v0
    s_waitcnt vmcnt(16)
    s_barrier
    ds_read2st64_b32 v[40:41], v34 offset0:0 offset1:1
    ds_read2st64_b32 v[42:43], v34 offset0:2 offset1:3
    ds_read2st64_b32 v[44:45], v34 offset0:4 offset1:5
    ds_read2st64_b32 v[46:47], v34 offset0:6 offset1:7
    ds_read2st64_b32 v[48:49], v34 offset0:8 offset1:9
    ds_read2st64_b32 v[50:51], v34 offset0:10 offset1:11
    ds_read2st64_b32 v[52:53], v34 offset0:12 offset1:13
    ds_read2st64_b32 v[54:55], v34 offset0:14 offset1:15
    ds_read2st64_b32 v[56:57], v34 offset0:16 offset1:17
    ds_read2st64_b32 v[58:59], v34 offset0:18 offset1:19
    ds_read2st64_b32 v[60:61], v34 offset0:20 offset1:21
    ds_read2st64_b32 v[62:63], v34 offset0:22 offset1:23
    s_waitcnt lgkmcnt(10)
    v_mfma_f32_32x32x16_bf16 v[160:175], v[80:83], v[40:43], 0
    ds_read2st64_b32 v[64:65], v34 offset0:24 offset1:25
    ds_read2st64_b32 v[66:67], v34 offset0:26 offset1:27
    s_waitcnt lgkmcnt(10)
    v_mfma_f32_32x32x16_bf16 v[160:175], v[84:87], v[44:47], v[160:175]
    ds_read2st64_b32 v[68:69], v34 offset0:28 offset1:29
    ds_read2st64_b32 v[70:71], v34 offset0:30 offset1:31
    s_waitcnt lgkmcnt(10)
    v_mfma_f32_32x32x16_bf16 v[160:175], v[88:91], v[48:51], v[160:175]
    ds_read2st64_b32 a[0:1], v33 offset0:0 offset1:1
    ds_read2st64_b32 a[2:3], v33 offset0:2 offset1:3
    s_waitcnt lgkmcnt(10)
    v_mfma_f32_32x32x16_bf16 v[160:175], v[92:95], v[52:55], v[160:175]
    ds_read2st64_b32 a[4:5], v33 offset0:4 offset1:5
    ds_read2st64_b32 a[6:7], v33 offset0:6 offset1:7
    s_waitcnt vmcnt(0)
    v_lshlrev_b32 v12, 16, v72
    v_and_b32 v13, 0xffff0000, v72
    v_lshlrev_b32 v14, 16, v73
    s_waitcnt lgkmcnt(10)
    v_mfma_f32_32x32x16_bf16 v[160:175], v[96:99], v[56:59], v[160:175]
    ds_read2st64_b32 a[8:9], v33 offset0:8 offset1:9
    ds_read2st64_b32 a[10:11], v33 offset0:10 offset1:11
    v_and_b32 v15, 0xffff0000, v73
    v_lshlrev_b32 v16, 16, v74
    v_and_b32 v17, 0xffff0000, v74
    s_waitcnt lgkmcnt(10)
    v_mfma_f32_32x32x16_bf16 v[160:175], v[100:103], v[60:63], v[160:175]
    ds_read2st64_b32 a[12:13], v33 offset0:12 offset1:13
    ds_read2st64_b32 a[14:15], v33 offset0:14 offset1:15
    v_lshlrev_b32 v18, 16, v75
    v_and_b32 v19, 0xffff0000, v75
    v_lshlrev_b32 v20, 16, v76
    s_waitcnt lgkmcnt(10)
    v_mfma_f32_32x32x16_bf16 v[160:175], v[104:107], v[64:67], v[160:175]
    ds_read2st64_b32 a[16:17], v33 offset0:16 offset1:17
    ds_read2st64_b32 a[18:19], v33 offset0:18 offset1:19
    v_and_b32 v21, 0xffff0000, v76
    v_lshlrev_b32 v22, 16, v77
    v_and_b32 v23, 0xffff0000, v77
    s_waitcnt lgkmcnt(10)
    v_mfma_f32_32x32x16_bf16 v[160:175], v[108:111], v[68:71], v[160:175]
    ds_read2st64_b32 a[20:21], v33 offset0:20 offset1:21
    ds_read2st64_b32 a[22:23], v33 offset0:22 offset1:23
    v_lshlrev_b32 v24, 16, v78
    v_and_b32 v25, 0xffff0000, v78
    v_lshlrev_b32 v26, 16, v79
    s_waitcnt lgkmcnt(10)
    v_mfma_f32_32x32x16_bf16 v[224:239], v[80:83], a[0:3], 0
    ds_read2st64_b32 a[24:25], v33 offset0:24 offset1:25
    ds_read2st64_b32 a[26:27], v33 offset0:26 offset1:27
    v_and_b32 v27, 0xffff0000, v79
    v_lshlrev_b32 v208, 16, v200
    v_and_b32 v209, 0xffff0000, v200
    v_lshlrev_b32 v210, 16, v201
    v_and_b32 v211, 0xffff0000, v201
    s_waitcnt lgkmcnt(10)
    v_mfma_f32_32x32x16_bf16 v[224:239], v[84:87], a[4:7], v[224:239]
    ds_read2st64_b32 a[28:29], v33 offset0:28 offset1:29
    ds_read2st64_b32 a[30:31], v33 offset0:30 offset1:31
    v_lshlrev_b32 v212, 16, v202
    v_and_b32 v213, 0xffff0000, v202
    v_lshlrev_b32 v214, 16, v203
    v_and_b32 v215, 0xffff0000, v203
    v_lshlrev_b32 v216, 16, v204
    s_waitcnt lgkmcnt(10)
    v_mfma_f32_32x32x16_bf16 v[224:239], v[88:91], a[8:11], v[224:239]
    v_mul_f32 v176, v160, v12
    v_mul_f32 v177, v160, v13
    v_mul_f32 v178, v162, v14
    v_mul_f32 v179, v162, v15
    v_mul_f32 v180, v164, v16
    v_mul_f32 v181, v164, v17
    v_mul_f32 v182, v166, v18
    s_waitcnt lgkmcnt(8)
    v_mfma_f32_32x32x16_bf16 v[224:239], v[92:95], a[12:15], v[224:239]
    v_mul_f32 v183, v166, v19
    v_fma_f32 v176, -v161, v13, v176
    v_fma_f32 v177, -v161, v12, -v177
    v_fma_f32 v178, -v163, v15, v178
    v_fma_f32 v179, -v163, v14, -v179
    v_fma_f32 v180, -v165, v17, v180
    v_fma_f32 v181, -v165, v16, -v181
    s_waitcnt lgkmcnt(6)
    v_mfma_f32_32x32x16_bf16 v[224:239], v[96:99], a[16:19], v[224:239]
    v_fma_f32 v182, -v167, v19, v182
    v_fma_f32 v183, -v167, v18, -v183
    v_cvt_pk_bf16_f32 v72, v176, v177
    v_cvt_pk_bf16_f32 v73, v178, v179
    v_cvt_pk_bf16_f32 v74, v180, v181
    v_cvt_pk_bf16_f32 v75, v182, v183
    ds_write_b128 v30, v[72:75] offset:49664
    s_waitcnt lgkmcnt(5)
    v_mfma_f32_32x32x16_bf16 v[224:239], v[100:103], a[20:23], v[224:239]
    v_mul_f32 v184, v168, v20
    v_mul_f32 v185, v168, v21
    v_mul_f32 v186, v170, v22
    v_mul_f32 v187, v170, v23
    v_mul_f32 v188, v172, v24
    v_mul_f32 v189, v172, v25
    v_mul_f32 v190, v174, v26
    s_waitcnt lgkmcnt(3)
    v_mfma_f32_32x32x16_bf16 v[224:239], v[104:107], a[24:27], v[224:239]
    v_mul_f32 v191, v174, v27
    v_fma_f32 v184, -v169, v21, v184
    v_fma_f32 v185, -v169, v20, -v185
    v_fma_f32 v186, -v171, v23, v186
    v_fma_f32 v187, -v171, v22, -v187
    v_fma_f32 v188, -v173, v25, v188
    v_fma_f32 v189, -v173, v24, -v189
    s_waitcnt lgkmcnt(1)
    v_mfma_f32_32x32x16_bf16 v[224:239], v[108:111], a[28:31], v[224:239]
    v_fma_f32 v190, -v175, v27, v190
    v_fma_f32 v191, -v175, v26, -v191
    v_cvt_pk_bf16_f32 v76, v184, v185
    v_cvt_pk_bf16_f32 v77, v186, v187
    v_cvt_pk_bf16_f32 v78, v188, v189
    v_cvt_pk_bf16_f32 v79, v190, v191
    ds_write_b128 v30, v[76:79] offset:50688
    v_and_b32 v217, 0xffff0000, v204
    v_lshlrev_b32 v218, 16, v205
    v_and_b32 v219, 0xffff0000, v205
    v_lshlrev_b32 v220, 16, v206
    v_and_b32 v221, 0xffff0000, v206
    v_lshlrev_b32 v222, 16, v207
    v_and_b32 v223, 0xffff0000, v207
    s_waitcnt lgkmcnt(0)
    s_barrier
    ds_read_b128 v[40:43], v2 offset:49664
    ds_read_b128 v[44:47], v2 offset:50688
    ds_read_b128 v[48:51], v2 offset:51712
    ds_read_b128 v[52:55], v2 offset:52736
    ds_read_b128 v[56:59], v2 offset:53760
    ds_read_b128 v[60:63], v2 offset:54784
    ds_read_b128 v[64:67], v2 offset:55808
    ds_read_b128 v[68:71], v2 offset:56832
    v_mul_f32 v240, v224, v208
    v_mul_f32 v241, v224, v209
    v_mul_f32 v242, v226, v210
    v_mul_f32 v243, v226, v211
    v_mul_f32 v244, v228, v212
    v_mul_f32 v245, v228, v213
    v_mul_f32 v246, v230, v214
    v_mul_f32 v247, v230, v215
    v_fma_f32 v240, -v225, v209, v240
    v_fma_f32 v241, -v225, v208, -v241
    v_fma_f32 v242, -v227, v211, v242
    v_fma_f32 v243, -v227, v210, -v243
    v_fma_f32 v244, -v229, v213, v244
    v_fma_f32 v245, -v229, v212, -v245
    s_waitcnt lgkmcnt(7)
    v_mfma_f32_32x32x16_bf16 v[176:191], v[40:43], v[80:83], 0
    v_fma_f32 v246, -v231, v215, v246
    v_fma_f32 v247, -v231, v214, -v247
    v_cvt_pk_bf16_f32 v200, v240, v241
    v_cvt_pk_bf16_f32 v201, v242, v243
    v_cvt_pk_bf16_f32 v202, v244, v245
    s_waitcnt lgkmcnt(6)
    v_mfma_f32_32x32x16_bf16 v[176:191], v[44:47], v[84:87], v[176:191]
    v_cvt_pk_bf16_f32 v203, v246, v247
    ds_write_b128 v30, v[200:203] offset:8192
    v_mul_f32 v248, v232, v216
    v_mul_f32 v249, v232, v217
    v_mul_f32 v250, v234, v218
    s_waitcnt lgkmcnt(6)
    v_mfma_f32_32x32x16_bf16 v[176:191], v[48:51], v[88:91], v[176:191]
    v_mul_f32 v251, v234, v219
    v_mul_f32 v252, v236, v220
    v_mul_f32 v253, v236, v221
    v_mul_f32 v254, v238, v222
    v_mul_f32 v255, v238, v223
    s_waitcnt lgkmcnt(5)
    v_mfma_f32_32x32x16_bf16 v[176:191], v[52:55], v[92:95], v[176:191]
    v_fma_f32 v248, -v233, v217, v248
    v_fma_f32 v249, -v233, v216, -v249
    v_fma_f32 v250, -v235, v219, v250
    v_fma_f32 v251, -v235, v218, -v251
    v_fma_f32 v252, -v237, v221, v252
    s_waitcnt lgkmcnt(4)
    v_mfma_f32_32x32x16_bf16 v[176:191], v[56:59], v[96:99], v[176:191]
    v_fma_f32 v253, -v237, v220, -v253
    v_fma_f32 v254, -v239, v223, v254
    v_fma_f32 v255, -v239, v222, -v255
    v_cvt_pk_bf16_f32 v204, v248, v249
    v_cvt_pk_bf16_f32 v205, v250, v251
    s_waitcnt lgkmcnt(3)
    v_mfma_f32_32x32x16_bf16 v[176:191], v[60:63], v[100:103], v[176:191]
    v_cvt_pk_bf16_f32 v206, v252, v253
    v_cvt_pk_bf16_f32 v207, v254, v255
    ds_write_b128 v30, v[204:207] offset:9216
    s_waitcnt lgkmcnt(3)
    v_mfma_f32_32x32x16_bf16 v[176:191], v[64:67], v[104:107], v[176:191]
    s_waitcnt lgkmcnt(0)
    s_barrier
    ds_read_b128 a[0:3], v2 offset:8192
    ds_read_b128 a[4:7], v2 offset:9216
    ds_read_b128 a[8:11], v2 offset:10240
    ds_read_b128 a[12:15], v2 offset:11264
    ds_read_b128 a[16:19], v2 offset:12288
    ds_read_b128 a[20:23], v2 offset:13312
    ds_read_b128 a[24:27], v2 offset:14336
    ds_read_b128 a[28:31], v2 offset:15360
    v_mfma_f32_32x32x16_bf16 v[176:191], v[68:71], v[108:111], v[176:191]
    s_waitcnt lgkmcnt(7)
    v_mfma_f32_32x32x16_bf16 v[240:255], a[0:3], v[80:83], 0
    s_waitcnt lgkmcnt(6)
    v_mfma_f32_32x32x16_bf16 v[240:255], a[4:7], v[84:87], v[240:255]
    s_nop 7
    v_mul_f32 v160, v176, v112
    v_mul_f32 v161, v177, v113
    v_mul_f32 v162, v178, v114
    v_mul_f32 v163, v179, v115
    v_mul_f32 v164, v180, v116
    v_mul_f32 v165, v181, v117
    s_waitcnt lgkmcnt(5)
    v_mfma_f32_32x32x16_bf16 v[240:255], a[8:11], v[88:91], v[240:255]
    v_mul_f32 v166, v182, v118
    v_mul_f32 v167, v183, v119
    v_mul_f32 v168, v184, v120
    v_mul_f32 v169, v185, v121
    v_mul_f32 v170, v186, v122
    v_mul_f32 v171, v187, v123
    s_waitcnt lgkmcnt(4)
    v_mfma_f32_32x32x16_bf16 v[240:255], a[12:15], v[92:95], v[240:255]
    v_mul_f32 v172, v188, v124
    v_mul_f32 v173, v189, v125
    v_mul_f32 v174, v190, v126
    v_mul_f32 v175, v191, v127
    v_fmac_f32_dpp v160, v176, v128 quad_perm:[1,0,3,2] row_mask:0xf bank_mask:0xf
    v_fmac_f32_dpp v161, v177, v129 quad_perm:[1,0,3,2] row_mask:0xf bank_mask:0xf
    s_waitcnt lgkmcnt(3)
    v_mfma_f32_32x32x16_bf16 v[240:255], a[16:19], v[96:99], v[240:255]
    v_fmac_f32_dpp v162, v178, v130 quad_perm:[1,0,3,2] row_mask:0xf bank_mask:0xf
    v_fmac_f32_dpp v163, v179, v131 quad_perm:[1,0,3,2] row_mask:0xf bank_mask:0xf
    v_fmac_f32_dpp v164, v180, v132 quad_perm:[1,0,3,2] row_mask:0xf bank_mask:0xf
    v_fmac_f32_dpp v165, v181, v133 quad_perm:[1,0,3,2] row_mask:0xf bank_mask:0xf
    v_fmac_f32_dpp v166, v182, v134 quad_perm:[1,0,3,2] row_mask:0xf bank_mask:0xf
    v_fmac_f32_dpp v167, v183, v135 quad_perm:[1,0,3,2] row_mask:0xf bank_mask:0xf
    s_waitcnt lgkmcnt(2)
    v_mfma_f32_32x32x16_bf16 v[240:255], a[20:23], v[100:103], v[240:255]
    v_fmac_f32_dpp v168, v184, v136 quad_perm:[1,0,3,2] row_mask:0xf bank_mask:0xf
    v_fmac_f32_dpp v169, v185, v137 quad_perm:[1,0,3,2] row_mask:0xf bank_mask:0xf
    v_fmac_f32_dpp v170, v186, v138 quad_perm:[1,0,3,2] row_mask:0xf bank_mask:0xf
    v_fmac_f32_dpp v171, v187, v139 quad_perm:[1,0,3,2] row_mask:0xf bank_mask:0xf
    v_fmac_f32_dpp v172, v188, v140 quad_perm:[1,0,3,2] row_mask:0xf bank_mask:0xf
    v_fmac_f32_dpp v173, v189, v141 quad_perm:[1,0,3,2] row_mask:0xf bank_mask:0xf
    s_waitcnt lgkmcnt(1)
    v_mfma_f32_32x32x16_bf16 v[240:255], a[24:27], v[104:107], v[240:255]
    v_fmac_f32_dpp v174, v190, v142 quad_perm:[1,0,3,2] row_mask:0xf bank_mask:0xf
    v_fmac_f32_dpp v175, v191, v143 quad_perm:[1,0,3,2] row_mask:0xf bank_mask:0xf
    v_cvt_pk_bf16_f32 v40, v160, v161
    v_cvt_pk_bf16_f32 v41, v162, v163
    v_cvt_pk_bf16_f32 v42, v164, v165
    v_cvt_pk_bf16_f32 v43, v166, v167
    s_waitcnt lgkmcnt(0)
    v_mfma_f32_32x32x16_bf16 v[240:255], a[28:31], v[108:111], v[240:255]
    v_cvt_pk_bf16_f32 v44, v168, v169
    v_cvt_pk_bf16_f32 v45, v170, v171
    v_cvt_pk_bf16_f32 v46, v172, v173
    v_cvt_pk_bf16_f32 v47, v174, v175
    s_nop 1
    v_mfma_f32_32x32x16_bf16 v[80:95], v[40:43], v[144:147], 0
    s_nop 4
    v_mul_f32 v224, v240, v112
    v_mul_f32 v225, v241, v113
    v_mul_f32 v226, v242, v114
    v_mul_f32 v227, v243, v115
    v_mul_f32 v228, v244, v116
    v_mul_f32 v229, v245, v117
    v_mfma_f32_32x32x16_bf16 v[96:111], v[40:43], v[152:155], 0
    v_mul_f32 v230, v246, v118
    v_mul_f32 v231, v247, v119
    v_mul_f32 v232, v248, v120
    v_mul_f32 v233, v249, v121
    v_mul_f32 v234, v250, v122
    v_mul_f32 v235, v251, v123
    v_mfma_f32_32x32x16_bf16 v[80:95], v[44:47], v[148:151], v[80:95]
    v_mul_f32 v236, v252, v124
    v_mul_f32 v237, v253, v125
    v_mul_f32 v238, v254, v126
    v_mul_f32 v239, v255, v127
    v_fmac_f32_dpp v224, v240, v128 quad_perm:[1,0,3,2] row_mask:0xf bank_mask:0xf
    v_fmac_f32_dpp v225, v241, v129 quad_perm:[1,0,3,2] row_mask:0xf bank_mask:0xf
    v_mfma_f32_32x32x16_bf16 v[96:111], v[44:47], v[156:159], v[96:111]
    v_fmac_f32_dpp v226, v242, v130 quad_perm:[1,0,3,2] row_mask:0xf bank_mask:0xf
    v_fmac_f32_dpp v227, v243, v131 quad_perm:[1,0,3,2] row_mask:0xf bank_mask:0xf
    v_fmac_f32_dpp v228, v244, v132 quad_perm:[1,0,3,2] row_mask:0xf bank_mask:0xf
    v_fmac_f32_dpp v229, v245, v133 quad_perm:[1,0,3,2] row_mask:0xf bank_mask:0xf
    v_fmac_f32_dpp v230, v246, v134 quad_perm:[1,0,3,2] row_mask:0xf bank_mask:0xf
    v_fmac_f32_dpp v231, v247, v135 quad_perm:[1,0,3,2] row_mask:0xf bank_mask:0xf
    v_fmac_f32_dpp v232, v248, v136 quad_perm:[1,0,3,2] row_mask:0xf bank_mask:0xf
    v_fmac_f32_dpp v233, v249, v137 quad_perm:[1,0,3,2] row_mask:0xf bank_mask:0xf
    v_fmac_f32_dpp v234, v250, v138 quad_perm:[1,0,3,2] row_mask:0xf bank_mask:0xf
    v_fmac_f32_dpp v235, v251, v139 quad_perm:[1,0,3,2] row_mask:0xf bank_mask:0xf
    v_fmac_f32_dpp v236, v252, v140 quad_perm:[1,0,3,2] row_mask:0xf bank_mask:0xf
    v_fmac_f32_dpp v237, v253, v141 quad_perm:[1,0,3,2] row_mask:0xf bank_mask:0xf
    v_fmac_f32_dpp v238, v254, v142 quad_perm:[1,0,3,2] row_mask:0xf bank_mask:0xf
    v_fmac_f32_dpp v239, v255, v143 quad_perm:[1,0,3,2] row_mask:0xf bank_mask:0xf
    v_cvt_pk_bf16_f32 v200, v224, v225
    v_cvt_pk_bf16_f32 v201, v226, v227
    v_cvt_pk_bf16_f32 v202, v228, v229
    v_cvt_pk_bf16_f32 v203, v230, v231
    v_cvt_pk_bf16_f32 v204, v232, v233
    v_cvt_pk_bf16_f32 v205, v234, v235
    v_cvt_pk_bf16_f32 v206, v236, v237
    v_cvt_pk_bf16_f32 v207, v238, v239
    s_nop 1
    v_mfma_f32_32x32x16_bf16 v[208:223], v[200:203], v[144:147], 0
    v_sub_f32 v48, v80, v97
    v_add_f32 v49, v96, v81
    v_cvt_pk_bf16_f32 v64, v48, v49
    buffer_store_dword v64, v31, s[12:15], s30 offen offset:2048 sc1
    v_sub_f32 v50, v82, v99
    v_mfma_f32_32x32x16_bf16 v[176:191], v[200:203], v[152:155], 0
    v_add_f32 v51, v98, v83
    v_cvt_pk_bf16_f32 v65, v50, v51
    buffer_store_dword v65, v31, s[12:15], s31 offen offset:2048 sc1
    v_sub_f32 v52, v84, v101
    v_add_f32 v53, v100, v85
    v_mfma_f32_32x32x16_bf16 v[208:223], v[204:207], v[148:151], v[208:223]
    v_cvt_pk_bf16_f32 v66, v52, v53
    buffer_store_dword v66, v31, s[12:15], s32 offen offset:2048 sc1
    v_sub_f32 v54, v86, v103
    v_add_f32 v55, v102, v87
    v_cvt_pk_bf16_f32 v67, v54, v55
    v_mfma_f32_32x32x16_bf16 v[176:191], v[204:207], v[156:159], v[176:191]
    buffer_store_dword v67, v31, s[12:15], s33 offen offset:2048 sc1
    v_sub_f32 v56, v88, v105
    v_add_f32 v57, v104, v89
    v_cvt_pk_bf16_f32 v68, v56, v57
    buffer_store_dword v68, v31, s[12:15], s34 offen offset:2048 sc1
    v_sub_f32 v58, v90, v107
    v_add_f32 v59, v106, v91
    v_cvt_pk_bf16_f32 v69, v58, v59
    buffer_store_dword v69, v31, s[12:15], s35 offen offset:2048 sc1
    v_sub_f32 v60, v92, v109
    v_add_f32 v61, v108, v93
    v_cvt_pk_bf16_f32 v70, v60, v61
    buffer_store_dword v70, v31, s[12:15], s36 offen offset:2048 sc1
    v_sub_f32 v62, v94, v111
    v_add_f32 v63, v110, v95
    v_cvt_pk_bf16_f32 v71, v62, v63
    buffer_store_dword v71, v31, s[12:15], s37 offen offset:2048 sc1
    v_sub_f32 v224, v208, v177
    v_add_f32 v225, v176, v209
    v_cvt_pk_bf16_f32 v160, v224, v225
    buffer_store_dword v160, v31, s[12:15], s30 offen offset:0 sc1
    v_sub_f32 v226, v210, v179
    v_add_f32 v227, v178, v211
    v_cvt_pk_bf16_f32 v161, v226, v227
    buffer_store_dword v161, v31, s[12:15], s31 offen offset:0 sc1
    v_sub_f32 v228, v212, v181
    v_add_f32 v229, v180, v213
    v_cvt_pk_bf16_f32 v162, v228, v229
    buffer_store_dword v162, v31, s[12:15], s32 offen offset:0 sc1
    v_sub_f32 v230, v214, v183
    v_add_f32 v231, v182, v215
    v_cvt_pk_bf16_f32 v163, v230, v231
    buffer_store_dword v163, v31, s[12:15], s33 offen offset:0 sc1
    v_sub_f32 v232, v216, v185
    v_add_f32 v233, v184, v217
    v_cvt_pk_bf16_f32 v164, v232, v233
    buffer_store_dword v164, v31, s[12:15], s34 offen offset:0 sc1
    v_sub_f32 v234, v218, v187
    v_add_f32 v235, v186, v219
    v_cvt_pk_bf16_f32 v165, v234, v235
    buffer_store_dword v165, v31, s[12:15], s35 offen offset:0 sc1
    v_sub_f32 v236, v220, v189
    v_add_f32 v237, v188, v221
    v_cvt_pk_bf16_f32 v166, v236, v237
    buffer_store_dword v166, v31, s[12:15], s36 offen offset:0 sc1
    v_sub_f32 v238, v222, v191
    v_add_f32 v239, v190, v223
    v_cvt_pk_bf16_f32 v167, v238, v239
    buffer_store_dword v167, v31, s[12:15], s37 offen offset:0 sc1
    s_branch L_back
L_sequential_preLN__spectral_gfnet__geglu_ffn__prompt_kernel_helper:
    s_waitcnt lgkmcnt(0)
    v_dot2c_f32_bf16 v18, v136, v22
    v_dot2c_f32_bf16 v19, v136, v136
    v_dot2c_f32_bf16 v20, v137, v22
    v_dot2c_f32_bf16 v21, v137, v137
    v_dot2c_f32_bf16 v18, v138, v22
    v_dot2c_f32_bf16 v19, v138, v138
    v_dot2c_f32_bf16 v20, v139, v22
    v_dot2c_f32_bf16 v21, v139, v139
    v_dot2c_f32_bf16 v18, v140, v22
    v_dot2c_f32_bf16 v19, v140, v140
    v_dot2c_f32_bf16 v20, v141, v22
    v_dot2c_f32_bf16 v21, v141, v141
    v_dot2c_f32_bf16 v18, v142, v22
    v_dot2c_f32_bf16 v19, v142, v142
    v_dot2c_f32_bf16 v20, v143, v22
    v_dot2c_f32_bf16 v21, v143, v143
    v_dot2c_f32_bf16 v18, v144, v22
    v_dot2c_f32_bf16 v19, v144, v144
    v_dot2c_f32_bf16 v20, v145, v22
    v_dot2c_f32_bf16 v21, v145, v145
    v_dot2c_f32_bf16 v18, v146, v22
    v_dot2c_f32_bf16 v19, v146, v146
    v_dot2c_f32_bf16 v20, v147, v22
    v_dot2c_f32_bf16 v21, v147, v147
    v_dot2c_f32_bf16 v18, v148, v22
    v_dot2c_f32_bf16 v19, v148, v148
    v_dot2c_f32_bf16 v20, v149, v22
    v_dot2c_f32_bf16 v21, v149, v149
    v_dot2c_f32_bf16 v18, v150, v22
    v_dot2c_f32_bf16 v19, v150, v150
    v_dot2c_f32_bf16 v20, v151, v22
    v_dot2c_f32_bf16 v21, v151, v151
    v_dot2c_f32_bf16 v18, v152, v22
    v_dot2c_f32_bf16 v19, v152, v152
    v_dot2c_f32_bf16 v20, v153, v22
    v_dot2c_f32_bf16 v21, v153, v153
    v_dot2c_f32_bf16 v18, v154, v22
    v_dot2c_f32_bf16 v19, v154, v154
    v_dot2c_f32_bf16 v20, v155, v22
    v_dot2c_f32_bf16 v21, v155, v155
    v_dot2c_f32_bf16 v18, v156, v22
    v_dot2c_f32_bf16 v19, v156, v156
    v_dot2c_f32_bf16 v20, v157, v22
    v_dot2c_f32_bf16 v21, v157, v157
    v_dot2c_f32_bf16 v18, v158, v22
    v_dot2c_f32_bf16 v19, v158, v158
    v_dot2c_f32_bf16 v20, v159, v22
    v_dot2c_f32_bf16 v21, v159, v159
    v_dot2c_f32_bf16 v18, v160, v22
    v_dot2c_f32_bf16 v19, v160, v160
    v_dot2c_f32_bf16 v20, v161, v22
    v_dot2c_f32_bf16 v21, v161, v161
    v_dot2c_f32_bf16 v18, v162, v22
    v_dot2c_f32_bf16 v19, v162, v162
    v_dot2c_f32_bf16 v20, v163, v22
    v_dot2c_f32_bf16 v21, v163, v163
    v_dot2c_f32_bf16 v18, v164, v22
    v_dot2c_f32_bf16 v19, v164, v164
    v_dot2c_f32_bf16 v20, v165, v22
    v_dot2c_f32_bf16 v21, v165, v165
    v_dot2c_f32_bf16 v18, v166, v22
    v_dot2c_f32_bf16 v19, v166, v166
    v_dot2c_f32_bf16 v20, v167, v22
    v_dot2c_f32_bf16 v21, v167, v167
    v_dot2c_f32_bf16 v18, v168, v22
    v_dot2c_f32_bf16 v19, v168, v168
    v_dot2c_f32_bf16 v20, v169, v22
    v_dot2c_f32_bf16 v21, v169, v169
    v_dot2c_f32_bf16 v18, v170, v22
    v_dot2c_f32_bf16 v19, v170, v170
    v_dot2c_f32_bf16 v20, v171, v22
    v_dot2c_f32_bf16 v21, v171, v171
    s_nop 2
    v_add_f32 v18, v18, v20
    v_add_f32 v19, v19, v21
    s_nop 0
    v_add_f32_dpp v18, v18, v18 quad_perm:[1,0,3,2] row_mask:0xf bank_mask:0xf
    v_add_f32_dpp v19, v19, v19 quad_perm:[1,0,3,2] row_mask:0xf bank_mask:0xf
    s_nop 0
    v_add_f32_dpp v18, v18, v18 quad_perm:[2,3,0,1] row_mask:0xf bank_mask:0xf
    v_add_f32_dpp v19, v19, v19 quad_perm:[2,3,0,1] row_mask:0xf bank_mask:0xf
    s_nop 0
    v_add_f32_dpp v18, v18, v18 row_half_mirror row_mask:0xf bank_mask:0xf
    v_add_f32_dpp v19, v19, v19 row_half_mirror row_mask:0xf bank_mask:0xf
    s_nop 0
    v_mul_f32 v18, 0x3ae38e39, v18
    v_mul_f32 v19, 0x3ae38e39, v19
    s_nop 0
    v_fma_f32 v19, -v18, v18, v19
    v_max_f32 v19, 0, v19
    s_nop 0
    v_add_f32 v19, 0x3727c5ac, v19
    v_rsq_f32 v19, v19
    s_nop 0
    ds_write_b32 v23, v18 offset:36992
    v_mul_f32 v19, 0x35e38e39, v19
    s_nop 0
    ds_write_b32 v23, v19 offset:36864
    s_nop 0
    s_waitcnt lgkmcnt(0)
    s_barrier
    s_branch L_sequential_preLN__spectral_gfnet__geglu_ffn__prompt_kernel_s2
L_sequential_preLN__spectral_gfnet__geglu_ffn__prompt_kernel_hgen:
    s_waitcnt vmcnt(0)
    buffer_load_dword v1, v224, s[60:63], s72 offen
    s_branch L_sequential_preLN__spectral_gfnet__geglu_ffn__prompt_kernel_nogen
L_sequential_preLN__spectral_gfnet__geglu_ffn__prompt_kernel_wt:
    s_load_dwordx4 s[28:31], s[0:1], 8
    s_sub_u32 s23, s2, 0
    v_lshlrev_b32 v3, 4, v0
    s_mul_i32 s24, s23, 18496
    s_lshl_b32 s25, s20, 10
    s_waitcnt lgkmcnt(0)
    s_or_b32 s40, s2, s20
    s_cmp_lg_u32 s40, 0
    s_cbranch_scc1 L_sequential_preLN__spectral_gfnet__geglu_ffn__prompt_kernel_nn
    s_memrealtime s[40:41]
    s_mov_b32 s36, s96
    s_and_b32 s37, s97, 0xffff
    s_mov_b32 s38, 128
    s_mov_b32 s39, 0x20000
    v_lshlrev_b32 v13, 2, v0
    s_waitcnt lgkmcnt(0)
    s_or_b32 s42, s40, 1
    v_mov_b32 v14, s42
    buffer_store_dword v14, v13, s[36:39], 0 offen sc1
L_sequential_preLN__spectral_gfnet__geglu_ffn__prompt_kernel_nn:
    s_mov_b32 s8, s28
    s_and_b32 s9, s29, 0xffff
    s_mov_b32 s10, 1183744
    s_mov_b32 s11, 0x20000
    s_mov_b32 s12, s30
    s_and_b32 s13, s31, 0xffff
    s_mov_b32 s14, 1183744
    s_mov_b32 s15, 0x20000
    s_mov_b32 s16, s6
    s_and_b32 s17, s7, 0xffff
    s_mov_b32 s18, 48768000
    s_mov_b32 s19, 0x20000
    s_add_u32 m0, s25, 0
    s_add_u32 s26, s24, 0
    buffer_load_dwordx4 v3, s[8:11], s26 offen lds
    s_add_u32 m0, s25, 20480
    s_add_u32 s26, s24, 0
    buffer_load_dwordx4 v3, s[12:15], s26 offen lds
    s_add_u32 m0, s25, 4096
    s_add_u32 s26, s24, 4096
    buffer_load_dwordx4 v3, s[8:11], s26 offen lds
    s_add_u32 m0, s25, 24576
    s_add_u32 s26, s24, 4096
    buffer_load_dwordx4 v3, s[12:15], s26 offen lds
    s_add_u32 m0, s25, 8192
    s_add_u32 s26, s24, 8192
    buffer_load_dwordx4 v3, s[8:11], s26 offen lds
    s_add_u32 m0, s25, 28672
    s_add_u32 s26, s24, 8192
    buffer_load_dwordx4 v3, s[12:15], s26 offen lds
    s_add_u32 m0, s25, 12288
    s_add_u32 s26, s24, 12288
    buffer_load_dwordx4 v3, s[8:11], s26 offen lds
    s_add_u32 m0, s25, 32768
    s_add_u32 s26, s24, 12288
    buffer_load_dwordx4 v3, s[12:15], s26 offen lds
    s_add_u32 m0, s25, 16384
    s_add_u32 s26, s24, 16384
    buffer_load_dwordx4 v3, s[8:11], s26 offen lds
    s_add_u32 m0, s25, 36864
    s_add_u32 s26, s24, 16384
    buffer_load_dwordx4 v3, s[12:15], s26 offen lds
    v_mov_b32 v8, 0
    v_mov_b32 v9, 0
    v_mov_b32 v10, 0
    v_mov_b32 v11, 0
    s_mul_i32 s26, s23, 13312
    s_add_u32 s26, s26, 47673344
    buffer_store_dwordx4 v[8:11], v3, s[16:19], s26 offen sc1
    s_add_u32 s26, s26, 4096
    buffer_store_dwordx4 v[8:11], v3, s[16:19], s26 offen sc1
    s_add_u32 s26, s26, 4096
    buffer_store_dwordx4 v[8:11], v3, s[16:19], s26 offen sc1
    s_add_u32 s26, s26, 4096
    s_cmp_eq_u32 s20, 0
    s_cselect_b32 s26, s26, 0x40000000
    buffer_store_dwordx4 v[8:11], v3, s[16:19], s26 offen sc1
    s_lshl_b32 s26, s23, 7
    s_add_u32 s26, s26, 48611328
    v_cmp_gt_u32 vcc, 8, v0
    v_bfrev_b32 v12, 2
    s_nop 0
    v_cndmask_b32 v12, v12, v3, vcc
    buffer_store_dwordx4 v[8:11], v12, s[16:19], s26 offen sc1
    s_mul_i32 s26, s23, 2304
    s_add_u32 s26, s26, 48619520
    v_cmp_gt_u32 vcc, 144, v0
    v_bfrev_b32 v12, 2
    s_nop 0
    v_cndmask_b32 v12, v12, v3, vcc
    buffer_store_dwordx4 v[8:11], v12, s[16:19], s26 offen sc1
    s_lshl_b32 s27, s23, 2
    s_add_u32 s27, s27, s20
    s_cmp_ge_u32 s27, 162
    s_cbranch_scc1 L_sequential_preLN__spectral_gfnet__geglu_ffn__prompt_kernel_nog
    s_mul_hi_u32 s28, s27, 0x1c71c71d
    s_mul_i32 s29, s28, 9
    s_sub_u32 s29, s27, s29
    s_and_b32 s30, s28, 1
    s_lshr_b32 s28, s28, 1
    v_and_b32 v12, 7, v2
    v_bfe_u32 v13, v2, 3, 1
    v_lshl_add_u32 v12, v13, 4, v12
    v_bfe_u32 v13, v2, 4, 1
    v_lshl_add_u32 v12, v13, 3, v12
    s_lshl_b32 s28, s28, 5
    v_add_u32 v12, s28, v12
    v_cvt_f32_u32 v12, v12
    v_lshrrev_b32 v13, 5, v2
    s_lshl_b32 s29, s29, 4
    s_add_u32 s29, s29, s30
    s_add_u32 s29, s29, 1
    v_lshl_add_u32 v13, v13, 3, s29
    v_cvt_f32_u32 v13, v13
    s_lshl_b32 s27, s27, 10
    s_add_u32 s27, s27, 9437184
    v_lshlrev_b32 v28, 4, v2
    v_add_f32 v14, 0x00000000, v13
    v_mul_f32 v14, v14, v12
    v_mul_f32 v14, 0x3ae38e39, v14
    v_add_f32 v15, 0x40000000, v13
    v_mul_f32 v15, v15, v12
    v_mul_f32 v15, 0x3ae38e39, v15
    v_add_f32 v16, 0x40800000, v13
    v_mul_f32 v16, v16, v12
    v_mul_f32 v16, 0x3ae38e39, v16
    v_add_f32 v17, 0x40c00000, v13
    v_mul_f32 v17, v17, v12
    v_mul_f32 v17, 0x3ae38e39, v17
    v_cos_f32 v18, v14
    v_cos_f32 v19, v15
    v_cos_f32 v20, v16
    v_cos_f32 v21, v17
    v_sin_f32 v14, v14
    v_sin_f32 v15, v15
    v_sin_f32 v16, v16
    v_sin_f32 v17, v17
    s_nop 0
    v_cvt_pk_bf16_f32 v108, v18, v14
    v_cvt_pk_bf16_f32 v109, v19, v15
    v_cvt_pk_bf16_f32 v110, v20, v16
    v_cvt_pk_bf16_f32 v111, v21, v17
    buffer_store_dwordx4 v[108:111], v28, s[16:19], s27 offen sc1
    s_add_u32 s27, s27, 9216
L_sequential_preLN__spectral_gfnet__geglu_ffn__prompt_kernel_nog:
    v_and_b32 v3, 7, v0
    v_lshrrev_b32 v4, 3, v0
    v_mul_u32_u24 v5, 2312, v3
    v_lshl_add_u32 v5, v4, 1, v5
    v_lshlrev_b32 v6, 4, v3
    v_lshl_add_u32 v6, v4, 13, v6
    s_lshl_b32 s24, s23, 7
    s_add_u32 s24, s24, 7077888
    s_waitcnt vmcnt(0)
    s_barrier
    ds_read_u16 v32, v5 offset:2
    ds_read_u16 v72, v5 offset:20482
    ds_read_u16 v33, v5 offset:580
    ds_read_u16 v73, v5 offset:21060
    ds_read_u16 v34, v5 offset:1158
    ds_read_u16 v74, v5 offset:21638
    ds_read_u16 v35, v5 offset:1736
    ds_read_u16 v75, v5 offset:22216
    ds_read_u16 v36, v5 offset:66
    ds_read_u16 v76, v5 offset:20546
    ds_read_u16 v37, v5 offset:644
    ds_read_u16 v77, v5 offset:21124
    ds_read_u16 v38, v5 offset:1222
    ds_read_u16 v78, v5 offset:21702
    ds_read_u16 v39, v5 offset:1800
    ds_read_u16 v79, v5 offset:22280
    s_waitcnt lgkmcnt(8)
    v_lshl_or_b32 v32, v72, 16, v32
    v_lshl_or_b32 v33, v73, 16, v33
    v_lshl_or_b32 v34, v74, 16, v34
    v_lshl_or_b32 v35, v75, 16, v35
    s_add_u32 s26, s24, 0
    buffer_store_dwordx4 v[32:35], v6, s[16:19], s26 offen sc1
    ds_read_u16 v40, v5 offset:130
    ds_read_u16 v80, v5 offset:20610
    ds_read_u16 v41, v5 offset:708
    ds_read_u16 v81, v5 offset:21188
    ds_read_u16 v42, v5 offset:1286
    ds_read_u16 v82, v5 offset:21766
    ds_read_u16 v43, v5 offset:1864
    ds_read_u16 v83, v5 offset:22344
    s_waitcnt lgkmcnt(8)
    v_lshl_or_b32 v36, v76, 16, v36
    v_lshl_or_b32 v37, v77, 16, v37
    v_lshl_or_b32 v38, v78, 16, v38
    v_lshl_or_b32 v39, v79, 16, v39
    s_add_u32 s26, s24, 262144
    buffer_store_dwordx4 v[36:39], v6, s[16:19], s26 offen sc1
    ds_read_u16 v44, v5 offset:194
    ds_read_u16 v84, v5 offset:20674
    ds_read_u16 v45, v5 offset:772
    ds_read_u16 v85, v5 offset:21252
    ds_read_u16 v46, v5 offset:1350
    ds_read_u16 v86, v5 offset:21830
    ds_read_u16 v47, v5 offset:1928
    ds_read_u16 v87, v5 offset:22408
    s_waitcnt lgkmcnt(8)
    v_lshl_or_b32 v40, v80, 16, v40
    v_lshl_or_b32 v41, v81, 16, v41
    v_lshl_or_b32 v42, v82, 16, v42
    v_lshl_or_b32 v43, v83, 16, v43
    s_add_u32 s26, s24, 524288
    buffer_store_dwordx4 v[40:43], v6, s[16:19], s26 offen sc1
    ds_read_u16 v48, v5 offset:258
    ds_read_u16 v88, v5 offset:20738
    ds_read_u16 v49, v5 offset:836
    ds_read_u16 v89, v5 offset:21316
    ds_read_u16 v50, v5 offset:1414
    ds_read_u16 v90, v5 offset:21894
    ds_read_u16 v51, v5 offset:1992
    ds_read_u16 v91, v5 offset:22472
    s_waitcnt lgkmcnt(8)
    v_lshl_or_b32 v44, v84, 16, v44
    v_lshl_or_b32 v45, v85, 16, v45
    v_lshl_or_b32 v46, v86, 16, v46
    v_lshl_or_b32 v47, v87, 16, v47
    s_add_u32 s26, s24, 786432
    buffer_store_dwordx4 v[44:47], v6, s[16:19], s26 offen sc1
    ds_read_u16 v52, v5 offset:322
    ds_read_u16 v92, v5 offset:20802
    ds_read_u16 v53, v5 offset:900
    ds_read_u16 v93, v5 offset:21380
    ds_read_u16 v54, v5 offset:1478
    ds_read_u16 v94, v5 offset:21958
    ds_read_u16 v55, v5 offset:2056
    ds_read_u16 v95, v5 offset:22536
    s_waitcnt lgkmcnt(8)
    v_lshl_or_b32 v48, v88, 16, v48
    v_lshl_or_b32 v49, v89, 16, v49
    v_lshl_or_b32 v50, v90, 16, v50
    v_lshl_or_b32 v51, v91, 16, v51
    s_add_u32 s26, s24, 1048576
    buffer_store_dwordx4 v[48:51], v6, s[16:19], s26 offen sc1
    ds_read_u16 v56, v5 offset:386
    ds_read_u16 v96, v5 offset:20866
    ds_read_u16 v57, v5 offset:964
    ds_read_u16 v97, v5 offset:21444
    ds_read_u16 v58, v5 offset:1542
    ds_read_u16 v98, v5 offset:22022
    ds_read_u16 v59, v5 offset:2120
    ds_read_u16 v99, v5 offset:22600
    s_waitcnt lgkmcnt(8)
    v_lshl_or_b32 v52, v92, 16, v52
    v_lshl_or_b32 v53, v93, 16, v53
    v_lshl_or_b32 v54, v94, 16, v54
    v_lshl_or_b32 v55, v95, 16, v55
    s_add_u32 s26, s24, 1310720
    buffer_store_dwordx4 v[52:55], v6, s[16:19], s26 offen sc1
    ds_read_u16 v60, v5 offset:450
    ds_read_u16 v100, v5 offset:20930
    ds_read_u16 v61, v5 offset:1028
    ds_read_u16 v101, v5 offset:21508
    ds_read_u16 v62, v5 offset:1606
    ds_read_u16 v102, v5 offset:22086
    ds_read_u16 v63, v5 offset:2184
    ds_read_u16 v103, v5 offset:22664
    s_waitcnt lgkmcnt(8)
    v_lshl_or_b32 v56, v96, 16, v56
    v_lshl_or_b32 v57, v97, 16, v57
    v_lshl_or_b32 v58, v98, 16, v58
    v_lshl_or_b32 v59, v99, 16, v59
    s_add_u32 s26, s24, 1572864
    buffer_store_dwordx4 v[56:59], v6, s[16:19], s26 offen sc1
    ds_read_u16 v64, v5 offset:514
    ds_read_u16 v104, v5 offset:20994
    ds_read_u16 v65, v5 offset:1092
    ds_read_u16 v105, v5 offset:21572
    ds_read_u16 v66, v5 offset:1670
    ds_read_u16 v106, v5 offset:22150
    ds_read_u16 v67, v5 offset:2248
    ds_read_u16 v107, v5 offset:22728
    s_waitcnt lgkmcnt(8)
    v_lshl_or_b32 v60, v100, 16, v60
    v_lshl_or_b32 v61, v101, 16, v61
    v_lshl_or_b32 v62, v102, 16, v62
    v_lshl_or_b32 v63, v103, 16, v63
    s_add_u32 s26, s24, 1835008
    buffer_store_dwordx4 v[60:63], v6, s[16:19], s26 offen sc1
    s_waitcnt lgkmcnt(0)
    v_lshl_or_b32 v64, v104, 16, v64
    v_lshl_or_b32 v65, v105, 16, v65
    v_lshl_or_b32 v66, v106, 16, v66
    v_lshl_or_b32 v67, v107, 16, v67
    s_add_u32 s26, s24, 2097152
    buffer_store_dwordx4 v[64:67], v6, s[16:19], s26 offen sc1
    s_waitcnt vmcnt(0)
    s_barrier
    s_lshl_b32 s30, s23, 7
    s_add_u32 s30, s30, 48611328
    s_cmp_eq_u32 s20, 0
    s_cselect_b32 s30, s30, 0x40000000
    s_mov_b32 s33, 1
    v_mov_b32 v0, v2
    s_branch L_sequential_preLN__spectral_gfnet__geglu_ffn__prompt_kernel_s2
L_sequential_preLN__spectral_gfnet__geglu_ffn__prompt_kernel_end:
    s_endpgm
L_back:
    s_lshr_b32 s49, s2, 3
    s_sub_u32 s50, s49, 8
    s_mul_hi_u32 s3, s50, 0x55555556
    s_add_u32 s50, s50, s3
    s_lshl_b32 s3, s49, 2
    s_add_u32 s3, s3, 3
    s_cmp_lt_u32 s49, 8
    s_cselect_b32 s50, s3, s50
    s_lshl_b32 s50, s50, 3
    s_and_b32 s3, s2, 7
    s_or_b32 s3, s3, s50
    s_mov_b32 s2, s3
    s_mov_b32 s28, s20
    s_mov_b32 s66, s6
    s_mov_b32 s67, s7
    s_load_dwordx4 s[4:7], s[0:1], 32
    s_load_dwordx4 s[8:11], s[0:1], 48
    s_load_dwordx2 s[96:97], s[0:1], 0
    s_lshr_b32 s49, s2, 3
    s_and_b32 s30, s49, 3
    s_lshr_b32 s29, s49, 2
    s_and_b32 s49, s2, 7
    s_and_b32 s50, s49, 3
    s_lshl_b32 s50, s50, 2
    s_add_u32 s30, s30, s50
    s_lshr_b32 s49, s49, 2
    s_lshl_b32 s49, s49, 3
    s_add_u32 s29, s29, s49
    s_lshl_b32 s31, s29, 2
    s_add_u32 s31, s31, s28
    s_lshr_b32 s32, s30, 2
    s_lshl_b32 s44, s29, 2
    s_add_u32 s32, s32, s44
    s_and_b32 s44, s30, 3
    s_mul_i32 s33, s44, 3
    s_add_u32 s33, s33, s28
    s_max_u32 s45, s44, s28
    s_cmp_lt_u32 s45, 3
    s_cselect_b32 s35, 1, 0
    s_mul_i32 s98, s32, 13312
    s_lshl_b32 s99, s33, 7
    s_add_u32 s98, s98, s99
    s_add_u32 s98, s98, 47684864
    s_cmp_eq_u32 s35, 1
    s_cselect_b32 s98, s98, 0x40000000
    v_lshlrev_b32 v2, 4, v0
    s_mul_i32 s36, s32, 36864
    s_add_u32 s37, s36, 2359296
    s_mul_i32 s38, s33, 18432
    s_add_u32 s38, s38, 9437184
    s_mov_b32 s54, s37
    s_lshr_b32 s39, s28, 1
    s_mul_i32 s39, s39, 18
    s_and_b32 s55, s28, 1
    s_mul_i32 s55, s55, 7
    s_add_u32 s55, s55, s39
    s_add_u32 s55, s55, 4
    s_lshl_b32 s39, s55, 10
    s_add_u32 s37, s37, s39
    s_add_u32 s39, s39, 36864
    v_lshrrev_b32 v5, 5, v0
    v_and_b32 v6, 31, v0
    v_lshrrev_b32 v7, 2, v0
    v_mul_u32_u24 v7, 73728, v7
    v_lshrrev_b32 v8, 4, v0
    v_xor_b32 v8, v8, v0
    v_and_b32 v8, 3, v8
    v_lshl_add_u32 v7, v8, 4, v7
    s_mul_i32 s40, s32, 1152
    s_lshl_b32 s45, s33, 6
    s_add_u32 s40, s40, s45
    s_lshl_b32 s42, s28, 12
    s_add_u32 s42, s42, 147456
    v_lshlrev_b32 v8, 2, v6
    s_lshl_b32 s41, s32, 7
    s_add_u32 s41, s41, 9768960
    v_and_b32 v10, 1, v0
    v_lshlrev_b32 v10, 4, v10
    v_bfe_u32 v11, v0, 1, 1
    v_and_b32 v12, 1, v0
    v_xor_b32 v12, v12, v11
    v_lshlrev_b32 v12, 15, v12
    v_lshl_or_b32 v11, v11, 31, v12
    v_lshlrev_b32 v3, 2, v0
    v_add_u32 v19, 36864, v3
    s_and_b32 s46, s101, 1
    s_mul_i32 s46, s46, 144
    s_lshr_b32 s47, s101, 1
    s_add_u32 s46, s46, s47
    s_mul_i32 s47, s28, 288
    s_add_u32 s46, s46, s47
    s_lshl_b32 s46, s46, 7
    s_add_u32 s46, s46, 48619520
    s_sub_u32 s47, s46, 2048
    s_cmp_lt_u32 s101, 64
    s_cselect_b32 s47, s47, 0x40000000
    s_lshr_b32 s48, s32, 4
    s_mul_i32 s51, s48, 36864
    s_add_u32 s51, s51, 48619520
    s_lshl_b32 s48, s55, 10
    s_add_u32 s48, s48, s51
    v_lshlrev_b32 v24, 7, v0
    v_min_u32 v4, 7040, v24
    v_mul_u32_u24 v26, 14336, v5
    v_add_u32 v26, v26, v24
    s_lshl_b32 s52, s28, 10
    s_add_u32 s52, s52, s101
    s_cmp_eq_u32 s52, 96
    s_mov_b32 s53, 48766976
    s_cselect_b32 s56, s53, 0x40000000
    s_mov_b32 s57, 48767104
    s_cmp_eq_u32 s52, 32
    s_cselect_b32 s52, s57, s56
    s_mov_b32 s20, s66
    s_and_b32 s21, s67, 0xffff
    s_mov_b32 s22, 48768000
    s_mov_b32 s23, 0x20000
    s_waitcnt vmcnt(0) lgkmcnt(0)
    buffer_store_dword v197, v196, s[20:23], s46 offen sc1
    buffer_store_dword v197, v196, s[20:23], s47 offen sc1
    s_mov_b32 s24, s96
    s_and_b32 s25, s97, 0xffff
    s_mov_b32 s26, 2359296
    s_mov_b32 s27, 0x20000
    s_cmp_eq_u32 s35, 0
    s_cbranch_scc1 L_ffn_kernel_nog
    s_add_u32 s45, s38, 0
    buffer_load_dwordx4 v[100:103], v2, s[20:23], s45 offen offset:0 sc1
    buffer_load_dwordx4 v[104:107], v2, s[20:23], s45 offen offset:1024 sc1
    buffer_load_dwordx4 v[108:111], v2, s[20:23], s45 offen offset:2048 sc1
    buffer_load_dwordx4 v[112:115], v2, s[20:23], s45 offen offset:3072 sc1
    s_add_u32 s45, s38, 4096
    buffer_load_dwordx4 v[116:119], v2, s[20:23], s45 offen offset:0 sc1
    buffer_load_dwordx4 v[120:123], v2, s[20:23], s45 offen offset:1024 sc1
    buffer_load_dwordx4 v[124:127], v2, s[20:23], s45 offen offset:2048 sc1
    buffer_load_dwordx4 v[128:131], v2, s[20:23], s45 offen offset:3072 sc1
    s_add_u32 s45, s38, 8192
    buffer_load_dwordx4 v[132:135], v2, s[20:23], s45 offen offset:0 sc1
    buffer_load_dwordx4 v[136:139], v2, s[20:23], s45 offen offset:1024 sc1
    buffer_load_dwordx4 v[140:143], v2, s[20:23], s45 offen offset:2048 sc1
    buffer_load_dwordx4 v[144:147], v2, s[20:23], s45 offen offset:3072 sc1
    s_add_u32 s45, s38, 12288
    buffer_load_dwordx4 v[148:151], v2, s[20:23], s45 offen offset:0 sc1
    buffer_load_dwordx4 v[152:155], v2, s[20:23], s45 offen offset:1024 sc1
    buffer_load_dwordx4 v[156:159], v2, s[20:23], s45 offen offset:2048 sc1
    buffer_load_dwordx4 v[160:163], v2, s[20:23], s45 offen offset:3072 sc1
    s_add_u32 s45, s38, 16384
    buffer_load_dwordx4 v[164:167], v2, s[20:23], s45 offen offset:0 sc1
    buffer_load_dwordx4 v[168:171], v2, s[20:23], s45 offen offset:1024 sc1
    s_add_u32 m0, s42, 0
    s_add_u32 s43, s40, 0
    buffer_load_dwordx4 v7, s[24:27], s43 offen lds
    s_add_u32 m0, s42, 1024
    s_add_u32 s43, s40, 1179648
    buffer_load_dwordx4 v7, s[24:27], s43 offen lds
    s_add_u32 m0, s42, 2048
    s_add_u32 s43, s40, 576
    buffer_load_dwordx4 v7, s[24:27], s43 offen lds
    s_add_u32 m0, s42, 3072
    s_add_u32 s43, s40, 1180224
    buffer_load_dwordx4 v7, s[24:27], s43 offen lds
    s_waitcnt vmcnt(21)
    v_alignbit_b32 v172, v100, v100, v10
    v_alignbit_b32 v173, v101, v101, v10
    v_alignbit_b32 v174, v102, v102, v10
    v_alignbit_b32 v175, v103, v103, v10
    v_xor_b32 v172, v11, v172
    v_xor_b32 v173, v11, v173
    v_xor_b32 v174, v11, v174
    v_xor_b32 v175, v11, v175
    s_waitcnt vmcnt(20)
    v_alignbit_b32 v176, v104, v104, v10
    v_alignbit_b32 v177, v105, v105, v10
    v_alignbit_b32 v178, v106, v106, v10
    v_alignbit_b32 v179, v107, v107, v10
    v_xor_b32 v176, v11, v176
    v_xor_b32 v177, v11, v177
    v_xor_b32 v178, v11, v178
    v_xor_b32 v179, v11, v179
    s_waitcnt vmcnt(19)
    v_alignbit_b32 v180, v108, v108, v10
    v_alignbit_b32 v181, v109, v109, v10
    v_alignbit_b32 v182, v110, v110, v10
    v_alignbit_b32 v183, v111, v111, v10
    v_xor_b32 v180, v11, v180
    v_xor_b32 v181, v11, v181
    v_xor_b32 v182, v11, v182
    v_xor_b32 v183, v11, v183
    s_waitcnt vmcnt(18)
    v_alignbit_b32 v184, v112, v112, v10
    v_alignbit_b32 v185, v113, v113, v10
    v_alignbit_b32 v186, v114, v114, v10
    v_alignbit_b32 v187, v115, v115, v10
    v_xor_b32 v184, v11, v184
    v_xor_b32 v185, v11, v185
    v_xor_b32 v186, v11, v186
    v_xor_b32 v187, v11, v187
    s_waitcnt vmcnt(17)
    v_alignbit_b32 v188, v116, v116, v10
    v_alignbit_b32 v189, v117, v117, v10
    v_alignbit_b32 v190, v118, v118, v10
    v_alignbit_b32 v191, v119, v119, v10
    v_xor_b32 v188, v11, v188
    v_xor_b32 v189, v11, v189
    v_xor_b32 v190, v11, v190
    v_xor_b32 v191, v11, v191
    s_waitcnt vmcnt(16)
    v_alignbit_b32 v192, v120, v120, v10
    v_alignbit_b32 v193, v121, v121, v10
    v_alignbit_b32 v194, v122, v122, v10
    v_alignbit_b32 v195, v123, v123, v10
    v_xor_b32 v192, v11, v192
    v_xor_b32 v193, v11, v193
    v_xor_b32 v194, v11, v194
    v_xor_b32 v195, v11, v195
    s_branch L_ffn_kernel_gd
L_ffn_kernel_nog:
    s_lshr_b32 s77, s2, 5
    s_getpc_b64 s[72:73]
L_ffn_kernel_pc0:
    s_add_u32 s72, s72, L_ffn_kernel_join-L_ffn_kernel_pc0
    s_addc_u32 s73, s73, (L_ffn_kernel_join-L_ffn_kernel_pc0)>>32
    s_and_b32 s73, s73, 0xffff
    s_mov_b32 s74, L_ffn_kernel_fin-L_ffn_kernel_join
    s_mov_b32 s75, 0x20000
    v_lshlrev_b32 v39, 7, v0
    s_mul_i32 s76, s77, 8192
    buffer_load_dword v253, v39, s[72:75], s76 offen
L_ffn_kernel_gd:
    s_cmp_lt_u32 s101, 96
    s_cbranch_scc1 L_ffn_kernel_nw2
    s_load_dwordx2 s[68:69], s[0:1], 32
    s_lshr_b32 s74, s2, 3
    s_and_b32 s72, s74, 3
    s_lshr_b32 s73, s74, 2
    s_and_b32 s74, s2, 7
    s_and_b32 s75, s74, 3
    s_lshl_b32 s75, s75, 2
    s_add_u32 s72, s72, s75
    s_lshr_b32 s74, s74, 2
    s_lshl_b32 s74, s74, 3
    s_add_u32 s73, s73, s74
    v_lshrrev_b32 v28, 3, v0
    v_and_b32 v29, 7, v0
    v_and_b32 v30, 6, v28
    v_xor_b32 v29, v29, v30
    v_lshlrev_b32 v29, 4, v29
    v_mul_u32_u24 v28, 9216, v28
    v_add_u32 v28, v28, v29
    v_add_u32 v29, 72704, v28
    v_add_u32 v30, 145408, v28
    v_add_u32 v31, 218112, v28
    s_lshr_b32 s73, s72, 1
    s_and_b32 s72, s72, 1
    s_mul_i32 s73, s73, 1152
    s_mul_i32 s72, s72, 640
    s_add_u32 s72, s72, s73
    s_mul_i32 s73, s28, 663552
    s_add_u32 s72, s72, s73
    s_mul_i32 s73, s28, 9216
    s_waitcnt lgkmcnt(0)
    s_and_b32 s69, s69, 0xffff
    s_mov_b32 s70, 5308416
    s_mov_b32 s71, 0x20000
    s_add_u32 m0, s73, 73728
    s_add_u32 s74, s72, 0
    buffer_load_dwordx4 v28, s[68:71], s74 offen offset:0 lds
    buffer_load_dwordx4 v29, s[68:71], s74 offen offset:1024 lds
    buffer_load_dwordx4 v30, s[68:71], s74 offen offset:2048 lds
    buffer_load_dwordx4 v31, s[68:71], s74 offen offset:3072 lds
    s_add_u32 m0, s73, 77824
    s_add_u32 s74, s72, 294912
    buffer_load_dwordx4 v28, s[68:71], s74 offen offset:0 lds
    buffer_load_dwordx4 v29, s[68:71], s74 offen offset:1024 lds
    buffer_load_dwordx4 v30, s[68:71], s74 offen offset:2048 lds
    buffer_load_dwordx4 v31, s[68:71], s74 offen offset:3072 lds
    s_add_u32 m0, s73, 81920
    s_add_u32 s74, s72, 589824
    buffer_load_dwordx4 v28, s[68:71], s74 offen offset:0 lds
    s_add_u32 m0, s73, 110592
    s_add_u32 s74, s72, 2654208
    buffer_load_dwordx4 v28, s[68:71], s74 offen offset:0 lds
    buffer_load_dwordx4 v29, s[68:71], s74 offen offset:1024 lds
    buffer_load_dwordx4 v30, s[68:71], s74 offen offset:2048 lds
    buffer_load_dwordx4 v31, s[68:71], s74 offen offset:3072 lds
    s_add_u32 m0, s73, 114688
    s_add_u32 s74, s72, 2949120
    buffer_load_dwordx4 v28, s[68:71], s74 offen offset:0 lds
    buffer_load_dwordx4 v29, s[68:71], s74 offen offset:1024 lds
    buffer_load_dwordx4 v30, s[68:71], s74 offen offset:2048 lds
    buffer_load_dwordx4 v31, s[68:71], s74 offen offset:3072 lds
    s_add_u32 m0, s73, 118784
    s_add_u32 s74, s72, 3244032
    buffer_load_dwordx4 v28, s[68:71], s74 offen offset:0 lds
L_ffn_kernel_nw2:
    s_barrier
    s_cmp_lt_u32 s101, 96
    s_cbranch_scc1 L_ffn_kernel_tf
    s_mov_b32 s99, 200000
    s_branch L_ffn_kernel_c0
L_ffn_kernel_cw:
    s_sleep 2
L_ffn_kernel_c0:
    buffer_load_dword v25, v4, s[20:23], s48 offen sc1
    s_sub_u32 s99, s99, 1
    s_waitcnt vmcnt(0)
    v_xor_b32 v25, s100, v25
    v_cmp_ne_u32 vcc, 0, v25
    s_cmp_eq_u32 s99, 0
    s_cbranch_scc1 L_ffn_kernel_cg
    s_cbranch_vccnz L_ffn_kernel_cw
L_ffn_kernel_cg:
    s_add_u32 m0, s39, 0
    s_add_u32 s44, s37, 0
    buffer_load_dwordx4 v2, s[20:23], s44 offen offset:0 sc1 lds
    buffer_load_dwordx4 v2, s[20:23], s44 offen offset:1024 sc1 lds
    buffer_load_dwordx4 v2, s[20:23], s44 offen offset:2048 sc1 lds
    buffer_load_dwordx4 v2, s[20:23], s44 offen offset:3072 sc1 lds
    s_add_u32 m0, s39, 4096
    s_add_u32 s44, s37, 4096
    buffer_load_dwordx4 v2, s[20:23], s44 offen offset:0 sc1 lds
    buffer_load_dwordx4 v2, s[20:23], s44 offen offset:1024 sc1 lds
    buffer_load_dwordx4 v2, s[20:23], s44 offen offset:2048 sc1 lds
    s_cmp_eq_u32 s35, 0
    s_cbranch_scc1 L_ffn_kernel_nr
    v_alignbit_b32 v196, v124, v124, v10
    v_alignbit_b32 v197, v125, v125, v10
    v_alignbit_b32 v198, v126, v126, v10
    v_alignbit_b32 v199, v127, v127, v10
    v_xor_b32 v196, v11, v196
    v_xor_b32 v197, v11, v197
    v_xor_b32 v198, v11, v198
    v_xor_b32 v199, v11, v199
    v_alignbit_b32 v200, v128, v128, v10
    v_alignbit_b32 v201, v129, v129, v10
    v_alignbit_b32 v202, v130, v130, v10
    v_alignbit_b32 v203, v131, v131, v10
    v_xor_b32 v200, v11, v200
    v_xor_b32 v201, v11, v201
    v_xor_b32 v202, v11, v202
    v_xor_b32 v203, v11, v203
    v_alignbit_b32 v204, v132, v132, v10
    v_alignbit_b32 v205, v133, v133, v10
    v_alignbit_b32 v206, v134, v134, v10
    v_alignbit_b32 v207, v135, v135, v10
    v_xor_b32 v204, v11, v204
    v_xor_b32 v205, v11, v205
    v_xor_b32 v206, v11, v206
    v_xor_b32 v207, v11, v207
    v_alignbit_b32 v208, v136, v136, v10
    v_alignbit_b32 v209, v137, v137, v10
    v_alignbit_b32 v210, v138, v138, v10
    v_alignbit_b32 v211, v139, v139, v10
    v_xor_b32 v208, v11, v208
    v_xor_b32 v209, v11, v209
    v_xor_b32 v210, v11, v210
    v_xor_b32 v211, v11, v211
    v_alignbit_b32 v212, v140, v140, v10
    v_alignbit_b32 v213, v141, v141, v10
    v_alignbit_b32 v214, v142, v142, v10
    v_alignbit_b32 v215, v143, v143, v10
    v_xor_b32 v212, v11, v212
    v_xor_b32 v213, v11, v213
    v_xor_b32 v214, v11, v214
    v_xor_b32 v215, v11, v215
    v_alignbit_b32 v216, v144, v144, v10
    v_alignbit_b32 v217, v145, v145, v10
    v_alignbit_b32 v218, v146, v146, v10
    v_alignbit_b32 v219, v147, v147, v10
    v_xor_b32 v216, v11, v216
    v_xor_b32 v217, v11, v217
    v_xor_b32 v218, v11, v218
    v_xor_b32 v219, v11, v219
    v_alignbit_b32 v220, v148, v148, v10
    v_alignbit_b32 v221, v149, v149, v10
    v_alignbit_b32 v222, v150, v150, v10
    v_alignbit_b32 v223, v151, v151, v10
    v_xor_b32 v220, v11, v220
    v_xor_b32 v221, v11, v221
    v_xor_b32 v222, v11, v222
    v_xor_b32 v223, v11, v223
    v_alignbit_b32 v224, v152, v152, v10
    v_alignbit_b32 v225, v153, v153, v10
    v_alignbit_b32 v226, v154, v154, v10
    v_alignbit_b32 v227, v155, v155, v10
    v_xor_b32 v224, v11, v224
    v_xor_b32 v225, v11, v225
    v_xor_b32 v226, v11, v226
    v_xor_b32 v227, v11, v227
    v_alignbit_b32 v228, v156, v156, v10
    v_alignbit_b32 v229, v157, v157, v10
    v_alignbit_b32 v230, v158, v158, v10
    v_alignbit_b32 v231, v159, v159, v10
    v_xor_b32 v228, v11, v228
    v_xor_b32 v229, v11, v229
    v_xor_b32 v230, v11, v230
    v_xor_b32 v231, v11, v231
    v_alignbit_b32 v232, v160, v160, v10
    v_alignbit_b32 v233, v161, v161, v10
    v_alignbit_b32 v234, v162, v162, v10
    v_alignbit_b32 v235, v163, v163, v10
    v_xor_b32 v232, v11, v232
    v_xor_b32 v233, v11, v233
    v_xor_b32 v234, v11, v234
    v_xor_b32 v235, v11, v235
    v_alignbit_b32 v236, v164, v164, v10
    v_alignbit_b32 v237, v165, v165, v10
    v_alignbit_b32 v238, v166, v166, v10
    v_alignbit_b32 v239, v167, v167, v10
    v_xor_b32 v236, v11, v236
    v_xor_b32 v237, v11, v237
    v_xor_b32 v238, v11, v238
    v_xor_b32 v239, v11, v239
    v_alignbit_b32 v240, v168, v168, v10
    v_alignbit_b32 v241, v169, v169, v10
    v_alignbit_b32 v242, v170, v170, v10
    v_alignbit_b32 v243, v171, v171, v10
    v_xor_b32 v240, v11, v240
    v_xor_b32 v241, v11, v241
    v_xor_b32 v242, v11, v242
    v_xor_b32 v243, v11, v243
    s_branch L_ffn_kernel_nr2
L_ffn_kernel_nr:
    s_cmp_eq_u32 s28, 3
    s_cselect_b32 s55, s51, 0x40000000
    buffer_load_dword v25, v26, s[20:23], s55 offen sc1
L_ffn_kernel_nr2:
    s_waitcnt vmcnt(0)
    s_barrier
    s_cmp_eq_u32 s35, 0
    s_cbranch_scc1 L_ffn_kernel_in3
    buffer_load_dword v9, v8, s[20:23], s41 offen sc1
    ds_read2st64_b32 v[96:97], v19 offset0:16 offset1:17
    ds_read2st64_b32 v[98:99], v19 offset0:18 offset1:19
    ds_read2st64_b32 v[244:245], v19 offset0:20 offset1:21
    ds_read2st64_b32 v[246:247], v19 offset0:22 offset1:23
    ds_read2st64_b32 v[20:21], v19 offset0:24 offset1:25
    ds_read2st64_b32 v[22:23], v19 offset0:26 offset1:27
    ds_read2st64_b32 v[252:253], v19 offset0:28 offset1:29
    ds_read2st64_b32 v[254:255], v19 offset0:30 offset1:31
    ds_read2st64_b32 v[12:13], v19 offset0:32 offset1:33
    ds_read2st64_b32 v[14:15], v19 offset0:34 offset1:35
    s_waitcnt lgkmcnt(8)
    v_mfma_f32_32x32x16_bf16 v[32:47], v[116:119], v[96:99], 0
    ds_read2st64_b32 v[28:29], v19 offset0:36 offset1:37
    ds_read2st64_b32 v[30:31], v19 offset0:38 offset1:39
    v_bfe_u32 v7, v0, 2, 2
    v_lshlrev_b32 v7, 4, v7
    v_lshl_add_u32 v7, v6, 6, v7
    s_waitcnt lgkmcnt(8)
    v_mfma_f32_32x32x16_bf16 v[32:47], v[120:123], v[244:247], v[32:47]
    ds_read2st64_b32 v[96:97], v19 offset0:40 offset1:41
    ds_read2st64_b32 v[98:99], v19 offset0:42 offset1:43
    v_lshl_add_u32 v7, v5, 3, v7
    v_add_u32 v7, s42, v7
    v_xor_b32 v16, 16, v7
    s_waitcnt lgkmcnt(8)
    v_mfma_f32_32x32x16_bf16 v[32:47], v[124:127], v[20:23], v[32:47]
    ds_read2st64_b32 v[244:245], v19 offset0:44 offset1:45
    ds_read2st64_b32 v[246:247], v19 offset0:46 offset1:47
    v_xor_b32 v17, 32, v7
    v_xor_b32 v18, 48, v7
    s_lshl_b32 s44, s33, 11
    s_waitcnt lgkmcnt(8)
    v_mfma_f32_32x32x16_bf16 v[32:47], v[128:131], v[252:255], v[32:47]
    ds_read2st64_b32 v[20:21], v19 offset0:48 offset1:49
    ds_read2st64_b32 v[22:23], v19 offset0:50 offset1:51
    s_add_u32 s44, s44, s36
    s_add_u32 s44, s44, 4718592
    s_add_u32 s45, s44, 18432
    s_waitcnt lgkmcnt(8)
    v_mfma_f32_32x32x16_bf16 v[32:47], v[132:135], v[12:15], v[32:47]
    ds_read2st64_b32 v[252:253], v19 offset0:52 offset1:53
    ds_read2st64_b32 v[254:255], v19 offset0:54 offset1:55
    ds_read_b64 v[116:117], v7 offset:0
    ds_read_b64 v[118:119], v17 offset:0
    ds_read_b64 v[120:121], v16 offset:0
    ds_read_b64 v[122:123], v18 offset:0
    ds_read_b64 v[124:125], v7 offset:2048
    ds_read_b64 v[126:127], v17 offset:2048
    ds_read_b64 v[128:129], v16 offset:2048
    ds_read_b64 v[130:131], v18 offset:2048
    s_waitcnt lgkmcnt(15)
    v_mfma_f32_32x32x16_bf16 v[32:47], v[172:175], v[28:31], v[32:47]
    ds_read2st64_b32 v[12:13], v19 offset0:56 offset1:57
    ds_read2st64_b32 v[14:15], v19 offset0:58 offset1:59
    v_and_b32 v2, 15, v0
    v_lshlrev_b32 v2, 4, v2
    v_lshl_add_u32 v2, v5, 8, v2
    s_waitcnt lgkmcnt(15)
    v_mfma_f32_32x32x16_bf16 v[32:47], v[176:179], v[96:99], v[32:47]
    ds_read2st64_b32 v[28:29], v19 offset0:60 offset1:61
    ds_read2st64_b32 v[30:31], v19 offset0:62 offset1:63
    v_bfe_u32 v8, v0, 4, 1
    v_lshl_add_u32 v2, v8, 10, v2
    s_waitcnt lgkmcnt(4)
    v_lshlrev_b32 v64, 16, v116
    v_mfma_f32_32x32x16_bf16 v[32:47], v[180:183], v[244:247], v[32:47]
    ds_read2st64_b32 v[96:97], v19 offset0:64 offset1:65
    ds_read2st64_b32 v[98:99], v19 offset0:66 offset1:67
    v_and_b32 v65, 0xffff0000, v116
    v_lshlrev_b32 v66, 16, v117
    v_and_b32 v67, 0xffff0000, v117
    v_mfma_f32_32x32x16_bf16 v[32:47], v[184:187], v[20:23], v[32:47]
    ds_read2st64_b32 v[244:245], v19 offset0:68 offset1:69
    ds_read2st64_b32 v[246:247], v19 offset0:70 offset1:71
    v_lshlrev_b32 v68, 16, v118
    v_and_b32 v69, 0xffff0000, v118
    v_lshlrev_b32 v70, 16, v119
    v_mfma_f32_32x32x16_bf16 v[32:47], v[188:191], v[252:255], v[32:47]
    ds_read2st64_b32 v[20:21], v19 offset0:88 offset1:89
    ds_read2st64_b32 v[22:23], v19 offset0:90 offset1:91
    v_and_b32 v71, 0xffff0000, v119
    v_lshlrev_b32 v72, 16, v120
    v_and_b32 v73, 0xffff0000, v120
    s_waitcnt lgkmcnt(8)
    v_mfma_f32_32x32x16_bf16 v[32:47], v[192:195], v[12:15], v[32:47]
    ds_read2st64_b32 v[252:253], v19 offset0:92 offset1:93
    ds_read2st64_b32 v[254:255], v19 offset0:94 offset1:95
    v_lshlrev_b32 v74, 16, v121
    v_and_b32 v75, 0xffff0000, v121
    v_lshlrev_b32 v76, 16, v122
    s_waitcnt lgkmcnt(8)
    v_mfma_f32_32x32x16_bf16 v[32:47], v[196:199], v[28:31], v[32:47]
    ds_read2st64_b32 v[12:13], v19 offset0:96 offset1:97
    ds_read2st64_b32 v[14:15], v19 offset0:98 offset1:99
    v_and_b32 v77, 0xffff0000, v122
    v_lshlrev_b32 v78, 16, v123
    v_and_b32 v79, 0xffff0000, v123
    s_waitcnt lgkmcnt(8)
    v_mfma_f32_32x32x16_bf16 v[32:47], v[200:203], v[96:99], v[32:47]
    ds_read2st64_b32 v[28:29], v19 offset0:100 offset1:101
    ds_read2st64_b32 v[30:31], v19 offset0:102 offset1:103
    v_lshlrev_b32 v80, 16, v124
    v_and_b32 v81, 0xffff0000, v124
    v_lshlrev_b32 v82, 16, v125
    s_waitcnt lgkmcnt(8)
    v_mfma_f32_32x32x16_bf16 v[32:47], v[204:207], v[244:247], v[32:47]
    ds_read2st64_b32 v[96:97], v19 offset0:104 offset1:105
    ds_read2st64_b32 v[98:99], v19 offset0:106 offset1:107
    v_and_b32 v83, 0xffff0000, v125
    v_lshlrev_b32 v84, 16, v126
    v_and_b32 v85, 0xffff0000, v126
    s_waitcnt vmcnt(0)
    v_sub_f32 v48, 0, v9
    v_sub_f32 v49, 0, v9
    v_sub_f32 v50, 0, v9
    v_sub_f32 v51, 0, v9
    v_sub_f32 v52, 0, v9
    v_sub_f32 v53, 0, v9
    v_sub_f32 v54, 0, v9
    v_sub_f32 v55, 0, v9
    v_sub_f32 v56, 0, v9
    v_sub_f32 v57, 0, v9
    v_sub_f32 v58, 0, v9
    v_sub_f32 v59, 0, v9
    v_sub_f32 v60, 0, v9
    v_sub_f32 v61, 0, v9
    v_sub_f32 v62, 0, v9
    v_sub_f32 v63, 0, v9
    s_nop 0
    s_waitcnt lgkmcnt(8)
    v_mfma_f32_32x32x16_bf16 v[48:63], v[152:155], v[20:23], v[48:63]
    ds_read2st64_b32 v[244:245], v19 offset0:108 offset1:109
    ds_read2st64_b32 v[246:247], v19 offset0:110 offset1:111
    v_lshlrev_b32 v86, 16, v127
    v_and_b32 v87, 0xffff0000, v127
    v_lshlrev_b32 v88, 16, v128
    s_waitcnt lgkmcnt(8)
    v_mfma_f32_32x32x16_bf16 v[48:63], v[156:159], v[252:255], v[48:63]
    ds_read2st64_b32 v[20:21], v19 offset0:112 offset1:113
    ds_read2st64_b32 v[22:23], v19 offset0:114 offset1:115
    v_and_b32 v89, 0xffff0000, v128
    v_lshlrev_b32 v90, 16, v129
    v_and_b32 v91, 0xffff0000, v129
    s_waitcnt lgkmcnt(8)
    v_mfma_f32_32x32x16_bf16 v[48:63], v[160:163], v[12:15], v[48:63]
    ds_read2st64_b32 v[252:253], v19 offset0:116 offset1:117
    ds_read2st64_b32 v[254:255], v19 offset0:118 offset1:119
    v_lshlrev_b32 v92, 16, v130
    v_and_b32 v93, 0xffff0000, v130
    v_lshlrev_b32 v94, 16, v131
    s_waitcnt lgkmcnt(8)
    v_mfma_f32_32x32x16_bf16 v[48:63], v[164:167], v[28:31], v[48:63]
    ds_read2st64_b32 v[12:13], v19 offset0:120 offset1:121
    ds_read2st64_b32 v[14:15], v19 offset0:122 offset1:123
    v_and_b32 v95, 0xffff0000, v131
    s_waitcnt lgkmcnt(8)
    v_mfma_f32_32x32x16_bf16 v[48:63], v[168:171], v[96:99], v[48:63]
    ds_read2st64_b32 v[28:29], v19 offset0:124 offset1:125
    ds_read2st64_b32 v[30:31], v19 offset0:126 offset1:127
    s_waitcnt lgkmcnt(8)
    v_mfma_f32_32x32x16_bf16 v[48:63], v[208:211], v[244:247], v[48:63]
    ds_read2st64_b32 v[96:97], v19 offset0:128 offset1:129
    ds_read2st64_b32 v[98:99], v19 offset0:130 offset1:131
    s_waitcnt lgkmcnt(8)
    v_mfma_f32_32x32x16_bf16 v[48:63], v[212:215], v[20:23], v[48:63]
    ds_read2st64_b32 v[244:245], v19 offset0:132 offset1:133
    ds_read2st64_b32 v[246:247], v19 offset0:134 offset1:135
    s_waitcnt lgkmcnt(8)
    v_mfma_f32_32x32x16_bf16 v[48:63], v[216:219], v[252:255], v[48:63]
    ds_read2st64_b32 v[20:21], v19 offset0:136 offset1:137
    ds_read2st64_b32 v[22:23], v19 offset0:138 offset1:139
    s_waitcnt lgkmcnt(8)
    v_mfma_f32_32x32x16_bf16 v[48:63], v[220:223], v[12:15], v[48:63]
    ds_read2st64_b32 v[252:253], v19 offset0:140 offset1:141
    ds_read2st64_b32 v[254:255], v19 offset0:142 offset1:143
    s_waitcnt lgkmcnt(8)
    v_mfma_f32_32x32x16_bf16 v[48:63], v[224:227], v[28:31], v[48:63]
    s_waitcnt lgkmcnt(6)
    v_mfma_f32_32x32x16_bf16 v[48:63], v[228:231], v[96:99], v[48:63]
    s_waitcnt lgkmcnt(4)
    v_mfma_f32_32x32x16_bf16 v[48:63], v[232:235], v[244:247], v[48:63]
    s_barrier
    ds_read2st64_b32 v[12:13], v19 offset0:0 offset1:1
    ds_read2st64_b32 v[14:15], v19 offset0:2 offset1:3
    ds_read2st64_b32 v[28:29], v19 offset0:4 offset1:5
    ds_read2st64_b32 v[30:31], v19 offset0:6 offset1:7
    ds_read2st64_b32 v[96:97], v19 offset0:8 offset1:9
    ds_read2st64_b32 v[98:99], v19 offset0:10 offset1:11
    s_waitcnt lgkmcnt(8)
    v_mfma_f32_32x32x16_bf16 v[48:63], v[236:239], v[20:23], v[48:63]
    ds_read2st64_b32 v[244:245], v19 offset0:12 offset1:13
    ds_read2st64_b32 v[246:247], v19 offset0:14 offset1:15
    s_waitcnt lgkmcnt(8)
    v_mfma_f32_32x32x16_bf16 v[48:63], v[240:243], v[252:255], v[48:63]
    ds_read2st64_b32 v[20:21], v19 offset0:72 offset1:73
    ds_read2st64_b32 v[22:23], v19 offset0:74 offset1:75
    s_waitcnt lgkmcnt(8)
    v_mfma_f32_32x32x16_bf16 v[32:47], v[100:103], v[12:15], v[32:47]
    ds_read2st64_b32 v[252:253], v19 offset0:76 offset1:77
    ds_read2st64_b32 v[254:255], v19 offset0:78 offset1:79
    s_waitcnt lgkmcnt(8)
    v_mfma_f32_32x32x16_bf16 v[32:47], v[104:107], v[28:31], v[32:47]
    ds_read2st64_b32 v[12:13], v19 offset0:80 offset1:81
    ds_read2st64_b32 v[14:15], v19 offset0:82 offset1:83
    s_waitcnt lgkmcnt(8)
    v_mfma_f32_32x32x16_bf16 v[32:47], v[108:111], v[96:99], v[32:47]
    ds_read2st64_b32 v[28:29], v19 offset0:84 offset1:85
    ds_read2st64_b32 v[30:31], v19 offset0:86 offset1:87
    s_waitcnt lgkmcnt(8)
    v_mfma_f32_32x32x16_bf16 v[32:47], v[112:115], v[244:247], v[32:47]
    s_waitcnt lgkmcnt(6)
    v_mfma_f32_32x32x16_bf16 v[48:63], v[136:139], v[20:23], v[48:63]
    s_waitcnt lgkmcnt(4)
    v_mfma_f32_32x32x16_bf16 v[48:63], v[140:143], v[252:255], v[48:63]
    s_waitcnt lgkmcnt(2)
    v_mfma_f32_32x32x16_bf16 v[48:63], v[144:147], v[12:15], v[48:63]
    s_waitcnt lgkmcnt(0)
    v_mfma_f32_32x32x16_bf16 v[48:63], v[148:151], v[28:31], v[48:63]
    s_nop 3
    v_add_f32 v64, v64, v32
    v_sub_f32 v80, v80, v32
    v_add_f32 v65, v65, v33
    v_sub_f32 v81, v81, v33
    v_add_f32 v66, v66, v34
    v_sub_f32 v82, v82, v34
    v_add_f32 v67, v67, v35
    v_sub_f32 v83, v83, v35
    v_add_f32 v68, v68, v36
    v_sub_f32 v84, v84, v36
    v_add_f32 v69, v69, v37
    v_sub_f32 v85, v85, v37
    v_add_f32 v70, v70, v38
    v_sub_f32 v86, v86, v38
    v_add_f32 v71, v71, v39
    v_sub_f32 v87, v87, v39
    v_add_f32 v72, v72, v40
    v_sub_f32 v88, v88, v40
    v_add_f32 v73, v73, v41
    v_sub_f32 v89, v89, v41
    v_add_f32 v74, v74, v42
    v_sub_f32 v90, v90, v42
    v_add_f32 v75, v75, v43
    v_sub_f32 v91, v91, v43
    v_add_f32 v76, v76, v44
    v_sub_f32 v92, v92, v44
    v_add_f32 v77, v77, v45
    v_sub_f32 v93, v93, v45
    v_add_f32 v78, v78, v46
    v_sub_f32 v94, v94, v46
    v_add_f32 v79, v79, v47
    v_sub_f32 v95, v95, v47
    s_mul_i32 s34, s32, 9
    s_add_u32 s34, s34, s33
    s_lshl_b32 s34, s34, 8
    s_add_u32 s34, s34, 9777152
    v_add_f32 v64, v64, v48
    v_add_f32 v65, v65, v49
    v_add_f32 v66, v66, v50
    v_add_f32 v67, v67, v51
    v_add_f32 v68, v68, v52
    v_add_f32 v69, v69, v53
    v_add_f32 v70, v70, v54
    v_add_f32 v71, v71, v55
    v_cvt_pk_bf16_f32 v156, v64, v65
    v_cvt_pk_bf16_f32 v157, v66, v67
    v_cvt_pk_bf16_f32 v158, v68, v69
    v_cvt_pk_bf16_f32 v159, v70, v71
    buffer_store_dwordx4 v[156:159], v2, s[20:23], s44 offen offset:0 sc1
    v_add_f32 v72, v72, v56
    v_add_f32 v73, v73, v57
    v_add_f32 v74, v74, v58
    v_add_f32 v75, v75, v59
    v_add_f32 v76, v76, v60
    v_add_f32 v77, v77, v61
    v_add_f32 v78, v78, v62
    v_add_f32 v79, v79, v63
    v_cvt_pk_bf16_f32 v160, v72, v73
    v_cvt_pk_bf16_f32 v161, v74, v75
    v_cvt_pk_bf16_f32 v162, v76, v77
    v_cvt_pk_bf16_f32 v163, v78, v79
    buffer_store_dwordx4 v[160:163], v2, s[20:23], s44 offen offset:512 sc1
    v_add_f32 v80, v80, v48
    v_add_f32 v81, v81, v49
    v_add_f32 v82, v82, v50
    v_add_f32 v83, v83, v51
    v_add_f32 v84, v84, v52
    v_add_f32 v85, v85, v53
    v_add_f32 v86, v86, v54
    v_add_f32 v87, v87, v55
    v_cvt_pk_bf16_f32 v164, v80, v81
    v_cvt_pk_bf16_f32 v165, v82, v83
    v_cvt_pk_bf16_f32 v166, v84, v85
    v_cvt_pk_bf16_f32 v167, v86, v87
    buffer_store_dwordx4 v[164:167], v2, s[20:23], s45 offen offset:0 sc1
    v_add_f32 v88, v88, v56
    v_add_f32 v89, v89, v57
    v_add_f32 v90, v90, v58
    v_add_f32 v91, v91, v59
    v_add_f32 v92, v92, v60
    v_add_f32 v93, v93, v61
    v_add_f32 v94, v94, v62
    v_add_f32 v95, v95, v63
    v_cvt_pk_bf16_f32 v168, v88, v89
    v_cvt_pk_bf16_f32 v169, v90, v91
    v_cvt_pk_bf16_f32 v170, v92, v93
    v_cvt_pk_bf16_f32 v171, v94, v95
    buffer_store_dwordx4 v[168:171], v2, s[20:23], s45 offen offset:512 sc1
    v_mov_b32 v12, 0
    v_mov_b32 v13, 0
    v_dot2c_f32_bf16 v12, v156, v156
    v_dot2c_f32_bf16 v13, v157, v157
    v_dot2c_f32_bf16 v12, v158, v158
    v_dot2c_f32_bf16 v13, v159, v159
    v_dot2c_f32_bf16 v12, v160, v160
    v_dot2c_f32_bf16 v13, v161, v161
    v_dot2c_f32_bf16 v12, v162, v162
    v_dot2c_f32_bf16 v13, v163, v163
    v_dot2c_f32_bf16 v12, v164, v164
    v_dot2c_f32_bf16 v13, v165, v165
    v_dot2c_f32_bf16 v12, v166, v166
    v_dot2c_f32_bf16 v13, v167, v167
    v_dot2c_f32_bf16 v12, v168, v168
    v_dot2c_f32_bf16 v13, v169, v169
    v_dot2c_f32_bf16 v12, v170, v170
    v_dot2c_f32_bf16 v13, v171, v171
    s_nop 2
    v_add_f32 v12, v12, v13
    buffer_store_dword v12, v3, s[20:23], s34 offen sc1
L_ffn_kernel_join:
    v_cmp_eq_u32 vcc, 0, v0
    v_bfrev_b32 v36, 1
    v_mov_b32 v248, 1
    v_cndmask_b32 v245, v36, 0, vcc
    v_lshrrev_b32 v28, 3, v0
    v_and_b32 v29, 7, v0
    v_lshrrev_b32 v30, 2, v0
    v_and_b32 v31, 6, v28
    v_xor_b32 v29, v29, v31
    v_lshlrev_b32 v29, 4, v29
    v_mul_u32_u24 v1, 9216, v28
    v_add_u32 v1, v1, v29
    v_add_u32 v2, 72704, v1
    v_add_u32 v3, 145408, v1
    v_add_u32 v4, 218112, v1
    v_lshlrev_b32 v23, 4, v0
    s_lshr_b32 s68, s30, 1
    s_and_b32 s69, s30, 1
    s_mul_i32 s70, s68, 576
    s_mul_i32 s71, s69, 320
    s_add_u32 s71, s71, s70
    s_and_b32 s49, s28, 1
    s_mul_i32 s50, s28, 663552
    s_lshl_b32 s38, s71, 1
    s_add_u32 s38, s38, s50
    s_mul_i32 s33, s28, 9216
    s_mul_i32 s46, s31, 36864
    s_add_u32 s46, s46, 4718592
    v_and_b32 v32, 3, v0
    v_lshlrev_b32 v32, 3, v32
    v_bfe_u32 v33, v0, 3, 2
    v_lshl_add_u32 v33, v33, 5, v32
    v_lshl_add_u32 v9, v30, 7, v33
    v_xor_b32 v10, 32, v9
    v_xor_b32 v11, 64, v9
    v_xor_b32 v12, 96, v9
    v_add_u32 v13, 49152, v9
    v_add_u32 v14, 49152, v10
    v_add_u32 v15, 49152, v11
    v_add_u32 v16, 49152, v12
    v_add_u32 v17, 98304, v9
    v_add_u32 v18, 98304, v10
    v_add_u32 v19, 98304, v11
    v_add_u32 v20, 98304, v12
    v_bfe_u32 v33, v0, 4, 1
    v_lshl_add_u32 v33, v33, 5, v32
    v_lshl_add_u32 v21, v30, 6, v33
    v_xor_b32 v22, 32, v21
    s_mov_b32 s12, s4
    s_and_b32 s13, s5, 0xffff
    s_mov_b32 s14, 5308416
    s_mov_b32 s15, 0x20000
    s_mov_b32 s4, s6
    s_and_b32 s5, s7, 0xffff
    s_mov_b32 s6, 5308416
    s_mov_b32 s7, 0x20000
    v_lshlrev_b32 v39, 2, v0
    s_mul_i32 s64, s31, 2304
    s_add_u32 s64, s64, 9777152
    s_mov_b32 s16, s8
    s_and_b32 s17, s9, 0xffff
    s_mov_b32 s18, 5308416
    s_mov_b32 s19, 0x20000
    s_mov_b32 s24, s10
    s_and_b32 s25, s11, 0xffff
    s_mov_b32 s26, 2359296
    s_mov_b32 s27, 0x20000
    v_mul_u32_u24 v5, 1152, v28
    v_add_u32 v5, v5, v29
    v_and_b32 v31, 3, v0
    v_and_b32 v37, 2, v28
    v_xor_b32 v31, v31, v37
    v_lshlrev_b32 v31, 4, v31
    v_mul_u32_u24 v104, 9216, v30
    v_add_u32 v104, v104, v31
    v_mul_u32_u24 v240, 1152, v30
    v_add_u32 v240, v240, v31
    v_add_u32 v105, 146432, v104
    v_add_u32 v6, 8192, v5
    v_add_u32 v241, 17408, v240
    v_add_u32 v106, 292864, v104
    v_add_u32 v7, 16384, v5
    v_add_u32 v242, 34816, v240
    v_add_u32 v107, 439296, v104
    s_lshl_b32 s99, s28, 10
    s_add_u32 s99, s99, s101
    s_cmp_eq_u32 s99, 96
    s_mov_b32 s99, 48767232
    s_cselect_b32 s99, s99, 0x40000000
    v_mov_b32 v100, s100
    v_lshlrev_b32 v101, 2, v0
    buffer_store_dword v100, v101, s[20:23], s99 offen sc1
    s_waitcnt vmcnt(0)
    buffer_store_dword v248, v245, s[20:23], s98 offen sc1
    v_add_u32 v8, 24576, v5
    v_add_u32 v243, 52224, v240
    s_lshl_b32 s72, s69, 5
    s_add_u32 s72, s72, s70
    s_add_u32 s72, s72, 256
    s_xor_b32 s65, s69, 1
    s_mul_i32 s73, s65, 320
    s_add_u32 s73, s73, s70
    s_lshl_b32 s74, s65, 5
    s_add_u32 s74, s74, s70
    s_add_u32 s74, s74, 256
    s_lshl_b32 s39, s72, 1
    s_add_u32 s39, s39, s50
    s_add_u32 s39, s39, s50
    s_mul_i32 s75, s69, 640
    s_lshl_b32 s76, s69, 6
    s_add_u32 s76, s76, 512
    s_lshl_b32 s40, s28, 6
    s_add_u32 s40, s40, s71
    s_mul_i32 s40, s40, 1152
    s_add_u32 s40, s40, s75
    s_lshl_b32 s41, s28, 3
    s_add_u32 s41, s41, s72
    s_mul_i32 s41, s41, 1152
    s_add_u32 s41, s41, s75
    s_lshl_b32 s42, s28, 6
    s_add_u32 s42, s42, s73
    s_mul_i32 s42, s42, 1152
    s_add_u32 s42, s42, s75
    s_lshl_b32 s43, s28, 3
    s_add_u32 s43, s43, s74
    s_mul_i32 s43, s43, 1152
    s_add_u32 s43, s43, s75
    s_cmp_lt_u32 s28, 2
    s_cselect_b32 s44, s71, s73
    s_cselect_b32 s45, s72, s74
    s_cselect_b32 s36, 0, 18432
    s_lshl_b32 s65, s49, 7
    s_add_u32 s44, s44, s65
    s_mul_i32 s44, s44, 1152
    s_add_u32 s44, s44, s76
    s_lshl_b32 s65, s49, 4
    s_add_u32 s45, s45, s65
    s_mul_i32 s45, s45, 1152
    s_add_u32 s45, s45, s76
    s_lshl_b32 s65, s49, 10
    s_add_u32 s37, s36, s65
    s_add_u32 s37, s37, 16384
    s_lshl_b32 s65, s49, 13
    s_add_u32 s36, s36, s65
    s_lshl_b32 s34, s28, 13
    s_lshl_b32 s35, s28, 10
    s_lshl_b32 s48, s31, 1
    s_add_u32 s48, s48, s69
    s_mul_i32 s48, s48, 147456
    s_add_u32 s48, s48, 9924608
    s_lshl_b32 s47, s68, 8
    s_add_u32 s47, s47, s48
    s_lshl_b32 s65, s68, 11
    s_add_u32 s48, s48, s65
    s_mul_i32 s65, s31, 13312
    s_add_u32 s65, s65, 47673344
    s_mul_i32 s53, s30, 640
    s_add_u32 s53, s53, s65
    s_xor_b32 s54, s30, 1
    s_mul_i32 s60, s54, 18432
    s_mul_i32 s54, s54, 640
    s_add_u32 s54, s54, s65
    s_add_u32 s55, s65, s75
    s_add_u32 s55, s55, 10240
    s_lshl_b32 s56, s68, 2
    s_add_u32 s56, s56, s55
    s_mul_i32 s65, s31, 294912
    s_add_u32 s65, s65, 28798976
    s_add_u32 s60, s60, s65
    s_mul_i32 s57, s30, 18432
    s_add_u32 s57, s57, s65
    s_and_b32 s61, s68, 3
    s_lshl_b32 s61, s61, 6
    s_lshr_b32 s65, s68, 2
    s_lshl_b32 s65, s65, 10
    s_add_u32 s61, s61, s65
    s_add_u32 s61, s61, s46
    s_mul_i32 s62, s68, 294912
    s_mul_i32 s65, s31, 1152
    s_add_u32 s62, s62, s65
    s_lshl_b32 s63, s68, 4
    s_lshl_b32 s65, s31, 7
    s_add_u32 s63, s63, s65
    s_add_u32 s63, s63, 9768960
    v_and_b32 v32, 3, v0
    v_bfe_u32 v33, v0, 2, 2
    v_bfe_u32 v34, v0, 4, 1
    v_lshrrev_b32 v35, 5, v0
    v_lshrrev_b32 v36, 4, v0
    v_lshlrev_b32 v244, 4, v32
    v_lshl_add_u32 v249, v33, 8, v244
    v_lshl_add_u32 v249, v34, 3, v249
    v_lshl_add_u32 v249, v35, 11, v249
    v_lshl_add_u32 v244, v36, 6, v244
    v_lshl_add_u32 v244, v33, 11, v244
    v_and_b32 v36, 7, v0
    v_lshlrev_b32 v246, 2, v36
    s_add_u32 m0, s33, 0
    s_add_u32 s32, s38, 0
    buffer_load_dwordx4 v1, s[4:7], s32 offen offset:0 lds
    buffer_load_dwordx4 v2, s[4:7], s32 offen offset:1024 lds
    buffer_load_dwordx4 v3, s[4:7], s32 offen offset:2048 lds
    buffer_load_dwordx4 v4, s[4:7], s32 offen offset:3072 lds
    s_add_u32 m0, s33, 4096
    s_add_u32 s32, s38, 294912
    buffer_load_dwordx4 v1, s[4:7], s32 offen offset:0 lds
    buffer_load_dwordx4 v2, s[4:7], s32 offen offset:1024 lds
    buffer_load_dwordx4 v3, s[4:7], s32 offen offset:2048 lds
    buffer_load_dwordx4 v4, s[4:7], s32 offen offset:3072 lds
    s_add_u32 m0, s33, 8192
    s_add_u32 s32, s38, 589824
    buffer_load_dwordx4 v1, s[4:7], s32 offen offset:0 lds
    s_barrier
    v_and_b32 v32, 15, v0
    v_min_u32 v32, 8, v32
    v_lshlrev_b32 v32, 7, v32
    s_mul_i32 s98, s31, 13312
    s_add_u32 s98, s98, 47684864
    s_mov_b32 s99, 200000
    s_cmp_ge_u32 s101, 96
    s_cbranch_scc1 L_ffn_kernel_nhg
    s_mov_b32 s65, 48767232
L_ffn_kernel_hgw:
    buffer_load_dword v33, off, s[20:23], s65 sc1
    s_sub_u32 s99, s99, 1
    s_waitcnt vmcnt(0)
    v_cmp_ne_u32 vcc, s100, v33
    s_cmp_eq_u32 s99, 0
    s_cbranch_scc1 L_ffn_kernel_hg
    s_cbranch_vccz L_ffn_kernel_nhg
    s_sleep 6
    s_branch L_ffn_kernel_hgw
L_ffn_kernel_nhg:
L_ffn_kernel_hw:
    buffer_load_dword v33, v32, s[20:23], s98 offen sc1
    s_sub_u32 s99, s99, 1
    s_waitcnt vmcnt(0)
    v_cmp_eq_u32 vcc, 0, v33
    s_cmp_eq_u32 s99, 0
    s_cbranch_scc1 L_ffn_kernel_hg
    s_cbranch_vccnz L_ffn_kernel_hw
L_ffn_kernel_hg:
    s_lshl_b32 s65, s29, 1
    s_add_u32 s65, s65, s69
    s_lshl_b32 s65, s65, 2
    s_add_u32 s65, s65, s28
    s_mul_i32 s65, s65, 41
    v_min_u32 v251, 40, v0
    v_add_u32 v251, s65, v251
    v_min_u32 v251, 5183, v251
    v_lshlrev_b32 v251, 7, v251
    s_mul_i32 s65, s68, 663552
    s_and_b32 s77, s29, 1
    s_cmp_eq_u32 s77, 0
    s_cselect_b32 s96, s65, 0x40000000
    s_cmp_eq_u32 s77, 1
    s_cselect_b32 s97, s65, 0x40000000
    s_add_u32 s51, s46, 0
    buffer_load_dwordx4 a[0:3], v23, s[20:23], s51 offen offset:0 sc1
    buffer_load_dwordx4 a[4:7], v23, s[20:23], s51 offen offset:1024 sc1
    buffer_load_dwordx4 a[8:11], v23, s[20:23], s51 offen offset:2048 sc1
    buffer_load_dwordx4 a[12:15], v23, s[20:23], s51 offen offset:3072 sc1
    s_add_u32 s51, s46, 4096
    buffer_load_dwordx4 a[16:19], v23, s[20:23], s51 offen offset:0 sc1
    buffer_load_dwordx4 a[20:23], v23, s[20:23], s51 offen offset:1024 sc1
    buffer_load_dwordx4 a[24:27], v23, s[20:23], s51 offen offset:2048 sc1
    buffer_load_dwordx4 a[28:31], v23, s[20:23], s51 offen offset:3072 sc1
    s_add_u32 s51, s46, 8192
    buffer_load_dwordx4 a[32:35], v23, s[20:23], s51 offen offset:0 sc1
    buffer_load_dwordx4 a[36:39], v23, s[20:23], s51 offen offset:1024 sc1
    buffer_load_dwordx4 a[40:43], v23, s[20:23], s51 offen offset:2048 sc1
    buffer_load_dwordx4 a[44:47], v23, s[20:23], s51 offen offset:3072 sc1
    ds_read_b64_tr_b16 a[216:217], v13 offset:24576
    ds_read_b64_tr_b16 a[218:219], v13 offset:26624
    ds_read_b64_tr_b16 a[220:221], v14 offset:24576
    ds_read_b64_tr_b16 a[222:223], v14 offset:26624
    ds_read_b64_tr_b16 a[224:225], v15 offset:24576
    ds_read_b64_tr_b16 a[226:227], v15 offset:26624
    ds_read_b64_tr_b16 a[228:229], v16 offset:24576
    ds_read_b64_tr_b16 a[230:231], v16 offset:26624
    ds_read_b64_tr_b16 a[232:233], v13 offset:28672
    ds_read_b64_tr_b16 a[234:235], v13 offset:30720
    ds_read_b64_tr_b16 a[236:237], v14 offset:28672
    ds_read_b64_tr_b16 a[238:239], v14 offset:30720
    ds_read_b64_tr_b16 a[240:241], v15 offset:28672
    ds_read_b64_tr_b16 a[242:243], v15 offset:30720
    s_waitcnt vmcnt(11) lgkmcnt(12)
    v_mfma_f32_16x16x32_bf16 v[112:115], a[216:219], a[0:3], 0
    s_waitcnt vmcnt(10)
    ds_read_b64_tr_b16 a[244:245], v16 offset:28672
    v_mfma_f32_16x16x32_bf16 v[120:123], a[216:219], a[4:7], 0
    s_waitcnt lgkmcnt(9)
    ds_read_b64_tr_b16 a[246:247], v16 offset:30720
    v_mfma_f32_16x16x32_bf16 v[116:119], a[220:223], a[0:3], 0
    s_add_u32 s51, s46, 12288
    ds_read_b64_tr_b16 a[248:249], v13 offset:32768
    buffer_load_dwordx4 a[48:51], v23, s[20:23], s51 offen offset:0 sc1
    v_mfma_f32_16x16x32_bf16 v[124:127], a[220:223], a[4:7], 0
    ds_read_b64_tr_b16 a[250:251], v13 offset:34816
    v_mfma_f32_16x16x32_bf16 v[128:131], a[224:227], a[0:3], 0
    ds_read_b64_tr_b16 a[252:253], v14 offset:32768
    v_mfma_f32_16x16x32_bf16 v[136:139], a[224:227], a[4:7], 0
    s_waitcnt lgkmcnt(9)
    ds_read_b64_tr_b16 a[254:255], v14 offset:34816
    v_mfma_f32_16x16x32_bf16 v[132:135], a[228:231], a[0:3], 0
    ds_read_b64_tr_b16 a[216:217], v15 offset:32768
    buffer_load_dwordx4 a[52:55], v23, s[20:23], s51 offen offset:1024 sc1
    v_mfma_f32_16x16x32_bf16 v[140:143], a[228:231], a[4:7], 0
    s_waitcnt vmcnt(10)
    ds_read_b64_tr_b16 a[218:219], v15 offset:34816
    v_mfma_f32_16x16x32_bf16 v[112:115], a[232:235], a[8:11], v[112:115]
    ds_read_b64_tr_b16 a[220:221], v16 offset:32768
    v_mfma_f32_16x16x32_bf16 v[120:123], a[232:235], a[12:15], v[120:123]
    s_waitcnt lgkmcnt(9)
    ds_read_b64_tr_b16 a[222:223], v16 offset:34816
    v_mfma_f32_16x16x32_bf16 v[116:119], a[236:239], a[8:11], v[116:119]
    ds_read_b64_tr_b16 a[224:225], v13 offset:36864
    buffer_load_dwordx4 a[56:59], v23, s[20:23], s51 offen offset:2048 sc1
    v_mfma_f32_16x16x32_bf16 v[124:127], a[236:239], a[12:15], v[124:127]
    ds_read_b64_tr_b16 a[226:227], v13 offset:38912
    v_mfma_f32_16x16x32_bf16 v[128:131], a[240:243], a[8:11], v[128:131]
    ds_read_b64_tr_b16 a[228:229], v14 offset:36864
    v_mfma_f32_16x16x32_bf16 v[136:139], a[240:243], a[12:15], v[136:139]
    s_waitcnt lgkmcnt(9)
    ds_read_b64_tr_b16 a[230:231], v14 offset:38912
    v_mfma_f32_16x16x32_bf16 v[132:135], a[244:247], a[8:11], v[132:135]
    ds_read_b64_tr_b16 a[232:233], v15 offset:36864
    buffer_load_dwordx4 a[60:63], v23, s[20:23], s51 offen offset:3072 sc1
    v_mfma_f32_16x16x32_bf16 v[140:143], a[244:247], a[12:15], v[140:143]
    s_waitcnt vmcnt(10)
    ds_read_b64_tr_b16 a[234:235], v15 offset:38912
    v_mfma_f32_16x16x32_bf16 v[112:115], a[248:251], a[16:19], v[112:115]
    s_add_u32 s51, s46, 16384
    ds_read_b64_tr_b16 a[236:237], v16 offset:36864
    v_mfma_f32_16x16x32_bf16 v[120:123], a[248:251], a[20:23], v[120:123]
    s_waitcnt lgkmcnt(9)
    ds_read_b64_tr_b16 a[238:239], v16 offset:38912
    v_mfma_f32_16x16x32_bf16 v[116:119], a[252:255], a[16:19], v[116:119]
    ds_read_b64_tr_b16 a[240:241], v13 offset:40960
    buffer_load_dwordx4 a[64:67], v23, s[20:23], s51 offen offset:0 sc1
    v_mfma_f32_16x16x32_bf16 v[124:127], a[252:255], a[20:23], v[124:127]
    ds_read_b64_tr_b16 a[242:243], v13 offset:43008
    v_mfma_f32_16x16x32_bf16 v[128:131], a[216:219], a[16:19], v[128:131]
    ds_read_b64_tr_b16 a[244:245], v14 offset:40960
    v_mfma_f32_16x16x32_bf16 v[136:139], a[216:219], a[20:23], v[136:139]
    s_waitcnt lgkmcnt(9)
    ds_read_b64_tr_b16 a[246:247], v14 offset:43008
    v_mfma_f32_16x16x32_bf16 v[132:135], a[220:223], a[16:19], v[132:135]
    ds_read_b64_tr_b16 a[248:249], v15 offset:40960
    buffer_load_dwordx4 a[68:71], v23, s[20:23], s51 offen offset:1024 sc1
    v_mfma_f32_16x16x32_bf16 v[140:143], a[220:223], a[20:23], v[140:143]
    s_waitcnt vmcnt(10)
    ds_read_b64_tr_b16 a[250:251], v15 offset:43008
    v_mfma_f32_16x16x32_bf16 v[112:115], a[224:227], a[24:27], v[112:115]
    ds_read_b64_tr_b16 a[252:253], v16 offset:40960
    v_mfma_f32_16x16x32_bf16 v[120:123], a[224:227], a[28:31], v[120:123]
    s_waitcnt lgkmcnt(9)
    ds_read_b64_tr_b16 a[254:255], v16 offset:43008
    v_mfma_f32_16x16x32_bf16 v[116:119], a[228:231], a[24:27], v[116:119]
    ds_read_b64_tr_b16 a[216:217], v13 offset:45056
    buffer_load_dwordx4 a[72:75], v23, s[20:23], s51 offen offset:2048 sc1
    v_mfma_f32_16x16x32_bf16 v[124:127], a[228:231], a[28:31], v[124:127]
    ds_read_b64_tr_b16 a[218:219], v13 offset:47104
    v_mfma_f32_16x16x32_bf16 v[128:131], a[232:235], a[24:27], v[128:131]
    ds_read_b64_tr_b16 a[220:221], v14 offset:45056
    v_mfma_f32_16x16x32_bf16 v[136:139], a[232:235], a[28:31], v[136:139]
    s_waitcnt lgkmcnt(9)
    ds_read_b64_tr_b16 a[222:223], v14 offset:47104
    v_mfma_f32_16x16x32_bf16 v[132:135], a[236:239], a[24:27], v[132:135]
    ds_read_b64_tr_b16 a[224:225], v15 offset:45056
    buffer_load_dwordx4 a[76:79], v23, s[20:23], s51 offen offset:3072 sc1
    v_mfma_f32_16x16x32_bf16 v[140:143], a[236:239], a[28:31], v[140:143]
    s_waitcnt vmcnt(10)
    ds_read_b64_tr_b16 a[226:227], v15 offset:47104
    v_mfma_f32_16x16x32_bf16 v[112:115], a[240:243], a[32:35], v[112:115]
    s_add_u32 s51, s46, 20480
    ds_read_b64_tr_b16 a[228:229], v16 offset:45056
    v_mfma_f32_16x16x32_bf16 v[120:123], a[240:243], a[36:39], v[120:123]
    s_waitcnt lgkmcnt(9)
    ds_read_b64_tr_b16 a[230:231], v16 offset:47104
    v_mfma_f32_16x16x32_bf16 v[116:119], a[244:247], a[32:35], v[116:119]
    ds_read_b64_tr_b16 a[232:233], v17 offset:0
    buffer_load_dwordx4 a[80:83], v23, s[20:23], s51 offen offset:0 sc1
    v_mfma_f32_16x16x32_bf16 v[124:127], a[244:247], a[36:39], v[124:127]
    ds_read_b64_tr_b16 a[234:235], v17 offset:2048
    v_mfma_f32_16x16x32_bf16 v[128:131], a[248:251], a[32:35], v[128:131]
    ds_read_b64_tr_b16 a[236:237], v18 offset:0
    v_mfma_f32_16x16x32_bf16 v[136:139], a[248:251], a[36:39], v[136:139]
    s_waitcnt lgkmcnt(9)
    ds_read_b64_tr_b16 a[238:239], v18 offset:2048
    v_mfma_f32_16x16x32_bf16 v[132:135], a[252:255], a[32:35], v[132:135]
    ds_read_b64_tr_b16 a[240:241], v19 offset:0
    buffer_load_dwordx4 a[84:87], v23, s[20:23], s51 offen offset:1024 sc1
    v_mfma_f32_16x16x32_bf16 v[140:143], a[252:255], a[36:39], v[140:143]
    s_waitcnt vmcnt(10)
    ds_read_b64_tr_b16 a[242:243], v19 offset:2048
    v_mfma_f32_16x16x32_bf16 v[112:115], a[216:219], a[40:43], v[112:115]
    ds_read_b64_tr_b16 a[244:245], v20 offset:0
    v_mfma_f32_16x16x32_bf16 v[120:123], a[216:219], a[44:47], v[120:123]
    s_waitcnt lgkmcnt(9)
    ds_read_b64_tr_b16 a[246:247], v20 offset:2048
    v_mfma_f32_16x16x32_bf16 v[116:119], a[220:223], a[40:43], v[116:119]
    ds_read_b64_tr_b16 a[248:249], v17 offset:4096
    buffer_load_dwordx4 a[88:91], v23, s[20:23], s51 offen offset:2048 sc1
    v_mfma_f32_16x16x32_bf16 v[124:127], a[220:223], a[44:47], v[124:127]
    ds_read_b64_tr_b16 a[250:251], v17 offset:6144
    v_mfma_f32_16x16x32_bf16 v[128:131], a[224:227], a[40:43], v[128:131]
    ds_read_b64_tr_b16 a[252:253], v18 offset:4096
    v_mfma_f32_16x16x32_bf16 v[136:139], a[224:227], a[44:47], v[136:139]
    s_waitcnt lgkmcnt(9)
    ds_read_b64_tr_b16 a[254:255], v18 offset:6144
    v_mfma_f32_16x16x32_bf16 v[132:135], a[228:231], a[40:43], v[132:135]
    ds_read_b64_tr_b16 a[216:217], v19 offset:4096
    buffer_load_dwordx4 a[92:95], v23, s[20:23], s51 offen offset:3072 sc1
    v_mfma_f32_16x16x32_bf16 v[140:143], a[228:231], a[44:47], v[140:143]
    s_waitcnt vmcnt(10)
    ds_read_b64_tr_b16 a[218:219], v19 offset:6144
    v_mfma_f32_16x16x32_bf16 v[112:115], a[232:235], a[48:51], v[112:115]
    s_add_u32 s51, s46, 24576
    ds_read_b64_tr_b16 a[220:221], v20 offset:4096
    v_mfma_f32_16x16x32_bf16 v[120:123], a[232:235], a[52:55], v[120:123]
    s_waitcnt lgkmcnt(9)
    ds_read_b64_tr_b16 a[222:223], v20 offset:6144
    v_mfma_f32_16x16x32_bf16 v[116:119], a[236:239], a[48:51], v[116:119]
    ds_read_b64_tr_b16 a[224:225], v17 offset:8192
    buffer_load_dwordx4 a[96:99], v23, s[20:23], s51 offen offset:0 sc1
    v_mfma_f32_16x16x32_bf16 v[124:127], a[236:239], a[52:55], v[124:127]
    ds_read_b64_tr_b16 a[226:227], v17 offset:10240
    v_mfma_f32_16x16x32_bf16 v[128:131], a[240:243], a[48:51], v[128:131]
    ds_read_b64_tr_b16 a[228:229], v18 offset:8192
    v_mfma_f32_16x16x32_bf16 v[136:139], a[240:243], a[52:55], v[136:139]
    s_waitcnt lgkmcnt(9)
    ds_read_b64_tr_b16 a[230:231], v18 offset:10240
    v_mfma_f32_16x16x32_bf16 v[132:135], a[244:247], a[48:51], v[132:135]
    ds_read_b64_tr_b16 a[232:233], v19 offset:8192
    buffer_load_dwordx4 a[100:103], v23, s[20:23], s51 offen offset:1024 sc1
    v_mfma_f32_16x16x32_bf16 v[140:143], a[244:247], a[52:55], v[140:143]
    s_waitcnt vmcnt(10)
    ds_read_b64_tr_b16 a[234:235], v19 offset:10240
    v_mfma_f32_16x16x32_bf16 v[112:115], a[248:251], a[56:59], v[112:115]
    ds_read_b64_tr_b16 a[236:237], v20 offset:8192
    v_mfma_f32_16x16x32_bf16 v[120:123], a[248:251], a[60:63], v[120:123]
    s_waitcnt lgkmcnt(9)
    ds_read_b64_tr_b16 a[238:239], v20 offset:10240
    v_mfma_f32_16x16x32_bf16 v[116:119], a[252:255], a[56:59], v[116:119]
    buffer_load_dwordx4 a[104:107], v23, s[20:23], s51 offen offset:2048 sc1
    v_mfma_f32_16x16x32_bf16 v[124:127], a[252:255], a[60:63], v[124:127]
    v_mfma_f32_16x16x32_bf16 v[128:131], a[216:219], a[56:59], v[128:131]
    v_mfma_f32_16x16x32_bf16 v[136:139], a[216:219], a[60:63], v[136:139]
    s_waitcnt lgkmcnt(0)
    s_barrier
    ds_read_b64_tr_b16 a[240:241], v17 offset:12288
    ds_read_b64_tr_b16 a[242:243], v17 offset:14336
    v_mfma_f32_16x16x32_bf16 v[132:135], a[220:223], a[56:59], v[132:135]
    ds_read_b64_tr_b16 a[244:245], v18 offset:12288
    ds_read_b64_tr_b16 a[246:247], v18 offset:14336
    v_mfma_f32_16x16x32_bf16 v[140:143], a[220:223], a[60:63], v[140:143]
    s_waitcnt vmcnt(9)
    ds_read_b64_tr_b16 a[248:249], v19 offset:12288
    buffer_load_dwordx4 a[108:111], v23, s[20:23], s51 offen offset:3072 sc1
    v_mfma_f32_16x16x32_bf16 v[112:115], a[224:227], a[64:67], v[112:115]
    s_add_u32 s51, s46, 28672
    ds_read_b64_tr_b16 a[250:251], v19 offset:14336
    v_mfma_f32_16x16x32_bf16 v[120:123], a[224:227], a[68:71], v[120:123]
    ds_read_b64_tr_b16 a[252:253], v20 offset:12288
    v_mfma_f32_16x16x32_bf16 v[116:119], a[228:231], a[64:67], v[116:119]
    ds_read_b64_tr_b16 a[254:255], v20 offset:14336
    v_mfma_f32_16x16x32_bf16 v[124:127], a[228:231], a[68:71], v[124:127]
    ds_read_b64_tr_b16 a[216:217], v17 offset:16384
    buffer_load_dwordx4 a[112:115], v23, s[20:23], s51 offen offset:0 sc1
    v_mfma_f32_16x16x32_bf16 v[128:131], a[232:235], a[64:67], v[128:131]
    ds_read_b64_tr_b16 a[218:219], v17 offset:18432
    v_mfma_f32_16x16x32_bf16 v[136:139], a[232:235], a[68:71], v[136:139]
    ds_read_b64_tr_b16 a[220:221], v18 offset:16384
    v_mfma_f32_16x16x32_bf16 v[132:135], a[236:239], a[64:67], v[132:135]
    ds_read_b64_tr_b16 a[222:223], v18 offset:18432
    v_mfma_f32_16x16x32_bf16 v[140:143], a[236:239], a[68:71], v[140:143]
    s_waitcnt vmcnt(9) lgkmcnt(8)
    ds_read_b64_tr_b16 a[224:225], v19 offset:16384
    buffer_load_dwordx4 a[116:119], v23, s[20:23], s51 offen offset:1024 sc1
    v_mfma_f32_16x16x32_bf16 v[112:115], a[240:243], a[72:75], v[112:115]
    ds_read_b64_tr_b16 a[226:227], v19 offset:18432
    v_mfma_f32_16x16x32_bf16 v[120:123], a[240:243], a[76:79], v[120:123]
    ds_read_b64_tr_b16 a[228:229], v20 offset:16384
    v_mfma_f32_16x16x32_bf16 v[116:119], a[244:247], a[72:75], v[116:119]
    ds_read_b64_tr_b16 a[230:231], v20 offset:18432
    v_mfma_f32_16x16x32_bf16 v[124:127], a[244:247], a[76:79], v[124:127]
    s_waitcnt lgkmcnt(8)
    ds_read_b64_tr_b16 a[232:233], v17 offset:20480
    buffer_load_dwordx4 a[120:123], v23, s[20:23], s51 offen offset:2048 sc1
    v_mfma_f32_16x16x32_bf16 v[128:131], a[248:251], a[72:75], v[128:131]
    ds_read_b64_tr_b16 a[234:235], v17 offset:22528
    v_mfma_f32_16x16x32_bf16 v[136:139], a[248:251], a[76:79], v[136:139]
    ds_read_b64_tr_b16 a[236:237], v18 offset:20480
    v_mfma_f32_16x16x32_bf16 v[132:135], a[252:255], a[72:75], v[132:135]
    ds_read_b64_tr_b16 a[238:239], v18 offset:22528
    v_mfma_f32_16x16x32_bf16 v[140:143], a[252:255], a[76:79], v[140:143]
    s_waitcnt vmcnt(9) lgkmcnt(8)
    ds_read_b64_tr_b16 a[240:241], v19 offset:20480
    buffer_load_dwordx4 a[124:127], v23, s[20:23], s51 offen offset:3072 sc1
    v_mfma_f32_16x16x32_bf16 v[112:115], a[216:219], a[80:83], v[112:115]
    s_add_u32 s51, s46, 32768
    ds_read_b64_tr_b16 a[242:243], v19 offset:22528
    v_mfma_f32_16x16x32_bf16 v[120:123], a[216:219], a[84:87], v[120:123]
    ds_read_b64_tr_b16 a[244:245], v20 offset:20480
    v_mfma_f32_16x16x32_bf16 v[116:119], a[220:223], a[80:83], v[116:119]
    ds_read_b64_tr_b16 a[246:247], v20 offset:22528
    v_mfma_f32_16x16x32_bf16 v[124:127], a[220:223], a[84:87], v[124:127]
    s_waitcnt lgkmcnt(8)
    ds_read_b64_tr_b16 a[248:249], v17 offset:24576
    buffer_load_dwordx4 a[128:131], v23, s[20:23], s51 offen offset:0 sc1
    v_mfma_f32_16x16x32_bf16 v[128:131], a[224:227], a[80:83], v[128:131]
    ds_read_b64_tr_b16 a[250:251], v17 offset:26624
    v_mfma_f32_16x16x32_bf16 v[136:139], a[224:227], a[84:87], v[136:139]
    ds_read_b64_tr_b16 a[252:253], v18 offset:24576
    v_mfma_f32_16x16x32_bf16 v[132:135], a[228:231], a[80:83], v[132:135]
    ds_read_b64_tr_b16 a[254:255], v18 offset:26624
    v_mfma_f32_16x16x32_bf16 v[140:143], a[228:231], a[84:87], v[140:143]
    s_waitcnt vmcnt(9) lgkmcnt(8)
    ds_read_b64_tr_b16 a[216:217], v19 offset:24576
    buffer_load_dwordx4 a[132:135], v23, s[20:23], s51 offen offset:1024 sc1
    v_mfma_f32_16x16x32_bf16 v[112:115], a[232:235], a[88:91], v[112:115]
    ds_read_b64_tr_b16 a[218:219], v19 offset:26624
    v_mfma_f32_16x16x32_bf16 v[120:123], a[232:235], a[92:95], v[120:123]
    ds_read_b64_tr_b16 a[220:221], v20 offset:24576
    v_mfma_f32_16x16x32_bf16 v[116:119], a[236:239], a[88:91], v[116:119]
    ds_read_b64_tr_b16 a[222:223], v20 offset:26624
    v_mfma_f32_16x16x32_bf16 v[124:127], a[236:239], a[92:95], v[124:127]
    s_waitcnt lgkmcnt(8)
    ds_read_b64_tr_b16 a[224:225], v17 offset:28672
    buffer_load_dwordx4 a[136:139], v23, s[20:23], s51 offen offset:2048 sc1
    v_mfma_f32_16x16x32_bf16 v[128:131], a[240:243], a[88:91], v[128:131]
    ds_read_b64_tr_b16 a[226:227], v17 offset:30720
    v_mfma_f32_16x16x32_bf16 v[136:139], a[240:243], a[92:95], v[136:139]
    ds_read_b64_tr_b16 a[228:229], v18 offset:28672
    v_mfma_f32_16x16x32_bf16 v[132:135], a[244:247], a[88:91], v[132:135]
    ds_read_b64_tr_b16 a[230:231], v18 offset:30720
    v_mfma_f32_16x16x32_bf16 v[140:143], a[244:247], a[92:95], v[140:143]
    s_waitcnt vmcnt(9) lgkmcnt(8)
    ds_read_b64_tr_b16 a[232:233], v19 offset:28672
    buffer_load_dwordx4 a[140:143], v23, s[20:23], s51 offen offset:3072 sc1
    v_mfma_f32_16x16x32_bf16 v[112:115], a[248:251], a[96:99], v[112:115]
    ds_read_b64_tr_b16 a[234:235], v19 offset:30720
    buffer_load_dword v40, v39, s[20:23], s64 offen offset:0 sc1
    v_mfma_f32_16x16x32_bf16 v[120:123], a[248:251], a[100:103], v[120:123]
    ds_read_b64_tr_b16 a[236:237], v20 offset:28672
    buffer_load_dword v41, v39, s[20:23], s64 offen offset:256 sc1
    v_mfma_f32_16x16x32_bf16 v[116:119], a[252:255], a[96:99], v[116:119]
    ds_read_b64_tr_b16 a[238:239], v20 offset:30720
    buffer_load_dword v42, v39, s[20:23], s64 offen offset:512 sc1
    v_mfma_f32_16x16x32_bf16 v[124:127], a[252:255], a[100:103], v[124:127]
    s_waitcnt lgkmcnt(8)
    ds_read_b64_tr_b16 a[240:241], v17 offset:32768
    buffer_load_dword v43, v39, s[20:23], s64 offen offset:768 sc1
    v_mfma_f32_16x16x32_bf16 v[128:131], a[216:219], a[96:99], v[128:131]
    ds_read_b64_tr_b16 a[242:243], v17 offset:34816
    buffer_load_dword v44, v39, s[20:23], s64 offen offset:1024 sc1
    v_mfma_f32_16x16x32_bf16 v[136:139], a[216:219], a[100:103], v[136:139]
    ds_read_b64_tr_b16 a[244:245], v18 offset:32768
    buffer_load_dword v45, v39, s[20:23], s64 offen offset:1280 sc1
    v_mfma_f32_16x16x32_bf16 v[132:135], a[220:223], a[96:99], v[132:135]
    ds_read_b64_tr_b16 a[246:247], v18 offset:34816
    buffer_load_dword v46, v39, s[20:23], s64 offen offset:1536 sc1
    v_mfma_f32_16x16x32_bf16 v[140:143], a[220:223], a[100:103], v[140:143]
    s_waitcnt vmcnt(15) lgkmcnt(8)
    ds_read_b64_tr_b16 a[248:249], v19 offset:32768
    buffer_load_dword v47, v39, s[20:23], s64 offen offset:1792 sc1
    v_mfma_f32_16x16x32_bf16 v[112:115], a[224:227], a[104:107], v[112:115]
    ds_read_b64_tr_b16 a[250:251], v19 offset:34816
    buffer_load_dword v48, v39, s[20:23], s64 offen offset:2048 sc1
    v_mfma_f32_16x16x32_bf16 v[120:123], a[224:227], a[108:111], v[120:123]
    s_add_u32 m0, s33, 36864
    ds_read_b64_tr_b16 a[252:253], v20 offset:32768
    v_mfma_f32_16x16x32_bf16 v[116:119], a[228:231], a[104:107], v[116:119]
    s_add_u32 s32, s38, 2654208
    ds_read_b64_tr_b16 a[254:255], v20 offset:34816
    v_mfma_f32_16x16x32_bf16 v[124:127], a[228:231], a[108:111], v[124:127]
    s_waitcnt lgkmcnt(8)
    ds_read_b64_tr_b16 a[216:217], v17 offset:36864
    v_mfma_f32_16x16x32_bf16 v[128:131], a[232:235], a[104:107], v[128:131]
    ds_read_b64_tr_b16 a[218:219], v17 offset:38912
    buffer_load_dwordx4 v1, s[4:7], s32 offen offset:0 lds
    v_mfma_f32_16x16x32_bf16 v[136:139], a[232:235], a[108:111], v[136:139]
    ds_read_b64_tr_b16 a[220:221], v18 offset:36864
    v_mfma_f32_16x16x32_bf16 v[132:135], a[236:239], a[104:107], v[132:135]
    ds_read_b64_tr_b16 a[222:223], v18 offset:38912
    v_mfma_f32_16x16x32_bf16 v[140:143], a[236:239], a[108:111], v[140:143]
    s_waitcnt vmcnt(16) lgkmcnt(8)
    ds_read_b64_tr_b16 a[224:225], v19 offset:36864
    v_mfma_f32_16x16x32_bf16 v[112:115], a[240:243], a[112:115], v[112:115]
    ds_read_b64_tr_b16 a[226:227], v19 offset:38912
    buffer_load_dwordx4 v2, s[4:7], s32 offen offset:1024 lds
    v_mfma_f32_16x16x32_bf16 v[120:123], a[240:243], a[116:119], v[120:123]
    ds_read_b64_tr_b16 a[228:229], v20 offset:36864
    v_mfma_f32_16x16x32_bf16 v[116:119], a[244:247], a[112:115], v[116:119]
    ds_read_b64_tr_b16 a[230:231], v20 offset:38912
    v_mfma_f32_16x16x32_bf16 v[124:127], a[244:247], a[116:119], v[124:127]
    s_waitcnt lgkmcnt(8)
    ds_read_b64_tr_b16 a[232:233], v17 offset:40960
    v_mfma_f32_16x16x32_bf16 v[128:131], a[248:251], a[112:115], v[128:131]
    ds_read_b64_tr_b16 a[234:235], v17 offset:43008
    buffer_load_dwordx4 v3, s[4:7], s32 offen offset:2048 lds
    v_mfma_f32_16x16x32_bf16 v[136:139], a[248:251], a[116:119], v[136:139]
    ds_read_b64_tr_b16 a[236:237], v18 offset:40960
    v_mfma_f32_16x16x32_bf16 v[132:135], a[252:255], a[112:115], v[132:135]
    ds_read_b64_tr_b16 a[238:239], v18 offset:43008
    v_mfma_f32_16x16x32_bf16 v[140:143], a[252:255], a[116:119], v[140:143]
    s_waitcnt vmcnt(16) lgkmcnt(8)
    ds_read_b64_tr_b16 a[240:241], v19 offset:40960
    v_mfma_f32_16x16x32_bf16 v[112:115], a[216:219], a[120:123], v[112:115]
    ds_read_b64_tr_b16 a[242:243], v19 offset:43008
    buffer_load_dwordx4 v4, s[4:7], s32 offen offset:3072 lds
    v_mfma_f32_16x16x32_bf16 v[120:123], a[216:219], a[124:127], v[120:123]
    s_add_u32 m0, s33, 40960
    ds_read_b64_tr_b16 a[244:245], v20 offset:40960
    v_mfma_f32_16x16x32_bf16 v[116:119], a[220:223], a[120:123], v[116:119]
    s_add_u32 s32, s38, 2949120
    ds_read_b64_tr_b16 a[246:247], v20 offset:43008
    v_mfma_f32_16x16x32_bf16 v[124:127], a[220:223], a[124:127], v[124:127]
    s_waitcnt lgkmcnt(8)
    ds_read_b64_tr_b16 a[248:249], v17 offset:45056
    v_mfma_f32_16x16x32_bf16 v[128:131], a[224:227], a[120:123], v[128:131]
    ds_read_b64_tr_b16 a[250:251], v17 offset:47104
    buffer_load_dwordx4 v1, s[4:7], s32 offen offset:0 lds
    v_mfma_f32_16x16x32_bf16 v[136:139], a[224:227], a[124:127], v[136:139]
    ds_read_b64_tr_b16 a[252:253], v18 offset:45056
    v_mfma_f32_16x16x32_bf16 v[132:135], a[228:231], a[120:123], v[132:135]
    ds_read_b64_tr_b16 a[254:255], v18 offset:47104
    v_mfma_f32_16x16x32_bf16 v[140:143], a[228:231], a[124:127], v[140:143]
    s_waitcnt vmcnt(16) lgkmcnt(8)
    ds_read_b64_tr_b16 a[216:217], v19 offset:45056
    v_mfma_f32_16x16x32_bf16 v[112:115], a[232:235], a[128:131], v[112:115]
    ds_read_b64_tr_b16 a[218:219], v19 offset:47104
    buffer_load_dwordx4 v2, s[4:7], s32 offen offset:1024 lds
    v_mfma_f32_16x16x32_bf16 v[120:123], a[232:235], a[132:135], v[120:123]
    ds_read_b64_tr_b16 a[220:221], v20 offset:45056
    v_mfma_f32_16x16x32_bf16 v[116:119], a[236:239], a[128:131], v[116:119]
    ds_read_b64_tr_b16 a[222:223], v20 offset:47104
    v_mfma_f32_16x16x32_bf16 v[124:127], a[236:239], a[132:135], v[124:127]
    s_waitcnt lgkmcnt(8)
    v_mfma_f32_16x16x32_bf16 v[128:131], a[240:243], a[128:131], v[128:131]
    buffer_load_dwordx4 v3, s[4:7], s32 offen offset:2048 lds
    v_mfma_f32_16x16x32_bf16 v[136:139], a[240:243], a[132:135], v[136:139]
    s_waitcnt lgkmcnt(0)
    s_barrier
    ds_read_b64_tr_b16 a[224:225], v9 offset:0
    ds_read_b64_tr_b16 a[226:227], v9 offset:2048
    v_mfma_f32_16x16x32_bf16 v[132:135], a[244:247], a[128:131], v[132:135]
    ds_read_b64_tr_b16 a[228:229], v10 offset:0
    ds_read_b64_tr_b16 a[230:231], v10 offset:2048
    v_mfma_f32_16x16x32_bf16 v[140:143], a[244:247], a[132:135], v[140:143]
    s_waitcnt vmcnt(16)
    ds_read_b64_tr_b16 a[232:233], v11 offset:0
    v_mfma_f32_16x16x32_bf16 v[112:115], a[248:251], a[136:139], v[112:115]
    ds_read_b64_tr_b16 a[234:235], v11 offset:2048
    buffer_load_dwordx4 v4, s[4:7], s32 offen offset:3072 lds
    v_mfma_f32_16x16x32_bf16 v[120:123], a[248:251], a[140:143], v[120:123]
    s_add_u32 m0, s33, 45056
    ds_read_b64_tr_b16 a[236:237], v12 offset:0
    v_mfma_f32_16x16x32_bf16 v[116:119], a[252:255], a[136:139], v[116:119]
    s_add_u32 s32, s38, 3244032
    ds_read_b64_tr_b16 a[238:239], v12 offset:2048
    v_mfma_f32_16x16x32_bf16 v[124:127], a[252:255], a[140:143], v[124:127]
    ds_read_b64_tr_b16 a[240:241], v9 offset:4096
    v_mfma_f32_16x16x32_bf16 v[128:131], a[216:219], a[136:139], v[128:131]
    s_waitcnt vmcnt(8)
    ds_read_b64_tr_b16 a[242:243], v9 offset:6144
    buffer_load_dwordx4 v1, s[4:7], s32 offen offset:0 lds
    v_add_f32 v40, v40, v41
    v_add_f32 v40, v40, v42
    v_mfma_f32_16x16x32_bf16 v[136:139], a[216:219], a[140:143], v[136:139]
    s_add_u32 m0, s33, 73728
    ds_read_b64_tr_b16 a[244:245], v10 offset:4096
    v_add_f32 v40, v40, v43
    v_add_f32 v40, v40, v44
    v_mfma_f32_16x16x32_bf16 v[132:135], a[220:223], a[136:139], v[132:135]
    s_add_u32 s32, s38, 128
    ds_read_b64_tr_b16 a[246:247], v10 offset:6144
    v_add_f32 v40, v40, v45
    v_mfma_f32_16x16x32_bf16 v[140:143], a[220:223], a[140:143], v[140:143]
    s_waitcnt lgkmcnt(8)
    ds_read_b64_tr_b16 a[248:249], v11 offset:4096
    v_add_f32 v40, v40, v46
    v_mfma_f32_16x16x32_bf16 v[208:211], a[224:227], a[0:3], 0
    ds_read_b64_tr_b16 a[250:251], v11 offset:6144
    buffer_load_dwordx4 v1, s[12:15], s32 offen offset:0 lds
    v_add_f32 v40, v40, v47
    v_add_f32 v40, v40, v48
    v_mfma_f32_16x16x32_bf16 v[216:219], a[224:227], a[4:7], 0
    ds_read_b64_tr_b16 a[252:253], v12 offset:4096
    v_mov_b32 v41, v40
    v_mfma_f32_16x16x32_bf16 v[212:215], a[228:231], a[0:3], 0
    ds_read_b64_tr_b16 a[254:255], v12 offset:6144
    v_mfma_f32_16x16x32_bf16 v[220:223], a[228:231], a[4:7], 0
    s_waitcnt lgkmcnt(8)
    ds_read_b64_tr_b16 a[216:217], v9 offset:8192
    v_permlane32_swap_b32 v40, v41
    v_mfma_f32_16x16x32_bf16 v[224:227], a[232:235], a[0:3], 0
    ds_read_b64_tr_b16 a[218:219], v9 offset:10240
    buffer_load_dwordx4 v2, s[12:15], s32 offen offset:1024 lds
    v_mfma_f32_16x16x32_bf16 v[232:235], a[232:235], a[4:7], 0
    ds_read_b64_tr_b16 a[220:221], v10 offset:8192
    v_add_f32 v40, v40, v41
    v_mov_b32 v250, 0x3727c5ac
    v_mfma_f32_16x16x32_bf16 v[228:231], a[236:239], a[0:3], 0
    ds_read_b64_tr_b16 a[222:223], v10 offset:10240
    v_fmac_f32 v250, 0x3ae38e39, v40
    v_mov_b32 v252, v250
    v_mfma_f32_16x16x32_bf16 v[236:239], a[236:239], a[4:7], 0
    s_waitcnt lgkmcnt(8)
    ds_read_b64_tr_b16 a[224:225], v11 offset:8192
    v_mfma_f32_16x16x32_bf16 v[208:211], a[240:243], a[8:11], v[208:211]
    ds_read_b64_tr_b16 a[226:227], v11 offset:10240
    buffer_load_dwordx4 v3, s[12:15], s32 offen offset:2048 lds
    v_permlane16_swap_b32 v250, v252
    v_mfma_f32_16x16x32_bf16 v[216:219], a[240:243], a[12:15], v[216:219]
    ds_read_b64_tr_b16 a[228:229], v12 offset:8192
    v_mfma_f32_16x16x32_bf16 v[212:215], a[244:247], a[8:11], v[212:215]
    ds_read_b64_tr_b16 a[230:231], v12 offset:10240
    v_rsq_f32 v43, v250
    v_mfma_f32_16x16x32_bf16 v[220:223], a[244:247], a[12:15], v[220:223]
    s_waitcnt lgkmcnt(8)
    ds_read_b64_tr_b16 a[232:233], v9 offset:12288
    v_mfma_f32_16x16x32_bf16 v[224:227], a[248:251], a[8:11], v[224:227]
    ds_read_b64_tr_b16 a[234:235], v9 offset:14336
    buffer_load_dwordx4 v4, s[12:15], s32 offen offset:3072 lds
    v_mul_f32 v24, 0xc0135761, v43
    v_mul_f32 v44, v43, v43
    v_mfma_f32_16x16x32_bf16 v[232:235], a[248:251], a[12:15], v[232:235]
    s_add_u32 m0, s33, 77824
    ds_read_b64_tr_b16 a[236:237], v10 offset:12288
    v_mul_f32 v44, v44, v43
    v_mul_f32 v26, 0xbdd2d3e8, v44
    v_mfma_f32_16x16x32_bf16 v[228:231], a[252:255], a[8:11], v[228:231]
    s_add_u32 s32, s38, 295040
    ds_read_b64_tr_b16 a[238:239], v10 offset:14336
    v_rsq_f32 v43, v252
    v_mfma_f32_16x16x32_bf16 v[236:239], a[252:255], a[12:15], v[236:239]
    s_waitcnt lgkmcnt(8)
    ds_read_b64_tr_b16 a[240:241], v11 offset:12288
    v_mfma_f32_16x16x32_bf16 v[208:211], a[216:219], a[16:19], v[208:211]
    ds_read_b64_tr_b16 a[242:243], v11 offset:14336
    buffer_load_dwordx4 v1, s[12:15], s32 offen offset:0 lds
    v_mul_f32 v25, 0xc0135761, v43
    v_mul_f32 v44, v43, v43
    v_mfma_f32_16x16x32_bf16 v[216:219], a[216:219], a[20:23], v[216:219]
    ds_read_b64_tr_b16 a[244:245], v12 offset:12288
    v_mul_f32 v44, v44, v43
    v_mfma_f32_16x16x32_bf16 v[212:215], a[220:223], a[16:19], v[212:215]
    ds_read_b64_tr_b16 a[246:247], v12 offset:14336
    v_mul_f32 v27, 0xbdd2d3e8, v44
    v_mfma_f32_16x16x32_bf16 v[220:223], a[220:223], a[20:23], v[220:223]
    s_waitcnt lgkmcnt(8)
    ds_read_b64_tr_b16 a[248:249], v9 offset:16384
    v_mul_f32 v28, v112, v112
    v_mfma_f32_16x16x32_bf16 v[224:227], a[224:227], a[16:19], v[224:227]
    ds_read_b64_tr_b16 a[250:251], v9 offset:18432
    buffer_load_dwordx4 v2, s[12:15], s32 offen offset:1024 lds
    v_fma_f32 v28, v28, v26, v24
    v_mul_f32 v28, v28, v112
    v_mfma_f32_16x16x32_bf16 v[232:235], a[224:227], a[20:23], v[232:235]
    ds_read_b64_tr_b16 a[252:253], v10 offset:16384
    v_exp_f32 v28, v28
    v_mfma_f32_16x16x32_bf16 v[228:231], a[228:231], a[16:19], v[228:231]
    ds_read_b64_tr_b16 a[254:255], v10 offset:18432
    v_fma_f32 v28, v28, v250, v250
    v_mfma_f32_16x16x32_bf16 v[236:239], a[228:231], a[20:23], v[236:239]
    s_waitcnt lgkmcnt(8)
    ds_read_b64_tr_b16 a[216:217], v11 offset:16384
    v_mul_f32 v29, v113, v113
    v_mfma_f32_16x16x32_bf16 v[208:211], a[232:235], a[24:27], v[208:211]
    ds_read_b64_tr_b16 a[218:219], v11 offset:18432
    buffer_load_dwordx4 v3, s[12:15], s32 offen offset:2048 lds
    v_rcp_f32 v28, v28
    v_mfma_f32_16x16x32_bf16 v[216:219], a[232:235], a[28:31], v[216:219]
    ds_read_b64_tr_b16 a[220:221], v12 offset:16384
    v_mul_f32 v112, v112, v28
    v_mfma_f32_16x16x32_bf16 v[212:215], a[236:239], a[24:27], v[212:215]
    ds_read_b64_tr_b16 a[222:223], v12 offset:18432
    v_fma_f32 v29, v29, v26, v24
    v_mfma_f32_16x16x32_bf16 v[220:223], a[236:239], a[28:31], v[220:223]
    s_waitcnt lgkmcnt(8)
    ds_read_b64_tr_b16 a[224:225], v9 offset:20480
    v_mul_f32 v29, v29, v113
    v_mfma_f32_16x16x32_bf16 v[224:227], a[240:243], a[24:27], v[224:227]
    ds_read_b64_tr_b16 a[226:227], v9 offset:22528
    buffer_load_dwordx4 v4, s[12:15], s32 offen offset:3072 lds
    v_exp_f32 v29, v29
    v_mfma_f32_16x16x32_bf16 v[232:235], a[240:243], a[28:31], v[232:235]
    s_add_u32 m0, s33, 81920
    ds_read_b64_tr_b16 a[228:229], v10 offset:20480
    v_fma_f32 v29, v29, v250, v250
    v_mfma_f32_16x16x32_bf16 v[228:231], a[244:247], a[24:27], v[228:231]
    s_add_u32 s32, s38, 589952
    ds_read_b64_tr_b16 a[230:231], v10 offset:22528
    v_mul_f32 v30, v114, v114
    v_mfma_f32_16x16x32_bf16 v[236:239], a[244:247], a[28:31], v[236:239]
    s_waitcnt lgkmcnt(8)
    ds_read_b64_tr_b16 a[232:233], v11 offset:20480
    v_rcp_f32 v29, v29
    v_mfma_f32_16x16x32_bf16 v[208:211], a[248:251], a[32:35], v[208:211]
    ds_read_b64_tr_b16 a[234:235], v11 offset:22528
    buffer_load_dwordx4 v1, s[12:15], s32 offen offset:0 lds
    v_mfma_f32_16x16x32_bf16 v[216:219], a[248:251], a[36:39], v[216:219]
    s_add_u32 m0, s33, 110592
    ds_read_b64_tr_b16 a[236:237], v12 offset:20480
    v_mul_f32 v113, v113, v29
    v_mfma_f32_16x16x32_bf16 v[212:215], a[252:255], a[32:35], v[212:215]
    s_add_u32 s32, s38, 2654336
    ds_read_b64_tr_b16 a[238:239], v12 offset:22528
    v_fma_f32 v30, v30, v26, v24
    v_mfma_f32_16x16x32_bf16 v[220:223], a[252:255], a[36:39], v[220:223]
    s_waitcnt lgkmcnt(8)
    ds_read_b64_tr_b16 a[240:241], v9 offset:24576
    v_mul_f32 v30, v30, v114
    v_mul_f32 v31, v115, v115
    v_mfma_f32_16x16x32_bf16 v[224:227], a[216:219], a[32:35], v[224:227]
    ds_read_b64_tr_b16 a[242:243], v9 offset:26624
    buffer_load_dwordx4 v1, s[12:15], s32 offen offset:0 lds
    v_exp_f32 v30, v30
    v_mfma_f32_16x16x32_bf16 v[232:235], a[216:219], a[36:39], v[232:235]
    ds_read_b64_tr_b16 a[244:245], v10 offset:24576
    v_fma_f32 v30, v30, v250, v250
    v_mfma_f32_16x16x32_bf16 v[228:231], a[220:223], a[32:35], v[228:231]
    ds_read_b64_tr_b16 a[246:247], v10 offset:26624
    v_rcp_f32 v30, v30
    v_mfma_f32_16x16x32_bf16 v[236:239], a[220:223], a[36:39], v[236:239]
    s_waitcnt lgkmcnt(8)
    ds_read_b64_tr_b16 a[248:249], v11 offset:24576
    v_mul_f32 v114, v114, v30
    v_mfma_f32_16x16x32_bf16 v[208:211], a[224:227], a[40:43], v[208:211]
    ds_read_b64_tr_b16 a[250:251], v11 offset:26624
    buffer_load_dwordx4 v2, s[12:15], s32 offen offset:1024 lds
    v_mfma_f32_16x16x32_bf16 v[216:219], a[224:227], a[44:47], v[216:219]
    ds_read_b64_tr_b16 a[252:253], v12 offset:24576
    v_fma_f32 v31, v31, v26, v24
    v_mfma_f32_16x16x32_bf16 v[212:215], a[228:231], a[40:43], v[212:215]
    ds_read_b64_tr_b16 a[254:255], v12 offset:26624
    v_mul_f32 v31, v31, v115
    v_mul_f32 v32, v116, v116
    v_mfma_f32_16x16x32_bf16 v[220:223], a[228:231], a[44:47], v[220:223]
    s_waitcnt lgkmcnt(8)
    ds_read_b64_tr_b16 a[216:217], v9 offset:28672
    v_exp_f32 v31, v31
    v_mfma_f32_16x16x32_bf16 v[224:227], a[232:235], a[40:43], v[224:227]
    ds_read_b64_tr_b16 a[218:219], v9 offset:30720
    buffer_load_dwordx4 v3, s[12:15], s32 offen offset:2048 lds
    v_mfma_f32_16x16x32_bf16 v[232:235], a[232:235], a[44:47], v[232:235]
    ds_read_b64_tr_b16 a[220:221], v10 offset:28672
    v_fma_f32 v31, v31, v250, v250
    v_mfma_f32_16x16x32_bf16 v[228:231], a[236:239], a[40:43], v[228:231]
    ds_read_b64_tr_b16 a[222:223], v10 offset:30720
    v_rcp_f32 v31, v31
    v_mfma_f32_16x16x32_bf16 v[236:239], a[236:239], a[44:47], v[236:239]
    s_waitcnt lgkmcnt(8)
    ds_read_b64_tr_b16 a[224:225], v11 offset:28672
    v_mul_f32 v115, v115, v31
    v_mfma_f32_16x16x32_bf16 v[208:211], a[240:243], a[48:51], v[208:211]
    ds_read_b64_tr_b16 a[226:227], v11 offset:30720
    buffer_load_dwordx4 v4, s[12:15], s32 offen offset:3072 lds
    v_fma_f32 v32, v32, v26, v24
    v_mfma_f32_16x16x32_bf16 v[216:219], a[240:243], a[52:55], v[216:219]
    s_add_u32 m0, s33, 114688
    ds_read_b64_tr_b16 a[228:229], v12 offset:28672
    v_mul_f32 v32, v32, v116
    v_mul_f32 v33, v117, v117
    v_mfma_f32_16x16x32_bf16 v[212:215], a[244:247], a[48:51], v[212:215]
    s_add_u32 s32, s38, 2949248
    ds_read_b64_tr_b16 a[230:231], v12 offset:30720
    v_exp_f32 v32, v32
    v_mfma_f32_16x16x32_bf16 v[220:223], a[244:247], a[52:55], v[220:223]
    s_waitcnt lgkmcnt(8)
    ds_read_b64_tr_b16 a[232:233], v9 offset:32768
    v_fma_f32 v32, v32, v250, v250
    v_mfma_f32_16x16x32_bf16 v[224:227], a[248:251], a[48:51], v[224:227]
    ds_read_b64_tr_b16 a[234:235], v9 offset:34816
    buffer_load_dwordx4 v1, s[12:15], s32 offen offset:0 lds
    v_mfma_f32_16x16x32_bf16 v[232:235], a[248:251], a[52:55], v[232:235]
    ds_read_b64_tr_b16 a[236:237], v10 offset:32768
    v_rcp_f32 v32, v32
    v_mfma_f32_16x16x32_bf16 v[228:231], a[252:255], a[48:51], v[228:231]
    ds_read_b64_tr_b16 a[238:239], v10 offset:34816
    v_mul_f32 v116, v116, v32
    v_mfma_f32_16x16x32_bf16 v[236:239], a[252:255], a[52:55], v[236:239]
    s_waitcnt lgkmcnt(8)
    ds_read_b64_tr_b16 a[240:241], v11 offset:32768
    v_fma_f32 v33, v33, v26, v24
    v_mfma_f32_16x16x32_bf16 v[208:211], a[216:219], a[56:59], v[208:211]
    ds_read_b64_tr_b16 a[242:243], v11 offset:34816
    buffer_load_dwordx4 v2, s[12:15], s32 offen offset:1024 lds
    v_mul_f32 v33, v33, v117
    v_mfma_f32_16x16x32_bf16 v[216:219], a[216:219], a[60:63], v[216:219]
    ds_read_b64_tr_b16 a[244:245], v12 offset:32768
    v_exp_f32 v33, v33
    v_mfma_f32_16x16x32_bf16 v[212:215], a[220:223], a[56:59], v[212:215]
    ds_read_b64_tr_b16 a[246:247], v12 offset:34816
    v_fma_f32 v33, v33, v250, v250
    v_mfma_f32_16x16x32_bf16 v[220:223], a[220:223], a[60:63], v[220:223]
    s_waitcnt lgkmcnt(8)
    v_rcp_f32 v33, v33
    v_mfma_f32_16x16x32_bf16 v[224:227], a[224:227], a[56:59], v[224:227]
    buffer_load_dwordx4 v3, s[12:15], s32 offen offset:2048 lds
    v_mul_f32 v117, v117, v33
    v_mfma_f32_16x16x32_bf16 v[232:235], a[224:227], a[60:63], v[232:235]
    s_waitcnt vmcnt(16) lgkmcnt(0)
    s_barrier
    ds_read_b64_tr_b16 a[248:249], v9 offset:36864
    ds_read_b64_tr_b16 a[250:251], v9 offset:38912
    v_mul_f32 v34, v118, v118
    v_mfma_f32_16x16x32_bf16 v[228:231], a[228:231], a[56:59], v[228:231]
    ds_read_b64_tr_b16 a[252:253], v10 offset:36864
    ds_read_b64_tr_b16 a[254:255], v10 offset:38912
    v_fma_f32 v34, v34, v26, v24
    v_mfma_f32_16x16x32_bf16 v[236:239], a[228:231], a[60:63], v[236:239]
    ds_read_b64_tr_b16 a[216:217], v11 offset:36864
    v_mul_f32 v34, v34, v118
    v_mfma_f32_16x16x32_bf16 v[208:211], a[232:235], a[64:67], v[208:211]
    ds_read_b64_tr_b16 a[218:219], v11 offset:38912
    buffer_load_dwordx4 v4, s[12:15], s32 offen offset:3072 lds
    v_exp_f32 v34, v34
    v_mfma_f32_16x16x32_bf16 v[216:219], a[232:235], a[68:71], v[216:219]
    s_add_u32 m0, s33, 118784
    ds_read_b64_tr_b16 a[220:221], v12 offset:36864
    v_fma_f32 v34, v34, v250, v250
    v_mfma_f32_16x16x32_bf16 v[212:215], a[236:239], a[64:67], v[212:215]
    s_add_u32 s32, s38, 3244160
    ds_read_b64_tr_b16 a[222:223], v12 offset:38912
    v_rcp_f32 v34, v34
    v_mfma_f32_16x16x32_bf16 v[220:223], a[236:239], a[68:71], v[220:223]
    ds_read_b64_tr_b16 a[224:225], v9 offset:40960
    v_mul_f32 v118, v118, v34
    v_mfma_f32_16x16x32_bf16 v[224:227], a[240:243], a[64:67], v[224:227]
    ds_read_b64_tr_b16 a[226:227], v9 offset:43008
    buffer_load_dwordx4 v1, s[12:15], s32 offen offset:0 lds
    v_mul_f32 v35, v119, v119
    v_mfma_f32_16x16x32_bf16 v[232:235], a[240:243], a[68:71], v[232:235]
    s_add_u32 m0, s33, 0
    ds_read_b64_tr_b16 a[228:229], v10 offset:40960
    v_fma_f32 v35, v35, v26, v24
    v_mfma_f32_16x16x32_bf16 v[228:231], a[244:247], a[64:67], v[228:231]
    s_add_u32 s32, s38, 128
    ds_read_b64_tr_b16 a[230:231], v10 offset:43008
    v_mul_f32 v35, v35, v119
    v_mfma_f32_16x16x32_bf16 v[236:239], a[244:247], a[68:71], v[236:239]
    s_waitcnt lgkmcnt(8)
    ds_read_b64_tr_b16 a[232:233], v11 offset:40960
    v_exp_f32 v35, v35
    v_mfma_f32_16x16x32_bf16 v[208:211], a[248:251], a[72:75], v[208:211]
    ds_read_b64_tr_b16 a[234:235], v11 offset:43008
    buffer_load_dwordx4 v1, s[4:7], s32 offen offset:0 lds
    v_fma_f32 v35, v35, v250, v250
    v_mfma_f32_16x16x32_bf16 v[216:219], a[248:251], a[76:79], v[216:219]
    ds_read_b64_tr_b16 a[236:237], v12 offset:40960
    v_rcp_f32 v35, v35
    v_mfma_f32_16x16x32_bf16 v[212:215], a[252:255], a[72:75], v[212:215]
    ds_read_b64_tr_b16 a[238:239], v12 offset:43008
    v_mul_f32 v119, v119, v35
    v_mfma_f32_16x16x32_bf16 v[220:223], a[252:255], a[76:79], v[220:223]
    s_waitcnt lgkmcnt(8)
    ds_read_b64_tr_b16 a[240:241], v9 offset:45056
    v_mul_f32 v36, v120, v120
    v_mfma_f32_16x16x32_bf16 v[224:227], a[216:219], a[72:75], v[224:227]
    ds_read_b64_tr_b16 a[242:243], v9 offset:47104
    buffer_load_dwordx4 v2, s[4:7], s32 offen offset:1024 lds
    v_fma_f32 v36, v36, v27, v25
    v_mfma_f32_16x16x32_bf16 v[232:235], a[216:219], a[76:79], v[232:235]
    ds_read_b64_tr_b16 a[244:245], v10 offset:45056
    v_mul_f32 v36, v36, v120
    v_mfma_f32_16x16x32_bf16 v[228:231], a[220:223], a[72:75], v[228:231]
    ds_read_b64_tr_b16 a[246:247], v10 offset:47104
    v_exp_f32 v36, v36
    v_mfma_f32_16x16x32_bf16 v[236:239], a[220:223], a[76:79], v[236:239]
    s_waitcnt lgkmcnt(8)
    ds_read_b64_tr_b16 a[248:249], v11 offset:45056
    v_fma_f32 v36, v36, v252, v252
    v_mfma_f32_16x16x32_bf16 v[208:211], a[224:227], a[80:83], v[208:211]
    ds_read_b64_tr_b16 a[250:251], v11 offset:47104
    buffer_load_dwordx4 v3, s[4:7], s32 offen offset:2048 lds
    v_rcp_f32 v36, v36
    v_mfma_f32_16x16x32_bf16 v[216:219], a[224:227], a[84:87], v[216:219]
    ds_read_b64_tr_b16 a[252:253], v12 offset:45056
    v_mul_f32 v120, v120, v36
    v_mfma_f32_16x16x32_bf16 v[212:215], a[228:231], a[80:83], v[212:215]
    ds_read_b64_tr_b16 a[254:255], v12 offset:47104
    v_mul_f32 v37, v121, v121
    v_mfma_f32_16x16x32_bf16 v[220:223], a[228:231], a[84:87], v[220:223]
    s_waitcnt lgkmcnt(8)
    ds_read_b64_tr_b16 a[216:217], v13 offset:0
    v_fma_f32 v37, v37, v27, v25
    v_mfma_f32_16x16x32_bf16 v[224:227], a[232:235], a[80:83], v[224:227]
    ds_read_b64_tr_b16 a[218:219], v13 offset:2048
    buffer_load_dwordx4 v4, s[4:7], s32 offen offset:3072 lds
    v_mul_f32 v37, v37, v121
    v_mfma_f32_16x16x32_bf16 v[232:235], a[232:235], a[84:87], v[232:235]
    s_add_u32 m0, s33, 4096
    ds_read_b64_tr_b16 a[220:221], v14 offset:0
    v_exp_f32 v37, v37
    v_mfma_f32_16x16x32_bf16 v[228:231], a[236:239], a[80:83], v[228:231]
    s_add_u32 s32, s38, 295040
    ds_read_b64_tr_b16 a[222:223], v14 offset:2048
    v_fma_f32 v37, v37, v252, v252
    v_mfma_f32_16x16x32_bf16 v[236:239], a[236:239], a[84:87], v[236:239]
    s_waitcnt lgkmcnt(8)
    ds_read_b64_tr_b16 a[224:225], v15 offset:0
    v_rcp_f32 v37, v37
    v_mfma_f32_16x16x32_bf16 v[208:211], a[240:243], a[88:91], v[208:211]
    ds_read_b64_tr_b16 a[226:227], v15 offset:2048
    buffer_load_dwordx4 v1, s[4:7], s32 offen offset:0 lds
    v_mfma_f32_16x16x32_bf16 v[216:219], a[240:243], a[92:95], v[216:219]
    ds_read_b64_tr_b16 a[228:229], v16 offset:0
    v_mul_f32 v121, v121, v37
    v_mfma_f32_16x16x32_bf16 v[212:215], a[244:247], a[88:91], v[212:215]
    ds_read_b64_tr_b16 a[230:231], v16 offset:2048
    v_mul_f32 v38, v122, v122
    v_fma_f32 v38, v38, v27, v25
    v_mfma_f32_16x16x32_bf16 v[220:223], a[244:247], a[92:95], v[220:223]
    s_waitcnt lgkmcnt(8)
    ds_read_b64_tr_b16 a[232:233], v13 offset:4096
    v_mul_f32 v38, v38, v122
    v_mfma_f32_16x16x32_bf16 v[224:227], a[248:251], a[88:91], v[224:227]
    ds_read_b64_tr_b16 a[234:235], v13 offset:6144
    buffer_load_dwordx4 v2, s[4:7], s32 offen offset:1024 lds
    v_exp_f32 v38, v38
    v_mfma_f32_16x16x32_bf16 v[232:235], a[248:251], a[92:95], v[232:235]
    ds_read_b64_tr_b16 a[236:237], v14 offset:4096
    v_fma_f32 v38, v38, v252, v252
    v_mfma_f32_16x16x32_bf16 v[228:231], a[252:255], a[88:91], v[228:231]
    ds_read_b64_tr_b16 a[238:239], v14 offset:6144
    v_rcp_f32 v38, v38
    v_mfma_f32_16x16x32_bf16 v[236:239], a[252:255], a[92:95], v[236:239]
    s_waitcnt lgkmcnt(8)
    ds_read_b64_tr_b16 a[240:241], v15 offset:4096
    v_mul_f32 v122, v122, v38
    v_mfma_f32_16x16x32_bf16 v[208:211], a[216:219], a[96:99], v[208:211]
    ds_read_b64_tr_b16 a[242:243], v15 offset:6144
    buffer_load_dwordx4 v3, s[4:7], s32 offen offset:2048 lds
    v_mfma_f32_16x16x32_bf16 v[216:219], a[216:219], a[100:103], v[216:219]
    ds_read_b64_tr_b16 a[244:245], v16 offset:4096
    v_mul_f32 v39, v123, v123
    v_fma_f32 v39, v39, v27, v25
    v_mfma_f32_16x16x32_bf16 v[212:215], a[220:223], a[96:99], v[212:215]
    ds_read_b64_tr_b16 a[246:247], v16 offset:6144
    v_mul_f32 v39, v39, v123
    v_mfma_f32_16x16x32_bf16 v[220:223], a[220:223], a[100:103], v[220:223]
    s_waitcnt lgkmcnt(8)
    ds_read_b64_tr_b16 a[248:249], v13 offset:8192
    v_exp_f32 v39, v39
    v_mfma_f32_16x16x32_bf16 v[224:227], a[224:227], a[96:99], v[224:227]
    ds_read_b64_tr_b16 a[250:251], v13 offset:10240
    buffer_load_dwordx4 v4, s[4:7], s32 offen offset:3072 lds
    v_mfma_f32_16x16x32_bf16 v[232:235], a[224:227], a[100:103], v[232:235]
    s_add_u32 m0, s33, 8192
    ds_read_b64_tr_b16 a[252:253], v14 offset:8192
    v_fma_f32 v39, v39, v252, v252
    v_mul_f32 v28, v124, v124
    v_mfma_f32_16x16x32_bf16 v[228:231], a[228:231], a[96:99], v[228:231]
    s_add_u32 s32, s38, 589952
    ds_read_b64_tr_b16 a[254:255], v14 offset:10240
    v_rcp_f32 v39, v39
    v_mfma_f32_16x16x32_bf16 v[236:239], a[228:231], a[100:103], v[236:239]
    s_waitcnt lgkmcnt(8)
    ds_read_b64_tr_b16 a[216:217], v15 offset:8192
    v_mul_f32 v123, v123, v39
    v_mfma_f32_16x16x32_bf16 v[208:211], a[232:235], a[104:107], v[208:211]
    ds_read_b64_tr_b16 a[218:219], v15 offset:10240
    buffer_load_dwordx4 v1, s[4:7], s32 offen offset:0 lds
    v_mfma_f32_16x16x32_bf16 v[216:219], a[232:235], a[108:111], v[216:219]
    ds_read_b64_tr_b16 a[220:221], v16 offset:8192
    v_fma_f32 v28, v28, v27, v25
    v_mul_f32 v28, v28, v124
    v_mfma_f32_16x16x32_bf16 v[212:215], a[236:239], a[104:107], v[212:215]
    ds_read_b64_tr_b16 a[222:223], v16 offset:10240
    v_exp_f32 v28, v28
    v_mfma_f32_16x16x32_bf16 v[220:223], a[236:239], a[108:111], v[220:223]
    s_waitcnt lgkmcnt(8)
    ds_read_b64_tr_b16 a[224:225], v13 offset:12288
    v_fma_f32 v28, v28, v252, v252
    v_mfma_f32_16x16x32_bf16 v[224:227], a[240:243], a[104:107], v[224:227]
    ds_read_b64_tr_b16 a[226:227], v13 offset:14336
    v_rcp_f32 v28, v28
    v_mfma_f32_16x16x32_bf16 v[232:235], a[240:243], a[108:111], v[232:235]
    ds_read_b64_tr_b16 a[228:229], v14 offset:12288
    v_mul_f32 v124, v124, v28
    v_mfma_f32_16x16x32_bf16 v[228:231], a[244:247], a[104:107], v[228:231]
    ds_read_b64_tr_b16 a[230:231], v14 offset:14336
    v_mul_f32 v29, v125, v125
    v_mfma_f32_16x16x32_bf16 v[236:239], a[244:247], a[108:111], v[236:239]
    s_waitcnt lgkmcnt(8)
    ds_read_b64_tr_b16 a[232:233], v15 offset:12288
    v_fma_f32 v29, v29, v27, v25
    v_mfma_f32_16x16x32_bf16 v[208:211], a[248:251], a[112:115], v[208:211]
    ds_read_b64_tr_b16 a[234:235], v15 offset:14336
    v_mul_f32 v29, v29, v125
    v_mfma_f32_16x16x32_bf16 v[216:219], a[248:251], a[116:119], v[216:219]
    ds_read_b64_tr_b16 a[236:237], v16 offset:12288
    v_exp_f32 v29, v29
    v_mfma_f32_16x16x32_bf16 v[212:215], a[252:255], a[112:115], v[212:215]
    ds_read_b64_tr_b16 a[238:239], v16 offset:14336
    v_fma_f32 v29, v29, v252, v252
    v_mfma_f32_16x16x32_bf16 v[220:223], a[252:255], a[116:119], v[220:223]
    s_waitcnt lgkmcnt(8)
    ds_read_b64_tr_b16 a[240:241], v13 offset:16384
    v_mul_f32 v30, v126, v126
    v_mfma_f32_16x16x32_bf16 v[224:227], a[216:219], a[112:115], v[224:227]
    ds_read_b64_tr_b16 a[242:243], v13 offset:18432
    v_rcp_f32 v29, v29
    v_mfma_f32_16x16x32_bf16 v[232:235], a[216:219], a[116:119], v[232:235]
    ds_read_b64_tr_b16 a[244:245], v14 offset:16384
    v_mul_f32 v125, v125, v29
    v_mfma_f32_16x16x32_bf16 v[228:231], a[220:223], a[112:115], v[228:231]
    ds_read_b64_tr_b16 a[246:247], v14 offset:18432
    v_fma_f32 v30, v30, v27, v25
    v_mfma_f32_16x16x32_bf16 v[236:239], a[220:223], a[116:119], v[236:239]
    s_waitcnt lgkmcnt(8)
    ds_read_b64_tr_b16 a[248:249], v15 offset:16384
    v_mul_f32 v30, v30, v126
    v_mfma_f32_16x16x32_bf16 v[208:211], a[224:227], a[120:123], v[208:211]
    ds_read_b64_tr_b16 a[250:251], v15 offset:18432
    v_exp_f32 v30, v30
    v_mfma_f32_16x16x32_bf16 v[216:219], a[224:227], a[124:127], v[216:219]
    ds_read_b64_tr_b16 a[252:253], v16 offset:16384
    v_fma_f32 v30, v30, v252, v252
    v_mfma_f32_16x16x32_bf16 v[212:215], a[228:231], a[120:123], v[212:215]
    ds_read_b64_tr_b16 a[254:255], v16 offset:18432
    v_mul_f32 v31, v127, v127
    v_mfma_f32_16x16x32_bf16 v[220:223], a[228:231], a[124:127], v[220:223]
    s_waitcnt lgkmcnt(8)
    ds_read_b64_tr_b16 a[216:217], v13 offset:20480
    v_rcp_f32 v30, v30
    v_mfma_f32_16x16x32_bf16 v[224:227], a[232:235], a[120:123], v[224:227]
    ds_read_b64_tr_b16 a[218:219], v13 offset:22528
    v_mul_f32 v126, v126, v30
    v_mfma_f32_16x16x32_bf16 v[232:235], a[232:235], a[124:127], v[232:235]
    ds_read_b64_tr_b16 a[220:221], v14 offset:20480
    v_fma_f32 v31, v31, v27, v25
    v_mfma_f32_16x16x32_bf16 v[228:231], a[236:239], a[120:123], v[228:231]
    ds_read_b64_tr_b16 a[222:223], v14 offset:22528
    v_mul_f32 v31, v31, v127
    v_mfma_f32_16x16x32_bf16 v[236:239], a[236:239], a[124:127], v[236:239]
    s_waitcnt lgkmcnt(8)
    ds_read_b64_tr_b16 a[224:225], v15 offset:20480
    v_exp_f32 v31, v31
    v_mfma_f32_16x16x32_bf16 v[208:211], a[240:243], a[128:131], v[208:211]
    ds_read_b64_tr_b16 a[226:227], v15 offset:22528
    v_fma_f32 v31, v31, v252, v252
    v_mfma_f32_16x16x32_bf16 v[216:219], a[240:243], a[132:135], v[216:219]
    ds_read_b64_tr_b16 a[228:229], v16 offset:20480
    v_mul_f32 v32, v128, v128
    v_mfma_f32_16x16x32_bf16 v[212:215], a[244:247], a[128:131], v[212:215]
    ds_read_b64_tr_b16 a[230:231], v16 offset:22528
    v_fma_f32 v32, v32, v26, v24
    v_mfma_f32_16x16x32_bf16 v[220:223], a[244:247], a[132:135], v[220:223]
    s_waitcnt lgkmcnt(8)
    v_rcp_f32 v31, v31
    v_mfma_f32_16x16x32_bf16 v[224:227], a[248:251], a[128:131], v[224:227]
    v_mul_f32 v127, v127, v31
    v_mul_f32 v32, v32, v128
    v_mfma_f32_16x16x32_bf16 v[232:235], a[248:251], a[132:135], v[232:235]
    s_waitcnt vmcnt(18) lgkmcnt(0)
    s_barrier
    ds_read_b64_tr_b16 a[232:233], v13 offset:24576
    ds_read_b64_tr_b16 a[234:235], v13 offset:26624
    v_mfma_f32_16x16x32_bf16 v[228:231], a[252:255], a[128:131], v[228:231]
    s_add_u32 m0, s33, 36864
    ds_read_b64_tr_b16 a[236:237], v14 offset:24576
    ds_read_b64_tr_b16 a[238:239], v14 offset:26624
    v_exp_f32 v32, v32
    v_mfma_f32_16x16x32_bf16 v[236:239], a[252:255], a[132:135], v[236:239]
    s_add_u32 s32, s38, 2654336
    ds_read_b64_tr_b16 a[240:241], v15 offset:24576
    buffer_load_dwordx4 v1, s[4:7], s32 offen offset:0 lds
    v_mfma_f32_16x16x32_bf16 v[208:211], a[216:219], a[136:139], v[208:211]
    ds_read_b64_tr_b16 a[242:243], v15 offset:26624
    v_fma_f32 v32, v32, v250, v250
    v_mfma_f32_16x16x32_bf16 v[216:219], a[216:219], a[140:143], v[216:219]
    ds_read_b64_tr_b16 a[244:245], v16 offset:24576
    v_rcp_f32 v32, v32
    v_mfma_f32_16x16x32_bf16 v[212:215], a[220:223], a[136:139], v[212:215]
    ds_read_b64_tr_b16 a[246:247], v16 offset:26624
    v_mul_f32 v128, v128, v32
    v_mfma_f32_16x16x32_bf16 v[220:223], a[220:223], a[140:143], v[220:223]
    ds_read_b64_tr_b16 a[248:249], v13 offset:28672
    buffer_load_dwordx4 v2, s[4:7], s32 offen offset:1024 lds
    v_mul_f32 v33, v129, v129
    v_mfma_f32_16x16x32_bf16 v[224:227], a[224:227], a[136:139], v[224:227]
    ds_read_b64_tr_b16 a[250:251], v13 offset:30720
    v_fma_f32 v33, v33, v26, v24
    v_mfma_f32_16x16x32_bf16 v[232:235], a[224:227], a[140:143], v[232:235]
    ds_read_b64_tr_b16 a[252:253], v14 offset:28672
    v_mul_f32 v33, v33, v129
    v_mfma_f32_16x16x32_bf16 v[228:231], a[228:231], a[136:139], v[228:231]
    ds_read_b64_tr_b16 a[254:255], v14 offset:30720
    v_exp_f32 v33, v33
    v_mfma_f32_16x16x32_bf16 v[236:239], a[228:231], a[140:143], v[236:239]
    s_waitcnt lgkmcnt(8)
    ds_read_b64_tr_b16 a[216:217], v15 offset:28672
    buffer_load_dwordx4 v3, s[4:7], s32 offen offset:2048 lds
    v_fma_f32 v33, v33, v250, v250
    v_mfma_f32_16x16x32_bf16 v[144:147], a[232:235], a[0:3], 0
    s_add_u32 s49, s57, 0
    ds_read_b64_tr_b16 a[218:219], v15 offset:30720
    v_rcp_f32 v33, v33
    v_mfma_f32_16x16x32_bf16 v[152:155], a[232:235], a[4:7], 0
    ds_read_b64_tr_b16 a[220:221], v16 offset:28672
    v_mul_f32 v208, v208, v112
    v_mfma_f32_16x16x32_bf16 v[148:151], a[236:239], a[0:3], 0
    ds_read_b64_tr_b16 a[222:223], v16 offset:30720
    v_mul_f32 v209, v209, v113
    v_mfma_f32_16x16x32_bf16 v[156:159], a[236:239], a[4:7], 0
    s_waitcnt lgkmcnt(8)
    ds_read_b64_tr_b16 a[224:225], v13 offset:32768
    v_cvt_pk_bf16_f32 v40, v208, v209
    v_mfma_f32_16x16x32_bf16 v[160:163], a[240:243], a[0:3], 0
    ds_read_b64_tr_b16 a[226:227], v13 offset:34816
    v_mul_f32 v210, v210, v114
    v_mfma_f32_16x16x32_bf16 v[168:171], a[240:243], a[4:7], 0
    ds_read_b64_tr_b16 a[228:229], v14 offset:32768
    v_mul_f32 v211, v211, v115
    v_cvt_pk_bf16_f32 v41, v210, v211
    v_mfma_f32_16x16x32_bf16 v[164:167], a[244:247], a[0:3], 0
    ds_read_b64_tr_b16 a[230:231], v14 offset:34816
    buffer_load_dwordx4 v4, s[4:7], s32 offen offset:3072 lds
    v_mul_f32 v212, v212, v116
    v_mfma_f32_16x16x32_bf16 v[172:175], a[244:247], a[4:7], 0
    s_waitcnt lgkmcnt(8)
    ds_read_b64_tr_b16 a[232:233], v15 offset:32768
    v_mul_f32 v213, v213, v117
    v_mfma_f32_16x16x32_bf16 v[144:147], a[248:251], a[8:11], v[144:147]
    s_add_u32 m0, s33, 40960
    ds_read_b64_tr_b16 a[234:235], v15 offset:34816
    v_cvt_pk_bf16_f32 v42, v212, v213
    v_mfma_f32_16x16x32_bf16 v[152:155], a[248:251], a[12:15], v[152:155]
    s_add_u32 s32, s38, 2949248
    ds_read_b64_tr_b16 a[236:237], v16 offset:32768
    v_mul_f32 v214, v214, v118
    v_mul_f32 v215, v215, v119
    v_mfma_f32_16x16x32_bf16 v[148:151], a[252:255], a[8:11], v[148:151]
    ds_read_b64_tr_b16 a[238:239], v16 offset:34816
    v_cvt_pk_bf16_f32 v43, v214, v215
    v_mfma_f32_16x16x32_bf16 v[156:159], a[252:255], a[12:15], v[156:159]
    s_waitcnt lgkmcnt(8)
    ds_read_b64_tr_b16 a[240:241], v13 offset:36864
    buffer_store_dwordx4 v[40:43], v23, s[20:23], s49 offen offset:0 sc1
    v_mul_f32 v216, v216, v120
    v_mfma_f32_16x16x32_bf16 v[160:163], a[216:219], a[8:11], v[160:163]
    s_add_u32 s50, s48, 98304
    ds_read_b64_tr_b16 a[242:243], v13 offset:38912
    v_mov_b32 v100, -1
    v_mov_b32 v101, -1
    v_mfma_f32_16x16x32_bf16 v[168:171], a[216:219], a[12:15], v[168:171]
    ds_read_b64_tr_b16 a[244:245], v14 offset:36864
    buffer_load_dwordx4 v1, s[4:7], s32 offen offset:0 lds
    v_mov_b32 v102, -1
    v_mfma_f32_16x16x32_bf16 v[164:167], a[220:223], a[8:11], v[164:167]
    ds_read_b64_tr_b16 a[246:247], v14 offset:38912
    v_mov_b32 v103, -1
    v_mfma_f32_16x16x32_bf16 v[172:175], a[220:223], a[12:15], v[172:175]
    s_waitcnt lgkmcnt(8)
    ds_read_b64_tr_b16 a[248:249], v15 offset:36864
    buffer_store_dwordx4 v[100:103], v23, s[20:23], s50 offen offset:0 sc1
    v_mul_f32 v217, v217, v121
    v_mfma_f32_16x16x32_bf16 v[144:147], a[224:227], a[16:19], v[144:147]
    ds_read_b64_tr_b16 a[250:251], v15 offset:38912
    v_cvt_pk_bf16_f32 v44, v216, v217
    v_mul_f32 v218, v218, v122
    v_mfma_f32_16x16x32_bf16 v[152:155], a[224:227], a[20:23], v[152:155]
    ds_read_b64_tr_b16 a[252:253], v16 offset:36864
    v_mul_f32 v219, v219, v123
    v_mfma_f32_16x16x32_bf16 v[148:151], a[228:231], a[16:19], v[148:151]
    ds_read_b64_tr_b16 a[254:255], v16 offset:38912
    v_cvt_pk_bf16_f32 v45, v218, v219
    v_mfma_f32_16x16x32_bf16 v[156:159], a[228:231], a[20:23], v[156:159]
    s_waitcnt lgkmcnt(8)
    ds_read_b64_tr_b16 a[216:217], v13 offset:40960
    v_mul_f32 v220, v220, v124
    v_mfma_f32_16x16x32_bf16 v[160:163], a[232:235], a[16:19], v[160:163]
    ds_read_b64_tr_b16 a[218:219], v13 offset:43008
    buffer_load_dwordx4 v2, s[4:7], s32 offen offset:1024 lds
    v_mul_f32 v221, v221, v125
    v_cvt_pk_bf16_f32 v46, v220, v221
    v_mfma_f32_16x16x32_bf16 v[168:171], a[232:235], a[20:23], v[168:171]
    ds_read_b64_tr_b16 a[220:221], v14 offset:40960
    v_mul_f32 v222, v222, v126
    v_mfma_f32_16x16x32_bf16 v[164:167], a[236:239], a[16:19], v[164:167]
    ds_read_b64_tr_b16 a[222:223], v14 offset:43008
    v_mul_f32 v223, v223, v127
    v_mfma_f32_16x16x32_bf16 v[172:175], a[236:239], a[20:23], v[172:175]
    s_waitcnt lgkmcnt(8)
    ds_read_b64_tr_b16 a[224:225], v15 offset:40960
    v_cvt_pk_bf16_f32 v47, v222, v223
    v_mul_f32 v224, v224, v128
    v_mfma_f32_16x16x32_bf16 v[144:147], a[240:243], a[24:27], v[144:147]
    ds_read_b64_tr_b16 a[226:227], v15 offset:43008
    buffer_store_dwordx4 v[44:47], v23, s[20:23], s49 offen offset:1024 sc1
    v_mul_f32 v129, v129, v33
    v_mfma_f32_16x16x32_bf16 v[152:155], a[240:243], a[28:31], v[152:155]
    ds_read_b64_tr_b16 a[228:229], v16 offset:40960
    buffer_store_dwordx4 v[100:103], v23, s[20:23], s50 offen offset:1024 sc1
    v_mul_f32 v225, v225, v129
    v_mfma_f32_16x16x32_bf16 v[148:151], a[244:247], a[24:27], v[148:151]
    s_add_u32 s50, s48, 114688
    ds_read_b64_tr_b16 a[230:231], v16 offset:43008
    v_cvt_pk_bf16_f32 v48, v224, v225
    v_mfma_f32_16x16x32_bf16 v[156:159], a[244:247], a[28:31], v[156:159]
    s_waitcnt lgkmcnt(8)
    ds_read_b64_tr_b16 a[232:233], v13 offset:45056
    buffer_load_dwordx4 v3, s[4:7], s32 offen offset:2048 lds
    v_mul_f32 v34, v130, v130
    v_fma_f32 v34, v34, v26, v24
    v_mfma_f32_16x16x32_bf16 v[160:163], a[248:251], a[24:27], v[160:163]
    ds_read_b64_tr_b16 a[234:235], v13 offset:47104
    v_mul_f32 v34, v34, v130
    v_mfma_f32_16x16x32_bf16 v[168:171], a[248:251], a[28:31], v[168:171]
    ds_read_b64_tr_b16 a[236:237], v14 offset:45056
    v_exp_f32 v34, v34
    v_mfma_f32_16x16x32_bf16 v[164:167], a[252:255], a[24:27], v[164:167]
    ds_read_b64_tr_b16 a[238:239], v14 offset:47104
    v_fma_f32 v34, v34, v250, v250
    v_mfma_f32_16x16x32_bf16 v[172:175], a[252:255], a[28:31], v[172:175]
    s_waitcnt lgkmcnt(8)
    ds_read_b64_tr_b16 a[240:241], v15 offset:45056
    v_rcp_f32 v34, v34
    v_mfma_f32_16x16x32_bf16 v[144:147], a[216:219], a[32:35], v[144:147]
    ds_read_b64_tr_b16 a[242:243], v15 offset:47104
    v_mul_f32 v130, v130, v34
    v_mfma_f32_16x16x32_bf16 v[152:155], a[216:219], a[36:39], v[152:155]
    ds_read_b64_tr_b16 a[244:245], v16 offset:45056
    v_mul_f32 v226, v226, v130
    v_mfma_f32_16x16x32_bf16 v[148:151], a[220:223], a[32:35], v[148:151]
    ds_read_b64_tr_b16 a[246:247], v16 offset:47104
    buffer_load_dwordx4 v4, s[4:7], s32 offen offset:3072 lds
    v_mul_f32 v35, v131, v131
    v_mfma_f32_16x16x32_bf16 v[156:159], a[220:223], a[36:39], v[156:159]
    s_waitcnt lgkmcnt(8)
    ds_read_b64_tr_b16 a[248:249], v17 offset:0
    buffer_store_dwordx4 v[100:103], v23, s[20:23], s50 offen offset:0 sc1
    v_fma_f32 v35, v35, v26, v24
    v_mfma_f32_16x16x32_bf16 v[160:163], a[224:227], a[32:35], v[160:163]
    s_add_u32 m0, s33, 45056
    ds_read_b64_tr_b16 a[250:251], v17 offset:2048
    v_mul_f32 v35, v35, v131
    v_mfma_f32_16x16x32_bf16 v[168:171], a[224:227], a[36:39], v[168:171]
    s_add_u32 s32, s38, 3244160
    ds_read_b64_tr_b16 a[252:253], v18 offset:0
    v_exp_f32 v35, v35
    v_mfma_f32_16x16x32_bf16 v[164:167], a[228:231], a[32:35], v[164:167]
    ds_read_b64_tr_b16 a[254:255], v18 offset:2048
    v_fma_f32 v35, v35, v250, v250
    v_mfma_f32_16x16x32_bf16 v[172:175], a[228:231], a[36:39], v[172:175]
    s_waitcnt lgkmcnt(8)
    ds_read_b64_tr_b16 a[216:217], v19 offset:0
    v_rcp_f32 v35, v35
    v_mfma_f32_16x16x32_bf16 v[144:147], a[232:235], a[40:43], v[144:147]
    ds_read_b64_tr_b16 a[218:219], v19 offset:2048
    v_mul_f32 v131, v131, v35
    v_mfma_f32_16x16x32_bf16 v[152:155], a[232:235], a[44:47], v[152:155]
    ds_read_b64_tr_b16 a[220:221], v20 offset:0
    buffer_load_dwordx4 v1, s[4:7], s32 offen offset:0 lds
    v_mul_f32 v227, v227, v131
    v_mfma_f32_16x16x32_bf16 v[148:151], a[236:239], a[40:43], v[148:151]
    ds_read_b64_tr_b16 a[222:223], v20 offset:2048
    v_cvt_pk_bf16_f32 v49, v226, v227
    v_mfma_f32_16x16x32_bf16 v[156:159], a[236:239], a[44:47], v[156:159]
    s_waitcnt lgkmcnt(8)
    ds_read_b64_tr_b16 a[224:225], v17 offset:4096
    v_mul_f32 v36, v132, v132
    v_mfma_f32_16x16x32_bf16 v[160:163], a[240:243], a[40:43], v[160:163]
    ds_read_b64_tr_b16 a[226:227], v17 offset:6144
    v_fma_f32 v36, v36, v26, v24
    v_mfma_f32_16x16x32_bf16 v[168:171], a[240:243], a[44:47], v[168:171]
    ds_read_b64_tr_b16 a[228:229], v18 offset:4096
    buffer_store_dwordx4 v[100:103], v23, s[20:23], s50 offen offset:1024 sc1
    v_mul_f32 v36, v36, v132
    v_mul_f32 v37, v133, v133
    v_mfma_f32_16x16x32_bf16 v[164:167], a[244:247], a[40:43], v[164:167]
    s_add_u32 s50, s48, 131072
    ds_read_b64_tr_b16 a[230:231], v18 offset:6144
    v_exp_f32 v36, v36
    v_mfma_f32_16x16x32_bf16 v[172:175], a[244:247], a[44:47], v[172:175]
    s_waitcnt lgkmcnt(8)
    ds_read_b64_tr_b16 a[232:233], v19 offset:4096
    v_fma_f32 v36, v36, v250, v250
    v_mfma_f32_16x16x32_bf16 v[144:147], a[248:251], a[48:51], v[144:147]
    ds_read_b64_tr_b16 a[234:235], v19 offset:6144
    v_fma_f32 v37, v37, v26, v24
    v_mfma_f32_16x16x32_bf16 v[152:155], a[248:251], a[52:55], v[152:155]
    ds_read_b64_tr_b16 a[236:237], v20 offset:4096
    v_rcp_f32 v36, v36
    v_mfma_f32_16x16x32_bf16 v[148:151], a[252:255], a[48:51], v[148:151]
    ds_read_b64_tr_b16 a[238:239], v20 offset:6144
    v_mul_f32 v132, v132, v36
    v_mfma_f32_16x16x32_bf16 v[156:159], a[252:255], a[52:55], v[156:159]
    s_waitcnt lgkmcnt(8)
    ds_read_b64_tr_b16 a[240:241], v17 offset:8192
    v_mul_f32 v228, v228, v132
    v_mfma_f32_16x16x32_bf16 v[160:163], a[216:219], a[48:51], v[160:163]
    ds_read_b64_tr_b16 a[242:243], v17 offset:10240
    v_mul_f32 v37, v37, v133
    v_mfma_f32_16x16x32_bf16 v[168:171], a[216:219], a[52:55], v[168:171]
    ds_read_b64_tr_b16 a[244:245], v18 offset:8192
    v_exp_f32 v37, v37
    v_mfma_f32_16x16x32_bf16 v[164:167], a[220:223], a[48:51], v[164:167]
    ds_read_b64_tr_b16 a[246:247], v18 offset:10240
    v_fma_f32 v37, v37, v250, v250
    v_mfma_f32_16x16x32_bf16 v[172:175], a[220:223], a[52:55], v[172:175]
    s_waitcnt lgkmcnt(8)
    ds_read_b64_tr_b16 a[248:249], v19 offset:8192
    buffer_store_dwordx4 v[100:103], v23, s[20:23], s50 offen offset:0 sc1
    v_mfma_f32_16x16x32_bf16 v[144:147], a[224:227], a[56:59], v[144:147]
    ds_read_b64_tr_b16 a[250:251], v19 offset:10240
    v_rcp_f32 v37, v37
    v_mfma_f32_16x16x32_bf16 v[152:155], a[224:227], a[60:63], v[152:155]
    ds_read_b64_tr_b16 a[252:253], v20 offset:8192
    v_mul_f32 v133, v133, v37
    v_mfma_f32_16x16x32_bf16 v[148:151], a[228:231], a[56:59], v[148:151]
    ds_read_b64_tr_b16 a[254:255], v20 offset:10240
    v_mul_f32 v229, v229, v133
    v_mfma_f32_16x16x32_bf16 v[156:159], a[228:231], a[60:63], v[156:159]
    s_waitcnt lgkmcnt(8)
    v_cvt_pk_bf16_f32 v50, v228, v229
    v_mul_f32 v38, v134, v134
    v_mfma_f32_16x16x32_bf16 v[160:163], a[232:235], a[56:59], v[160:163]
    v_fma_f32 v38, v38, v26, v24
    v_mul_f32 v38, v38, v134
    v_mfma_f32_16x16x32_bf16 v[168:171], a[232:235], a[60:63], v[168:171]
    s_waitcnt vmcnt(25) lgkmcnt(0)
    s_barrier
    ds_read_b64_tr_b16 a[216:217], v17 offset:12288
    ds_read_b64_tr_b16 a[218:219], v17 offset:14336
    v_mfma_f32_16x16x32_bf16 v[164:167], a[236:239], a[56:59], v[164:167]
    s_add_u32 m0, s33, 73728
    ds_read_b64_tr_b16 a[220:221], v18 offset:12288
    ds_read_b64_tr_b16 a[222:223], v18 offset:14336
    v_exp_f32 v38, v38
    v_mfma_f32_16x16x32_bf16 v[172:175], a[236:239], a[60:63], v[172:175]
    s_add_u32 s32, s38, 256
    ds_read_b64_tr_b16 a[224:225], v19 offset:12288
    buffer_load_dwordx4 v1, s[12:15], s32 offen offset:0 lds
    v_fma_f32 v38, v38, v250, v250
    v_mfma_f32_16x16x32_bf16 v[144:147], a[240:243], a[64:67], v[144:147]
    ds_read_b64_tr_b16 a[226:227], v19 offset:14336
    v_rcp_f32 v38, v38
    v_mfma_f32_16x16x32_bf16 v[152:155], a[240:243], a[68:71], v[152:155]
    ds_read_b64_tr_b16 a[228:229], v20 offset:12288
    buffer_store_dwordx4 v[100:103], v23, s[20:23], s50 offen offset:1024 sc1
    v_mfma_f32_16x16x32_bf16 v[148:151], a[244:247], a[64:67], v[148:151]
    ds_read_b64_tr_b16 a[230:231], v20 offset:14336
    v_mul_f32 v134, v134, v38
    v_mfma_f32_16x16x32_bf16 v[156:159], a[244:247], a[68:71], v[156:159]
    ds_read_b64_tr_b16 a[232:233], v17 offset:16384
    v_mul_f32 v230, v230, v134
    v_mul_f32 v39, v135, v135
    v_mfma_f32_16x16x32_bf16 v[160:163], a[248:251], a[64:67], v[160:163]
    ds_read_b64_tr_b16 a[234:235], v17 offset:18432
    v_fma_f32 v39, v39, v26, v24
    v_mfma_f32_16x16x32_bf16 v[168:171], a[248:251], a[68:71], v[168:171]
    ds_read_b64_tr_b16 a[236:237], v18 offset:16384
    v_mul_f32 v39, v39, v135
    v_mfma_f32_16x16x32_bf16 v[164:167], a[252:255], a[64:67], v[164:167]
    ds_read_b64_tr_b16 a[238:239], v18 offset:18432
    buffer_load_dwordx4 v2, s[12:15], s32 offen offset:1024 lds
    v_exp_f32 v39, v39
    v_mfma_f32_16x16x32_bf16 v[172:175], a[252:255], a[68:71], v[172:175]
    s_waitcnt lgkmcnt(8)
    ds_read_b64_tr_b16 a[240:241], v19 offset:16384
    v_fma_f32 v39, v39, v250, v250
    v_mfma_f32_16x16x32_bf16 v[144:147], a[216:219], a[72:75], v[144:147]
    ds_read_b64_tr_b16 a[242:243], v19 offset:18432
    v_rcp_f32 v39, v39
    v_mfma_f32_16x16x32_bf16 v[152:155], a[216:219], a[76:79], v[152:155]
    ds_read_b64_tr_b16 a[244:245], v20 offset:16384
    v_mul_f32 v135, v135, v39
    v_mfma_f32_16x16x32_bf16 v[148:151], a[220:223], a[72:75], v[148:151]
    ds_read_b64_tr_b16 a[246:247], v20 offset:18432
    v_mul_f32 v231, v231, v135
    v_mfma_f32_16x16x32_bf16 v[156:159], a[220:223], a[76:79], v[156:159]
    s_waitcnt lgkmcnt(8)
    ds_read_b64_tr_b16 a[248:249], v17 offset:20480
    v_cvt_pk_bf16_f32 v51, v230, v231
    v_mfma_f32_16x16x32_bf16 v[160:163], a[224:227], a[72:75], v[160:163]
    ds_read_b64_tr_b16 a[250:251], v17 offset:22528
    buffer_store_dwordx4 v[48:51], v23, s[20:23], s49 offen offset:2048 sc1
    v_mul_f32 v28, v136, v136
    v_mfma_f32_16x16x32_bf16 v[168:171], a[224:227], a[76:79], v[168:171]
    ds_read_b64_tr_b16 a[252:253], v18 offset:20480
    buffer_load_dwordx4 v3, s[12:15], s32 offen offset:2048 lds
    v_fma_f32 v28, v28, v27, v25
    v_mfma_f32_16x16x32_bf16 v[164:167], a[228:231], a[72:75], v[164:167]
    ds_read_b64_tr_b16 a[254:255], v18 offset:22528
    v_mul_f32 v28, v28, v136
    v_mul_f32 v29, v137, v137
    v_mfma_f32_16x16x32_bf16 v[172:175], a[228:231], a[76:79], v[172:175]
    s_waitcnt lgkmcnt(8)
    ds_read_b64_tr_b16 a[216:217], v19 offset:20480
    v_exp_f32 v28, v28
    v_mfma_f32_16x16x32_bf16 v[144:147], a[232:235], a[80:83], v[144:147]
    ds_read_b64_tr_b16 a[218:219], v19 offset:22528
    v_fma_f32 v28, v28, v252, v252
    v_mfma_f32_16x16x32_bf16 v[152:155], a[232:235], a[84:87], v[152:155]
    ds_read_b64_tr_b16 a[220:221], v20 offset:20480
    v_rcp_f32 v28, v28
    v_mfma_f32_16x16x32_bf16 v[148:151], a[236:239], a[80:83], v[148:151]
    ds_read_b64_tr_b16 a[222:223], v20 offset:22528
    v_mul_f32 v136, v136, v28
    v_mfma_f32_16x16x32_bf16 v[156:159], a[236:239], a[84:87], v[156:159]
    s_waitcnt lgkmcnt(8)
    ds_read_b64_tr_b16 a[224:225], v17 offset:24576
    v_mul_f32 v232, v232, v136
    v_mfma_f32_16x16x32_bf16 v[160:163], a[240:243], a[80:83], v[160:163]
    ds_read_b64_tr_b16 a[226:227], v17 offset:26624
    buffer_load_dwordx4 v4, s[12:15], s32 offen offset:3072 lds
    v_mfma_f32_16x16x32_bf16 v[168:171], a[240:243], a[84:87], v[168:171]
    s_add_u32 m0, s33, 77824
    ds_read_b64_tr_b16 a[228:229], v18 offset:24576
    v_fma_f32 v29, v29, v27, v25
    v_mul_f32 v29, v29, v137
    v_mfma_f32_16x16x32_bf16 v[164:167], a[244:247], a[80:83], v[164:167]
    s_add_u32 s32, s38, 295168
    ds_read_b64_tr_b16 a[230:231], v18 offset:26624
    v_exp_f32 v29, v29
    v_mfma_f32_16x16x32_bf16 v[172:175], a[244:247], a[84:87], v[172:175]
    s_waitcnt lgkmcnt(8)
    ds_read_b64_tr_b16 a[232:233], v19 offset:24576
    v_fma_f32 v29, v29, v252, v252
    v_mfma_f32_16x16x32_bf16 v[144:147], a[248:251], a[88:91], v[144:147]
    ds_read_b64_tr_b16 a[234:235], v19 offset:26624
    v_mul_f32 v30, v138, v138
    v_mfma_f32_16x16x32_bf16 v[152:155], a[248:251], a[92:95], v[152:155]
    ds_read_b64_tr_b16 a[236:237], v20 offset:24576
    v_rcp_f32 v29, v29
    v_mfma_f32_16x16x32_bf16 v[148:151], a[252:255], a[88:91], v[148:151]
    ds_read_b64_tr_b16 a[238:239], v20 offset:26624
    v_mul_f32 v137, v137, v29
    v_mfma_f32_16x16x32_bf16 v[156:159], a[252:255], a[92:95], v[156:159]
    s_waitcnt lgkmcnt(8)
    ds_read_b64_tr_b16 a[240:241], v17 offset:28672
    buffer_load_dwordx4 v1, s[12:15], s32 offen offset:0 lds
    v_mfma_f32_16x16x32_bf16 v[160:163], a[216:219], a[88:91], v[160:163]
    ds_read_b64_tr_b16 a[242:243], v17 offset:30720
    v_mul_f32 v233, v233, v137
    v_cvt_pk_bf16_f32 v52, v232, v233
    v_mfma_f32_16x16x32_bf16 v[168:171], a[216:219], a[92:95], v[168:171]
    ds_read_b64_tr_b16 a[244:245], v18 offset:28672
    v_fma_f32 v30, v30, v27, v25
    v_mfma_f32_16x16x32_bf16 v[164:167], a[220:223], a[88:91], v[164:167]
    ds_read_b64_tr_b16 a[246:247], v18 offset:30720
    v_mul_f32 v30, v30, v138
    v_mfma_f32_16x16x32_bf16 v[172:175], a[220:223], a[92:95], v[172:175]
    s_waitcnt lgkmcnt(8)
    ds_read_b64_tr_b16 a[248:249], v19 offset:28672
    v_exp_f32 v30, v30
    v_mfma_f32_16x16x32_bf16 v[144:147], a[224:227], a[96:99], v[144:147]
    ds_read_b64_tr_b16 a[250:251], v19 offset:30720
    v_fma_f32 v30, v30, v252, v252
    v_mfma_f32_16x16x32_bf16 v[152:155], a[224:227], a[100:103], v[152:155]
    ds_read_b64_tr_b16 a[252:253], v20 offset:28672
    v_rcp_f32 v30, v30
    v_mfma_f32_16x16x32_bf16 v[148:151], a[228:231], a[96:99], v[148:151]
    ds_read_b64_tr_b16 a[254:255], v20 offset:30720
    buffer_load_dwordx4 v2, s[12:15], s32 offen offset:1024 lds
    v_mfma_f32_16x16x32_bf16 v[156:159], a[228:231], a[100:103], v[156:159]
    s_waitcnt lgkmcnt(8)
    ds_read_b64_tr_b16 a[216:217], v17 offset:32768
    v_mul_f32 v138, v138, v30
    v_mfma_f32_16x16x32_bf16 v[160:163], a[232:235], a[96:99], v[160:163]
    ds_read_b64_tr_b16 a[218:219], v17 offset:34816
    v_mul_f32 v234, v234, v138
    v_mul_f32 v31, v139, v139
    v_mfma_f32_16x16x32_bf16 v[168:171], a[232:235], a[100:103], v[168:171]
    ds_read_b64_tr_b16 a[220:221], v18 offset:32768
    v_fma_f32 v31, v31, v27, v25
    v_mfma_f32_16x16x32_bf16 v[164:167], a[236:239], a[96:99], v[164:167]
    ds_read_b64_tr_b16 a[222:223], v18 offset:34816
    v_mul_f32 v31, v31, v139
    v_mfma_f32_16x16x32_bf16 v[172:175], a[236:239], a[100:103], v[172:175]
    s_waitcnt lgkmcnt(8)
    ds_read_b64_tr_b16 a[224:225], v19 offset:32768
    v_exp_f32 v31, v31
    v_mfma_f32_16x16x32_bf16 v[144:147], a[240:243], a[104:107], v[144:147]
    ds_read_b64_tr_b16 a[226:227], v19 offset:34816
    v_fma_f32 v31, v31, v252, v252
    v_mfma_f32_16x16x32_bf16 v[152:155], a[240:243], a[108:111], v[152:155]
    ds_read_b64_tr_b16 a[228:229], v20 offset:32768
    buffer_load_dwordx4 v3, s[12:15], s32 offen offset:2048 lds
    v_rcp_f32 v31, v31
    v_mfma_f32_16x16x32_bf16 v[148:151], a[244:247], a[104:107], v[148:151]
    ds_read_b64_tr_b16 a[230:231], v20 offset:34816
    v_mul_f32 v139, v139, v31
    v_mfma_f32_16x16x32_bf16 v[156:159], a[244:247], a[108:111], v[156:159]
    s_waitcnt lgkmcnt(8)
    ds_read_b64_tr_b16 a[232:233], v17 offset:36864
    v_mul_f32 v235, v235, v139
    v_mfma_f32_16x16x32_bf16 v[160:163], a[248:251], a[104:107], v[160:163]
    ds_read_b64_tr_b16 a[234:235], v17 offset:38912
    v_cvt_pk_bf16_f32 v53, v234, v235
    v_mfma_f32_16x16x32_bf16 v[168:171], a[248:251], a[108:111], v[168:171]
    ds_read_b64_tr_b16 a[236:237], v18 offset:36864
    v_mul_f32 v32, v140, v140
    v_mfma_f32_16x16x32_bf16 v[164:167], a[252:255], a[104:107], v[164:167]
    ds_read_b64_tr_b16 a[238:239], v18 offset:38912
    v_fma_f32 v32, v32, v27, v25
    v_mfma_f32_16x16x32_bf16 v[172:175], a[252:255], a[108:111], v[172:175]
    s_waitcnt lgkmcnt(8)
    ds_read_b64_tr_b16 a[240:241], v19 offset:36864
    v_mul_f32 v32, v32, v140
    v_mul_f32 v33, v141, v141
    v_mfma_f32_16x16x32_bf16 v[144:147], a[216:219], a[112:115], v[144:147]
    ds_read_b64_tr_b16 a[242:243], v19 offset:38912
    buffer_load_dwordx4 v4, s[12:15], s32 offen offset:3072 lds
    v_exp_f32 v32, v32
    v_mfma_f32_16x16x32_bf16 v[152:155], a[216:219], a[116:119], v[152:155]
    s_add_u32 m0, s33, 81920
    ds_read_b64_tr_b16 a[244:245], v20 offset:36864
    v_fma_f32 v32, v32, v252, v252
    v_mfma_f32_16x16x32_bf16 v[148:151], a[220:223], a[112:115], v[148:151]
    s_add_u32 s32, s38, 590080
    ds_read_b64_tr_b16 a[246:247], v20 offset:38912
    v_rcp_f32 v32, v32
    v_mfma_f32_16x16x32_bf16 v[156:159], a[220:223], a[116:119], v[156:159]
    s_waitcnt lgkmcnt(8)
    ds_read_b64_tr_b16 a[248:249], v17 offset:40960
    v_mul_f32 v140, v140, v32
    v_mfma_f32_16x16x32_bf16 v[160:163], a[224:227], a[112:115], v[160:163]
    ds_read_b64_tr_b16 a[250:251], v17 offset:43008
    v_mul_f32 v236, v236, v140
    v_mfma_f32_16x16x32_bf16 v[168:171], a[224:227], a[116:119], v[168:171]
    ds_read_b64_tr_b16 a[252:253], v18 offset:40960
    v_fma_f32 v33, v33, v27, v25
    v_mfma_f32_16x16x32_bf16 v[164:167], a[228:231], a[112:115], v[164:167]
    ds_read_b64_tr_b16 a[254:255], v18 offset:43008
    v_mul_f32 v33, v33, v141
    v_mfma_f32_16x16x32_bf16 v[172:175], a[228:231], a[116:119], v[172:175]
    s_waitcnt lgkmcnt(8)
    ds_read_b64_tr_b16 a[216:217], v19 offset:40960
    buffer_load_dwordx4 v1, s[12:15], s32 offen offset:0 lds
    v_exp_f32 v33, v33
    v_mfma_f32_16x16x32_bf16 v[144:147], a[232:235], a[120:123], v[144:147]
    ds_read_b64_tr_b16 a[218:219], v19 offset:43008
    v_fma_f32 v33, v33, v252, v252
    v_mfma_f32_16x16x32_bf16 v[152:155], a[232:235], a[124:127], v[152:155]
    ds_read_b64_tr_b16 a[220:221], v20 offset:40960
    v_rcp_f32 v33, v33
    v_mfma_f32_16x16x32_bf16 v[148:151], a[236:239], a[120:123], v[148:151]
    ds_read_b64_tr_b16 a[222:223], v20 offset:43008
    v_mul_f32 v141, v141, v33
    v_mfma_f32_16x16x32_bf16 v[156:159], a[236:239], a[124:127], v[156:159]
    s_waitcnt lgkmcnt(8)
    ds_read_b64_tr_b16 a[224:225], v17 offset:45056
    v_mul_f32 v237, v237, v141
    v_mfma_f32_16x16x32_bf16 v[160:163], a[240:243], a[120:123], v[160:163]
    ds_read_b64_tr_b16 a[226:227], v17 offset:47104
    v_cvt_pk_bf16_f32 v54, v236, v237
    v_mfma_f32_16x16x32_bf16 v[168:171], a[240:243], a[124:127], v[168:171]
    ds_read_b64_tr_b16 a[228:229], v18 offset:45056
    v_mul_f32 v34, v142, v142
    v_mfma_f32_16x16x32_bf16 v[164:167], a[244:247], a[120:123], v[164:167]
    ds_read_b64_tr_b16 a[230:231], v18 offset:47104
    v_fma_f32 v34, v34, v27, v25
    v_mfma_f32_16x16x32_bf16 v[172:175], a[244:247], a[124:127], v[172:175]
    s_waitcnt lgkmcnt(8)
    ds_read_b64_tr_b16 a[232:233], v19 offset:45056
    v_mul_f32 v34, v34, v142
    v_mfma_f32_16x16x32_bf16 v[144:147], a[248:251], a[128:131], v[144:147]
    ds_read_b64_tr_b16 a[234:235], v19 offset:47104
    v_exp_f32 v34, v34
    v_mfma_f32_16x16x32_bf16 v[152:155], a[248:251], a[132:135], v[152:155]
    ds_read_b64_tr_b16 a[236:237], v20 offset:45056
    v_fma_f32 v34, v34, v252, v252
    v_mfma_f32_16x16x32_bf16 v[148:151], a[252:255], a[128:131], v[148:151]
    ds_read_b64_tr_b16 a[238:239], v20 offset:47104
    v_rcp_f32 v34, v34
    v_mfma_f32_16x16x32_bf16 v[156:159], a[252:255], a[132:135], v[156:159]
    s_waitcnt lgkmcnt(8)
    v_mul_f32 v142, v142, v34
    v_mul_f32 v238, v238, v142
    v_mfma_f32_16x16x32_bf16 v[160:163], a[216:219], a[128:131], v[160:163]
    buffer_load_dword v253, v251, s[16:19], s96 offen
    v_mul_f32 v35, v143, v143
    v_mfma_f32_16x16x32_bf16 v[168:171], a[216:219], a[132:135], v[168:171]
    s_waitcnt vmcnt(28) lgkmcnt(0)
    s_barrier
    ds_read_b64_tr_b16 a[240:241], v9 offset:0
    ds_read_b64_tr_b16 a[242:243], v9 offset:2048
    v_mfma_f32_16x16x32_bf16 v[164:167], a[220:223], a[128:131], v[164:167]
    s_add_u32 m0, s33, 110592
    ds_read_b64_tr_b16 a[244:245], v10 offset:0
    ds_read_b64_tr_b16 a[246:247], v10 offset:2048
    v_fma_f32 v35, v35, v27, v25
    v_mfma_f32_16x16x32_bf16 v[172:175], a[220:223], a[132:135], v[172:175]
    s_add_u32 s32, s38, 2654464
    ds_read_b64_tr_b16 a[248:249], v11 offset:0
    buffer_load_dwordx4 v1, s[12:15], s32 offen offset:0 lds
    v_mul_f32 v35, v35, v143
    v_mfma_f32_16x16x32_bf16 v[144:147], a[224:227], a[136:139], v[144:147]
    ds_read_b64_tr_b16 a[250:251], v11 offset:2048
    v_exp_f32 v35, v35
    v_mfma_f32_16x16x32_bf16 v[152:155], a[224:227], a[140:143], v[152:155]
    ds_read_b64_tr_b16 a[252:253], v12 offset:0
    v_fma_f32 v35, v35, v252, v252
    v_mfma_f32_16x16x32_bf16 v[148:151], a[228:231], a[136:139], v[148:151]
    ds_read_b64_tr_b16 a[254:255], v12 offset:2048
    v_rcp_f32 v35, v35
    v_mfma_f32_16x16x32_bf16 v[156:159], a[228:231], a[140:143], v[156:159]
    ds_read_b64_tr_b16 a[216:217], v9 offset:4096
    v_mul_f32 v143, v143, v35
    v_mfma_f32_16x16x32_bf16 v[160:163], a[232:235], a[136:139], v[160:163]
    ds_read_b64_tr_b16 a[218:219], v9 offset:6144
    v_mul_f32 v239, v239, v143
    v_mfma_f32_16x16x32_bf16 v[168:171], a[232:235], a[140:143], v[168:171]
    ds_read_b64_tr_b16 a[220:221], v10 offset:4096
    v_cvt_pk_bf16_f32 v55, v238, v239
    v_mfma_f32_16x16x32_bf16 v[164:167], a[236:239], a[136:139], v[164:167]
    ds_read_b64_tr_b16 a[222:223], v10 offset:6144
    buffer_load_dwordx4 v2, s[12:15], s32 offen offset:1024 lds
    v_mfma_f32_16x16x32_bf16 v[172:175], a[236:239], a[140:143], v[172:175]
    s_waitcnt lgkmcnt(8)
    ds_read_b64_tr_b16 a[224:225], v11 offset:4096
    buffer_store_dwordx4 v[52:55], v23, s[20:23], s49 offen offset:3072 sc1
    v_mfma_f32_16x16x32_bf16 v[176:179], a[240:243], a[0:3], 0
    s_add_u32 s49, s57, 4096
    ds_read_b64_tr_b16 a[226:227], v11 offset:6144
    v_mul_f32 v36, v144, v144
    v_fma_f32 v36, v36, v26, v24
    v_mfma_f32_16x16x32_bf16 v[184:187], a[240:243], a[4:7], 0
    ds_read_b64_tr_b16 a[228:229], v12 offset:4096
    v_mul_f32 v36, v36, v144
    v_mul_f32 v37, v145, v145
    v_mfma_f32_16x16x32_bf16 v[180:183], a[244:247], a[0:3], 0
    ds_read_b64_tr_b16 a[230:231], v12 offset:6144
    v_exp_f32 v36, v36
    v_mfma_f32_16x16x32_bf16 v[188:191], a[244:247], a[4:7], 0
    s_waitcnt lgkmcnt(8)
    ds_read_b64_tr_b16 a[232:233], v9 offset:8192
    v_fma_f32 v36, v36, v250, v250
    v_mfma_f32_16x16x32_bf16 v[192:195], a[248:251], a[0:3], 0
    ds_read_b64_tr_b16 a[234:235], v9 offset:10240
    v_rcp_f32 v36, v36
    v_mfma_f32_16x16x32_bf16 v[200:203], a[248:251], a[4:7], 0
    ds_read_b64_tr_b16 a[236:237], v10 offset:8192
    buffer_load_dwordx4 v3, s[12:15], s32 offen offset:2048 lds
    v_mfma_f32_16x16x32_bf16 v[196:199], a[252:255], a[0:3], 0
    ds_read_b64_tr_b16 a[238:239], v10 offset:10240
    v_mul_f32 v144, v144, v36
    v_mfma_f32_16x16x32_bf16 v[204:207], a[252:255], a[4:7], 0
    s_waitcnt lgkmcnt(8)
    ds_read_b64_tr_b16 a[240:241], v11 offset:8192
    v_fma_f32 v37, v37, v26, v24
    v_mfma_f32_16x16x32_bf16 v[176:179], a[216:219], a[8:11], v[176:179]
    ds_read_b64_tr_b16 a[242:243], v11 offset:10240
    v_mul_f32 v37, v37, v145
    v_mul_f32 v38, v146, v146
    v_mfma_f32_16x16x32_bf16 v[184:187], a[216:219], a[12:15], v[184:187]
    ds_read_b64_tr_b16 a[244:245], v12 offset:8192
    v_exp_f32 v37, v37
    v_mfma_f32_16x16x32_bf16 v[180:183], a[220:223], a[8:11], v[180:183]
    ds_read_b64_tr_b16 a[246:247], v12 offset:10240
    v_fma_f32 v37, v37, v250, v250
    v_mfma_f32_16x16x32_bf16 v[188:191], a[220:223], a[12:15], v[188:191]
    s_waitcnt lgkmcnt(8)
    ds_read_b64_tr_b16 a[248:249], v9 offset:12288
    v_rcp_f32 v37, v37
    v_mfma_f32_16x16x32_bf16 v[192:195], a[224:227], a[8:11], v[192:195]
    ds_read_b64_tr_b16 a[250:251], v9 offset:14336
    buffer_load_dwordx4 v4, s[12:15], s32 offen offset:3072 lds
    v_mfma_f32_16x16x32_bf16 v[200:203], a[224:227], a[12:15], v[200:203]
    s_add_u32 m0, s33, 114688
    ds_read_b64_tr_b16 a[252:253], v10 offset:12288
    v_mul_f32 v145, v145, v37
    v_mfma_f32_16x16x32_bf16 v[196:199], a[228:231], a[8:11], v[196:199]
    s_add_u32 s32, s38, 2949376
    ds_read_b64_tr_b16 a[254:255], v10 offset:14336
    v_fma_f32 v38, v38, v26, v24
    v_mfma_f32_16x16x32_bf16 v[204:207], a[228:231], a[12:15], v[204:207]
    s_waitcnt lgkmcnt(8)
    ds_read_b64_tr_b16 a[216:217], v11 offset:12288
    v_mul_f32 v38, v38, v146
    v_mul_f32 v39, v147, v147
    v_mfma_f32_16x16x32_bf16 v[176:179], a[232:235], a[16:19], v[176:179]
    ds_read_b64_tr_b16 a[218:219], v11 offset:14336
    v_exp_f32 v38, v38
    v_mfma_f32_16x16x32_bf16 v[184:187], a[232:235], a[20:23], v[184:187]
    ds_read_b64_tr_b16 a[220:221], v12 offset:12288
    v_fma_f32 v38, v38, v250, v250
    v_mfma_f32_16x16x32_bf16 v[180:183], a[236:239], a[16:19], v[180:183]
    ds_read_b64_tr_b16 a[222:223], v12 offset:14336
    v_fma_f32 v39, v39, v26, v24
    v_mfma_f32_16x16x32_bf16 v[188:191], a[236:239], a[20:23], v[188:191]
    s_waitcnt lgkmcnt(8)
    ds_read_b64_tr_b16 a[224:225], v9 offset:16384
    buffer_load_dwordx4 v1, s[12:15], s32 offen offset:0 lds
    v_rcp_f32 v38, v38
    v_mfma_f32_16x16x32_bf16 v[192:195], a[240:243], a[16:19], v[192:195]
    ds_read_b64_tr_b16 a[226:227], v9 offset:18432
    v_mul_f32 v146, v146, v38
    v_mfma_f32_16x16x32_bf16 v[200:203], a[240:243], a[20:23], v[200:203]
    ds_read_b64_tr_b16 a[228:229], v10 offset:16384
    v_mul_f32 v39, v39, v147
    v_mfma_f32_16x16x32_bf16 v[196:199], a[244:247], a[16:19], v[196:199]
    ds_read_b64_tr_b16 a[230:231], v10 offset:18432
    v_exp_f32 v39, v39
    v_mfma_f32_16x16x32_bf16 v[204:207], a[244:247], a[20:23], v[204:207]
    s_waitcnt lgkmcnt(8)
    ds_read_b64_tr_b16 a[232:233], v11 offset:16384
    v_fma_f32 v39, v39, v250, v250
    v_mfma_f32_16x16x32_bf16 v[176:179], a[248:251], a[24:27], v[176:179]
    ds_read_b64_tr_b16 a[234:235], v11 offset:18432
    v_mul_f32 v28, v148, v148
    v_mfma_f32_16x16x32_bf16 v[184:187], a[248:251], a[28:31], v[184:187]
    ds_read_b64_tr_b16 a[236:237], v12 offset:16384
    v_fma_f32 v28, v28, v26, v24
    v_mfma_f32_16x16x32_bf16 v[180:183], a[252:255], a[24:27], v[180:183]
    ds_read_b64_tr_b16 a[238:239], v12 offset:18432
    buffer_load_dwordx4 v2, s[12:15], s32 offen offset:1024 lds
    v_rcp_f32 v39, v39
    v_mfma_f32_16x16x32_bf16 v[188:191], a[252:255], a[28:31], v[188:191]
    s_waitcnt lgkmcnt(8)
    ds_read_b64_tr_b16 a[240:241], v9 offset:20480
    v_mul_f32 v147, v147, v39
    v_mfma_f32_16x16x32_bf16 v[192:195], a[216:219], a[24:27], v[192:195]
    ds_read_b64_tr_b16 a[242:243], v9 offset:22528
    v_mul_f32 v28, v28, v148
    v_mfma_f32_16x16x32_bf16 v[200:203], a[216:219], a[28:31], v[200:203]
    ds_read_b64_tr_b16 a[244:245], v10 offset:20480
    v_exp_f32 v28, v28
    v_mfma_f32_16x16x32_bf16 v[196:199], a[220:223], a[24:27], v[196:199]
    ds_read_b64_tr_b16 a[246:247], v10 offset:22528
    v_fma_f32 v28, v28, v250, v250
    v_mfma_f32_16x16x32_bf16 v[204:207], a[220:223], a[28:31], v[204:207]
    s_waitcnt lgkmcnt(8)
    ds_read_b64_tr_b16 a[248:249], v11 offset:20480
    v_mul_f32 v29, v149, v149
    v_mfma_f32_16x16x32_bf16 v[176:179], a[224:227], a[32:35], v[176:179]
    ds_read_b64_tr_b16 a[250:251], v11 offset:22528
    v_fma_f32 v29, v29, v26, v24
    v_mfma_f32_16x16x32_bf16 v[184:187], a[224:227], a[36:39], v[184:187]
    ds_read_b64_tr_b16 a[252:253], v12 offset:20480
    buffer_load_dwordx4 v3, s[12:15], s32 offen offset:2048 lds
    v_rcp_f32 v28, v28
    v_mfma_f32_16x16x32_bf16 v[180:183], a[228:231], a[32:35], v[180:183]
    ds_read_b64_tr_b16 a[254:255], v12 offset:22528
    v_mul_f32 v148, v148, v28
    v_mfma_f32_16x16x32_bf16 v[188:191], a[228:231], a[36:39], v[188:191]
    s_waitcnt lgkmcnt(8)
    ds_read_b64_tr_b16 a[216:217], v9 offset:24576
    v_mul_f32 v29, v29, v149
    v_mfma_f32_16x16x32_bf16 v[192:195], a[232:235], a[32:35], v[192:195]
    ds_read_b64_tr_b16 a[218:219], v9 offset:26624
    v_mul_f32 v30, v150, v150
    v_mfma_f32_16x16x32_bf16 v[200:203], a[232:235], a[36:39], v[200:203]
    ds_read_b64_tr_b16 a[220:221], v10 offset:24576
    v_exp_f32 v29, v29
    v_mfma_f32_16x16x32_bf16 v[196:199], a[236:239], a[32:35], v[196:199]
    ds_read_b64_tr_b16 a[222:223], v10 offset:26624
    v_fma_f32 v29, v29, v250, v250
    v_mfma_f32_16x16x32_bf16 v[204:207], a[236:239], a[36:39], v[204:207]
    s_waitcnt lgkmcnt(8)
    ds_read_b64_tr_b16 a[224:225], v11 offset:24576
    v_fma_f32 v30, v30, v26, v24
    v_mfma_f32_16x16x32_bf16 v[176:179], a[240:243], a[40:43], v[176:179]
    ds_read_b64_tr_b16 a[226:227], v11 offset:26624
    buffer_load_dwordx4 v4, s[12:15], s32 offen offset:3072 lds
    v_rcp_f32 v29, v29
    v_mfma_f32_16x16x32_bf16 v[184:187], a[240:243], a[44:47], v[184:187]
    s_add_u32 m0, s33, 118784
    ds_read_b64_tr_b16 a[228:229], v12 offset:24576
    v_mul_f32 v149, v149, v29
    v_mfma_f32_16x16x32_bf16 v[180:183], a[244:247], a[40:43], v[180:183]
    s_add_u32 s32, s38, 3244288
    ds_read_b64_tr_b16 a[230:231], v12 offset:26624
    v_mul_f32 v30, v30, v150
    v_mfma_f32_16x16x32_bf16 v[188:191], a[244:247], a[44:47], v[188:191]
    s_waitcnt lgkmcnt(8)
    ds_read_b64_tr_b16 a[232:233], v9 offset:28672
    v_mul_f32 v31, v151, v151
    v_mfma_f32_16x16x32_bf16 v[192:195], a[248:251], a[40:43], v[192:195]
    ds_read_b64_tr_b16 a[234:235], v9 offset:30720
    v_exp_f32 v30, v30
    v_mfma_f32_16x16x32_bf16 v[200:203], a[248:251], a[44:47], v[200:203]
    ds_read_b64_tr_b16 a[236:237], v10 offset:28672
    v_fma_f32 v30, v30, v250, v250
    v_mfma_f32_16x16x32_bf16 v[196:199], a[252:255], a[40:43], v[196:199]
    ds_read_b64_tr_b16 a[238:239], v10 offset:30720
    v_fma_f32 v31, v31, v26, v24
    v_mfma_f32_16x16x32_bf16 v[204:207], a[252:255], a[44:47], v[204:207]
    s_waitcnt lgkmcnt(8)
    ds_read_b64_tr_b16 a[240:241], v11 offset:28672
    buffer_load_dwordx4 v1, s[12:15], s32 offen offset:0 lds
    v_mfma_f32_16x16x32_bf16 v[176:179], a[216:219], a[48:51], v[176:179]
    ds_read_b64_tr_b16 a[242:243], v11 offset:30720
    v_rcp_f32 v30, v30
    v_mfma_f32_16x16x32_bf16 v[184:187], a[216:219], a[52:55], v[184:187]
    s_waitcnt vmcnt(7)
    ds_read_b64_tr_b16 a[244:245], v12 offset:28672
    buffer_store_dword v248, v245, s[20:23], s53 offen offset:0 sc1
    v_mul_f32 v150, v150, v30
    v_mfma_f32_16x16x32_bf16 v[180:183], a[220:223], a[48:51], v[180:183]
    ds_read_b64_tr_b16 a[246:247], v12 offset:30720
    v_mul_f32 v31, v31, v151
    v_mfma_f32_16x16x32_bf16 v[188:191], a[220:223], a[52:55], v[188:191]
    s_waitcnt lgkmcnt(8)
    ds_read_b64_tr_b16 a[248:249], v9 offset:32768
    v_exp_f32 v31, v31
    v_mfma_f32_16x16x32_bf16 v[192:195], a[224:227], a[48:51], v[192:195]
    ds_read_b64_tr_b16 a[250:251], v9 offset:34816
    v_fma_f32 v31, v31, v250, v250
    v_mfma_f32_16x16x32_bf16 v[200:203], a[224:227], a[52:55], v[200:203]
    ds_read_b64_tr_b16 a[252:253], v10 offset:32768
    v_rcp_f32 v31, v31
    v_mfma_f32_16x16x32_bf16 v[196:199], a[228:231], a[48:51], v[196:199]
    ds_read_b64_tr_b16 a[254:255], v10 offset:34816
    v_mul_f32 v151, v151, v31
    v_mfma_f32_16x16x32_bf16 v[204:207], a[228:231], a[52:55], v[204:207]
    s_waitcnt lgkmcnt(8)
    ds_read_b64_tr_b16 a[216:217], v11 offset:32768
    v_mul_f32 v32, v152, v152
    v_mfma_f32_16x16x32_bf16 v[176:179], a[232:235], a[56:59], v[176:179]
    ds_read_b64_tr_b16 a[218:219], v11 offset:34816
    v_fma_f32 v32, v32, v27, v25
    v_mfma_f32_16x16x32_bf16 v[184:187], a[232:235], a[60:63], v[184:187]
    ds_read_b64_tr_b16 a[220:221], v12 offset:32768
    v_mul_f32 v32, v32, v152
    v_mfma_f32_16x16x32_bf16 v[180:183], a[236:239], a[56:59], v[180:183]
    ds_read_b64_tr_b16 a[222:223], v12 offset:34816
    v_exp_f32 v32, v32
    v_mfma_f32_16x16x32_bf16 v[188:191], a[236:239], a[60:63], v[188:191]
    s_waitcnt lgkmcnt(8)
    v_fma_f32 v32, v32, v252, v252
    v_mul_f32 v33, v153, v153
    v_mfma_f32_16x16x32_bf16 v[192:195], a[240:243], a[56:59], v[192:195]
    v_rcp_f32 v32, v32
    v_mfma_f32_16x16x32_bf16 v[200:203], a[240:243], a[60:63], v[200:203]
    s_waitcnt lgkmcnt(0)
    s_barrier
    ds_read_b64_tr_b16 a[224:225], v9 offset:36864
    ds_read_b64_tr_b16 a[226:227], v9 offset:38912
    v_mfma_f32_16x16x32_bf16 v[196:199], a[244:247], a[56:59], v[196:199]
    s_add_u32 m0, s33, 0
    ds_read_b64_tr_b16 a[228:229], v10 offset:36864
    ds_read_b64_tr_b16 a[230:231], v10 offset:38912
    v_mul_f32 v152, v152, v32
    v_mfma_f32_16x16x32_bf16 v[204:207], a[244:247], a[60:63], v[204:207]
    s_add_u32 s32, s38, 256
    ds_read_b64_tr_b16 a[232:233], v11 offset:36864
    buffer_load_dwordx4 v1, s[4:7], s32 offen offset:0 lds
    v_fma_f32 v33, v33, v27, v25
    v_mfma_f32_16x16x32_bf16 v[176:179], a[248:251], a[64:67], v[176:179]
    ds_read_b64_tr_b16 a[234:235], v11 offset:38912
    v_mul_f32 v33, v33, v153
    v_mfma_f32_16x16x32_bf16 v[184:187], a[248:251], a[68:71], v[184:187]
    ds_read_b64_tr_b16 a[236:237], v12 offset:36864
    v_exp_f32 v33, v33
    v_mfma_f32_16x16x32_bf16 v[180:183], a[252:255], a[64:67], v[180:183]
    ds_read_b64_tr_b16 a[238:239], v12 offset:38912
    v_fma_f32 v33, v33, v252, v252
    v_mfma_f32_16x16x32_bf16 v[188:191], a[252:255], a[68:71], v[188:191]
    ds_read_b64_tr_b16 a[240:241], v9 offset:40960
    v_rcp_f32 v33, v33
    v_mfma_f32_16x16x32_bf16 v[192:195], a[216:219], a[64:67], v[192:195]
    ds_read_b64_tr_b16 a[242:243], v9 offset:43008
    v_mul_f32 v153, v153, v33
    v_mfma_f32_16x16x32_bf16 v[200:203], a[216:219], a[68:71], v[200:203]
    ds_read_b64_tr_b16 a[244:245], v10 offset:40960
    v_mul_f32 v34, v154, v154
    v_mfma_f32_16x16x32_bf16 v[196:199], a[220:223], a[64:67], v[196:199]
    ds_read_b64_tr_b16 a[246:247], v10 offset:43008
    buffer_load_dwordx4 v2, s[4:7], s32 offen offset:1024 lds
    v_fma_f32 v34, v34, v27, v25
    v_mfma_f32_16x16x32_bf16 v[204:207], a[220:223], a[68:71], v[204:207]
    s_waitcnt lgkmcnt(8)
    ds_read_b64_tr_b16 a[248:249], v11 offset:40960
    v_mul_f32 v34, v34, v154
    v_mfma_f32_16x16x32_bf16 v[176:179], a[224:227], a[72:75], v[176:179]
    ds_read_b64_tr_b16 a[250:251], v11 offset:43008
    v_exp_f32 v34, v34
    v_mfma_f32_16x16x32_bf16 v[184:187], a[224:227], a[76:79], v[184:187]
    ds_read_b64_tr_b16 a[252:253], v12 offset:40960
    v_fma_f32 v34, v34, v252, v252
    v_mfma_f32_16x16x32_bf16 v[180:183], a[228:231], a[72:75], v[180:183]
    ds_read_b64_tr_b16 a[254:255], v12 offset:43008
    v_rcp_f32 v34, v34
    v_mfma_f32_16x16x32_bf16 v[188:191], a[228:231], a[76:79], v[188:191]
    s_waitcnt lgkmcnt(8)
    ds_read_b64_tr_b16 a[216:217], v9 offset:45056
    v_mul_f32 v154, v154, v34
    v_mfma_f32_16x16x32_bf16 v[192:195], a[232:235], a[72:75], v[192:195]
    ds_read_b64_tr_b16 a[218:219], v9 offset:47104
    v_mul_f32 v35, v155, v155
    v_mfma_f32_16x16x32_bf16 v[200:203], a[232:235], a[76:79], v[200:203]
    ds_read_b64_tr_b16 a[220:221], v10 offset:45056
    buffer_load_dwordx4 v3, s[4:7], s32 offen offset:2048 lds
    v_fma_f32 v35, v35, v27, v25
    v_mfma_f32_16x16x32_bf16 v[196:199], a[236:239], a[72:75], v[196:199]
    ds_read_b64_tr_b16 a[222:223], v10 offset:47104
    v_mul_f32 v35, v35, v155
    v_mfma_f32_16x16x32_bf16 v[204:207], a[236:239], a[76:79], v[204:207]
    s_waitcnt lgkmcnt(8)
    ds_read_b64_tr_b16 a[224:225], v11 offset:45056
    v_exp_f32 v35, v35
    v_mfma_f32_16x16x32_bf16 v[176:179], a[240:243], a[80:83], v[176:179]
    ds_read_b64_tr_b16 a[226:227], v11 offset:47104
    v_fma_f32 v35, v35, v252, v252
    v_mfma_f32_16x16x32_bf16 v[184:187], a[240:243], a[84:87], v[184:187]
    ds_read_b64_tr_b16 a[228:229], v12 offset:45056
    v_rcp_f32 v35, v35
    v_mfma_f32_16x16x32_bf16 v[180:183], a[244:247], a[80:83], v[180:183]
    ds_read_b64_tr_b16 a[230:231], v12 offset:47104
    v_mul_f32 v155, v155, v35
    v_mfma_f32_16x16x32_bf16 v[188:191], a[244:247], a[84:87], v[188:191]
    s_waitcnt lgkmcnt(8)
    ds_read_b64_tr_b16 a[232:233], v13 offset:0
    v_mul_f32 v36, v156, v156
    v_mfma_f32_16x16x32_bf16 v[192:195], a[248:251], a[80:83], v[192:195]
    ds_read_b64_tr_b16 a[234:235], v13 offset:2048
    buffer_load_dwordx4 v4, s[4:7], s32 offen offset:3072 lds
    v_fma_f32 v36, v36, v27, v25
    v_mfma_f32_16x16x32_bf16 v[200:203], a[248:251], a[84:87], v[200:203]
    s_add_u32 m0, s33, 4096
    ds_read_b64_tr_b16 a[236:237], v14 offset:0
    v_mul_f32 v36, v36, v156
    v_mfma_f32_16x16x32_bf16 v[196:199], a[252:255], a[80:83], v[196:199]
    s_add_u32 s32, s38, 295168
    ds_read_b64_tr_b16 a[238:239], v14 offset:2048
    v_exp_f32 v36, v36
    v_mfma_f32_16x16x32_bf16 v[204:207], a[252:255], a[84:87], v[204:207]
    s_waitcnt lgkmcnt(8)
    ds_read_b64_tr_b16 a[240:241], v15 offset:0
    v_fma_f32 v36, v36, v252, v252
    v_mfma_f32_16x16x32_bf16 v[176:179], a[216:219], a[88:91], v[176:179]
    ds_read_b64_tr_b16 a[242:243], v15 offset:2048
    v_rcp_f32 v36, v36
    v_mfma_f32_16x16x32_bf16 v[184:187], a[216:219], a[92:95], v[184:187]
    ds_read_b64_tr_b16 a[244:245], v16 offset:0
    v_mul_f32 v156, v156, v36
    v_mfma_f32_16x16x32_bf16 v[180:183], a[220:223], a[88:91], v[180:183]
    ds_read_b64_tr_b16 a[246:247], v16 offset:2048
    v_mul_f32 v37, v157, v157
    v_mfma_f32_16x16x32_bf16 v[188:191], a[220:223], a[92:95], v[188:191]
    s_waitcnt lgkmcnt(8)
    ds_read_b64_tr_b16 a[248:249], v13 offset:4096
    buffer_load_dwordx4 v1, s[4:7], s32 offen offset:0 lds
    v_fma_f32 v37, v37, v27, v25
    v_mfma_f32_16x16x32_bf16 v[192:195], a[224:227], a[88:91], v[192:195]
    ds_read_b64_tr_b16 a[250:251], v13 offset:6144
    v_mul_f32 v37, v37, v157
    v_mfma_f32_16x16x32_bf16 v[200:203], a[224:227], a[92:95], v[200:203]
    ds_read_b64_tr_b16 a[252:253], v14 offset:4096
    v_exp_f32 v37, v37
    v_mfma_f32_16x16x32_bf16 v[196:199], a[228:231], a[88:91], v[196:199]
    ds_read_b64_tr_b16 a[254:255], v14 offset:6144
    v_fma_f32 v37, v37, v252, v252
    v_mfma_f32_16x16x32_bf16 v[204:207], a[228:231], a[92:95], v[204:207]
    s_waitcnt lgkmcnt(8)
    ds_read_b64_tr_b16 a[216:217], v15 offset:4096
    v_rcp_f32 v37, v37
    v_mfma_f32_16x16x32_bf16 v[176:179], a[232:235], a[96:99], v[176:179]
    ds_read_b64_tr_b16 a[218:219], v15 offset:6144
    v_mul_f32 v157, v157, v37
    v_mfma_f32_16x16x32_bf16 v[184:187], a[232:235], a[100:103], v[184:187]
    ds_read_b64_tr_b16 a[220:221], v16 offset:4096
    v_mul_f32 v38, v158, v158
    v_mfma_f32_16x16x32_bf16 v[180:183], a[236:239], a[96:99], v[180:183]
    ds_read_b64_tr_b16 a[222:223], v16 offset:6144
    buffer_load_dwordx4 v2, s[4:7], s32 offen offset:1024 lds
    v_fma_f32 v38, v38, v27, v25
    v_mfma_f32_16x16x32_bf16 v[188:191], a[236:239], a[100:103], v[188:191]
    s_waitcnt lgkmcnt(8)
    ds_read_b64_tr_b16 a[224:225], v13 offset:8192
    v_mul_f32 v38, v38, v158
    v_mfma_f32_16x16x32_bf16 v[192:195], a[240:243], a[96:99], v[192:195]
    ds_read_b64_tr_b16 a[226:227], v13 offset:10240
    v_exp_f32 v38, v38
    v_mfma_f32_16x16x32_bf16 v[200:203], a[240:243], a[100:103], v[200:203]
    ds_read_b64_tr_b16 a[228:229], v14 offset:8192
    v_fma_f32 v38, v38, v252, v252
    v_mfma_f32_16x16x32_bf16 v[196:199], a[244:247], a[96:99], v[196:199]
    ds_read_b64_tr_b16 a[230:231], v14 offset:10240
    v_rcp_f32 v38, v38
    v_mfma_f32_16x16x32_bf16 v[204:207], a[244:247], a[100:103], v[204:207]
    s_waitcnt lgkmcnt(8)
    ds_read_b64_tr_b16 a[232:233], v15 offset:8192
    v_mul_f32 v158, v158, v38
    v_mfma_f32_16x16x32_bf16 v[176:179], a[248:251], a[104:107], v[176:179]
    ds_read_b64_tr_b16 a[234:235], v15 offset:10240
    v_mul_f32 v39, v159, v159
    v_mfma_f32_16x16x32_bf16 v[184:187], a[248:251], a[108:111], v[184:187]
    ds_read_b64_tr_b16 a[236:237], v16 offset:8192
    buffer_load_dwordx4 v3, s[4:7], s32 offen offset:2048 lds
    v_fma_f32 v39, v39, v27, v25
    v_mfma_f32_16x16x32_bf16 v[180:183], a[252:255], a[104:107], v[180:183]
    ds_read_b64_tr_b16 a[238:239], v16 offset:10240
    v_mul_f32 v39, v39, v159
    v_mfma_f32_16x16x32_bf16 v[188:191], a[252:255], a[108:111], v[188:191]
    s_waitcnt lgkmcnt(8)
    ds_read_b64_tr_b16 a[240:241], v13 offset:12288
    v_exp_f32 v39, v39
    v_mfma_f32_16x16x32_bf16 v[192:195], a[216:219], a[104:107], v[192:195]
    ds_read_b64_tr_b16 a[242:243], v13 offset:14336
    v_fma_f32 v39, v39, v252, v252
    v_mfma_f32_16x16x32_bf16 v[200:203], a[216:219], a[108:111], v[200:203]
    ds_read_b64_tr_b16 a[244:245], v14 offset:12288
    buffer_load_dword v247, off, s[20:23], s54 offset:0 sc1
    v_rcp_f32 v39, v39
    v_mfma_f32_16x16x32_bf16 v[196:199], a[220:223], a[104:107], v[196:199]
    ds_read_b64_tr_b16 a[246:247], v14 offset:14336
    v_mul_f32 v159, v159, v39
    v_mfma_f32_16x16x32_bf16 v[204:207], a[220:223], a[108:111], v[204:207]
    s_waitcnt lgkmcnt(8)
    ds_read_b64_tr_b16 a[248:249], v15 offset:12288
    v_mul_f32 v28, v160, v160
    v_mfma_f32_16x16x32_bf16 v[176:179], a[224:227], a[112:115], v[176:179]
    ds_read_b64_tr_b16 a[250:251], v15 offset:14336
    buffer_load_dwordx4 v4, s[4:7], s32 offen offset:3072 lds
    v_mfma_f32_16x16x32_bf16 v[184:187], a[224:227], a[116:119], v[184:187]
    s_add_u32 m0, s33, 8192
    ds_read_b64_tr_b16 a[252:253], v16 offset:12288
    v_fma_f32 v28, v28, v26, v24
    v_mul_f32 v28, v28, v160
    v_mfma_f32_16x16x32_bf16 v[180:183], a[228:231], a[112:115], v[180:183]
    s_add_u32 s32, s38, 590080
    ds_read_b64_tr_b16 a[254:255], v16 offset:14336
    v_exp_f32 v28, v28
    v_mfma_f32_16x16x32_bf16 v[188:191], a[228:231], a[116:119], v[188:191]
    s_waitcnt lgkmcnt(8)
    ds_read_b64_tr_b16 a[216:217], v13 offset:16384
    v_fma_f32 v28, v28, v250, v250
    v_mfma_f32_16x16x32_bf16 v[192:195], a[232:235], a[112:115], v[192:195]
    ds_read_b64_tr_b16 a[218:219], v13 offset:18432
    v_rcp_f32 v28, v28
    v_mfma_f32_16x16x32_bf16 v[200:203], a[232:235], a[116:119], v[200:203]
    ds_read_b64_tr_b16 a[220:221], v14 offset:16384
    v_mul_f32 v160, v160, v28
    v_mfma_f32_16x16x32_bf16 v[196:199], a[236:239], a[112:115], v[196:199]
    ds_read_b64_tr_b16 a[222:223], v14 offset:18432
    v_mul_f32 v29, v161, v161
    v_mfma_f32_16x16x32_bf16 v[204:207], a[236:239], a[116:119], v[204:207]
    s_waitcnt lgkmcnt(8)
    ds_read_b64_tr_b16 a[224:225], v15 offset:16384
    buffer_load_dwordx4 v1, s[4:7], s32 offen offset:0 lds
    v_mfma_f32_16x16x32_bf16 v[176:179], a[240:243], a[120:123], v[176:179]
    ds_read_b64_tr_b16 a[226:227], v15 offset:18432
    v_fma_f32 v29, v29, v26, v24
    v_mul_f32 v29, v29, v161
    v_mfma_f32_16x16x32_bf16 v[184:187], a[240:243], a[124:127], v[184:187]
    ds_read_b64_tr_b16 a[228:229], v16 offset:16384
    v_exp_f32 v29, v29
    v_mfma_f32_16x16x32_bf16 v[180:183], a[244:247], a[120:123], v[180:183]
    ds_read_b64_tr_b16 a[230:231], v16 offset:18432
    v_fma_f32 v29, v29, v250, v250
    v_mfma_f32_16x16x32_bf16 v[188:191], a[244:247], a[124:127], v[188:191]
    s_waitcnt lgkmcnt(8)
    ds_read_b64_tr_b16 a[232:233], v13 offset:20480
    v_mul_f32 v30, v162, v162
    v_mfma_f32_16x16x32_bf16 v[192:195], a[248:251], a[120:123], v[192:195]
    ds_read_b64_tr_b16 a[234:235], v13 offset:22528
    v_rcp_f32 v29, v29
    v_mfma_f32_16x16x32_bf16 v[200:203], a[248:251], a[124:127], v[200:203]
    ds_read_b64_tr_b16 a[236:237], v14 offset:20480
    v_mul_f32 v161, v161, v29
    v_mfma_f32_16x16x32_bf16 v[196:199], a[252:255], a[120:123], v[196:199]
    ds_read_b64_tr_b16 a[238:239], v14 offset:22528
    v_fma_f32 v30, v30, v26, v24
    v_mfma_f32_16x16x32_bf16 v[204:207], a[252:255], a[124:127], v[204:207]
    s_waitcnt lgkmcnt(8)
    ds_read_b64_tr_b16 a[240:241], v15 offset:20480
    v_mul_f32 v30, v30, v162
    v_mfma_f32_16x16x32_bf16 v[176:179], a[216:219], a[128:131], v[176:179]
    ds_read_b64_tr_b16 a[242:243], v15 offset:22528
    v_exp_f32 v30, v30
    v_mfma_f32_16x16x32_bf16 v[184:187], a[216:219], a[132:135], v[184:187]
    ds_read_b64_tr_b16 a[244:245], v16 offset:20480
    v_fma_f32 v30, v30, v250, v250
    v_mfma_f32_16x16x32_bf16 v[180:183], a[220:223], a[128:131], v[180:183]
    ds_read_b64_tr_b16 a[246:247], v16 offset:22528
    v_mul_f32 v31, v163, v163
    v_mfma_f32_16x16x32_bf16 v[188:191], a[220:223], a[132:135], v[188:191]
    s_waitcnt lgkmcnt(8)
    v_rcp_f32 v30, v30
    v_mfma_f32_16x16x32_bf16 v[192:195], a[224:227], a[128:131], v[192:195]
    v_mul_f32 v162, v162, v30
    v_fma_f32 v31, v31, v26, v24
    v_mfma_f32_16x16x32_bf16 v[200:203], a[224:227], a[132:135], v[200:203]
    s_waitcnt lgkmcnt(0)
    s_barrier
    ds_read_b64_tr_b16 a[248:249], v13 offset:24576
    ds_read_b64_tr_b16 a[250:251], v13 offset:26624
    v_mfma_f32_16x16x32_bf16 v[196:199], a[228:231], a[128:131], v[196:199]
    s_add_u32 m0, s33, 36864
    ds_read_b64_tr_b16 a[252:253], v14 offset:24576
    ds_read_b64_tr_b16 a[254:255], v14 offset:26624
    v_mul_f32 v31, v31, v163
    v_mfma_f32_16x16x32_bf16 v[204:207], a[228:231], a[132:135], v[204:207]
    s_add_u32 s32, s38, 2654464
    ds_read_b64_tr_b16 a[216:217], v15 offset:24576
    buffer_load_dwordx4 v1, s[4:7], s32 offen offset:0 lds
    v_exp_f32 v31, v31
    v_mfma_f32_16x16x32_bf16 v[176:179], a[232:235], a[136:139], v[176:179]
    ds_read_b64_tr_b16 a[218:219], v15 offset:26624
    v_fma_f32 v31, v31, v250, v250
    v_mfma_f32_16x16x32_bf16 v[184:187], a[232:235], a[140:143], v[184:187]
    ds_read_b64_tr_b16 a[220:221], v16 offset:24576
    v_mul_f32 v32, v164, v164
    v_mfma_f32_16x16x32_bf16 v[180:183], a[236:239], a[136:139], v[180:183]
    ds_read_b64_tr_b16 a[222:223], v16 offset:26624
    v_rcp_f32 v31, v31
    v_mfma_f32_16x16x32_bf16 v[188:191], a[236:239], a[140:143], v[188:191]
    ds_read_b64_tr_b16 a[224:225], v13 offset:28672
    v_mul_f32 v163, v163, v31
    v_mfma_f32_16x16x32_bf16 v[192:195], a[240:243], a[136:139], v[192:195]
    ds_read_b64_tr_b16 a[226:227], v13 offset:30720
    v_fma_f32 v32, v32, v26, v24
    v_mfma_f32_16x16x32_bf16 v[200:203], a[240:243], a[140:143], v[200:203]
    ds_read_b64_tr_b16 a[228:229], v14 offset:28672
    v_mul_f32 v32, v32, v164
    v_mfma_f32_16x16x32_bf16 v[196:199], a[244:247], a[136:139], v[196:199]
    ds_read_b64_tr_b16 a[230:231], v14 offset:30720
    buffer_load_dwordx4 v2, s[4:7], s32 offen offset:1024 lds
    v_exp_f32 v32, v32
    v_mfma_f32_16x16x32_bf16 v[204:207], a[244:247], a[140:143], v[204:207]
    s_waitcnt lgkmcnt(8)
    ds_read_b64_tr_b16 a[232:233], v15 offset:28672
    v_fma_f32 v32, v32, v250, v250
    v_mfma_f32_16x16x32_bf16 v[112:115], a[248:251], a[0:3], 0
    ds_read_b64_tr_b16 a[234:235], v15 offset:30720
    v_mul_f32 v176, v176, v144
    v_mfma_f32_16x16x32_bf16 v[120:123], a[248:251], a[4:7], 0
    s_waitcnt vmcnt(4)
    ds_read_b64_tr_b16 a[236:237], v16 offset:28672
    v_rcp_f32 v32, v32
    v_mfma_f32_16x16x32_bf16 v[116:119], a[252:255], a[0:3], 0
    ds_read_b64_tr_b16 a[238:239], v16 offset:30720
    v_cmp_eq_u32 vcc, 0, v247
    v_mfma_f32_16x16x32_bf16 v[124:127], a[252:255], a[4:7], 0
    s_waitcnt lgkmcnt(8)
    ds_read_b64_tr_b16 a[240:241], v13 offset:32768
    v_mul_f32 v177, v177, v145
    v_mfma_f32_16x16x32_bf16 v[128:131], a[216:219], a[0:3], 0
    s_cbranch_vccnz L_ffn_kernel_spinh0
L_ffn_kernel_reth0:
    ds_read_b64_tr_b16 a[242:243], v13 offset:34816
    v_cvt_pk_bf16_f32 v56, v176, v177
    v_mfma_f32_16x16x32_bf16 v[136:139], a[216:219], a[4:7], 0
    s_add_u32 s52, s60, 0
    ds_read_b64_tr_b16 a[244:245], v14 offset:32768
    buffer_load_dwordx4 v3, s[4:7], s32 offen offset:2048 lds
    v_mul_f32 v178, v178, v146
    v_mfma_f32_16x16x32_bf16 v[132:135], a[220:223], a[0:3], 0
    ds_read_b64_tr_b16 a[246:247], v14 offset:34816
    buffer_load_dwordx4 a[144:147], v23, s[20:23], s52 offen offset:0 sc1
    v_mul_f32 v179, v179, v147
    v_mfma_f32_16x16x32_bf16 v[140:143], a[220:223], a[4:7], 0
    s_waitcnt lgkmcnt(8)
    ds_read_b64_tr_b16 a[248:249], v15 offset:32768
    buffer_load_dwordx4 a[148:151], v23, s[20:23], s52 offen offset:1024 sc1
    v_cvt_pk_bf16_f32 v57, v178, v179
    v_mfma_f32_16x16x32_bf16 v[112:115], a[224:227], a[8:11], v[112:115]
    ds_read_b64_tr_b16 a[250:251], v15 offset:34816
    buffer_load_dwordx4 a[152:155], v23, s[20:23], s52 offen offset:2048 sc1
    v_mul_f32 v180, v180, v148
    v_mfma_f32_16x16x32_bf16 v[120:123], a[224:227], a[12:15], v[120:123]
    ds_read_b64_tr_b16 a[252:253], v16 offset:32768
    buffer_load_dwordx4 a[156:159], v23, s[20:23], s52 offen offset:3072 sc1
    v_mul_f32 v181, v181, v149
    v_cvt_pk_bf16_f32 v58, v180, v181
    v_mfma_f32_16x16x32_bf16 v[116:119], a[228:231], a[8:11], v[116:119]
    ds_read_b64_tr_b16 a[254:255], v16 offset:34816
    v_mul_f32 v182, v182, v150
    v_mfma_f32_16x16x32_bf16 v[124:127], a[228:231], a[12:15], v[124:127]
    s_waitcnt lgkmcnt(8)
    ds_read_b64_tr_b16 a[216:217], v13 offset:36864
    v_mul_f32 v183, v183, v151
    v_mfma_f32_16x16x32_bf16 v[128:131], a[232:235], a[8:11], v[128:131]
    ds_read_b64_tr_b16 a[218:219], v13 offset:38912
    buffer_load_dwordx4 v4, s[4:7], s32 offen offset:3072 lds
    v_cvt_pk_bf16_f32 v59, v182, v183
    v_mul_f32 v184, v184, v152
    v_mfma_f32_16x16x32_bf16 v[136:139], a[232:235], a[12:15], v[136:139]
    s_add_u32 m0, s33, 40960
    ds_read_b64_tr_b16 a[220:221], v14 offset:36864
    buffer_store_dwordx4 v[56:59], v23, s[20:23], s49 offen offset:0 sc1
    v_mul_f32 v185, v185, v153
    v_mfma_f32_16x16x32_bf16 v[132:135], a[236:239], a[8:11], v[132:135]
    s_add_u32 s32, s38, 2949376
    ds_read_b64_tr_b16 a[222:223], v14 offset:38912
    v_cvt_pk_bf16_f32 v60, v184, v185
    v_mfma_f32_16x16x32_bf16 v[140:143], a[236:239], a[12:15], v[140:143]
    s_waitcnt lgkmcnt(8)
    ds_read_b64_tr_b16 a[224:225], v15 offset:36864
    v_mul_f32 v186, v186, v154
    v_mfma_f32_16x16x32_bf16 v[112:115], a[240:243], a[16:19], v[112:115]
    ds_read_b64_tr_b16 a[226:227], v15 offset:38912
    v_mul_f32 v187, v187, v155
    v_cvt_pk_bf16_f32 v61, v186, v187
    v_mfma_f32_16x16x32_bf16 v[120:123], a[240:243], a[20:23], v[120:123]
    ds_read_b64_tr_b16 a[228:229], v16 offset:36864
    v_mul_f32 v188, v188, v156
    v_mfma_f32_16x16x32_bf16 v[116:119], a[244:247], a[16:19], v[116:119]
    ds_read_b64_tr_b16 a[230:231], v16 offset:38912
    v_mul_f32 v189, v189, v157
    v_mfma_f32_16x16x32_bf16 v[124:127], a[244:247], a[20:23], v[124:127]
    s_waitcnt lgkmcnt(8)
    ds_read_b64_tr_b16 a[232:233], v13 offset:40960
    buffer_load_dwordx4 v1, s[4:7], s32 offen offset:0 lds
    v_cvt_pk_bf16_f32 v62, v188, v189
    v_mul_f32 v190, v190, v158
    v_mfma_f32_16x16x32_bf16 v[128:131], a[248:251], a[16:19], v[128:131]
    ds_read_b64_tr_b16 a[234:235], v13 offset:43008
    v_mul_f32 v191, v191, v159
    v_mfma_f32_16x16x32_bf16 v[136:139], a[248:251], a[20:23], v[136:139]
    ds_read_b64_tr_b16 a[236:237], v14 offset:40960
    v_cvt_pk_bf16_f32 v63, v190, v191
    v_mfma_f32_16x16x32_bf16 v[132:135], a[252:255], a[16:19], v[132:135]
    ds_read_b64_tr_b16 a[238:239], v14 offset:43008
    buffer_store_dwordx4 v[60:63], v23, s[20:23], s49 offen offset:1024 sc1
    v_mul_f32 v192, v192, v160
    v_mfma_f32_16x16x32_bf16 v[140:143], a[252:255], a[20:23], v[140:143]
    s_waitcnt lgkmcnt(8)
    ds_read_b64_tr_b16 a[240:241], v15 offset:40960
    v_mul_f32 v193, v193, v161
    v_cvt_pk_bf16_f32 v64, v192, v193
    v_mfma_f32_16x16x32_bf16 v[112:115], a[216:219], a[24:27], v[112:115]
    ds_read_b64_tr_b16 a[242:243], v15 offset:43008
    v_mul_f32 v194, v194, v162
    v_mfma_f32_16x16x32_bf16 v[120:123], a[216:219], a[28:31], v[120:123]
    ds_read_b64_tr_b16 a[244:245], v16 offset:40960
    v_mul_f32 v195, v195, v163
    v_mfma_f32_16x16x32_bf16 v[116:119], a[220:223], a[24:27], v[116:119]
    ds_read_b64_tr_b16 a[246:247], v16 offset:43008
    buffer_load_dwordx4 v2, s[4:7], s32 offen offset:1024 lds
    v_cvt_pk_bf16_f32 v65, v194, v195
    v_mfma_f32_16x16x32_bf16 v[124:127], a[220:223], a[28:31], v[124:127]
    s_waitcnt lgkmcnt(8)
    ds_read_b64_tr_b16 a[248:249], v13 offset:45056
    v_mul_f32 v164, v164, v32
    v_mul_f32 v196, v196, v164
    v_mfma_f32_16x16x32_bf16 v[128:131], a[224:227], a[24:27], v[128:131]
    ds_read_b64_tr_b16 a[250:251], v13 offset:47104
    v_mul_f32 v33, v165, v165
    v_mfma_f32_16x16x32_bf16 v[136:139], a[224:227], a[28:31], v[136:139]
    ds_read_b64_tr_b16 a[252:253], v14 offset:45056
    v_fma_f32 v33, v33, v26, v24
    v_mfma_f32_16x16x32_bf16 v[132:135], a[228:231], a[24:27], v[132:135]
    ds_read_b64_tr_b16 a[254:255], v14 offset:47104
    v_mul_f32 v33, v33, v165
    v_mul_f32 v34, v166, v166
    v_mfma_f32_16x16x32_bf16 v[140:143], a[228:231], a[28:31], v[140:143]
    s_waitcnt lgkmcnt(8)
    ds_read_b64_tr_b16 a[216:217], v15 offset:45056
    v_exp_f32 v33, v33
    v_mfma_f32_16x16x32_bf16 v[112:115], a[232:235], a[32:35], v[112:115]
    ds_read_b64_tr_b16 a[218:219], v15 offset:47104
    v_fma_f32 v33, v33, v250, v250
    v_mfma_f32_16x16x32_bf16 v[120:123], a[232:235], a[36:39], v[120:123]
    ds_read_b64_tr_b16 a[220:221], v16 offset:45056
    buffer_load_dwordx4 v3, s[4:7], s32 offen offset:2048 lds
    v_mfma_f32_16x16x32_bf16 v[116:119], a[236:239], a[32:35], v[116:119]
    ds_read_b64_tr_b16 a[222:223], v16 offset:47104
    v_rcp_f32 v33, v33
    v_mfma_f32_16x16x32_bf16 v[124:127], a[236:239], a[36:39], v[124:127]
    s_waitcnt lgkmcnt(8)
    ds_read_b64_tr_b16 a[224:225], v17 offset:0
    v_mul_f32 v165, v165, v33
    v_mfma_f32_16x16x32_bf16 v[128:131], a[240:243], a[32:35], v[128:131]
    ds_read_b64_tr_b16 a[226:227], v17 offset:2048
    v_mul_f32 v197, v197, v165
    v_mfma_f32_16x16x32_bf16 v[136:139], a[240:243], a[36:39], v[136:139]
    ds_read_b64_tr_b16 a[228:229], v18 offset:0
    v_cvt_pk_bf16_f32 v66, v196, v197
    v_fma_f32 v34, v34, v26, v24
    v_mfma_f32_16x16x32_bf16 v[132:135], a[244:247], a[32:35], v[132:135]
    ds_read_b64_tr_b16 a[230:231], v18 offset:2048
    v_mul_f32 v34, v34, v166
    v_mfma_f32_16x16x32_bf16 v[140:143], a[244:247], a[36:39], v[140:143]
    s_waitcnt lgkmcnt(8)
    ds_read_b64_tr_b16 a[232:233], v19 offset:0
    v_exp_f32 v34, v34
    v_mfma_f32_16x16x32_bf16 v[112:115], a[248:251], a[40:43], v[112:115]
    ds_read_b64_tr_b16 a[234:235], v19 offset:2048
    buffer_load_dwordx4 v4, s[4:7], s32 offen offset:3072 lds
    v_mfma_f32_16x16x32_bf16 v[120:123], a[248:251], a[44:47], v[120:123]
    s_add_u32 m0, s33, 45056
    ds_read_b64_tr_b16 a[236:237], v20 offset:0
    v_fma_f32 v34, v34, v250, v250
    v_mul_f32 v35, v167, v167
    v_mfma_f32_16x16x32_bf16 v[116:119], a[252:255], a[40:43], v[116:119]
    s_add_u32 s32, s38, 3244288
    ds_read_b64_tr_b16 a[238:239], v20 offset:2048
    v_rcp_f32 v34, v34
    v_mfma_f32_16x16x32_bf16 v[124:127], a[252:255], a[44:47], v[124:127]
    s_waitcnt lgkmcnt(8)
    ds_read_b64_tr_b16 a[240:241], v17 offset:4096
    v_mul_f32 v166, v166, v34
    v_mfma_f32_16x16x32_bf16 v[128:131], a[216:219], a[40:43], v[128:131]
    ds_read_b64_tr_b16 a[242:243], v17 offset:6144
    v_mul_f32 v198, v198, v166
    v_mfma_f32_16x16x32_bf16 v[136:139], a[216:219], a[44:47], v[136:139]
    ds_read_b64_tr_b16 a[244:245], v18 offset:4096
    v_fma_f32 v35, v35, v26, v24
    v_mfma_f32_16x16x32_bf16 v[132:135], a[220:223], a[40:43], v[132:135]
    ds_read_b64_tr_b16 a[246:247], v18 offset:6144
    v_mul_f32 v35, v35, v167
    v_mfma_f32_16x16x32_bf16 v[140:143], a[220:223], a[44:47], v[140:143]
    s_waitcnt lgkmcnt(8)
    ds_read_b64_tr_b16 a[248:249], v19 offset:4096
    buffer_load_dwordx4 v1, s[4:7], s32 offen offset:0 lds
    v_exp_f32 v35, v35
    v_mfma_f32_16x16x32_bf16 v[112:115], a[224:227], a[48:51], v[112:115]
    ds_read_b64_tr_b16 a[250:251], v19 offset:6144
    v_fma_f32 v35, v35, v250, v250
    v_mfma_f32_16x16x32_bf16 v[120:123], a[224:227], a[52:55], v[120:123]
    ds_read_b64_tr_b16 a[252:253], v20 offset:4096
    v_rcp_f32 v35, v35
    v_mfma_f32_16x16x32_bf16 v[116:119], a[228:231], a[48:51], v[116:119]
    ds_read_b64_tr_b16 a[254:255], v20 offset:6144
    v_mul_f32 v167, v167, v35
    v_mfma_f32_16x16x32_bf16 v[124:127], a[228:231], a[52:55], v[124:127]
    s_waitcnt lgkmcnt(8)
    ds_read_b64_tr_b16 a[216:217], v17 offset:8192
    v_mul_f32 v199, v199, v167
    v_mfma_f32_16x16x32_bf16 v[128:131], a[232:235], a[48:51], v[128:131]
    ds_read_b64_tr_b16 a[218:219], v17 offset:10240
    v_cvt_pk_bf16_f32 v67, v198, v199
    v_mfma_f32_16x16x32_bf16 v[136:139], a[232:235], a[52:55], v[136:139]
    ds_read_b64_tr_b16 a[220:221], v18 offset:8192
    buffer_store_dwordx4 v[64:67], v23, s[20:23], s49 offen offset:2048 sc1
    v_mul_f32 v36, v168, v168
    v_mfma_f32_16x16x32_bf16 v[132:135], a[236:239], a[48:51], v[132:135]
    ds_read_b64_tr_b16 a[222:223], v18 offset:10240
    v_fma_f32 v36, v36, v27, v25
    v_mfma_f32_16x16x32_bf16 v[140:143], a[236:239], a[52:55], v[140:143]
    s_waitcnt lgkmcnt(8)
    ds_read_b64_tr_b16 a[224:225], v19 offset:8192
    v_mul_f32 v36, v36, v168
    v_mul_f32 v37, v169, v169
    v_mfma_f32_16x16x32_bf16 v[112:115], a[240:243], a[56:59], v[112:115]
    ds_read_b64_tr_b16 a[226:227], v19 offset:10240
    v_exp_f32 v36, v36
    v_mfma_f32_16x16x32_bf16 v[120:123], a[240:243], a[60:63], v[120:123]
    ds_read_b64_tr_b16 a[228:229], v20 offset:8192
    v_fma_f32 v36, v36, v252, v252
    v_mfma_f32_16x16x32_bf16 v[116:119], a[244:247], a[56:59], v[116:119]
    ds_read_b64_tr_b16 a[230:231], v20 offset:10240
    v_fma_f32 v37, v37, v27, v25
    v_mfma_f32_16x16x32_bf16 v[124:127], a[244:247], a[60:63], v[124:127]
    s_waitcnt lgkmcnt(8)
    v_rcp_f32 v36, v36
    v_mfma_f32_16x16x32_bf16 v[128:131], a[248:251], a[56:59], v[128:131]
    v_mul_f32 v168, v168, v36
    v_mul_f32 v200, v200, v168
    v_mfma_f32_16x16x32_bf16 v[136:139], a[248:251], a[60:63], v[136:139]
    s_waitcnt lgkmcnt(0)
    s_barrier
    ds_read_b64_tr_b16 a[232:233], v17 offset:12288
    ds_read_b64_tr_b16 a[234:235], v17 offset:14336
    v_mfma_f32_16x16x32_bf16 v[132:135], a[252:255], a[56:59], v[132:135]
    s_add_u32 m0, s33, 73728
    ds_read_b64_tr_b16 a[236:237], v18 offset:12288
    ds_read_b64_tr_b16 a[238:239], v18 offset:14336
    v_mfma_f32_16x16x32_bf16 v[140:143], a[252:255], a[60:63], v[140:143]
    s_add_u32 s32, s38, 384
    ds_read_b64_tr_b16 a[240:241], v19 offset:12288
    buffer_load_dwordx4 v1, s[12:15], s32 offen offset:0 lds
    v_mul_f32 v37, v37, v169
    v_mul_f32 v38, v170, v170
    v_mfma_f32_16x16x32_bf16 v[112:115], a[216:219], a[64:67], v[112:115]
    ds_read_b64_tr_b16 a[242:243], v19 offset:14336
    v_exp_f32 v37, v37
    v_mfma_f32_16x16x32_bf16 v[120:123], a[216:219], a[68:71], v[120:123]
    ds_read_b64_tr_b16 a[244:245], v20 offset:12288
    v_fma_f32 v37, v37, v252, v252
    v_mfma_f32_16x16x32_bf16 v[116:119], a[220:223], a[64:67], v[116:119]
    ds_read_b64_tr_b16 a[246:247], v20 offset:14336
    v_rcp_f32 v37, v37
    v_mfma_f32_16x16x32_bf16 v[124:127], a[220:223], a[68:71], v[124:127]
    ds_read_b64_tr_b16 a[248:249], v17 offset:16384
    v_mul_f32 v169, v169, v37
    v_mfma_f32_16x16x32_bf16 v[128:131], a[224:227], a[64:67], v[128:131]
    ds_read_b64_tr_b16 a[250:251], v17 offset:18432
    v_mul_f32 v201, v201, v169
    v_mfma_f32_16x16x32_bf16 v[136:139], a[224:227], a[68:71], v[136:139]
    ds_read_b64_tr_b16 a[252:253], v18 offset:16384
    v_cvt_pk_bf16_f32 v68, v200, v201
    v_mfma_f32_16x16x32_bf16 v[132:135], a[228:231], a[64:67], v[132:135]
    ds_read_b64_tr_b16 a[254:255], v18 offset:18432
    buffer_load_dwordx4 v2, s[12:15], s32 offen offset:1024 lds
    v_fma_f32 v38, v38, v27, v25
    v_mfma_f32_16x16x32_bf16 v[140:143], a[228:231], a[68:71], v[140:143]
    s_waitcnt lgkmcnt(8)
    ds_read_b64_tr_b16 a[216:217], v19 offset:16384
    v_mul_f32 v38, v38, v170
    v_mfma_f32_16x16x32_bf16 v[112:115], a[232:235], a[72:75], v[112:115]
    ds_read_b64_tr_b16 a[218:219], v19 offset:18432
    v_exp_f32 v38, v38
    v_mfma_f32_16x16x32_bf16 v[120:123], a[232:235], a[76:79], v[120:123]
    ds_read_b64_tr_b16 a[220:221], v20 offset:16384
    v_fma_f32 v38, v38, v252, v252
    v_mfma_f32_16x16x32_bf16 v[116:119], a[236:239], a[72:75], v[116:119]
    ds_read_b64_tr_b16 a[222:223], v20 offset:18432
    v_rcp_f32 v38, v38
    v_mfma_f32_16x16x32_bf16 v[124:127], a[236:239], a[76:79], v[124:127]
    s_waitcnt lgkmcnt(8)
    ds_read_b64_tr_b16 a[224:225], v17 offset:20480
    v_mul_f32 v170, v170, v38
    v_mfma_f32_16x16x32_bf16 v[128:131], a[240:243], a[72:75], v[128:131]
    ds_read_b64_tr_b16 a[226:227], v17 offset:22528
    v_mul_f32 v202, v202, v170
    v_mfma_f32_16x16x32_bf16 v[136:139], a[240:243], a[76:79], v[136:139]
    ds_read_b64_tr_b16 a[228:229], v18 offset:20480
    buffer_load_dwordx4 v3, s[12:15], s32 offen offset:2048 lds
    v_mul_f32 v39, v171, v171
    v_mfma_f32_16x16x32_bf16 v[132:135], a[244:247], a[72:75], v[132:135]
    ds_read_b64_tr_b16 a[230:231], v18 offset:22528
    v_fma_f32 v39, v39, v27, v25
    v_mfma_f32_16x16x32_bf16 v[140:143], a[244:247], a[76:79], v[140:143]
    s_waitcnt lgkmcnt(8)
    ds_read_b64_tr_b16 a[232:233], v19 offset:20480
    v_mul_f32 v39, v39, v171
    v_mfma_f32_16x16x32_bf16 v[112:115], a[248:251], a[80:83], v[112:115]
    ds_read_b64_tr_b16 a[234:235], v19 offset:22528
    v_exp_f32 v39, v39
    v_mfma_f32_16x16x32_bf16 v[120:123], a[248:251], a[84:87], v[120:123]
    ds_read_b64_tr_b16 a[236:237], v20 offset:20480
    v_fma_f32 v39, v39, v252, v252
    v_mfma_f32_16x16x32_bf16 v[116:119], a[252:255], a[80:83], v[116:119]
    ds_read_b64_tr_b16 a[238:239], v20 offset:22528
    v_rcp_f32 v39, v39
    v_mfma_f32_16x16x32_bf16 v[124:127], a[252:255], a[84:87], v[124:127]
    s_waitcnt lgkmcnt(8)
    ds_read_b64_tr_b16 a[240:241], v17 offset:24576
    v_mul_f32 v171, v171, v39
    v_mfma_f32_16x16x32_bf16 v[128:131], a[216:219], a[80:83], v[128:131]
    ds_read_b64_tr_b16 a[242:243], v17 offset:26624
    buffer_load_dwordx4 v4, s[12:15], s32 offen offset:3072 lds
    v_mul_f32 v203, v203, v171
    v_mfma_f32_16x16x32_bf16 v[136:139], a[216:219], a[84:87], v[136:139]
    s_add_u32 m0, s33, 77824
    ds_read_b64_tr_b16 a[244:245], v18 offset:24576
    v_cvt_pk_bf16_f32 v69, v202, v203
    v_mfma_f32_16x16x32_bf16 v[132:135], a[220:223], a[80:83], v[132:135]
    s_add_u32 s32, s38, 295296
    ds_read_b64_tr_b16 a[246:247], v18 offset:26624
    v_mul_f32 v28, v172, v172
    v_mfma_f32_16x16x32_bf16 v[140:143], a[220:223], a[84:87], v[140:143]
    s_waitcnt lgkmcnt(8)
    ds_read_b64_tr_b16 a[248:249], v19 offset:24576
    v_fma_f32 v28, v28, v27, v25
    v_mfma_f32_16x16x32_bf16 v[112:115], a[224:227], a[88:91], v[112:115]
    ds_read_b64_tr_b16 a[250:251], v19 offset:26624
    v_mul_f32 v28, v28, v172
    v_mul_f32 v29, v173, v173
    v_mfma_f32_16x16x32_bf16 v[120:123], a[224:227], a[92:95], v[120:123]
    ds_read_b64_tr_b16 a[252:253], v20 offset:24576
    v_exp_f32 v28, v28
    v_mfma_f32_16x16x32_bf16 v[116:119], a[228:231], a[88:91], v[116:119]
    ds_read_b64_tr_b16 a[254:255], v20 offset:26624
    v_fma_f32 v28, v28, v252, v252
    v_mfma_f32_16x16x32_bf16 v[124:127], a[228:231], a[92:95], v[124:127]
    s_waitcnt lgkmcnt(8)
    ds_read_b64_tr_b16 a[216:217], v17 offset:28672
    buffer_load_dwordx4 v1, s[12:15], s32 offen offset:0 lds
    v_rcp_f32 v28, v28
    v_mfma_f32_16x16x32_bf16 v[128:131], a[232:235], a[88:91], v[128:131]
    ds_read_b64_tr_b16 a[218:219], v17 offset:30720
    v_mul_f32 v172, v172, v28
    v_mfma_f32_16x16x32_bf16 v[136:139], a[232:235], a[92:95], v[136:139]
    ds_read_b64_tr_b16 a[220:221], v18 offset:28672
    v_mul_f32 v204, v204, v172
    v_mfma_f32_16x16x32_bf16 v[132:135], a[236:239], a[88:91], v[132:135]
    ds_read_b64_tr_b16 a[222:223], v18 offset:30720
    v_fma_f32 v29, v29, v27, v25
    v_mfma_f32_16x16x32_bf16 v[140:143], a[236:239], a[92:95], v[140:143]
    s_waitcnt lgkmcnt(8)
    ds_read_b64_tr_b16 a[224:225], v19 offset:28672
    v_mul_f32 v29, v29, v173
    v_mfma_f32_16x16x32_bf16 v[112:115], a[240:243], a[96:99], v[112:115]
    ds_read_b64_tr_b16 a[226:227], v19 offset:30720
    v_exp_f32 v29, v29
    v_mfma_f32_16x16x32_bf16 v[120:123], a[240:243], a[100:103], v[120:123]
    ds_read_b64_tr_b16 a[228:229], v20 offset:28672
    v_fma_f32 v29, v29, v252, v252
    v_mfma_f32_16x16x32_bf16 v[116:119], a[244:247], a[96:99], v[116:119]
    ds_read_b64_tr_b16 a[230:231], v20 offset:30720
    buffer_load_dwordx4 v2, s[12:15], s32 offen offset:1024 lds
    v_mfma_f32_16x16x32_bf16 v[124:127], a[244:247], a[100:103], v[124:127]
    s_waitcnt lgkmcnt(8)
    ds_read_b64_tr_b16 a[232:233], v17 offset:32768
    v_rcp_f32 v29, v29
    v_mfma_f32_16x16x32_bf16 v[128:131], a[248:251], a[96:99], v[128:131]
    ds_read_b64_tr_b16 a[234:235], v17 offset:34816
    v_mul_f32 v173, v173, v29
    v_mfma_f32_16x16x32_bf16 v[136:139], a[248:251], a[100:103], v[136:139]
    ds_read_b64_tr_b16 a[236:237], v18 offset:32768
    v_mul_f32 v205, v205, v173
    v_mfma_f32_16x16x32_bf16 v[132:135], a[252:255], a[96:99], v[132:135]
    ds_read_b64_tr_b16 a[238:239], v18 offset:34816
    v_cvt_pk_bf16_f32 v70, v204, v205
    v_mul_f32 v30, v174, v174
    v_mfma_f32_16x16x32_bf16 v[140:143], a[252:255], a[100:103], v[140:143]
    s_waitcnt lgkmcnt(8)
    ds_read_b64_tr_b16 a[240:241], v19 offset:32768
    v_fma_f32 v30, v30, v27, v25
    v_mfma_f32_16x16x32_bf16 v[112:115], a[216:219], a[104:107], v[112:115]
    ds_read_b64_tr_b16 a[242:243], v19 offset:34816
    v_mul_f32 v30, v30, v174
    v_mfma_f32_16x16x32_bf16 v[120:123], a[216:219], a[108:111], v[120:123]
    ds_read_b64_tr_b16 a[244:245], v20 offset:32768
    buffer_load_dwordx4 v3, s[12:15], s32 offen offset:2048 lds
    v_exp_f32 v30, v30
    v_mfma_f32_16x16x32_bf16 v[116:119], a[220:223], a[104:107], v[116:119]
    ds_read_b64_tr_b16 a[246:247], v20 offset:34816
    v_fma_f32 v30, v30, v252, v252
    v_mfma_f32_16x16x32_bf16 v[124:127], a[220:223], a[108:111], v[124:127]
    s_waitcnt lgkmcnt(8)
    ds_read_b64_tr_b16 a[248:249], v17 offset:36864
    v_rcp_f32 v30, v30
    v_mfma_f32_16x16x32_bf16 v[128:131], a[224:227], a[104:107], v[128:131]
    ds_read_b64_tr_b16 a[250:251], v17 offset:38912
    v_mul_f32 v174, v174, v30
    v_mfma_f32_16x16x32_bf16 v[136:139], a[224:227], a[108:111], v[136:139]
    ds_read_b64_tr_b16 a[252:253], v18 offset:36864
    v_mul_f32 v206, v206, v174
    v_mfma_f32_16x16x32_bf16 v[132:135], a[228:231], a[104:107], v[132:135]
    ds_read_b64_tr_b16 a[254:255], v18 offset:38912
    v_mul_f32 v31, v175, v175
    v_mfma_f32_16x16x32_bf16 v[140:143], a[228:231], a[108:111], v[140:143]
    s_waitcnt lgkmcnt(8)
    ds_read_b64_tr_b16 a[216:217], v19 offset:36864
    v_fma_f32 v31, v31, v27, v25
    v_mfma_f32_16x16x32_bf16 v[112:115], a[232:235], a[112:115], v[112:115]
    ds_read_b64_tr_b16 a[218:219], v19 offset:38912
    buffer_load_dwordx4 v4, s[12:15], s32 offen offset:3072 lds
    v_mul_f32 v31, v31, v175
    v_mfma_f32_16x16x32_bf16 v[120:123], a[232:235], a[116:119], v[120:123]
    s_add_u32 m0, s33, 81920
    ds_read_b64_tr_b16 a[220:221], v20 offset:36864
    v_exp_f32 v31, v31
    v_mfma_f32_16x16x32_bf16 v[116:119], a[236:239], a[112:115], v[116:119]
    s_add_u32 s32, s38, 590208
    ds_read_b64_tr_b16 a[222:223], v20 offset:38912
    v_fma_f32 v31, v31, v252, v252
    v_mfma_f32_16x16x32_bf16 v[124:127], a[236:239], a[116:119], v[124:127]
    s_waitcnt lgkmcnt(8)
    ds_read_b64_tr_b16 a[224:225], v17 offset:40960
    v_rcp_f32 v31, v31
    v_mfma_f32_16x16x32_bf16 v[128:131], a[240:243], a[112:115], v[128:131]
    ds_read_b64_tr_b16 a[226:227], v17 offset:43008
    v_mul_f32 v175, v175, v31
    v_mfma_f32_16x16x32_bf16 v[136:139], a[240:243], a[116:119], v[136:139]
    ds_read_b64_tr_b16 a[228:229], v18 offset:40960
    v_mul_f32 v207, v207, v175
    v_mfma_f32_16x16x32_bf16 v[132:135], a[244:247], a[112:115], v[132:135]
    ds_read_b64_tr_b16 a[230:231], v18 offset:43008
    v_cvt_pk_bf16_f32 v71, v206, v207
    v_mfma_f32_16x16x32_bf16 v[140:143], a[244:247], a[116:119], v[140:143]
    s_waitcnt lgkmcnt(8)
    ds_read_b64_tr_b16 a[232:233], v19 offset:40960
    buffer_load_dwordx4 v1, s[12:15], s32 offen offset:0 lds
    v_mfma_f32_16x16x32_bf16 v[112:115], a[248:251], a[120:123], v[112:115]
    ds_read_b64_tr_b16 a[234:235], v19 offset:43008
    buffer_store_dwordx4 v[68:71], v23, s[20:23], s49 offen offset:3072 sc1
    v_mfma_f32_16x16x32_bf16 v[120:123], a[248:251], a[124:127], v[120:123]
    s_add_u32 s49, s57, 8192
    ds_read_b64_tr_b16 a[236:237], v20 offset:40960
    v_mfma_f32_16x16x32_bf16 v[116:119], a[252:255], a[120:123], v[116:119]
    ds_read_b64_tr_b16 a[238:239], v20 offset:43008
    v_mfma_f32_16x16x32_bf16 v[124:127], a[252:255], a[124:127], v[124:127]
    s_waitcnt lgkmcnt(8)
    ds_read_b64_tr_b16 a[240:241], v17 offset:45056
    v_mfma_f32_16x16x32_bf16 v[128:131], a[216:219], a[120:123], v[128:131]
    ds_read_b64_tr_b16 a[242:243], v17 offset:47104
    v_mfma_f32_16x16x32_bf16 v[136:139], a[216:219], a[124:127], v[136:139]
    ds_read_b64_tr_b16 a[244:245], v18 offset:45056
    v_mfma_f32_16x16x32_bf16 v[132:135], a[220:223], a[120:123], v[132:135]
    ds_read_b64_tr_b16 a[246:247], v18 offset:47104
    v_mfma_f32_16x16x32_bf16 v[140:143], a[220:223], a[124:127], v[140:143]
    s_waitcnt lgkmcnt(8)
    ds_read_b64_tr_b16 a[248:249], v19 offset:45056
    v_mfma_f32_16x16x32_bf16 v[112:115], a[224:227], a[128:131], v[112:115]
    ds_read_b64_tr_b16 a[250:251], v19 offset:47104
    v_mfma_f32_16x16x32_bf16 v[120:123], a[224:227], a[132:135], v[120:123]
    ds_read_b64_tr_b16 a[252:253], v20 offset:45056
    v_mfma_f32_16x16x32_bf16 v[116:119], a[228:231], a[128:131], v[116:119]
    ds_read_b64_tr_b16 a[254:255], v20 offset:47104
    v_mfma_f32_16x16x32_bf16 v[124:127], a[228:231], a[132:135], v[124:127]
    s_waitcnt lgkmcnt(8)
    v_mfma_f32_16x16x32_bf16 v[128:131], a[232:235], a[128:131], v[128:131]
    v_mfma_f32_16x16x32_bf16 v[136:139], a[232:235], a[132:135], v[136:139]
    s_waitcnt vmcnt(26) lgkmcnt(0)
    s_barrier
    ds_read_b64_tr_b16 a[216:217], v9 offset:0
    ds_read_b64_tr_b16 a[218:219], v9 offset:2048
    v_mfma_f32_16x16x32_bf16 v[132:135], a[236:239], a[128:131], v[132:135]
    s_add_u32 m0, s33, 110592
    ds_read_b64_tr_b16 a[220:221], v10 offset:0
    ds_read_b64_tr_b16 a[222:223], v10 offset:2048
    v_mfma_f32_16x16x32_bf16 v[140:143], a[236:239], a[132:135], v[140:143]
    s_add_u32 s32, s38, 2654592
    ds_read_b64_tr_b16 a[224:225], v11 offset:0
    buffer_load_dwordx4 v1, s[12:15], s32 offen offset:0 lds
    v_mfma_f32_16x16x32_bf16 v[112:115], a[240:243], a[136:139], v[112:115]
    ds_read_b64_tr_b16 a[226:227], v11 offset:2048
    v_mfma_f32_16x16x32_bf16 v[120:123], a[240:243], a[140:143], v[120:123]
    ds_read_b64_tr_b16 a[228:229], v12 offset:0
    v_mfma_f32_16x16x32_bf16 v[116:119], a[244:247], a[136:139], v[116:119]
    ds_read_b64_tr_b16 a[230:231], v12 offset:2048
    v_mfma_f32_16x16x32_bf16 v[124:127], a[244:247], a[140:143], v[124:127]
    ds_read_b64_tr_b16 a[232:233], v9 offset:4096
    v_mfma_f32_16x16x32_bf16 v[128:131], a[248:251], a[136:139], v[128:131]
    ds_read_b64_tr_b16 a[234:235], v9 offset:6144
    v_mfma_f32_16x16x32_bf16 v[136:139], a[248:251], a[140:143], v[136:139]
    ds_read_b64_tr_b16 a[236:237], v10 offset:4096
    v_mfma_f32_16x16x32_bf16 v[132:135], a[252:255], a[136:139], v[132:135]
    ds_read_b64_tr_b16 a[238:239], v10 offset:6144
    buffer_load_dwordx4 v2, s[12:15], s32 offen offset:1024 lds
    v_mfma_f32_16x16x32_bf16 v[140:143], a[252:255], a[140:143], v[140:143]
    s_waitcnt lgkmcnt(8)
    ds_read_b64_tr_b16 a[240:241], v11 offset:4096
    v_mfma_f32_16x16x32_bf16 v[208:211], a[216:219], a[0:3], 0
    ds_read_b64_tr_b16 a[242:243], v11 offset:6144
    v_mul_f32 v32, v112, v112
    v_fma_f32 v32, v32, v26, v24
    v_mfma_f32_16x16x32_bf16 v[216:219], a[216:219], a[4:7], 0
    ds_read_b64_tr_b16 a[244:245], v12 offset:4096
    v_mul_f32 v32, v32, v112
    v_mul_f32 v33, v113, v113
    v_mfma_f32_16x16x32_bf16 v[212:215], a[220:223], a[0:3], 0
    ds_read_b64_tr_b16 a[246:247], v12 offset:6144
    v_exp_f32 v32, v32
    v_mfma_f32_16x16x32_bf16 v[220:223], a[220:223], a[4:7], 0
    s_waitcnt lgkmcnt(8)
    ds_read_b64_tr_b16 a[248:249], v9 offset:8192
    v_fma_f32 v32, v32, v250, v250
    v_mfma_f32_16x16x32_bf16 v[224:227], a[224:227], a[0:3], 0
    ds_read_b64_tr_b16 a[250:251], v9 offset:10240
    v_rcp_f32 v32, v32
    v_mfma_f32_16x16x32_bf16 v[232:235], a[224:227], a[4:7], 0
    ds_read_b64_tr_b16 a[252:253], v10 offset:8192
    buffer_load_dwordx4 v3, s[12:15], s32 offen offset:2048 lds
    v_mfma_f32_16x16x32_bf16 v[228:231], a[228:231], a[0:3], 0
    ds_read_b64_tr_b16 a[254:255], v10 offset:10240
    v_mul_f32 v112, v112, v32
    v_mfma_f32_16x16x32_bf16 v[236:239], a[228:231], a[4:7], 0
    s_waitcnt lgkmcnt(8)
    ds_read_b64_tr_b16 a[216:217], v11 offset:8192
    v_fma_f32 v33, v33, v26, v24
    v_mul_f32 v33, v33, v113
    v_mfma_f32_16x16x32_bf16 v[208:211], a[232:235], a[8:11], v[208:211]
    ds_read_b64_tr_b16 a[218:219], v11 offset:10240
    v_exp_f32 v33, v33
    v_mfma_f32_16x16x32_bf16 v[216:219], a[232:235], a[12:15], v[216:219]
    ds_read_b64_tr_b16 a[220:221], v12 offset:8192
    v_fma_f32 v33, v33, v250, v250
    v_mfma_f32_16x16x32_bf16 v[212:215], a[236:239], a[8:11], v[212:215]
    ds_read_b64_tr_b16 a[222:223], v12 offset:10240
    v_rcp_f32 v33, v33
    v_mfma_f32_16x16x32_bf16 v[220:223], a[236:239], a[12:15], v[220:223]
    s_waitcnt lgkmcnt(8)
    ds_read_b64_tr_b16 a[224:225], v9 offset:12288
    v_mul_f32 v113, v113, v33
    v_mfma_f32_16x16x32_bf16 v[224:227], a[240:243], a[8:11], v[224:227]
    ds_read_b64_tr_b16 a[226:227], v9 offset:14336
    buffer_load_dwordx4 v4, s[12:15], s32 offen offset:3072 lds
    v_mfma_f32_16x16x32_bf16 v[232:235], a[240:243], a[12:15], v[232:235]
    s_add_u32 m0, s33, 114688
    ds_read_b64_tr_b16 a[228:229], v10 offset:12288
    v_mul_f32 v34, v114, v114
    v_fma_f32 v34, v34, v26, v24
    v_mfma_f32_16x16x32_bf16 v[228:231], a[244:247], a[8:11], v[228:231]
    s_add_u32 s32, s38, 2949504
    ds_read_b64_tr_b16 a[230:231], v10 offset:14336
    v_mul_f32 v34, v34, v114
    v_mfma_f32_16x16x32_bf16 v[236:239], a[244:247], a[12:15], v[236:239]
    s_waitcnt lgkmcnt(8)
    ds_read_b64_tr_b16 a[232:233], v11 offset:12288
    v_exp_f32 v34, v34
    v_mfma_f32_16x16x32_bf16 v[208:211], a[248:251], a[16:19], v[208:211]
    ds_read_b64_tr_b16 a[234:235], v11 offset:14336
    v_fma_f32 v34, v34, v250, v250
    v_mfma_f32_16x16x32_bf16 v[216:219], a[248:251], a[20:23], v[216:219]
    ds_read_b64_tr_b16 a[236:237], v12 offset:12288
    v_rcp_f32 v34, v34
    v_mfma_f32_16x16x32_bf16 v[212:215], a[252:255], a[16:19], v[212:215]
    ds_read_b64_tr_b16 a[238:239], v12 offset:14336
    v_mul_f32 v114, v114, v34
    v_mfma_f32_16x16x32_bf16 v[220:223], a[252:255], a[20:23], v[220:223]
    s_waitcnt lgkmcnt(8)
    ds_read_b64_tr_b16 a[240:241], v9 offset:16384
    buffer_load_dwordx4 v1, s[12:15], s32 offen offset:0 lds
    v_mul_f32 v35, v115, v115
    v_mfma_f32_16x16x32_bf16 v[224:227], a[216:219], a[16:19], v[224:227]
    ds_read_b64_tr_b16 a[242:243], v9 offset:18432
    v_fma_f32 v35, v35, v26, v24
    v_mfma_f32_16x16x32_bf16 v[232:235], a[216:219], a[20:23], v[232:235]
    ds_read_b64_tr_b16 a[244:245], v10 offset:16384
    v_mul_f32 v35, v35, v115
    v_mfma_f32_16x16x32_bf16 v[228:231], a[220:223], a[16:19], v[228:231]
    ds_read_b64_tr_b16 a[246:247], v10 offset:18432
    v_exp_f32 v35, v35
    v_mfma_f32_16x16x32_bf16 v[236:239], a[220:223], a[20:23], v[236:239]
    s_waitcnt lgkmcnt(8)
    ds_read_b64_tr_b16 a[248:249], v11 offset:16384
    v_fma_f32 v35, v35, v250, v250
    v_mfma_f32_16x16x32_bf16 v[208:211], a[224:227], a[24:27], v[208:211]
    ds_read_b64_tr_b16 a[250:251], v11 offset:18432
    v_rcp_f32 v35, v35
    v_mfma_f32_16x16x32_bf16 v[216:219], a[224:227], a[28:31], v[216:219]
    ds_read_b64_tr_b16 a[252:253], v12 offset:16384
    v_mul_f32 v115, v115, v35
    v_mfma_f32_16x16x32_bf16 v[212:215], a[228:231], a[24:27], v[212:215]
    s_waitcnt vmcnt(5)
    ds_read_b64_tr_b16 a[254:255], v12 offset:18432
    buffer_load_dwordx4 v2, s[12:15], s32 offen offset:1024 lds
    v_mul_f32 v36, v116, v116
    v_mfma_f32_16x16x32_bf16 v[220:223], a[228:231], a[28:31], v[220:223]
    s_waitcnt lgkmcnt(8)
    ds_read_b64_tr_b16 a[216:217], v9 offset:20480
    buffer_store_dword v248, v245, s[20:23], s53 offen offset:128 sc1
    v_fma_f32 v36, v36, v26, v24
    v_mfma_f32_16x16x32_bf16 v[224:227], a[232:235], a[24:27], v[224:227]
    ds_read_b64_tr_b16 a[218:219], v9 offset:22528
    v_mul_f32 v36, v36, v116
    v_mul_f32 v37, v117, v117
    v_mfma_f32_16x16x32_bf16 v[232:235], a[232:235], a[28:31], v[232:235]
    ds_read_b64_tr_b16 a[220:221], v10 offset:20480
    v_exp_f32 v36, v36
    v_mfma_f32_16x16x32_bf16 v[228:231], a[236:239], a[24:27], v[228:231]
    ds_read_b64_tr_b16 a[222:223], v10 offset:22528
    v_fma_f32 v36, v36, v250, v250
    v_mfma_f32_16x16x32_bf16 v[236:239], a[236:239], a[28:31], v[236:239]
    s_waitcnt lgkmcnt(8)
    ds_read_b64_tr_b16 a[224:225], v11 offset:20480
    v_rcp_f32 v36, v36
    v_mfma_f32_16x16x32_bf16 v[208:211], a[240:243], a[32:35], v[208:211]
    ds_read_b64_tr_b16 a[226:227], v11 offset:22528
    v_mul_f32 v116, v116, v36
    v_mfma_f32_16x16x32_bf16 v[216:219], a[240:243], a[36:39], v[216:219]
    ds_read_b64_tr_b16 a[228:229], v12 offset:20480
    buffer_load_dwordx4 v3, s[12:15], s32 offen offset:2048 lds
    v_mfma_f32_16x16x32_bf16 v[212:215], a[244:247], a[32:35], v[212:215]
    ds_read_b64_tr_b16 a[230:231], v12 offset:22528
    v_fma_f32 v37, v37, v26, v24
    v_mul_f32 v37, v37, v117
    v_mfma_f32_16x16x32_bf16 v[220:223], a[244:247], a[36:39], v[220:223]
    s_waitcnt lgkmcnt(8)
    ds_read_b64_tr_b16 a[232:233], v9 offset:24576
    v_exp_f32 v37, v37
    v_mfma_f32_16x16x32_bf16 v[224:227], a[248:251], a[32:35], v[224:227]
    ds_read_b64_tr_b16 a[234:235], v9 offset:26624
    v_fma_f32 v37, v37, v250, v250
    v_mfma_f32_16x16x32_bf16 v[232:235], a[248:251], a[36:39], v[232:235]
    ds_read_b64_tr_b16 a[236:237], v10 offset:24576
    v_rcp_f32 v37, v37
    v_mfma_f32_16x16x32_bf16 v[228:231], a[252:255], a[32:35], v[228:231]
    ds_read_b64_tr_b16 a[238:239], v10 offset:26624
    v_mul_f32 v117, v117, v37
    v_mfma_f32_16x16x32_bf16 v[236:239], a[252:255], a[36:39], v[236:239]
    s_waitcnt lgkmcnt(8)
    ds_read_b64_tr_b16 a[240:241], v11 offset:24576
    v_mul_f32 v38, v118, v118
    v_mfma_f32_16x16x32_bf16 v[208:211], a[216:219], a[40:43], v[208:211]
    ds_read_b64_tr_b16 a[242:243], v11 offset:26624
    buffer_load_dwordx4 v4, s[12:15], s32 offen offset:3072 lds
    v_fma_f32 v38, v38, v26, v24
    v_mfma_f32_16x16x32_bf16 v[216:219], a[216:219], a[44:47], v[216:219]
    s_add_u32 m0, s33, 118784
    ds_read_b64_tr_b16 a[244:245], v12 offset:24576
    v_mul_f32 v38, v38, v118
    v_mfma_f32_16x16x32_bf16 v[212:215], a[220:223], a[40:43], v[212:215]
    s_add_u32 s32, s38, 3244416
    ds_read_b64_tr_b16 a[246:247], v12 offset:26624
    v_exp_f32 v38, v38
    v_mfma_f32_16x16x32_bf16 v[220:223], a[220:223], a[44:47], v[220:223]
    s_waitcnt lgkmcnt(8)
    ds_read_b64_tr_b16 a[248:249], v9 offset:28672
    v_fma_f32 v38, v38, v250, v250
    v_mfma_f32_16x16x32_bf16 v[224:227], a[224:227], a[40:43], v[224:227]
    ds_read_b64_tr_b16 a[250:251], v9 offset:30720
    v_rcp_f32 v38, v38
    v_mfma_f32_16x16x32_bf16 v[232:235], a[224:227], a[44:47], v[232:235]
    ds_read_b64_tr_b16 a[252:253], v10 offset:28672
    v_mul_f32 v118, v118, v38
    v_mfma_f32_16x16x32_bf16 v[228:231], a[228:231], a[40:43], v[228:231]
    ds_read_b64_tr_b16 a[254:255], v10 offset:30720
    v_mul_f32 v39, v119, v119
    v_mfma_f32_16x16x32_bf16 v[236:239], a[228:231], a[44:47], v[236:239]
    s_waitcnt lgkmcnt(8)
    ds_read_b64_tr_b16 a[216:217], v11 offset:28672
    buffer_load_dwordx4 v1, s[12:15], s32 offen offset:0 lds
    v_fma_f32 v39, v39, v26, v24
    v_mfma_f32_16x16x32_bf16 v[208:211], a[232:235], a[48:51], v[208:211]
    ds_read_b64_tr_b16 a[218:219], v11 offset:30720
    v_mul_f32 v39, v39, v119
    v_mfma_f32_16x16x32_bf16 v[216:219], a[232:235], a[52:55], v[216:219]
    ds_read_b64_tr_b16 a[220:221], v12 offset:28672
    v_exp_f32 v39, v39
    v_mfma_f32_16x16x32_bf16 v[212:215], a[236:239], a[48:51], v[212:215]
    ds_read_b64_tr_b16 a[222:223], v12 offset:30720
    v_fma_f32 v39, v39, v250, v250
    v_mfma_f32_16x16x32_bf16 v[220:223], a[236:239], a[52:55], v[220:223]
    s_waitcnt lgkmcnt(8)
    ds_read_b64_tr_b16 a[224:225], v9 offset:32768
    v_rcp_f32 v39, v39
    v_mfma_f32_16x16x32_bf16 v[224:227], a[240:243], a[48:51], v[224:227]
    ds_read_b64_tr_b16 a[226:227], v9 offset:34816
    v_mul_f32 v119, v119, v39
    v_mfma_f32_16x16x32_bf16 v[232:235], a[240:243], a[52:55], v[232:235]
    ds_read_b64_tr_b16 a[228:229], v10 offset:32768
    v_mul_f32 v28, v120, v120
    v_mfma_f32_16x16x32_bf16 v[228:231], a[244:247], a[48:51], v[228:231]
    ds_read_b64_tr_b16 a[230:231], v10 offset:34816
    v_fma_f32 v28, v28, v27, v25
    v_mfma_f32_16x16x32_bf16 v[236:239], a[244:247], a[52:55], v[236:239]
    s_waitcnt lgkmcnt(8)
    ds_read_b64_tr_b16 a[232:233], v11 offset:32768
    v_mul_f32 v28, v28, v120
    v_mfma_f32_16x16x32_bf16 v[208:211], a[248:251], a[56:59], v[208:211]
    ds_read_b64_tr_b16 a[234:235], v11 offset:34816
    v_exp_f32 v28, v28
    v_mfma_f32_16x16x32_bf16 v[216:219], a[248:251], a[60:63], v[216:219]
    ds_read_b64_tr_b16 a[236:237], v12 offset:32768
    v_fma_f32 v28, v28, v252, v252
    v_mfma_f32_16x16x32_bf16 v[212:215], a[252:255], a[56:59], v[212:215]
    ds_read_b64_tr_b16 a[238:239], v12 offset:34816
    v_rcp_f32 v28, v28
    v_mfma_f32_16x16x32_bf16 v[220:223], a[252:255], a[60:63], v[220:223]
    s_waitcnt lgkmcnt(8)
    v_mul_f32 v120, v120, v28
    v_mul_f32 v29, v121, v121
    v_mfma_f32_16x16x32_bf16 v[224:227], a[216:219], a[56:59], v[224:227]
    buffer_load_dword v253, v251, s[16:19], s97 offen
    v_fma_f32 v29, v29, v27, v25
    v_mfma_f32_16x16x32_bf16 v[232:235], a[216:219], a[60:63], v[232:235]
    s_waitcnt lgkmcnt(0)
    s_barrier
    ds_read_b64_tr_b16 a[240:241], v9 offset:36864
    ds_read_b64_tr_b16 a[242:243], v9 offset:38912
    v_mfma_f32_16x16x32_bf16 v[228:231], a[220:223], a[56:59], v[228:231]
    s_add_u32 m0, s33, 0
    ds_read_b64_tr_b16 a[244:245], v10 offset:36864
    ds_read_b64_tr_b16 a[246:247], v10 offset:38912
    v_mul_f32 v29, v29, v121
    v_mul_f32 v30, v122, v122
    v_mfma_f32_16x16x32_bf16 v[236:239], a[220:223], a[60:63], v[236:239]
    s_add_u32 s32, s38, 384
    ds_read_b64_tr_b16 a[248:249], v11 offset:36864
    buffer_load_dwordx4 v1, s[4:7], s32 offen offset:0 lds
    v_exp_f32 v29, v29
    v_mfma_f32_16x16x32_bf16 v[208:211], a[224:227], a[64:67], v[208:211]
    ds_read_b64_tr_b16 a[250:251], v11 offset:38912
    v_fma_f32 v29, v29, v252, v252
    v_mfma_f32_16x16x32_bf16 v[216:219], a[224:227], a[68:71], v[216:219]
    ds_read_b64_tr_b16 a[252:253], v12 offset:36864
    v_rcp_f32 v29, v29
    v_mfma_f32_16x16x32_bf16 v[212:215], a[228:231], a[64:67], v[212:215]
    ds_read_b64_tr_b16 a[254:255], v12 offset:38912
    v_mul_f32 v121, v121, v29
    v_mfma_f32_16x16x32_bf16 v[220:223], a[228:231], a[68:71], v[220:223]
    ds_read_b64_tr_b16 a[216:217], v9 offset:40960
    v_fma_f32 v30, v30, v27, v25
    v_mfma_f32_16x16x32_bf16 v[224:227], a[232:235], a[64:67], v[224:227]
    ds_read_b64_tr_b16 a[218:219], v9 offset:43008
    v_mul_f32 v30, v30, v122
    v_mfma_f32_16x16x32_bf16 v[232:235], a[232:235], a[68:71], v[232:235]
    ds_read_b64_tr_b16 a[220:221], v10 offset:40960
    v_exp_f32 v30, v30
    v_mfma_f32_16x16x32_bf16 v[228:231], a[236:239], a[64:67], v[228:231]
    ds_read_b64_tr_b16 a[222:223], v10 offset:43008
    buffer_load_dwordx4 v2, s[4:7], s32 offen offset:1024 lds
    v_mfma_f32_16x16x32_bf16 v[236:239], a[236:239], a[68:71], v[236:239]
    s_waitcnt lgkmcnt(8)
    ds_read_b64_tr_b16 a[224:225], v11 offset:40960
    v_fma_f32 v30, v30, v252, v252
    v_mul_f32 v31, v123, v123
    v_mfma_f32_16x16x32_bf16 v[208:211], a[240:243], a[72:75], v[208:211]
    ds_read_b64_tr_b16 a[226:227], v11 offset:43008
    v_rcp_f32 v30, v30
    v_mfma_f32_16x16x32_bf16 v[216:219], a[240:243], a[76:79], v[216:219]
    ds_read_b64_tr_b16 a[228:229], v12 offset:40960
    v_mul_f32 v122, v122, v30
    v_mfma_f32_16x16x32_bf16 v[212:215], a[244:247], a[72:75], v[212:215]
    ds_read_b64_tr_b16 a[230:231], v12 offset:43008
    v_fma_f32 v31, v31, v27, v25
    v_mfma_f32_16x16x32_bf16 v[220:223], a[244:247], a[76:79], v[220:223]
    s_waitcnt lgkmcnt(8)
    ds_read_b64_tr_b16 a[232:233], v9 offset:45056
    v_mul_f32 v31, v31, v123
    v_mfma_f32_16x16x32_bf16 v[224:227], a[248:251], a[72:75], v[224:227]
    ds_read_b64_tr_b16 a[234:235], v9 offset:47104
    v_exp_f32 v31, v31
    v_mfma_f32_16x16x32_bf16 v[232:235], a[248:251], a[76:79], v[232:235]
    ds_read_b64_tr_b16 a[236:237], v10 offset:45056
    buffer_load_dwordx4 v3, s[4:7], s32 offen offset:2048 lds
    v_fma_f32 v31, v31, v252, v252
    v_mfma_f32_16x16x32_bf16 v[228:231], a[252:255], a[72:75], v[228:231]
    ds_read_b64_tr_b16 a[238:239], v10 offset:47104
    v_rcp_f32 v31, v31
    v_mfma_f32_16x16x32_bf16 v[236:239], a[252:255], a[76:79], v[236:239]
    s_waitcnt lgkmcnt(8)
    ds_read_b64_tr_b16 a[240:241], v11 offset:45056
    v_mul_f32 v123, v123, v31
    v_mfma_f32_16x16x32_bf16 v[208:211], a[216:219], a[80:83], v[208:211]
    ds_read_b64_tr_b16 a[242:243], v11 offset:47104
    v_mul_f32 v32, v124, v124
    v_mfma_f32_16x16x32_bf16 v[216:219], a[216:219], a[84:87], v[216:219]
    ds_read_b64_tr_b16 a[244:245], v12 offset:45056
    v_fma_f32 v32, v32, v27, v25
    v_mfma_f32_16x16x32_bf16 v[212:215], a[220:223], a[80:83], v[212:215]
    ds_read_b64_tr_b16 a[246:247], v12 offset:47104
    v_mul_f32 v32, v32, v124
    v_mfma_f32_16x16x32_bf16 v[220:223], a[220:223], a[84:87], v[220:223]
    s_waitcnt lgkmcnt(8)
    ds_read_b64_tr_b16 a[248:249], v13 offset:0
    v_exp_f32 v32, v32
    v_mfma_f32_16x16x32_bf16 v[224:227], a[224:227], a[80:83], v[224:227]
    ds_read_b64_tr_b16 a[250:251], v13 offset:2048
    buffer_load_dwordx4 v4, s[4:7], s32 offen offset:3072 lds
    v_fma_f32 v32, v32, v252, v252
    v_mfma_f32_16x16x32_bf16 v[232:235], a[224:227], a[84:87], v[232:235]
    s_add_u32 m0, s33, 4096
    ds_read_b64_tr_b16 a[252:253], v14 offset:0
    v_rcp_f32 v32, v32
    v_mfma_f32_16x16x32_bf16 v[228:231], a[228:231], a[80:83], v[228:231]
    s_add_u32 s32, s38, 295296
    ds_read_b64_tr_b16 a[254:255], v14 offset:2048
    v_mul_f32 v124, v124, v32
    v_mfma_f32_16x16x32_bf16 v[236:239], a[228:231], a[84:87], v[236:239]
    s_waitcnt lgkmcnt(8)
    ds_read_b64_tr_b16 a[216:217], v15 offset:0
    buffer_load_dword v254, off, s[20:23], s54 offset:128 sc1
    v_mul_f32 v33, v125, v125
    v_mfma_f32_16x16x32_bf16 v[208:211], a[232:235], a[88:91], v[208:211]
    ds_read_b64_tr_b16 a[218:219], v15 offset:2048
    v_fma_f32 v33, v33, v27, v25
    v_mfma_f32_16x16x32_bf16 v[216:219], a[232:235], a[92:95], v[216:219]
    ds_read_b64_tr_b16 a[220:221], v16 offset:0
    v_mul_f32 v33, v33, v125
    v_mul_f32 v34, v126, v126
    v_mfma_f32_16x16x32_bf16 v[212:215], a[236:239], a[88:91], v[212:215]
    ds_read_b64_tr_b16 a[222:223], v16 offset:2048
    v_exp_f32 v33, v33
    v_mfma_f32_16x16x32_bf16 v[220:223], a[236:239], a[92:95], v[220:223]
    s_waitcnt lgkmcnt(8)
    ds_read_b64_tr_b16 a[224:225], v13 offset:4096
    buffer_load_dwordx4 v1, s[4:7], s32 offen offset:0 lds
    v_mfma_f32_16x16x32_bf16 v[224:227], a[240:243], a[88:91], v[224:227]
    ds_read_b64_tr_b16 a[226:227], v13 offset:6144
    v_fma_f32 v33, v33, v252, v252
    v_fma_f32 v34, v34, v27, v25
    v_mfma_f32_16x16x32_bf16 v[232:235], a[240:243], a[92:95], v[232:235]
    ds_read_b64_tr_b16 a[228:229], v14 offset:4096
    v_rcp_f32 v33, v33
    v_mfma_f32_16x16x32_bf16 v[228:231], a[244:247], a[88:91], v[228:231]
    ds_read_b64_tr_b16 a[230:231], v14 offset:6144
    v_mul_f32 v125, v125, v33
    v_mfma_f32_16x16x32_bf16 v[236:239], a[244:247], a[92:95], v[236:239]
    s_waitcnt lgkmcnt(8)
    ds_read_b64_tr_b16 a[232:233], v15 offset:4096
    v_mul_f32 v34, v34, v126
    v_mfma_f32_16x16x32_bf16 v[208:211], a[248:251], a[96:99], v[208:211]
    ds_read_b64_tr_b16 a[234:235], v15 offset:6144
    v_exp_f32 v34, v34
    v_mfma_f32_16x16x32_bf16 v[216:219], a[248:251], a[100:103], v[216:219]
    ds_read_b64_tr_b16 a[236:237], v16 offset:4096
    v_fma_f32 v34, v34, v252, v252
    v_mfma_f32_16x16x32_bf16 v[212:215], a[252:255], a[96:99], v[212:215]
    ds_read_b64_tr_b16 a[238:239], v16 offset:6144
    buffer_load_dwordx4 v2, s[4:7], s32 offen offset:1024 lds
    v_mfma_f32_16x16x32_bf16 v[220:223], a[252:255], a[100:103], v[220:223]
    s_waitcnt lgkmcnt(8)
    ds_read_b64_tr_b16 a[240:241], v13 offset:8192
    v_rcp_f32 v34, v34
    v_mfma_f32_16x16x32_bf16 v[224:227], a[216:219], a[96:99], v[224:227]
    ds_read_b64_tr_b16 a[242:243], v13 offset:10240
    v_mul_f32 v126, v126, v34
    v_mfma_f32_16x16x32_bf16 v[232:235], a[216:219], a[100:103], v[232:235]
    ds_read_b64_tr_b16 a[244:245], v14 offset:8192
    v_mul_f32 v35, v127, v127
    v_mfma_f32_16x16x32_bf16 v[228:231], a[220:223], a[96:99], v[228:231]
    ds_read_b64_tr_b16 a[246:247], v14 offset:10240
    v_fma_f32 v35, v35, v27, v25
    v_mul_f32 v35, v35, v127
    v_mfma_f32_16x16x32_bf16 v[236:239], a[220:223], a[100:103], v[236:239]
    s_waitcnt lgkmcnt(8)
    ds_read_b64_tr_b16 a[248:249], v15 offset:8192
    v_exp_f32 v35, v35
    v_mfma_f32_16x16x32_bf16 v[208:211], a[224:227], a[104:107], v[208:211]
    ds_read_b64_tr_b16 a[250:251], v15 offset:10240
    v_fma_f32 v35, v35, v252, v252
    v_mfma_f32_16x16x32_bf16 v[216:219], a[224:227], a[108:111], v[216:219]
    ds_read_b64_tr_b16 a[252:253], v16 offset:8192
    buffer_load_dwordx4 v3, s[4:7], s32 offen offset:2048 lds
    v_rcp_f32 v35, v35
    v_mfma_f32_16x16x32_bf16 v[212:215], a[228:231], a[104:107], v[212:215]
    ds_read_b64_tr_b16 a[254:255], v16 offset:10240
    v_mul_f32 v127, v127, v35
    v_mfma_f32_16x16x32_bf16 v[220:223], a[228:231], a[108:111], v[220:223]
    s_waitcnt lgkmcnt(8)
    ds_read_b64_tr_b16 a[216:217], v13 offset:12288
    v_mul_f32 v36, v128, v128
    v_mfma_f32_16x16x32_bf16 v[224:227], a[232:235], a[104:107], v[224:227]
    ds_read_b64_tr_b16 a[218:219], v13 offset:14336
    v_fma_f32 v36, v36, v26, v24
    v_mfma_f32_16x16x32_bf16 v[232:235], a[232:235], a[108:111], v[232:235]
    ds_read_b64_tr_b16 a[220:221], v14 offset:12288
    v_mul_f32 v36, v36, v128
    v_mfma_f32_16x16x32_bf16 v[228:231], a[236:239], a[104:107], v[228:231]
    ds_read_b64_tr_b16 a[222:223], v14 offset:14336
    v_exp_f32 v36, v36
    v_mfma_f32_16x16x32_bf16 v[236:239], a[236:239], a[108:111], v[236:239]
    s_waitcnt lgkmcnt(8)
    ds_read_b64_tr_b16 a[224:225], v15 offset:12288
    v_fma_f32 v36, v36, v250, v250
    v_mfma_f32_16x16x32_bf16 v[208:211], a[240:243], a[112:115], v[208:211]
    ds_read_b64_tr_b16 a[226:227], v15 offset:14336
    buffer_load_dwordx4 v4, s[4:7], s32 offen offset:3072 lds
    v_rcp_f32 v36, v36
    v_mfma_f32_16x16x32_bf16 v[216:219], a[240:243], a[116:119], v[216:219]
    s_add_u32 m0, s33, 8192
    ds_read_b64_tr_b16 a[228:229], v16 offset:12288
    v_mul_f32 v128, v128, v36
    v_mfma_f32_16x16x32_bf16 v[212:215], a[244:247], a[112:115], v[212:215]
    s_add_u32 s32, s38, 590208
    ds_read_b64_tr_b16 a[230:231], v16 offset:14336
    v_mul_f32 v37, v129, v129
    v_mfma_f32_16x16x32_bf16 v[220:223], a[244:247], a[116:119], v[220:223]
    s_waitcnt lgkmcnt(8)
    ds_read_b64_tr_b16 a[232:233], v13 offset:16384
    v_fma_f32 v37, v37, v26, v24
    v_mfma_f32_16x16x32_bf16 v[224:227], a[248:251], a[112:115], v[224:227]
    ds_read_b64_tr_b16 a[234:235], v13 offset:18432
    v_mul_f32 v37, v37, v129
    v_mfma_f32_16x16x32_bf16 v[232:235], a[248:251], a[116:119], v[232:235]
    ds_read_b64_tr_b16 a[236:237], v14 offset:16384
    v_exp_f32 v37, v37
    v_mfma_f32_16x16x32_bf16 v[228:231], a[252:255], a[112:115], v[228:231]
    ds_read_b64_tr_b16 a[238:239], v14 offset:18432
    v_fma_f32 v37, v37, v250, v250
    v_mfma_f32_16x16x32_bf16 v[236:239], a[252:255], a[116:119], v[236:239]
    s_waitcnt lgkmcnt(8)
    ds_read_b64_tr_b16 a[240:241], v15 offset:16384
    buffer_load_dwordx4 v1, s[4:7], s32 offen offset:0 lds
    v_rcp_f32 v37, v37
    v_mfma_f32_16x16x32_bf16 v[208:211], a[216:219], a[120:123], v[208:211]
    ds_read_b64_tr_b16 a[242:243], v15 offset:18432
    v_mul_f32 v129, v129, v37
    v_mfma_f32_16x16x32_bf16 v[216:219], a[216:219], a[124:127], v[216:219]
    ds_read_b64_tr_b16 a[244:245], v16 offset:16384
    v_mul_f32 v38, v130, v130
    v_mfma_f32_16x16x32_bf16 v[212:215], a[220:223], a[120:123], v[212:215]
    ds_read_b64_tr_b16 a[246:247], v16 offset:18432
    v_fma_f32 v38, v38, v26, v24
    v_mfma_f32_16x16x32_bf16 v[220:223], a[220:223], a[124:127], v[220:223]
    s_waitcnt lgkmcnt(8)
    ds_read_b64_tr_b16 a[248:249], v13 offset:20480
    v_mul_f32 v38, v38, v130
    v_mul_f32 v39, v131, v131
    v_mfma_f32_16x16x32_bf16 v[224:227], a[224:227], a[120:123], v[224:227]
    s_waitcnt vmcnt(5)
    ds_read_b64_tr_b16 a[250:251], v13 offset:22528
    v_exp_f32 v38, v38
    v_mfma_f32_16x16x32_bf16 v[232:235], a[224:227], a[124:127], v[232:235]
    ds_read_b64_tr_b16 a[252:253], v14 offset:20480
    v_cmp_eq_u32 vcc, 0, v254
    v_mfma_f32_16x16x32_bf16 v[228:231], a[228:231], a[120:123], v[228:231]
    s_cbranch_vccnz L_ffn_kernel_spinh1
L_ffn_kernel_reth1:
    ds_read_b64_tr_b16 a[254:255], v14 offset:22528
    v_fma_f32 v38, v38, v250, v250
    v_mfma_f32_16x16x32_bf16 v[236:239], a[228:231], a[124:127], v[236:239]
    s_waitcnt lgkmcnt(8)
    ds_read_b64_tr_b16 a[216:217], v15 offset:20480
    v_rcp_f32 v38, v38
    v_mfma_f32_16x16x32_bf16 v[208:211], a[232:235], a[128:131], v[208:211]
    s_add_u32 s52, s60, 4096
    ds_read_b64_tr_b16 a[218:219], v15 offset:22528
    v_mul_f32 v130, v130, v38
    v_mfma_f32_16x16x32_bf16 v[216:219], a[232:235], a[132:135], v[216:219]
    ds_read_b64_tr_b16 a[220:221], v16 offset:20480
    buffer_load_dwordx4 a[160:163], v23, s[20:23], s52 offen offset:0 sc1
    v_fma_f32 v39, v39, v26, v24
    v_mfma_f32_16x16x32_bf16 v[212:215], a[236:239], a[128:131], v[212:215]
    ds_read_b64_tr_b16 a[222:223], v16 offset:22528
    buffer_load_dwordx4 a[164:167], v23, s[20:23], s52 offen offset:1024 sc1
    v_mul_f32 v39, v39, v131
    v_mfma_f32_16x16x32_bf16 v[220:223], a[236:239], a[132:135], v[220:223]
    s_waitcnt lgkmcnt(8)
    buffer_load_dwordx4 a[168:171], v23, s[20:23], s52 offen offset:2048 sc1
    v_exp_f32 v39, v39
    v_mfma_f32_16x16x32_bf16 v[224:227], a[240:243], a[128:131], v[224:227]
    buffer_load_dwordx4 a[172:175], v23, s[20:23], s52 offen offset:3072 sc1
    v_fma_f32 v39, v39, v250, v250
    v_mfma_f32_16x16x32_bf16 v[232:235], a[240:243], a[132:135], v[232:235]
    s_waitcnt lgkmcnt(0)
    s_barrier
    ds_read_b64_tr_b16 a[224:225], v13 offset:24576
    ds_read_b64_tr_b16 a[226:227], v13 offset:26624
    v_rcp_f32 v39, v39
    v_mfma_f32_16x16x32_bf16 v[228:231], a[244:247], a[128:131], v[228:231]
    s_add_u32 m0, s33, 36864
    ds_read_b64_tr_b16 a[228:229], v14 offset:24576
    ds_read_b64_tr_b16 a[230:231], v14 offset:26624
    v_mfma_f32_16x16x32_bf16 v[236:239], a[244:247], a[132:135], v[236:239]
    s_add_u32 s32, s38, 2654592
    ds_read_b64_tr_b16 a[232:233], v15 offset:24576
    buffer_load_dwordx4 v1, s[4:7], s32 offen offset:0 lds
    v_mul_f32 v131, v131, v39
    v_mul_f32 v28, v132, v132
    v_mfma_f32_16x16x32_bf16 v[208:211], a[248:251], a[136:139], v[208:211]
    ds_read_b64_tr_b16 a[234:235], v15 offset:26624
    v_fma_f32 v28, v28, v26, v24
    v_mfma_f32_16x16x32_bf16 v[216:219], a[248:251], a[140:143], v[216:219]
    ds_read_b64_tr_b16 a[236:237], v16 offset:24576
    v_mul_f32 v28, v28, v132
    v_mfma_f32_16x16x32_bf16 v[212:215], a[252:255], a[136:139], v[212:215]
    ds_read_b64_tr_b16 a[238:239], v16 offset:26624
    v_exp_f32 v28, v28
    v_mfma_f32_16x16x32_bf16 v[220:223], a[252:255], a[140:143], v[220:223]
    ds_read_b64_tr_b16 a[240:241], v13 offset:28672
    v_fma_f32 v28, v28, v250, v250
    v_mfma_f32_16x16x32_bf16 v[224:227], a[216:219], a[136:139], v[224:227]
    ds_read_b64_tr_b16 a[242:243], v13 offset:30720
    v_rcp_f32 v28, v28
    v_mfma_f32_16x16x32_bf16 v[232:235], a[216:219], a[140:143], v[232:235]
    ds_read_b64_tr_b16 a[244:245], v14 offset:28672
    v_mul_f32 v132, v132, v28
    v_mfma_f32_16x16x32_bf16 v[228:231], a[220:223], a[136:139], v[228:231]
    ds_read_b64_tr_b16 a[246:247], v14 offset:30720
    buffer_load_dwordx4 v2, s[4:7], s32 offen offset:1024 lds
    v_mul_f32 v29, v133, v133
    v_mfma_f32_16x16x32_bf16 v[236:239], a[220:223], a[140:143], v[236:239]
    s_waitcnt lgkmcnt(8)
    ds_read_b64_tr_b16 a[248:249], v15 offset:28672
    v_fma_f32 v29, v29, v26, v24
    v_mfma_f32_16x16x32_bf16 v[144:147], a[224:227], a[0:3], 0
    ds_read_b64_tr_b16 a[250:251], v15 offset:30720
    v_mul_f32 v208, v208, v112
    v_mul_f32 v209, v209, v113
    v_mfma_f32_16x16x32_bf16 v[152:155], a[224:227], a[4:7], 0
    ds_read_b64_tr_b16 a[252:253], v16 offset:28672
    v_cvt_pk_bf16_f32 v72, v208, v209
    v_mfma_f32_16x16x32_bf16 v[148:151], a[228:231], a[0:3], 0
    ds_read_b64_tr_b16 a[254:255], v16 offset:30720
    v_mul_f32 v210, v210, v114
    v_mfma_f32_16x16x32_bf16 v[156:159], a[228:231], a[4:7], 0
    s_waitcnt lgkmcnt(8)
    ds_read_b64_tr_b16 a[216:217], v13 offset:32768
    v_mul_f32 v211, v211, v115
    v_cvt_pk_bf16_f32 v73, v210, v211
    v_mfma_f32_16x16x32_bf16 v[160:163], a[232:235], a[0:3], 0
    ds_read_b64_tr_b16 a[218:219], v13 offset:34816
    v_mul_f32 v212, v212, v116
    v_mfma_f32_16x16x32_bf16 v[168:171], a[232:235], a[4:7], 0
    ds_read_b64_tr_b16 a[220:221], v14 offset:32768
    buffer_load_dwordx4 v3, s[4:7], s32 offen offset:2048 lds
    v_mul_f32 v213, v213, v117
    v_mfma_f32_16x16x32_bf16 v[164:167], a[236:239], a[0:3], 0
    ds_read_b64_tr_b16 a[222:223], v14 offset:34816
    v_cvt_pk_bf16_f32 v74, v212, v213
    v_mul_f32 v214, v214, v118
    v_mfma_f32_16x16x32_bf16 v[172:175], a[236:239], a[4:7], 0
    s_waitcnt lgkmcnt(8)
    ds_read_b64_tr_b16 a[224:225], v15 offset:32768
    v_mul_f32 v215, v215, v119
    v_mfma_f32_16x16x32_bf16 v[144:147], a[240:243], a[8:11], v[144:147]
    ds_read_b64_tr_b16 a[226:227], v15 offset:34816
    v_cvt_pk_bf16_f32 v75, v214, v215
    v_mfma_f32_16x16x32_bf16 v[152:155], a[240:243], a[12:15], v[152:155]
    ds_read_b64_tr_b16 a[228:229], v16 offset:32768
    buffer_store_dwordx4 v[72:75], v23, s[20:23], s49 offen offset:0 sc1
    v_mul_f32 v216, v216, v120
    v_mul_f32 v217, v217, v121
    v_mfma_f32_16x16x32_bf16 v[148:151], a[244:247], a[8:11], v[148:151]
    ds_read_b64_tr_b16 a[230:231], v16 offset:34816
    v_cvt_pk_bf16_f32 v76, v216, v217
    v_mfma_f32_16x16x32_bf16 v[156:159], a[244:247], a[12:15], v[156:159]
    s_waitcnt lgkmcnt(8)
    ds_read_b64_tr_b16 a[232:233], v13 offset:36864
    v_mul_f32 v218, v218, v122
    v_mfma_f32_16x16x32_bf16 v[160:163], a[248:251], a[8:11], v[160:163]
    ds_read_b64_tr_b16 a[234:235], v13 offset:38912
    buffer_load_dwordx4 v4, s[4:7], s32 offen offset:3072 lds
    v_mul_f32 v219, v219, v123
    v_cvt_pk_bf16_f32 v77, v218, v219
    v_mfma_f32_16x16x32_bf16 v[168:171], a[248:251], a[12:15], v[168:171]
    s_add_u32 m0, s33, 40960
    ds_read_b64_tr_b16 a[236:237], v14 offset:36864
    v_mul_f32 v220, v220, v124
    v_mfma_f32_16x16x32_bf16 v[164:167], a[252:255], a[8:11], v[164:167]
    s_add_u32 s32, s38, 2949504
    ds_read_b64_tr_b16 a[238:239], v14 offset:38912
    v_mul_f32 v221, v221, v125
    v_mfma_f32_16x16x32_bf16 v[172:175], a[252:255], a[12:15], v[172:175]
    s_waitcnt lgkmcnt(8)
    ds_read_b64_tr_b16 a[240:241], v15 offset:36864
    v_cvt_pk_bf16_f32 v78, v220, v221
    v_mul_f32 v222, v222, v126
    v_mfma_f32_16x16x32_bf16 v[144:147], a[216:219], a[16:19], v[144:147]
    ds_read_b64_tr_b16 a[242:243], v15 offset:38912
    v_mul_f32 v223, v223, v127
    v_mfma_f32_16x16x32_bf16 v[152:155], a[216:219], a[20:23], v[152:155]
    ds_read_b64_tr_b16 a[244:245], v16 offset:36864
    v_cvt_pk_bf16_f32 v79, v222, v223
    v_mfma_f32_16x16x32_bf16 v[148:151], a[220:223], a[16:19], v[148:151]
    ds_read_b64_tr_b16 a[246:247], v16 offset:38912
    buffer_store_dwordx4 v[76:79], v23, s[20:23], s49 offen offset:1024 sc1
    v_mul_f32 v224, v224, v128
    v_mfma_f32_16x16x32_bf16 v[156:159], a[220:223], a[20:23], v[156:159]
    s_waitcnt lgkmcnt(8)
    ds_read_b64_tr_b16 a[248:249], v13 offset:40960
    buffer_load_dwordx4 v1, s[4:7], s32 offen offset:0 lds
    v_mul_f32 v225, v225, v129
    v_cvt_pk_bf16_f32 v80, v224, v225
    v_mfma_f32_16x16x32_bf16 v[160:163], a[224:227], a[16:19], v[160:163]
    ds_read_b64_tr_b16 a[250:251], v13 offset:43008
    v_mul_f32 v226, v226, v130
    v_mfma_f32_16x16x32_bf16 v[168:171], a[224:227], a[20:23], v[168:171]
    ds_read_b64_tr_b16 a[252:253], v14 offset:40960
    v_mul_f32 v227, v227, v131
    v_mfma_f32_16x16x32_bf16 v[164:167], a[228:231], a[16:19], v[164:167]
    ds_read_b64_tr_b16 a[254:255], v14 offset:43008
    v_cvt_pk_bf16_f32 v81, v226, v227
    v_mul_f32 v228, v228, v132
    v_mfma_f32_16x16x32_bf16 v[172:175], a[228:231], a[20:23], v[172:175]
    s_waitcnt lgkmcnt(8)
    ds_read_b64_tr_b16 a[216:217], v15 offset:40960
    v_mul_f32 v29, v29, v133
    v_mfma_f32_16x16x32_bf16 v[144:147], a[232:235], a[24:27], v[144:147]
    ds_read_b64_tr_b16 a[218:219], v15 offset:43008
    v_exp_f32 v29, v29
    v_mfma_f32_16x16x32_bf16 v[152:155], a[232:235], a[28:31], v[152:155]
    ds_read_b64_tr_b16 a[220:221], v16 offset:40960
    v_fma_f32 v29, v29, v250, v250
    v_mfma_f32_16x16x32_bf16 v[148:151], a[236:239], a[24:27], v[148:151]
    ds_read_b64_tr_b16 a[222:223], v16 offset:43008
    buffer_load_dwordx4 v2, s[4:7], s32 offen offset:1024 lds
    v_rcp_f32 v29, v29
    v_mfma_f32_16x16x32_bf16 v[156:159], a[236:239], a[28:31], v[156:159]
    s_waitcnt lgkmcnt(8)
    ds_read_b64_tr_b16 a[224:225], v13 offset:45056
    v_mul_f32 v133, v133, v29
    v_mfma_f32_16x16x32_bf16 v[160:163], a[240:243], a[24:27], v[160:163]
    ds_read_b64_tr_b16 a[226:227], v13 offset:47104
    v_mul_f32 v229, v229, v133
    v_mfma_f32_16x16x32_bf16 v[168:171], a[240:243], a[28:31], v[168:171]
    ds_read_b64_tr_b16 a[228:229], v14 offset:45056
    v_cvt_pk_bf16_f32 v82, v228, v229
    v_mfma_f32_16x16x32_bf16 v[164:167], a[244:247], a[24:27], v[164:167]
    ds_read_b64_tr_b16 a[230:231], v14 offset:47104
    v_mul_f32 v30, v134, v134
    v_mfma_f32_16x16x32_bf16 v[172:175], a[244:247], a[28:31], v[172:175]
    s_waitcnt lgkmcnt(8)
    ds_read_b64_tr_b16 a[232:233], v15 offset:45056
    v_fma_f32 v30, v30, v26, v24
    v_mul_f32 v30, v30, v134
    v_mfma_f32_16x16x32_bf16 v[144:147], a[248:251], a[32:35], v[144:147]
    ds_read_b64_tr_b16 a[234:235], v15 offset:47104
    v_exp_f32 v30, v30
    v_mfma_f32_16x16x32_bf16 v[152:155], a[248:251], a[36:39], v[152:155]
    ds_read_b64_tr_b16 a[236:237], v16 offset:45056
    buffer_load_dwordx4 v3, s[4:7], s32 offen offset:2048 lds
    v_mfma_f32_16x16x32_bf16 v[148:151], a[252:255], a[32:35], v[148:151]
    ds_read_b64_tr_b16 a[238:239], v16 offset:47104
    v_fma_f32 v30, v30, v250, v250
    v_mul_f32 v31, v135, v135
    v_mfma_f32_16x16x32_bf16 v[156:159], a[252:255], a[36:39], v[156:159]
    s_waitcnt lgkmcnt(8)
    ds_read_b64_tr_b16 a[240:241], v17 offset:0
    v_rcp_f32 v30, v30
    v_mfma_f32_16x16x32_bf16 v[160:163], a[216:219], a[32:35], v[160:163]
    ds_read_b64_tr_b16 a[242:243], v17 offset:2048
    v_mul_f32 v134, v134, v30
    v_mfma_f32_16x16x32_bf16 v[168:171], a[216:219], a[36:39], v[168:171]
    ds_read_b64_tr_b16 a[244:245], v18 offset:0
    v_mul_f32 v230, v230, v134
    v_mfma_f32_16x16x32_bf16 v[164:167], a[220:223], a[32:35], v[164:167]
    ds_read_b64_tr_b16 a[246:247], v18 offset:2048
    v_fma_f32 v31, v31, v26, v24
    v_mfma_f32_16x16x32_bf16 v[172:175], a[220:223], a[36:39], v[172:175]
    s_waitcnt lgkmcnt(8)
    ds_read_b64_tr_b16 a[248:249], v19 offset:0
    v_mul_f32 v31, v31, v135
    v_mfma_f32_16x16x32_bf16 v[144:147], a[224:227], a[40:43], v[144:147]
    ds_read_b64_tr_b16 a[250:251], v19 offset:2048
    buffer_load_dwordx4 v4, s[4:7], s32 offen offset:3072 lds
    v_exp_f32 v31, v31
    v_mfma_f32_16x16x32_bf16 v[152:155], a[224:227], a[44:47], v[152:155]
    s_add_u32 m0, s33, 45056
    ds_read_b64_tr_b16 a[252:253], v20 offset:0
    v_fma_f32 v31, v31, v250, v250
    v_mfma_f32_16x16x32_bf16 v[148:151], a[228:231], a[40:43], v[148:151]
    s_add_u32 s32, s38, 3244416
    ds_read_b64_tr_b16 a[254:255], v20 offset:2048
    v_rcp_f32 v31, v31
    v_mfma_f32_16x16x32_bf16 v[156:159], a[228:231], a[44:47], v[156:159]
    s_waitcnt lgkmcnt(8)
    ds_read_b64_tr_b16 a[216:217], v17 offset:4096
    v_mul_f32 v135, v135, v31
    v_mfma_f32_16x16x32_bf16 v[160:163], a[232:235], a[40:43], v[160:163]
    ds_read_b64_tr_b16 a[218:219], v17 offset:6144
    v_mul_f32 v231, v231, v135
    v_mfma_f32_16x16x32_bf16 v[168:171], a[232:235], a[44:47], v[168:171]
    ds_read_b64_tr_b16 a[220:221], v18 offset:4096
    v_cvt_pk_bf16_f32 v83, v230, v231
    v_mfma_f32_16x16x32_bf16 v[164:167], a[236:239], a[40:43], v[164:167]
    ds_read_b64_tr_b16 a[222:223], v18 offset:6144
    buffer_store_dwordx4 v[80:83], v23, s[20:23], s49 offen offset:2048 sc1
    v_mul_f32 v32, v136, v136
    v_fma_f32 v32, v32, v27, v25
    v_mfma_f32_16x16x32_bf16 v[172:175], a[236:239], a[44:47], v[172:175]
    s_waitcnt lgkmcnt(8)
    ds_read_b64_tr_b16 a[224:225], v19 offset:4096
    buffer_load_dwordx4 v1, s[4:7], s32 offen offset:0 lds
    v_mul_f32 v32, v32, v136
    v_mfma_f32_16x16x32_bf16 v[144:147], a[240:243], a[48:51], v[144:147]
    ds_read_b64_tr_b16 a[226:227], v19 offset:6144
    v_exp_f32 v32, v32
    v_mfma_f32_16x16x32_bf16 v[152:155], a[240:243], a[52:55], v[152:155]
    ds_read_b64_tr_b16 a[228:229], v20 offset:4096
    v_fma_f32 v32, v32, v252, v252
    v_mfma_f32_16x16x32_bf16 v[148:151], a[244:247], a[48:51], v[148:151]
    ds_read_b64_tr_b16 a[230:231], v20 offset:6144
    v_rcp_f32 v32, v32
    v_mfma_f32_16x16x32_bf16 v[156:159], a[244:247], a[52:55], v[156:159]
    s_waitcnt lgkmcnt(8)
    ds_read_b64_tr_b16 a[232:233], v17 offset:8192
    v_mul_f32 v136, v136, v32
    v_mfma_f32_16x16x32_bf16 v[160:163], a[248:251], a[48:51], v[160:163]
    ds_read_b64_tr_b16 a[234:235], v17 offset:10240
    v_mul_f32 v232, v232, v136
    v_mfma_f32_16x16x32_bf16 v[168:171], a[248:251], a[52:55], v[168:171]
    ds_read_b64_tr_b16 a[236:237], v18 offset:8192
    v_mul_f32 v33, v137, v137
    v_mfma_f32_16x16x32_bf16 v[164:167], a[252:255], a[48:51], v[164:167]
    ds_read_b64_tr_b16 a[238:239], v18 offset:10240
    v_fma_f32 v33, v33, v27, v25
    v_mfma_f32_16x16x32_bf16 v[172:175], a[252:255], a[52:55], v[172:175]
    s_waitcnt lgkmcnt(8)
    ds_read_b64_tr_b16 a[240:241], v19 offset:8192
    v_mul_f32 v33, v33, v137
    v_mul_f32 v34, v138, v138
    v_mfma_f32_16x16x32_bf16 v[144:147], a[216:219], a[56:59], v[144:147]
    ds_read_b64_tr_b16 a[242:243], v19 offset:10240
    v_exp_f32 v33, v33
    v_mfma_f32_16x16x32_bf16 v[152:155], a[216:219], a[60:63], v[152:155]
    ds_read_b64_tr_b16 a[244:245], v20 offset:8192
    v_fma_f32 v33, v33, v252, v252
    v_mfma_f32_16x16x32_bf16 v[148:151], a[220:223], a[56:59], v[148:151]
    ds_read_b64_tr_b16 a[246:247], v20 offset:10240
    v_rcp_f32 v33, v33
    v_mfma_f32_16x16x32_bf16 v[156:159], a[220:223], a[60:63], v[156:159]
    s_waitcnt lgkmcnt(8)
    v_mul_f32 v137, v137, v33
    v_mul_f32 v233, v233, v137
    v_mfma_f32_16x16x32_bf16 v[160:163], a[224:227], a[56:59], v[160:163]
    v_cvt_pk_bf16_f32 v84, v232, v233
    v_fma_f32 v34, v34, v27, v25
    v_mfma_f32_16x16x32_bf16 v[168:171], a[224:227], a[60:63], v[168:171]
    s_waitcnt lgkmcnt(0)
    s_barrier
    ds_read_b64_tr_b16 a[248:249], v17 offset:12288
    ds_read_b64_tr_b16 a[250:251], v17 offset:14336
    v_mfma_f32_16x16x32_bf16 v[164:167], a[228:231], a[56:59], v[164:167]
    s_add_u32 m0, s33, 73728
    ds_read_b64_tr_b16 a[252:253], v18 offset:12288
    ds_read_b64_tr_b16 a[254:255], v18 offset:14336
    v_mfma_f32_16x16x32_bf16 v[172:175], a[228:231], a[60:63], v[172:175]
    s_add_u32 s32, s39, 0
    ds_read_b64_tr_b16 a[216:217], v19 offset:12288
    buffer_load_dwordx4 v104, s[12:15], s32 offen offset:0 lds
    v_mul_f32 v34, v34, v138
    v_mfma_f32_16x16x32_bf16 v[144:147], a[232:235], a[64:67], v[144:147]
    ds_read_b64_tr_b16 a[218:219], v19 offset:14336
    v_exp_f32 v34, v34
    v_mfma_f32_16x16x32_bf16 v[152:155], a[232:235], a[68:71], v[152:155]
    ds_read_b64_tr_b16 a[220:221], v20 offset:12288
    v_fma_f32 v34, v34, v252, v252
    v_mfma_f32_16x16x32_bf16 v[148:151], a[236:239], a[64:67], v[148:151]
    ds_read_b64_tr_b16 a[222:223], v20 offset:14336
    v_rcp_f32 v34, v34
    v_mfma_f32_16x16x32_bf16 v[156:159], a[236:239], a[68:71], v[156:159]
    ds_read_b64_tr_b16 a[224:225], v17 offset:16384
    v_mul_f32 v138, v138, v34
    v_mfma_f32_16x16x32_bf16 v[160:163], a[240:243], a[64:67], v[160:163]
    ds_read_b64_tr_b16 a[226:227], v17 offset:18432
    v_mul_f32 v234, v234, v138
    v_mfma_f32_16x16x32_bf16 v[168:171], a[240:243], a[68:71], v[168:171]
    ds_read_b64_tr_b16 a[228:229], v18 offset:16384
    v_mul_f32 v35, v139, v139
    v_mfma_f32_16x16x32_bf16 v[164:167], a[244:247], a[64:67], v[164:167]
    ds_read_b64_tr_b16 a[230:231], v18 offset:18432
    buffer_load_dwordx4 v105, s[12:15], s32 offen offset:1024 lds
    v_fma_f32 v35, v35, v27, v25
    v_mul_f32 v35, v35, v139
    v_mfma_f32_16x16x32_bf16 v[172:175], a[244:247], a[68:71], v[172:175]
    s_waitcnt lgkmcnt(8)
    ds_read_b64_tr_b16 a[232:233], v19 offset:16384
    v_exp_f32 v35, v35
    v_mfma_f32_16x16x32_bf16 v[144:147], a[248:251], a[72:75], v[144:147]
    ds_read_b64_tr_b16 a[234:235], v19 offset:18432
    v_fma_f32 v35, v35, v252, v252
    v_mfma_f32_16x16x32_bf16 v[152:155], a[248:251], a[76:79], v[152:155]
    ds_read_b64_tr_b16 a[236:237], v20 offset:16384
    v_rcp_f32 v35, v35
    v_mfma_f32_16x16x32_bf16 v[148:151], a[252:255], a[72:75], v[148:151]
    ds_read_b64_tr_b16 a[238:239], v20 offset:18432
    v_mul_f32 v139, v139, v35
    v_mfma_f32_16x16x32_bf16 v[156:159], a[252:255], a[76:79], v[156:159]
    s_waitcnt lgkmcnt(8)
    ds_read_b64_tr_b16 a[240:241], v17 offset:20480
    v_mul_f32 v235, v235, v139
    v_mfma_f32_16x16x32_bf16 v[160:163], a[216:219], a[72:75], v[160:163]
    ds_read_b64_tr_b16 a[242:243], v17 offset:22528
    v_cvt_pk_bf16_f32 v85, v234, v235
    v_mfma_f32_16x16x32_bf16 v[168:171], a[216:219], a[76:79], v[168:171]
    ds_read_b64_tr_b16 a[244:245], v18 offset:20480
    buffer_load_dwordx4 v106, s[12:15], s32 offen offset:2048 lds
    v_mul_f32 v36, v140, v140
    v_mfma_f32_16x16x32_bf16 v[164:167], a[220:223], a[72:75], v[164:167]
    ds_read_b64_tr_b16 a[246:247], v18 offset:22528
    v_fma_f32 v36, v36, v27, v25
    v_mfma_f32_16x16x32_bf16 v[172:175], a[220:223], a[76:79], v[172:175]
    s_waitcnt lgkmcnt(8)
    ds_read_b64_tr_b16 a[248:249], v19 offset:20480
    v_mul_f32 v36, v36, v140
    v_mul_f32 v37, v141, v141
    v_mfma_f32_16x16x32_bf16 v[144:147], a[224:227], a[80:83], v[144:147]
    ds_read_b64_tr_b16 a[250:251], v19 offset:22528
    v_exp_f32 v36, v36
    v_mfma_f32_16x16x32_bf16 v[152:155], a[224:227], a[84:87], v[152:155]
    ds_read_b64_tr_b16 a[252:253], v20 offset:20480
    v_fma_f32 v36, v36, v252, v252
    v_mfma_f32_16x16x32_bf16 v[148:151], a[228:231], a[80:83], v[148:151]
    ds_read_b64_tr_b16 a[254:255], v20 offset:22528
    v_rcp_f32 v36, v36
    v_mfma_f32_16x16x32_bf16 v[156:159], a[228:231], a[84:87], v[156:159]
    s_waitcnt lgkmcnt(8)
    ds_read_b64_tr_b16 a[216:217], v17 offset:24576
    v_mul_f32 v140, v140, v36
    v_mfma_f32_16x16x32_bf16 v[160:163], a[232:235], a[80:83], v[160:163]
    ds_read_b64_tr_b16 a[218:219], v17 offset:26624
    buffer_load_dwordx4 v107, s[12:15], s32 offen offset:3072 lds
    v_mfma_f32_16x16x32_bf16 v[168:171], a[232:235], a[84:87], v[168:171]
    s_add_u32 m0, s33, 77824
    ds_read_b64_tr_b16 a[220:221], v18 offset:24576
    v_mul_f32 v236, v236, v140
    v_fma_f32 v37, v37, v27, v25
    v_mfma_f32_16x16x32_bf16 v[164:167], a[236:239], a[80:83], v[164:167]
    s_add_u32 s32, s39, 589824
    ds_read_b64_tr_b16 a[222:223], v18 offset:26624
    v_mul_f32 v37, v37, v141
    v_mfma_f32_16x16x32_bf16 v[172:175], a[236:239], a[84:87], v[172:175]
    s_waitcnt lgkmcnt(8)
    ds_read_b64_tr_b16 a[224:225], v19 offset:24576
    v_exp_f32 v37, v37
    v_mfma_f32_16x16x32_bf16 v[144:147], a[240:243], a[88:91], v[144:147]
    ds_read_b64_tr_b16 a[226:227], v19 offset:26624
    v_fma_f32 v37, v37, v252, v252
    v_mfma_f32_16x16x32_bf16 v[152:155], a[240:243], a[92:95], v[152:155]
    ds_read_b64_tr_b16 a[228:229], v20 offset:24576
    v_rcp_f32 v37, v37
    v_mfma_f32_16x16x32_bf16 v[148:151], a[244:247], a[88:91], v[148:151]
    ds_read_b64_tr_b16 a[230:231], v20 offset:26624
    v_mul_f32 v141, v141, v37
    v_mfma_f32_16x16x32_bf16 v[156:159], a[244:247], a[92:95], v[156:159]
    s_waitcnt lgkmcnt(8)
    ds_read_b64_tr_b16 a[232:233], v17 offset:28672
    buffer_load_dwordx4 v104, s[12:15], s32 offen offset:0 lds
    v_mul_f32 v237, v237, v141
    v_mfma_f32_16x16x32_bf16 v[160:163], a[248:251], a[88:91], v[160:163]
    ds_read_b64_tr_b16 a[234:235], v17 offset:30720
    v_cvt_pk_bf16_f32 v86, v236, v237
    v_mfma_f32_16x16x32_bf16 v[168:171], a[248:251], a[92:95], v[168:171]
    ds_read_b64_tr_b16 a[236:237], v18 offset:28672
    v_mul_f32 v38, v142, v142
    v_mfma_f32_16x16x32_bf16 v[164:167], a[252:255], a[88:91], v[164:167]
    ds_read_b64_tr_b16 a[238:239], v18 offset:30720
    v_fma_f32 v38, v38, v27, v25
    v_mul_f32 v38, v38, v142
    v_mfma_f32_16x16x32_bf16 v[172:175], a[252:255], a[92:95], v[172:175]
    s_waitcnt lgkmcnt(8)
    ds_read_b64_tr_b16 a[240:241], v19 offset:28672
    v_exp_f32 v38, v38
    v_mfma_f32_16x16x32_bf16 v[144:147], a[216:219], a[96:99], v[144:147]
    ds_read_b64_tr_b16 a[242:243], v19 offset:30720
    v_fma_f32 v38, v38, v252, v252
    v_mfma_f32_16x16x32_bf16 v[152:155], a[216:219], a[100:103], v[152:155]
    ds_read_b64_tr_b16 a[244:245], v20 offset:28672
    v_rcp_f32 v38, v38
    v_mfma_f32_16x16x32_bf16 v[148:151], a[220:223], a[96:99], v[148:151]
    ds_read_b64_tr_b16 a[246:247], v20 offset:30720
    buffer_load_dwordx4 v105, s[12:15], s32 offen offset:1024 lds
    v_mfma_f32_16x16x32_bf16 v[156:159], a[220:223], a[100:103], v[156:159]
    s_waitcnt lgkmcnt(8)
    ds_read_b64_tr_b16 a[248:249], v17 offset:32768
    v_mul_f32 v142, v142, v38
    v_mfma_f32_16x16x32_bf16 v[160:163], a[224:227], a[96:99], v[160:163]
    ds_read_b64_tr_b16 a[250:251], v17 offset:34816
    v_mul_f32 v238, v238, v142
    v_mul_f32 v39, v143, v143
    v_mfma_f32_16x16x32_bf16 v[168:171], a[224:227], a[100:103], v[168:171]
    ds_read_b64_tr_b16 a[252:253], v18 offset:32768
    v_fma_f32 v39, v39, v27, v25
    v_mfma_f32_16x16x32_bf16 v[164:167], a[228:231], a[96:99], v[164:167]
    ds_read_b64_tr_b16 a[254:255], v18 offset:34816
    v_mul_f32 v39, v39, v143
    v_mfma_f32_16x16x32_bf16 v[172:175], a[228:231], a[100:103], v[172:175]
    s_waitcnt lgkmcnt(8)
    ds_read_b64_tr_b16 a[216:217], v19 offset:32768
    v_exp_f32 v39, v39
    v_mfma_f32_16x16x32_bf16 v[144:147], a[232:235], a[104:107], v[144:147]
    ds_read_b64_tr_b16 a[218:219], v19 offset:34816
    v_fma_f32 v39, v39, v252, v252
    v_mfma_f32_16x16x32_bf16 v[152:155], a[232:235], a[108:111], v[152:155]
    ds_read_b64_tr_b16 a[220:221], v20 offset:32768
    buffer_load_dwordx4 v106, s[12:15], s32 offen offset:2048 lds
    v_rcp_f32 v39, v39
    v_mfma_f32_16x16x32_bf16 v[148:151], a[236:239], a[104:107], v[148:151]
    ds_read_b64_tr_b16 a[222:223], v20 offset:34816
    v_mul_f32 v143, v143, v39
    v_mfma_f32_16x16x32_bf16 v[156:159], a[236:239], a[108:111], v[156:159]
    s_waitcnt lgkmcnt(8)
    ds_read_b64_tr_b16 a[224:225], v17 offset:36864
    v_mul_f32 v239, v239, v143
    v_mfma_f32_16x16x32_bf16 v[160:163], a[240:243], a[104:107], v[160:163]
    ds_read_b64_tr_b16 a[226:227], v17 offset:38912
    v_cvt_pk_bf16_f32 v87, v238, v239
    v_mfma_f32_16x16x32_bf16 v[168:171], a[240:243], a[108:111], v[168:171]
    ds_read_b64_tr_b16 a[228:229], v18 offset:36864
    buffer_store_dwordx4 v[84:87], v23, s[20:23], s49 offen offset:3072 sc1
    v_mfma_f32_16x16x32_bf16 v[164:167], a[244:247], a[104:107], v[164:167]
    s_add_u32 s49, s57, 12288
    ds_read_b64_tr_b16 a[230:231], v18 offset:38912
    v_mfma_f32_16x16x32_bf16 v[172:175], a[244:247], a[108:111], v[172:175]
    s_waitcnt lgkmcnt(8)
    ds_read_b64_tr_b16 a[232:233], v19 offset:36864
    v_mfma_f32_16x16x32_bf16 v[144:147], a[248:251], a[112:115], v[144:147]
    ds_read_b64_tr_b16 a[234:235], v19 offset:38912
    buffer_load_dwordx4 v107, s[12:15], s32 offen offset:3072 lds
    v_mfma_f32_16x16x32_bf16 v[152:155], a[248:251], a[116:119], v[152:155]
    s_add_u32 m0, s33, 81920
    ds_read_b64_tr_b16 a[236:237], v20 offset:36864
    v_mfma_f32_16x16x32_bf16 v[148:151], a[252:255], a[112:115], v[148:151]
    s_add_u32 s32, s39, 1179648
    ds_read_b64_tr_b16 a[238:239], v20 offset:38912
    v_mfma_f32_16x16x32_bf16 v[156:159], a[252:255], a[116:119], v[156:159]
    s_waitcnt lgkmcnt(8)
    ds_read_b64_tr_b16 a[240:241], v17 offset:40960
    v_mfma_f32_16x16x32_bf16 v[160:163], a[216:219], a[112:115], v[160:163]
    ds_read_b64_tr_b16 a[242:243], v17 offset:43008
    v_mfma_f32_16x16x32_bf16 v[168:171], a[216:219], a[116:119], v[168:171]
    ds_read_b64_tr_b16 a[244:245], v18 offset:40960
    v_mfma_f32_16x16x32_bf16 v[164:167], a[220:223], a[112:115], v[164:167]
    ds_read_b64_tr_b16 a[246:247], v18 offset:43008
    v_mfma_f32_16x16x32_bf16 v[172:175], a[220:223], a[116:119], v[172:175]
    s_waitcnt lgkmcnt(8)
    ds_read_b64_tr_b16 a[248:249], v19 offset:40960
    buffer_load_dwordx4 v104, s[12:15], s32 offen offset:0 lds
    v_mfma_f32_16x16x32_bf16 v[144:147], a[224:227], a[120:123], v[144:147]
    ds_read_b64_tr_b16 a[250:251], v19 offset:43008
    v_mfma_f32_16x16x32_bf16 v[152:155], a[224:227], a[124:127], v[152:155]
    ds_read_b64_tr_b16 a[252:253], v20 offset:40960
    v_mfma_f32_16x16x32_bf16 v[148:151], a[228:231], a[120:123], v[148:151]
    ds_read_b64_tr_b16 a[254:255], v20 offset:43008
    v_mfma_f32_16x16x32_bf16 v[156:159], a[228:231], a[124:127], v[156:159]
    s_waitcnt lgkmcnt(8)
    ds_read_b64_tr_b16 a[216:217], v17 offset:45056
    v_mfma_f32_16x16x32_bf16 v[160:163], a[232:235], a[120:123], v[160:163]
    ds_read_b64_tr_b16 a[218:219], v17 offset:47104
    v_mfma_f32_16x16x32_bf16 v[168:171], a[232:235], a[124:127], v[168:171]
    ds_read_b64_tr_b16 a[220:221], v18 offset:45056
    v_mfma_f32_16x16x32_bf16 v[164:167], a[236:239], a[120:123], v[164:167]
    ds_read_b64_tr_b16 a[222:223], v18 offset:47104
    v_mfma_f32_16x16x32_bf16 v[172:175], a[236:239], a[124:127], v[172:175]
    s_waitcnt lgkmcnt(8)
    ds_read_b64_tr_b16 a[224:225], v19 offset:45056
    v_mfma_f32_16x16x32_bf16 v[144:147], a[240:243], a[128:131], v[144:147]
    ds_read_b64_tr_b16 a[226:227], v19 offset:47104
    v_mfma_f32_16x16x32_bf16 v[152:155], a[240:243], a[132:135], v[152:155]
    ds_read_b64_tr_b16 a[228:229], v20 offset:45056
    v_mfma_f32_16x16x32_bf16 v[148:151], a[244:247], a[128:131], v[148:151]
    ds_read_b64_tr_b16 a[230:231], v20 offset:47104
    v_mfma_f32_16x16x32_bf16 v[156:159], a[244:247], a[132:135], v[156:159]
    s_waitcnt lgkmcnt(8)
    v_mfma_f32_16x16x32_bf16 v[160:163], a[248:251], a[128:131], v[160:163]
    v_mfma_f32_16x16x32_bf16 v[168:171], a[248:251], a[132:135], v[168:171]
    s_waitcnt vmcnt(26) lgkmcnt(0)
    s_barrier
    ds_read_b64_tr_b16 a[232:233], v9 offset:0
    ds_read_b64_tr_b16 a[234:235], v9 offset:2048
    v_mfma_f32_16x16x32_bf16 v[164:167], a[252:255], a[128:131], v[164:167]
    s_add_u32 m0, s33, 110592
    ds_read_b64_tr_b16 a[236:237], v10 offset:0
    ds_read_b64_tr_b16 a[238:239], v10 offset:2048
    v_mfma_f32_16x16x32_bf16 v[172:175], a[252:255], a[132:135], v[172:175]
    s_add_u32 s32, s39, 0
    ds_read_b64_tr_b16 a[240:241], v11 offset:0
    buffer_load_dwordx4 v104, s[4:7], s32 offen offset:0 lds
    v_mfma_f32_16x16x32_bf16 v[144:147], a[216:219], a[136:139], v[144:147]
    ds_read_b64_tr_b16 a[242:243], v11 offset:2048
    v_mfma_f32_16x16x32_bf16 v[152:155], a[216:219], a[140:143], v[152:155]
    ds_read_b64_tr_b16 a[244:245], v12 offset:0
    v_mfma_f32_16x16x32_bf16 v[148:151], a[220:223], a[136:139], v[148:151]
    ds_read_b64_tr_b16 a[246:247], v12 offset:2048
    v_mfma_f32_16x16x32_bf16 v[156:159], a[220:223], a[140:143], v[156:159]
    ds_read_b64_tr_b16 a[248:249], v9 offset:4096
    v_mfma_f32_16x16x32_bf16 v[160:163], a[224:227], a[136:139], v[160:163]
    ds_read_b64_tr_b16 a[250:251], v9 offset:6144
    v_mfma_f32_16x16x32_bf16 v[168:171], a[224:227], a[140:143], v[168:171]
    ds_read_b64_tr_b16 a[252:253], v10 offset:4096
    v_mfma_f32_16x16x32_bf16 v[164:167], a[228:231], a[136:139], v[164:167]
    ds_read_b64_tr_b16 a[254:255], v10 offset:6144
    buffer_load_dwordx4 v105, s[4:7], s32 offen offset:1024 lds
    v_mfma_f32_16x16x32_bf16 v[172:175], a[228:231], a[140:143], v[172:175]
    s_waitcnt lgkmcnt(8)
    ds_read_b64_tr_b16 a[216:217], v11 offset:4096
    v_mfma_f32_16x16x32_bf16 v[176:179], a[232:235], a[0:3], 0
    ds_read_b64_tr_b16 a[218:219], v11 offset:6144
    v_mul_f32 v28, v144, v144
    v_fma_f32 v28, v28, v26, v24
    v_mfma_f32_16x16x32_bf16 v[184:187], a[232:235], a[4:7], 0
    ds_read_b64_tr_b16 a[220:221], v12 offset:4096
    v_mul_f32 v28, v28, v144
    v_mul_f32 v29, v145, v145
    v_mfma_f32_16x16x32_bf16 v[180:183], a[236:239], a[0:3], 0
    ds_read_b64_tr_b16 a[222:223], v12 offset:6144
    v_exp_f32 v28, v28
    v_mfma_f32_16x16x32_bf16 v[188:191], a[236:239], a[4:7], 0
    s_waitcnt lgkmcnt(8)
    ds_read_b64_tr_b16 a[224:225], v9 offset:8192
    v_fma_f32 v28, v28, v250, v250
    v_mfma_f32_16x16x32_bf16 v[192:195], a[240:243], a[0:3], 0
    ds_read_b64_tr_b16 a[226:227], v9 offset:10240
    v_rcp_f32 v28, v28
    v_mfma_f32_16x16x32_bf16 v[200:203], a[240:243], a[4:7], 0
    ds_read_b64_tr_b16 a[228:229], v10 offset:8192
    buffer_load_dwordx4 v106, s[4:7], s32 offen offset:2048 lds
    v_mul_f32 v144, v144, v28
    v_mfma_f32_16x16x32_bf16 v[196:199], a[244:247], a[0:3], 0
    ds_read_b64_tr_b16 a[230:231], v10 offset:10240
    v_fma_f32 v29, v29, v26, v24
    v_mfma_f32_16x16x32_bf16 v[204:207], a[244:247], a[4:7], 0
    s_waitcnt lgkmcnt(8)
    ds_read_b64_tr_b16 a[232:233], v11 offset:8192
    v_mul_f32 v29, v29, v145
    v_mul_f32 v30, v146, v146
    v_mfma_f32_16x16x32_bf16 v[176:179], a[248:251], a[8:11], v[176:179]
    ds_read_b64_tr_b16 a[234:235], v11 offset:10240
    v_exp_f32 v29, v29
    v_mfma_f32_16x16x32_bf16 v[184:187], a[248:251], a[12:15], v[184:187]
    ds_read_b64_tr_b16 a[236:237], v12 offset:8192
    v_fma_f32 v29, v29, v250, v250
    v_mfma_f32_16x16x32_bf16 v[180:183], a[252:255], a[8:11], v[180:183]
    ds_read_b64_tr_b16 a[238:239], v12 offset:10240
    v_rcp_f32 v29, v29
    v_mfma_f32_16x16x32_bf16 v[188:191], a[252:255], a[12:15], v[188:191]
    s_waitcnt lgkmcnt(8)
    ds_read_b64_tr_b16 a[240:241], v9 offset:12288
    v_mul_f32 v145, v145, v29
    v_mfma_f32_16x16x32_bf16 v[192:195], a[216:219], a[8:11], v[192:195]
    ds_read_b64_tr_b16 a[242:243], v9 offset:14336
    buffer_load_dwordx4 v107, s[4:7], s32 offen offset:3072 lds
    v_fma_f32 v30, v30, v26, v24
    v_mfma_f32_16x16x32_bf16 v[200:203], a[216:219], a[12:15], v[200:203]
    s_add_u32 m0, s33, 114688
    ds_read_b64_tr_b16 a[244:245], v10 offset:12288
    v_mul_f32 v30, v30, v146
    v_mfma_f32_16x16x32_bf16 v[196:199], a[220:223], a[8:11], v[196:199]
    s_add_u32 s32, s39, 589824
    ds_read_b64_tr_b16 a[246:247], v10 offset:14336
    v_exp_f32 v30, v30
    v_mfma_f32_16x16x32_bf16 v[204:207], a[220:223], a[12:15], v[204:207]
    s_waitcnt lgkmcnt(8)
    ds_read_b64_tr_b16 a[248:249], v11 offset:12288
    v_fma_f32 v30, v30, v250, v250
    v_mfma_f32_16x16x32_bf16 v[176:179], a[224:227], a[16:19], v[176:179]
    s_waitcnt vmcnt(6)
    ds_read_b64_tr_b16 a[250:251], v11 offset:14336
    buffer_store_dword v248, v245, s[20:23], s53 offen offset:256 sc1
    v_rcp_f32 v30, v30
    v_mfma_f32_16x16x32_bf16 v[184:187], a[224:227], a[20:23], v[184:187]
    ds_read_b64_tr_b16 a[252:253], v12 offset:12288
    v_mul_f32 v146, v146, v30
    v_mfma_f32_16x16x32_bf16 v[180:183], a[228:231], a[16:19], v[180:183]
    ds_read_b64_tr_b16 a[254:255], v12 offset:14336
    v_mul_f32 v31, v147, v147
    v_fma_f32 v31, v31, v26, v24
    v_mfma_f32_16x16x32_bf16 v[188:191], a[228:231], a[20:23], v[188:191]
    s_waitcnt lgkmcnt(8)
    ds_read_b64_tr_b16 a[216:217], v9 offset:16384
    buffer_load_dwordx4 v104, s[4:7], s32 offen offset:0 lds
    v_mul_f32 v31, v31, v147
    v_mfma_f32_16x16x32_bf16 v[192:195], a[232:235], a[16:19], v[192:195]
    ds_read_b64_tr_b16 a[218:219], v9 offset:18432
    v_exp_f32 v31, v31
    v_mfma_f32_16x16x32_bf16 v[200:203], a[232:235], a[20:23], v[200:203]
    ds_read_b64_tr_b16 a[220:221], v10 offset:16384
    v_fma_f32 v31, v31, v250, v250
    v_mfma_f32_16x16x32_bf16 v[196:199], a[236:239], a[16:19], v[196:199]
    ds_read_b64_tr_b16 a[222:223], v10 offset:18432
    v_rcp_f32 v31, v31
    v_mfma_f32_16x16x32_bf16 v[204:207], a[236:239], a[20:23], v[204:207]
    s_waitcnt lgkmcnt(8)
    ds_read_b64_tr_b16 a[224:225], v11 offset:16384
    v_mul_f32 v147, v147, v31
    v_mfma_f32_16x16x32_bf16 v[176:179], a[240:243], a[24:27], v[176:179]
    ds_read_b64_tr_b16 a[226:227], v11 offset:18432
    v_mul_f32 v32, v148, v148
    v_fma_f32 v32, v32, v26, v24
    v_mfma_f32_16x16x32_bf16 v[184:187], a[240:243], a[28:31], v[184:187]
    ds_read_b64_tr_b16 a[228:229], v12 offset:16384
    v_mul_f32 v32, v32, v148
    v_mfma_f32_16x16x32_bf16 v[180:183], a[244:247], a[24:27], v[180:183]
    ds_read_b64_tr_b16 a[230:231], v12 offset:18432
    buffer_load_dwordx4 v105, s[4:7], s32 offen offset:1024 lds
    v_exp_f32 v32, v32
    v_mfma_f32_16x16x32_bf16 v[188:191], a[244:247], a[28:31], v[188:191]
    s_waitcnt lgkmcnt(8)
    ds_read_b64_tr_b16 a[232:233], v9 offset:20480
    v_fma_f32 v32, v32, v250, v250
    v_mfma_f32_16x16x32_bf16 v[192:195], a[248:251], a[24:27], v[192:195]
    ds_read_b64_tr_b16 a[234:235], v9 offset:22528
    v_rcp_f32 v32, v32
    v_mfma_f32_16x16x32_bf16 v[200:203], a[248:251], a[28:31], v[200:203]
    ds_read_b64_tr_b16 a[236:237], v10 offset:20480
    v_mul_f32 v148, v148, v32
    v_mfma_f32_16x16x32_bf16 v[196:199], a[252:255], a[24:27], v[196:199]
    ds_read_b64_tr_b16 a[238:239], v10 offset:22528
    v_mul_f32 v33, v149, v149
    v_mfma_f32_16x16x32_bf16 v[204:207], a[252:255], a[28:31], v[204:207]
    s_waitcnt lgkmcnt(8)
    ds_read_b64_tr_b16 a[240:241], v11 offset:20480
    v_fma_f32 v33, v33, v26, v24
    v_mul_f32 v33, v33, v149
    v_mfma_f32_16x16x32_bf16 v[176:179], a[216:219], a[32:35], v[176:179]
    ds_read_b64_tr_b16 a[242:243], v11 offset:22528
    v_exp_f32 v33, v33
    v_mfma_f32_16x16x32_bf16 v[184:187], a[216:219], a[36:39], v[184:187]
    ds_read_b64_tr_b16 a[244:245], v12 offset:20480
    buffer_load_dwordx4 v106, s[4:7], s32 offen offset:2048 lds
    v_fma_f32 v33, v33, v250, v250
    v_mfma_f32_16x16x32_bf16 v[180:183], a[220:223], a[32:35], v[180:183]
    ds_read_b64_tr_b16 a[246:247], v12 offset:22528
    v_rcp_f32 v33, v33
    v_mfma_f32_16x16x32_bf16 v[188:191], a[220:223], a[36:39], v[188:191]
    s_waitcnt lgkmcnt(8)
    ds_read_b64_tr_b16 a[248:249], v9 offset:24576
    v_mul_f32 v149, v149, v33
    v_mfma_f32_16x16x32_bf16 v[192:195], a[224:227], a[32:35], v[192:195]
    ds_read_b64_tr_b16 a[250:251], v9 offset:26624
    v_mul_f32 v34, v150, v150
    v_mfma_f32_16x16x32_bf16 v[200:203], a[224:227], a[36:39], v[200:203]
    ds_read_b64_tr_b16 a[252:253], v10 offset:24576
    v_fma_f32 v34, v34, v26, v24
    v_mul_f32 v34, v34, v150
    v_mfma_f32_16x16x32_bf16 v[196:199], a[228:231], a[32:35], v[196:199]
    ds_read_b64_tr_b16 a[254:255], v10 offset:26624
    v_exp_f32 v34, v34
    v_mfma_f32_16x16x32_bf16 v[204:207], a[228:231], a[36:39], v[204:207]
    s_waitcnt lgkmcnt(8)
    ds_read_b64_tr_b16 a[216:217], v11 offset:24576
    v_fma_f32 v34, v34, v250, v250
    v_mfma_f32_16x16x32_bf16 v[176:179], a[232:235], a[40:43], v[176:179]
    ds_read_b64_tr_b16 a[218:219], v11 offset:26624
    buffer_load_dwordx4 v107, s[4:7], s32 offen offset:3072 lds
    v_rcp_f32 v34, v34
    v_mfma_f32_16x16x32_bf16 v[184:187], a[232:235], a[44:47], v[184:187]
    s_add_u32 m0, s33, 118784
    ds_read_b64_tr_b16 a[220:221], v12 offset:24576
    v_mul_f32 v150, v150, v34
    v_mfma_f32_16x16x32_bf16 v[180:183], a[236:239], a[40:43], v[180:183]
    s_add_u32 s32, s39, 1179648
    ds_read_b64_tr_b16 a[222:223], v12 offset:26624
    v_mul_f32 v35, v151, v151
    v_mfma_f32_16x16x32_bf16 v[188:191], a[236:239], a[44:47], v[188:191]
    s_waitcnt lgkmcnt(8)
    ds_read_b64_tr_b16 a[224:225], v9 offset:28672
    v_fma_f32 v35, v35, v26, v24
    v_mfma_f32_16x16x32_bf16 v[192:195], a[240:243], a[40:43], v[192:195]
    ds_read_b64_tr_b16 a[226:227], v9 offset:30720
    v_mul_f32 v35, v35, v151
    v_mul_f32 v36, v152, v152
    v_mfma_f32_16x16x32_bf16 v[200:203], a[240:243], a[44:47], v[200:203]
    ds_read_b64_tr_b16 a[228:229], v10 offset:28672
    v_exp_f32 v35, v35
    v_mfma_f32_16x16x32_bf16 v[196:199], a[244:247], a[40:43], v[196:199]
    ds_read_b64_tr_b16 a[230:231], v10 offset:30720
    v_fma_f32 v35, v35, v250, v250
    v_mfma_f32_16x16x32_bf16 v[204:207], a[244:247], a[44:47], v[204:207]
    s_waitcnt lgkmcnt(8)
    ds_read_b64_tr_b16 a[232:233], v11 offset:28672
    buffer_load_dwordx4 v104, s[4:7], s32 offen offset:0 lds
    v_rcp_f32 v35, v35
    v_mfma_f32_16x16x32_bf16 v[176:179], a[248:251], a[48:51], v[176:179]
    ds_read_b64_tr_b16 a[234:235], v11 offset:30720
    v_mul_f32 v151, v151, v35
    v_mfma_f32_16x16x32_bf16 v[184:187], a[248:251], a[52:55], v[184:187]
    ds_read_b64_tr_b16 a[236:237], v12 offset:28672
    v_fma_f32 v36, v36, v27, v25
    v_mfma_f32_16x16x32_bf16 v[180:183], a[252:255], a[48:51], v[180:183]
    ds_read_b64_tr_b16 a[238:239], v12 offset:30720
    v_mul_f32 v36, v36, v152
    v_mul_f32 v37, v153, v153
    v_mfma_f32_16x16x32_bf16 v[188:191], a[252:255], a[52:55], v[188:191]
    s_waitcnt lgkmcnt(8)
    ds_read_b64_tr_b16 a[240:241], v9 offset:32768
    v_exp_f32 v36, v36
    v_mfma_f32_16x16x32_bf16 v[192:195], a[216:219], a[48:51], v[192:195]
    ds_read_b64_tr_b16 a[242:243], v9 offset:34816
    v_fma_f32 v36, v36, v252, v252
    v_mfma_f32_16x16x32_bf16 v[200:203], a[216:219], a[52:55], v[200:203]
    ds_read_b64_tr_b16 a[244:245], v10 offset:32768
    v_rcp_f32 v36, v36
    v_mfma_f32_16x16x32_bf16 v[196:199], a[220:223], a[48:51], v[196:199]
    ds_read_b64_tr_b16 a[246:247], v10 offset:34816
    v_mul_f32 v152, v152, v36
    v_mfma_f32_16x16x32_bf16 v[204:207], a[220:223], a[52:55], v[204:207]
    s_waitcnt lgkmcnt(8)
    ds_read_b64_tr_b16 a[248:249], v11 offset:32768
    v_fma_f32 v37, v37, v27, v25
    v_mfma_f32_16x16x32_bf16 v[176:179], a[224:227], a[56:59], v[176:179]
    ds_read_b64_tr_b16 a[250:251], v11 offset:34816
    v_mul_f32 v37, v37, v153
    v_mfma_f32_16x16x32_bf16 v[184:187], a[224:227], a[60:63], v[184:187]
    ds_read_b64_tr_b16 a[252:253], v12 offset:32768
    v_exp_f32 v37, v37
    v_mfma_f32_16x16x32_bf16 v[180:183], a[228:231], a[56:59], v[180:183]
    ds_read_b64_tr_b16 a[254:255], v12 offset:34816
    v_fma_f32 v37, v37, v252, v252
    v_mfma_f32_16x16x32_bf16 v[188:191], a[228:231], a[60:63], v[188:191]
    s_waitcnt lgkmcnt(8)
    v_rcp_f32 v37, v37
    v_mfma_f32_16x16x32_bf16 v[192:195], a[232:235], a[56:59], v[192:195]
    v_mul_f32 v153, v153, v37
    v_mul_f32 v38, v154, v154
    v_mfma_f32_16x16x32_bf16 v[200:203], a[232:235], a[60:63], v[200:203]
    s_waitcnt lgkmcnt(0)
    s_barrier
    ds_read_b64_tr_b16 a[216:217], v9 offset:36864
    ds_read_b64_tr_b16 a[218:219], v9 offset:38912
    v_fma_f32 v38, v38, v27, v25
    v_mfma_f32_16x16x32_bf16 v[196:199], a[236:239], a[56:59], v[196:199]
    s_add_u32 m0, s34, 0
    ds_read_b64_tr_b16 a[220:221], v10 offset:36864
    ds_read_b64_tr_b16 a[222:223], v10 offset:38912
    v_mul_f32 v38, v38, v154
    v_mfma_f32_16x16x32_bf16 v[204:207], a[236:239], a[60:63], v[204:207]
    s_add_u32 s32, s40, 0
    ds_read_b64_tr_b16 a[224:225], v11 offset:36864
    buffer_load_dwordx4 v5, s[16:19], s32 offen offset:0 lds
    v_exp_f32 v38, v38
    v_mfma_f32_16x16x32_bf16 v[176:179], a[240:243], a[64:67], v[176:179]
    ds_read_b64_tr_b16 a[226:227], v11 offset:38912
    v_fma_f32 v38, v38, v252, v252
    v_mfma_f32_16x16x32_bf16 v[184:187], a[240:243], a[68:71], v[184:187]
    ds_read_b64_tr_b16 a[228:229], v12 offset:36864
    v_rcp_f32 v38, v38
    v_mfma_f32_16x16x32_bf16 v[180:183], a[244:247], a[64:67], v[180:183]
    ds_read_b64_tr_b16 a[230:231], v12 offset:38912
    v_mul_f32 v154, v154, v38
    v_mfma_f32_16x16x32_bf16 v[188:191], a[244:247], a[68:71], v[188:191]
    ds_read_b64_tr_b16 a[232:233], v9 offset:40960
    v_mul_f32 v39, v155, v155
    v_mfma_f32_16x16x32_bf16 v[192:195], a[248:251], a[64:67], v[192:195]
    ds_read_b64_tr_b16 a[234:235], v9 offset:43008
    v_fma_f32 v39, v39, v27, v25
    v_mul_f32 v39, v39, v155
    v_mfma_f32_16x16x32_bf16 v[200:203], a[248:251], a[68:71], v[200:203]
    ds_read_b64_tr_b16 a[236:237], v10 offset:40960
    v_exp_f32 v39, v39
    v_mfma_f32_16x16x32_bf16 v[196:199], a[252:255], a[64:67], v[196:199]
    ds_read_b64_tr_b16 a[238:239], v10 offset:43008
    buffer_load_dwordx4 v6, s[16:19], s32 offen offset:1024 lds
    v_fma_f32 v39, v39, v252, v252
    v_mfma_f32_16x16x32_bf16 v[204:207], a[252:255], a[68:71], v[204:207]
    s_waitcnt lgkmcnt(8)
    ds_read_b64_tr_b16 a[240:241], v11 offset:40960
    v_rcp_f32 v39, v39
    v_mfma_f32_16x16x32_bf16 v[176:179], a[216:219], a[72:75], v[176:179]
    ds_read_b64_tr_b16 a[242:243], v11 offset:43008
    v_mul_f32 v155, v155, v39
    v_mfma_f32_16x16x32_bf16 v[184:187], a[216:219], a[76:79], v[184:187]
    ds_read_b64_tr_b16 a[244:245], v12 offset:40960
    v_mul_f32 v28, v156, v156
    v_mfma_f32_16x16x32_bf16 v[180:183], a[220:223], a[72:75], v[180:183]
    ds_read_b64_tr_b16 a[246:247], v12 offset:43008
    v_fma_f32 v28, v28, v27, v25
    v_mul_f32 v28, v28, v156
    v_mfma_f32_16x16x32_bf16 v[188:191], a[220:223], a[76:79], v[188:191]
    s_waitcnt lgkmcnt(8)
    ds_read_b64_tr_b16 a[248:249], v9 offset:45056
    v_exp_f32 v28, v28
    v_mfma_f32_16x16x32_bf16 v[192:195], a[224:227], a[72:75], v[192:195]
    ds_read_b64_tr_b16 a[250:251], v9 offset:47104
    buffer_load_dword v247, off, s[20:23], s54 offset:256 sc1
    v_fma_f32 v28, v28, v252, v252
    v_mfma_f32_16x16x32_bf16 v[200:203], a[224:227], a[76:79], v[200:203]
    ds_read_b64_tr_b16 a[252:253], v10 offset:45056
    buffer_load_dwordx4 v7, s[16:19], s32 offen offset:2048 lds
    v_rcp_f32 v28, v28
    v_mfma_f32_16x16x32_bf16 v[196:199], a[228:231], a[72:75], v[196:199]
    ds_read_b64_tr_b16 a[254:255], v10 offset:47104
    v_mul_f32 v156, v156, v28
    v_mfma_f32_16x16x32_bf16 v[204:207], a[228:231], a[76:79], v[204:207]
    s_waitcnt lgkmcnt(8)
    ds_read_b64_tr_b16 a[216:217], v11 offset:45056
    v_mul_f32 v29, v157, v157
    v_mfma_f32_16x16x32_bf16 v[176:179], a[232:235], a[80:83], v[176:179]
    ds_read_b64_tr_b16 a[218:219], v11 offset:47104
    v_fma_f32 v29, v29, v27, v25
    v_mfma_f32_16x16x32_bf16 v[184:187], a[232:235], a[84:87], v[184:187]
    ds_read_b64_tr_b16 a[220:221], v12 offset:45056
    v_mul_f32 v29, v29, v157
    v_mul_f32 v30, v158, v158
    v_mfma_f32_16x16x32_bf16 v[180:183], a[236:239], a[80:83], v[180:183]
    ds_read_b64_tr_b16 a[222:223], v12 offset:47104
    v_exp_f32 v29, v29
    v_mfma_f32_16x16x32_bf16 v[188:191], a[236:239], a[84:87], v[188:191]
    s_waitcnt lgkmcnt(8)
    ds_read_b64_tr_b16 a[224:225], v13 offset:0
    v_fma_f32 v29, v29, v252, v252
    v_mfma_f32_16x16x32_bf16 v[192:195], a[240:243], a[80:83], v[192:195]
    ds_read_b64_tr_b16 a[226:227], v13 offset:2048
    buffer_load_dwordx4 v8, s[16:19], s32 offen offset:3072 lds
    v_rcp_f32 v29, v29
    v_mfma_f32_16x16x32_bf16 v[200:203], a[240:243], a[84:87], v[200:203]
    s_add_u32 m0, s34, 4096
    ds_read_b64_tr_b16 a[228:229], v14 offset:0
    v_mul_f32 v157, v157, v29
    v_mfma_f32_16x16x32_bf16 v[196:199], a[244:247], a[80:83], v[196:199]
    s_add_u32 s32, s40, 36864
    ds_read_b64_tr_b16 a[230:231], v14 offset:2048
    v_fma_f32 v30, v30, v27, v25
    v_mfma_f32_16x16x32_bf16 v[204:207], a[244:247], a[84:87], v[204:207]
    s_waitcnt lgkmcnt(8)
    ds_read_b64_tr_b16 a[232:233], v15 offset:0
    v_mul_f32 v30, v30, v158
    v_mul_f32 v31, v159, v159
    v_mfma_f32_16x16x32_bf16 v[176:179], a[248:251], a[88:91], v[176:179]
    ds_read_b64_tr_b16 a[234:235], v15 offset:2048
    v_exp_f32 v30, v30
    v_mfma_f32_16x16x32_bf16 v[184:187], a[248:251], a[92:95], v[184:187]
    ds_read_b64_tr_b16 a[236:237], v16 offset:0
    v_fma_f32 v30, v30, v252, v252
    v_mfma_f32_16x16x32_bf16 v[180:183], a[252:255], a[88:91], v[180:183]
    ds_read_b64_tr_b16 a[238:239], v16 offset:2048
    v_rcp_f32 v30, v30
    v_mfma_f32_16x16x32_bf16 v[188:191], a[252:255], a[92:95], v[188:191]
    s_waitcnt lgkmcnt(8)
    ds_read_b64_tr_b16 a[240:241], v13 offset:4096
    buffer_load_dwordx4 v5, s[16:19], s32 offen offset:0 lds
    v_mfma_f32_16x16x32_bf16 v[192:195], a[216:219], a[88:91], v[192:195]
    ds_read_b64_tr_b16 a[242:243], v13 offset:6144
    v_mul_f32 v158, v158, v30
    v_fma_f32 v31, v31, v27, v25
    v_mfma_f32_16x16x32_bf16 v[200:203], a[216:219], a[92:95], v[200:203]
    ds_read_b64_tr_b16 a[244:245], v14 offset:4096
    v_mul_f32 v31, v31, v159
    v_mfma_f32_16x16x32_bf16 v[196:199], a[220:223], a[88:91], v[196:199]
    ds_read_b64_tr_b16 a[246:247], v14 offset:6144
    v_exp_f32 v31, v31
    v_mfma_f32_16x16x32_bf16 v[204:207], a[220:223], a[92:95], v[204:207]
    s_waitcnt lgkmcnt(8)
    ds_read_b64_tr_b16 a[248:249], v15 offset:4096
    v_fma_f32 v31, v31, v252, v252
    v_mfma_f32_16x16x32_bf16 v[176:179], a[224:227], a[96:99], v[176:179]
    ds_read_b64_tr_b16 a[250:251], v15 offset:6144
    v_rcp_f32 v31, v31
    v_mfma_f32_16x16x32_bf16 v[184:187], a[224:227], a[100:103], v[184:187]
    ds_read_b64_tr_b16 a[252:253], v16 offset:4096
    v_mul_f32 v159, v159, v31
    v_mfma_f32_16x16x32_bf16 v[180:183], a[228:231], a[96:99], v[180:183]
    ds_read_b64_tr_b16 a[254:255], v16 offset:6144
    buffer_load_dwordx4 v6, s[16:19], s32 offen offset:1024 lds
    v_mul_f32 v32, v160, v160
    v_fma_f32 v32, v32, v26, v24
    v_mfma_f32_16x16x32_bf16 v[188:191], a[228:231], a[100:103], v[188:191]
    s_waitcnt lgkmcnt(8)
    ds_read_b64_tr_b16 a[216:217], v13 offset:8192
    v_mul_f32 v32, v32, v160
    v_mfma_f32_16x16x32_bf16 v[192:195], a[232:235], a[96:99], v[192:195]
    ds_read_b64_tr_b16 a[218:219], v13 offset:10240
    v_exp_f32 v32, v32
    v_mfma_f32_16x16x32_bf16 v[200:203], a[232:235], a[100:103], v[200:203]
    ds_read_b64_tr_b16 a[220:221], v14 offset:8192
    v_fma_f32 v32, v32, v250, v250
    v_mfma_f32_16x16x32_bf16 v[196:199], a[236:239], a[96:99], v[196:199]
    ds_read_b64_tr_b16 a[222:223], v14 offset:10240
    v_rcp_f32 v32, v32
    v_mfma_f32_16x16x32_bf16 v[204:207], a[236:239], a[100:103], v[204:207]
    s_waitcnt lgkmcnt(8)
    ds_read_b64_tr_b16 a[224:225], v15 offset:8192
    v_mul_f32 v160, v160, v32
    v_mfma_f32_16x16x32_bf16 v[176:179], a[240:243], a[104:107], v[176:179]
    ds_read_b64_tr_b16 a[226:227], v15 offset:10240
    v_mul_f32 v33, v161, v161
    v_mfma_f32_16x16x32_bf16 v[184:187], a[240:243], a[108:111], v[184:187]
    ds_read_b64_tr_b16 a[228:229], v16 offset:8192
    buffer_load_dwordx4 v7, s[16:19], s32 offen offset:2048 lds
    v_fma_f32 v33, v33, v26, v24
    v_mul_f32 v33, v33, v161
    v_mfma_f32_16x16x32_bf16 v[180:183], a[244:247], a[104:107], v[180:183]
    ds_read_b64_tr_b16 a[230:231], v16 offset:10240
    v_exp_f32 v33, v33
    v_mfma_f32_16x16x32_bf16 v[188:191], a[244:247], a[108:111], v[188:191]
    s_waitcnt lgkmcnt(8)
    ds_read_b64_tr_b16 a[232:233], v13 offset:12288
    v_fma_f32 v33, v33, v250, v250
    v_mfma_f32_16x16x32_bf16 v[192:195], a[248:251], a[104:107], v[192:195]
    ds_read_b64_tr_b16 a[234:235], v13 offset:14336
    v_rcp_f32 v33, v33
    v_mfma_f32_16x16x32_bf16 v[200:203], a[248:251], a[108:111], v[200:203]
    ds_read_b64_tr_b16 a[236:237], v14 offset:12288
    v_mul_f32 v161, v161, v33
    v_mfma_f32_16x16x32_bf16 v[196:199], a[252:255], a[104:107], v[196:199]
    ds_read_b64_tr_b16 a[238:239], v14 offset:14336
    v_mul_f32 v34, v162, v162
    v_mfma_f32_16x16x32_bf16 v[204:207], a[252:255], a[108:111], v[204:207]
    s_waitcnt lgkmcnt(8)
    ds_read_b64_tr_b16 a[240:241], v15 offset:12288
    v_fma_f32 v34, v34, v26, v24
    v_mul_f32 v34, v34, v162
    v_mfma_f32_16x16x32_bf16 v[176:179], a[216:219], a[112:115], v[176:179]
    s_waitcnt vmcnt(5)
    ds_read_b64_tr_b16 a[242:243], v15 offset:14336
    buffer_load_dwordx4 v8, s[16:19], s32 offen offset:3072 lds
    v_exp_f32 v34, v34
    v_mfma_f32_16x16x32_bf16 v[184:187], a[216:219], a[116:119], v[184:187]
    s_add_u32 m0, s35, 32768
    ds_read_b64_tr_b16 a[244:245], v16 offset:12288
    v_cmp_eq_u32 vcc, 0, v247
    v_mfma_f32_16x16x32_bf16 v[180:183], a[220:223], a[112:115], v[180:183]
    s_add_u32 s32, s41, 0
    ds_read_b64_tr_b16 a[246:247], v16 offset:14336
    v_fma_f32 v34, v34, v250, v250
    v_mfma_f32_16x16x32_bf16 v[188:191], a[220:223], a[116:119], v[188:191]
    s_waitcnt lgkmcnt(8)
    ds_read_b64_tr_b16 a[248:249], v13 offset:16384
    v_rcp_f32 v34, v34
    v_mfma_f32_16x16x32_bf16 v[192:195], a[224:227], a[112:115], v[192:195]
    s_cbranch_vccnz L_ffn_kernel_spinh2
L_ffn_kernel_reth2:
    ds_read_b64_tr_b16 a[250:251], v13 offset:18432
    v_mul_f32 v162, v162, v34
    v_mfma_f32_16x16x32_bf16 v[200:203], a[224:227], a[116:119], v[200:203]
    s_add_u32 s52, s60, 8192
    ds_read_b64_tr_b16 a[252:253], v14 offset:16384
    v_mul_f32 v35, v163, v163
    v_fma_f32 v35, v35, v26, v24
    v_mfma_f32_16x16x32_bf16 v[196:199], a[228:231], a[112:115], v[196:199]
    ds_read_b64_tr_b16 a[254:255], v14 offset:18432
    buffer_load_dwordx4 a[176:179], v23, s[20:23], s52 offen offset:0 sc1
    v_mul_f32 v35, v35, v163
    v_mfma_f32_16x16x32_bf16 v[204:207], a[228:231], a[116:119], v[204:207]
    s_waitcnt lgkmcnt(8)
    ds_read_b64_tr_b16 a[216:217], v15 offset:16384
    buffer_load_dwordx4 v5, s[16:19], s32 offen offset:0 lds
    v_exp_f32 v35, v35
    v_mfma_f32_16x16x32_bf16 v[176:179], a[232:235], a[120:123], v[176:179]
    ds_read_b64_tr_b16 a[218:219], v15 offset:18432
    buffer_load_dwordx4 a[180:183], v23, s[20:23], s52 offen offset:1024 sc1
    v_fma_f32 v35, v35, v250, v250
    v_mfma_f32_16x16x32_bf16 v[184:187], a[232:235], a[124:127], v[184:187]
    ds_read_b64_tr_b16 a[220:221], v16 offset:16384
    buffer_load_dwordx4 a[184:187], v23, s[20:23], s52 offen offset:2048 sc1
    v_rcp_f32 v35, v35
    v_mfma_f32_16x16x32_bf16 v[180:183], a[236:239], a[120:123], v[180:183]
    ds_read_b64_tr_b16 a[222:223], v16 offset:18432
    buffer_load_dwordx4 a[188:191], v23, s[20:23], s52 offen offset:3072 sc1
    v_mul_f32 v163, v163, v35
    v_mfma_f32_16x16x32_bf16 v[188:191], a[236:239], a[124:127], v[188:191]
    s_waitcnt lgkmcnt(8)
    ds_read_b64_tr_b16 a[224:225], v13 offset:20480
    v_mul_f32 v36, v164, v164
    v_mfma_f32_16x16x32_bf16 v[192:195], a[240:243], a[120:123], v[192:195]
    ds_read_b64_tr_b16 a[226:227], v13 offset:22528
    v_fma_f32 v36, v36, v26, v24
    v_mul_f32 v36, v36, v164
    v_mfma_f32_16x16x32_bf16 v[200:203], a[240:243], a[124:127], v[200:203]
    ds_read_b64_tr_b16 a[228:229], v14 offset:20480
    v_exp_f32 v36, v36
    v_mfma_f32_16x16x32_bf16 v[196:199], a[244:247], a[120:123], v[196:199]
    ds_read_b64_tr_b16 a[230:231], v14 offset:22528
    v_fma_f32 v36, v36, v250, v250
    v_mfma_f32_16x16x32_bf16 v[204:207], a[244:247], a[124:127], v[204:207]
    s_waitcnt lgkmcnt(8)
    ds_read_b64_tr_b16 a[232:233], v15 offset:20480
    v_rcp_f32 v36, v36
    v_mfma_f32_16x16x32_bf16 v[176:179], a[248:251], a[128:131], v[176:179]
    ds_read_b64_tr_b16 a[234:235], v15 offset:22528
    v_mul_f32 v164, v164, v36
    v_mfma_f32_16x16x32_bf16 v[184:187], a[248:251], a[132:135], v[184:187]
    ds_read_b64_tr_b16 a[236:237], v16 offset:20480
    v_mul_f32 v37, v165, v165
    v_mfma_f32_16x16x32_bf16 v[180:183], a[252:255], a[128:131], v[180:183]
    ds_read_b64_tr_b16 a[238:239], v16 offset:22528
    v_fma_f32 v37, v37, v26, v24
    v_mul_f32 v37, v37, v165
    v_mfma_f32_16x16x32_bf16 v[188:191], a[252:255], a[132:135], v[188:191]
    s_waitcnt lgkmcnt(8)
    v_exp_f32 v37, v37
    v_mfma_f32_16x16x32_bf16 v[192:195], a[216:219], a[128:131], v[192:195]
    v_fma_f32 v37, v37, v250, v250
    v_mul_f32 v38, v166, v166
    v_mfma_f32_16x16x32_bf16 v[200:203], a[216:219], a[132:135], v[200:203]
    s_waitcnt lgkmcnt(0)
    s_barrier
    v_add_u32 v21, 73728, v21
    v_add_u32 v22, 73728, v22
    ds_read_b64_tr_b16 a[240:241], v21 offset:0
    ds_read_b64_tr_b16 a[242:243], v21 offset:1024
    v_mfma_f32_16x16x32_bf16 v[196:199], a[220:223], a[128:131], v[196:199]
    s_add_u32 m0, s34, 36864
    ds_read_b64_tr_b16 a[244:245], v22 offset:0
    ds_read_b64_tr_b16 a[246:247], v22 offset:1024
    v_rcp_f32 v37, v37
    v_mfma_f32_16x16x32_bf16 v[204:207], a[220:223], a[132:135], v[204:207]
    s_add_u32 s32, s40, 128
    ds_read_b64_tr_b16 a[248:249], v21 offset:2048
    buffer_load_dwordx4 v5, s[16:19], s32 offen offset:0 lds
    v_mul_f32 v165, v165, v37
    v_mfma_f32_16x16x32_bf16 v[176:179], a[224:227], a[136:139], v[176:179]
    ds_read_b64_tr_b16 a[250:251], v21 offset:3072
    v_fma_f32 v38, v38, v26, v24
    v_mfma_f32_16x16x32_bf16 v[184:187], a[224:227], a[140:143], v[184:187]
    ds_read_b64_tr_b16 a[252:253], v22 offset:2048
    v_mul_f32 v38, v38, v166
    v_mul_f32 v39, v167, v167
    v_mfma_f32_16x16x32_bf16 v[180:183], a[228:231], a[136:139], v[180:183]
    ds_read_b64_tr_b16 a[254:255], v22 offset:3072
    v_exp_f32 v38, v38
    v_mfma_f32_16x16x32_bf16 v[188:191], a[228:231], a[140:143], v[188:191]
    ds_read_b64_tr_b16 a[216:217], v21 offset:4096
    v_fma_f32 v38, v38, v250, v250
    v_mfma_f32_16x16x32_bf16 v[192:195], a[232:235], a[136:139], v[192:195]
    ds_read_b64_tr_b16 a[218:219], v21 offset:5120
    v_rcp_f32 v38, v38
    v_mfma_f32_16x16x32_bf16 v[200:203], a[232:235], a[140:143], v[200:203]
    ds_read_b64_tr_b16 a[220:221], v22 offset:4096
    v_mul_f32 v166, v166, v38
    v_mfma_f32_16x16x32_bf16 v[196:199], a[236:239], a[136:139], v[196:199]
    ds_read_b64_tr_b16 a[222:223], v22 offset:5120
    buffer_load_dwordx4 v6, s[16:19], s32 offen offset:1024 lds
    v_fma_f32 v39, v39, v26, v24
    v_mfma_f32_16x16x32_bf16 v[204:207], a[236:239], a[140:143], v[204:207]
    s_waitcnt lgkmcnt(8)
    ds_read_b64_tr_b16 a[224:225], v21 offset:6144
    v_mul_f32 v39, v39, v167
    v_mul_f32 v28, v168, v168
    v_mfma_f32_16x16x32_bf16 v[112:115], a[240:243], a[0:3], 0
    ds_read_b64_tr_b16 a[226:227], v21 offset:7168
    v_exp_f32 v39, v39
    v_mfma_f32_16x16x32_bf16 v[120:123], a[240:243], a[4:7], 0
    ds_read_b64_tr_b16 a[228:229], v22 offset:6144
    v_mul_f32 v176, v176, v144
    v_mfma_f32_16x16x32_bf16 v[116:119], a[244:247], a[0:3], 0
    ds_read_b64_tr_b16 a[230:231], v22 offset:7168
    v_mul_f32 v177, v177, v145
    v_mfma_f32_16x16x32_bf16 v[124:127], a[244:247], a[4:7], 0
    s_waitcnt lgkmcnt(8)
    ds_read_b64_tr_b16 a[232:233], v21 offset:8192
    v_cvt_pk_bf16_f32 v88, v176, v177
    v_mfma_f32_16x16x32_bf16 v[112:115], a[248:251], a[8:11], v[112:115]
    ds_read_b64_tr_b16 a[234:235], v21 offset:9216
    v_mul_f32 v178, v178, v146
    v_mul_f32 v179, v179, v147
    v_mfma_f32_16x16x32_bf16 v[120:123], a[248:251], a[12:15], v[120:123]
    ds_read_b64_tr_b16 a[236:237], v22 offset:8192
    buffer_load_dwordx4 v7, s[16:19], s32 offen offset:2048 lds
    v_cvt_pk_bf16_f32 v89, v178, v179
    v_mfma_f32_16x16x32_bf16 v[116:119], a[252:255], a[8:11], v[116:119]
    ds_read_b64_tr_b16 a[238:239], v22 offset:9216
    v_mul_f32 v180, v180, v148
    v_mul_f32 v181, v181, v149
    v_mfma_f32_16x16x32_bf16 v[124:127], a[252:255], a[12:15], v[124:127]
    s_waitcnt lgkmcnt(8)
    ds_read_b64_tr_b16 a[240:241], v21 offset:10240
    v_cvt_pk_bf16_f32 v90, v180, v181
    v_mfma_f32_16x16x32_bf16 v[112:115], a[216:219], a[16:19], v[112:115]
    ds_read_b64_tr_b16 a[242:243], v21 offset:11264
    v_mul_f32 v182, v182, v150
    v_mul_f32 v183, v183, v151
    v_mfma_f32_16x16x32_bf16 v[120:123], a[216:219], a[20:23], v[120:123]
    ds_read_b64_tr_b16 a[244:245], v22 offset:10240
    buffer_store_dword v248, v245, s[20:23], s56 offen offset:512 sc1
    v_cvt_pk_bf16_f32 v91, v182, v183
    v_mfma_f32_16x16x32_bf16 v[116:119], a[220:223], a[16:19], v[116:119]
    ds_read_b64_tr_b16 a[246:247], v22 offset:11264
    buffer_store_dwordx4 v[88:91], v23, s[20:23], s49 offen offset:0 sc1
    v_mul_f32 v184, v184, v152
    v_mul_f32 v185, v185, v153
    v_mfma_f32_16x16x32_bf16 v[124:127], a[220:223], a[20:23], v[124:127]
    s_waitcnt lgkmcnt(8)
    ds_read_b64_tr_b16 a[248:249], v21 offset:12288
    v_cvt_pk_bf16_f32 v92, v184, v185
    v_mfma_f32_16x16x32_bf16 v[112:115], a[224:227], a[24:27], v[112:115]
    ds_read_b64_tr_b16 a[250:251], v21 offset:13312
    buffer_load_dwordx4 v8, s[16:19], s32 offen offset:3072 lds
    v_mul_f32 v186, v186, v154
    v_mul_f32 v187, v187, v155
    v_mfma_f32_16x16x32_bf16 v[120:123], a[224:227], a[28:31], v[120:123]
    s_add_u32 m0, s34, 40960
    ds_read_b64_tr_b16 a[252:253], v22 offset:12288
    v_cvt_pk_bf16_f32 v93, v186, v187
    v_mfma_f32_16x16x32_bf16 v[116:119], a[228:231], a[24:27], v[116:119]
    s_add_u32 s32, s40, 36992
    ds_read_b64_tr_b16 a[254:255], v22 offset:13312
    v_mul_f32 v188, v188, v156
    v_mul_f32 v189, v189, v157
    v_mfma_f32_16x16x32_bf16 v[124:127], a[228:231], a[28:31], v[124:127]
    s_waitcnt lgkmcnt(8)
    ds_read_b64_tr_b16 a[216:217], v21 offset:14336
    v_cvt_pk_bf16_f32 v94, v188, v189
    v_mfma_f32_16x16x32_bf16 v[112:115], a[232:235], a[32:35], v[112:115]
    ds_read_b64_tr_b16 a[218:219], v21 offset:15360
    v_mul_f32 v190, v190, v158
    v_mul_f32 v191, v191, v159
    v_mfma_f32_16x16x32_bf16 v[120:123], a[232:235], a[36:39], v[120:123]
    ds_read_b64_tr_b16 a[220:221], v22 offset:14336
    v_cvt_pk_bf16_f32 v95, v190, v191
    v_mfma_f32_16x16x32_bf16 v[116:119], a[236:239], a[32:35], v[116:119]
    ds_read_b64_tr_b16 a[222:223], v22 offset:15360
    buffer_store_dwordx4 v[92:95], v23, s[20:23], s49 offen offset:1024 sc1
    v_mul_f32 v192, v192, v160
    v_mfma_f32_16x16x32_bf16 v[124:127], a[236:239], a[36:39], v[124:127]
    s_waitcnt lgkmcnt(8)
    ds_read_b64_tr_b16 a[224:225], v21 offset:16384
    buffer_load_dwordx4 v5, s[16:19], s32 offen offset:0 lds
    v_mul_f32 v193, v193, v161
    v_cvt_pk_bf16_f32 v96, v192, v193
    v_mfma_f32_16x16x32_bf16 v[112:115], a[240:243], a[40:43], v[112:115]
    ds_read_b64_tr_b16 a[226:227], v21 offset:17408
    v_mul_f32 v194, v194, v162
    v_mfma_f32_16x16x32_bf16 v[120:123], a[240:243], a[44:47], v[120:123]
    ds_read_b64_tr_b16 a[228:229], v22 offset:16384
    v_mul_f32 v195, v195, v163
    v_cvt_pk_bf16_f32 v97, v194, v195
    v_mfma_f32_16x16x32_bf16 v[116:119], a[244:247], a[40:43], v[116:119]
    ds_read_b64_tr_b16 a[230:231], v22 offset:17408
    v_mul_f32 v196, v196, v164
    v_mfma_f32_16x16x32_bf16 v[124:127], a[244:247], a[44:47], v[124:127]
    s_waitcnt lgkmcnt(8)
    ds_read_b64_tr_b16 a[232:233], v21 offset:18432
    v_mul_f32 v197, v197, v165
    v_cvt_pk_bf16_f32 v98, v196, v197
    v_mfma_f32_16x16x32_bf16 v[112:115], a[248:251], a[48:51], v[112:115]
    ds_read_b64_tr_b16 a[234:235], v21 offset:19456
    v_mul_f32 v198, v198, v166
    v_mfma_f32_16x16x32_bf16 v[120:123], a[248:251], a[52:55], v[120:123]
    ds_read_b64_tr_b16 a[236:237], v22 offset:18432
    v_fma_f32 v39, v39, v250, v250
    v_fma_f32 v28, v28, v27, v25
    v_mfma_f32_16x16x32_bf16 v[116:119], a[252:255], a[48:51], v[116:119]
    ds_read_b64_tr_b16 a[238:239], v22 offset:19456
    buffer_load_dwordx4 v6, s[16:19], s32 offen offset:1024 lds
    v_rcp_f32 v39, v39
    v_mfma_f32_16x16x32_bf16 v[124:127], a[252:255], a[52:55], v[124:127]
    s_waitcnt lgkmcnt(8)
    ds_read_b64_tr_b16 a[240:241], v21 offset:20480
    v_mul_f32 v167, v167, v39
    v_mfma_f32_16x16x32_bf16 v[112:115], a[216:219], a[56:59], v[112:115]
    ds_read_b64_tr_b16 a[242:243], v21 offset:21504
    v_mul_f32 v199, v199, v167
    v_mfma_f32_16x16x32_bf16 v[120:123], a[216:219], a[60:63], v[120:123]
    ds_read_b64_tr_b16 a[244:245], v22 offset:20480
    v_cvt_pk_bf16_f32 v99, v198, v199
    v_mul_f32 v28, v28, v168
    v_mfma_f32_16x16x32_bf16 v[116:119], a[220:223], a[56:59], v[116:119]
    ds_read_b64_tr_b16 a[246:247], v22 offset:21504
    buffer_store_dwordx4 v[96:99], v23, s[20:23], s49 offen offset:2048 sc1
    v_exp_f32 v28, v28
    v_mfma_f32_16x16x32_bf16 v[124:127], a[220:223], a[60:63], v[124:127]
    s_waitcnt lgkmcnt(8)
    ds_read_b64_tr_b16 a[248:249], v21 offset:22528
    v_fma_f32 v28, v28, v252, v252
    v_mfma_f32_16x16x32_bf16 v[112:115], a[224:227], a[64:67], v[112:115]
    ds_read_b64_tr_b16 a[250:251], v21 offset:23552
    v_rcp_f32 v28, v28
    v_mfma_f32_16x16x32_bf16 v[120:123], a[224:227], a[68:71], v[120:123]
    ds_read_b64_tr_b16 a[252:253], v22 offset:22528
    buffer_load_dwordx4 v7, s[16:19], s32 offen offset:2048 lds
    v_mfma_f32_16x16x32_bf16 v[116:119], a[228:231], a[64:67], v[116:119]
    ds_read_b64_tr_b16 a[254:255], v22 offset:23552
    v_mul_f32 v168, v168, v28
    v_mul_f32 v200, v200, v168
    v_mfma_f32_16x16x32_bf16 v[124:127], a[228:231], a[68:71], v[124:127]
    s_waitcnt lgkmcnt(8)
    ds_read_b64_tr_b16 a[216:217], v21 offset:24576
    v_mul_f32 v29, v169, v169
    v_mfma_f32_16x16x32_bf16 v[112:115], a[232:235], a[72:75], v[112:115]
    ds_read_b64_tr_b16 a[218:219], v21 offset:25600
    v_fma_f32 v29, v29, v27, v25
    v_mul_f32 v29, v29, v169
    v_mfma_f32_16x16x32_bf16 v[120:123], a[232:235], a[76:79], v[120:123]
    ds_read_b64_tr_b16 a[220:221], v22 offset:24576
    v_exp_f32 v29, v29
    v_mfma_f32_16x16x32_bf16 v[116:119], a[236:239], a[72:75], v[116:119]
    ds_read_b64_tr_b16 a[222:223], v22 offset:25600
    v_fma_f32 v29, v29, v252, v252
    v_mfma_f32_16x16x32_bf16 v[124:127], a[236:239], a[76:79], v[124:127]
    s_waitcnt lgkmcnt(8)
    ds_read_b64_tr_b16 a[224:225], v21 offset:26624
    v_rcp_f32 v29, v29
    v_mfma_f32_16x16x32_bf16 v[112:115], a[240:243], a[80:83], v[112:115]
    ds_read_b64_tr_b16 a[226:227], v21 offset:27648
    buffer_load_dwordx4 v8, s[16:19], s32 offen offset:3072 lds
    v_mul_f32 v169, v169, v29
    v_mfma_f32_16x16x32_bf16 v[120:123], a[240:243], a[84:87], v[120:123]
    s_add_u32 m0, s35, 69632
    ds_read_b64_tr_b16 a[228:229], v22 offset:26624
    v_mul_f32 v201, v201, v169
    v_mfma_f32_16x16x32_bf16 v[116:119], a[244:247], a[80:83], v[116:119]
    s_add_u32 s32, s41, 128
    ds_read_b64_tr_b16 a[230:231], v22 offset:27648
    v_cvt_pk_bf16_f32 v100, v200, v201
    v_mul_f32 v30, v170, v170
    v_mfma_f32_16x16x32_bf16 v[124:127], a[244:247], a[84:87], v[124:127]
    s_waitcnt lgkmcnt(8)
    ds_read_b64_tr_b16 a[232:233], v21 offset:28672
    v_fma_f32 v30, v30, v27, v25
    v_mfma_f32_16x16x32_bf16 v[112:115], a[248:251], a[88:91], v[112:115]
    ds_read_b64_tr_b16 a[234:235], v21 offset:29696
    v_mul_f32 v30, v30, v170
    v_mul_f32 v31, v171, v171
    v_mfma_f32_16x16x32_bf16 v[120:123], a[248:251], a[92:95], v[120:123]
    ds_read_b64_tr_b16 a[236:237], v22 offset:28672
    v_exp_f32 v30, v30
    v_mfma_f32_16x16x32_bf16 v[116:119], a[252:255], a[88:91], v[116:119]
    ds_read_b64_tr_b16 a[238:239], v22 offset:29696
    v_fma_f32 v30, v30, v252, v252
    v_mfma_f32_16x16x32_bf16 v[124:127], a[252:255], a[92:95], v[124:127]
    s_waitcnt lgkmcnt(8)
    ds_read_b64_tr_b16 a[240:241], v21 offset:30720
    buffer_load_dwordx4 v5, s[16:19], s32 offen offset:0 lds
    v_rcp_f32 v30, v30
    v_mfma_f32_16x16x32_bf16 v[112:115], a[216:219], a[96:99], v[112:115]
    ds_read_b64_tr_b16 a[242:243], v21 offset:31744
    v_mul_f32 v170, v170, v30
    v_mfma_f32_16x16x32_bf16 v[120:123], a[216:219], a[100:103], v[120:123]
    ds_read_b64_tr_b16 a[244:245], v22 offset:30720
    v_mul_f32 v202, v202, v170
    v_mfma_f32_16x16x32_bf16 v[116:119], a[220:223], a[96:99], v[116:119]
    ds_read_b64_tr_b16 a[246:247], v22 offset:31744
    v_fma_f32 v31, v31, v27, v25
    v_mfma_f32_16x16x32_bf16 v[124:127], a[220:223], a[100:103], v[124:127]
    s_waitcnt lgkmcnt(8)
    ds_read_b64_tr_b16 a[248:249], v21 offset:32768
    v_mul_f32 v31, v31, v171
    v_mul_f32 v32, v172, v172
    v_mfma_f32_16x16x32_bf16 v[112:115], a[224:227], a[104:107], v[112:115]
    ds_read_b64_tr_b16 a[250:251], v21 offset:33792
    v_exp_f32 v31, v31
    v_mfma_f32_16x16x32_bf16 v[120:123], a[224:227], a[108:111], v[120:123]
    ds_read_b64_tr_b16 a[252:253], v22 offset:32768
    v_fma_f32 v31, v31, v252, v252
    v_mfma_f32_16x16x32_bf16 v[116:119], a[228:231], a[104:107], v[116:119]
    ds_read_b64_tr_b16 a[254:255], v22 offset:33792
    v_rcp_f32 v31, v31
    v_mfma_f32_16x16x32_bf16 v[124:127], a[228:231], a[108:111], v[124:127]
    s_waitcnt lgkmcnt(8)
    ds_read_b64_tr_b16 a[216:217], v21 offset:34816
    v_mul_f32 v171, v171, v31
    v_mfma_f32_16x16x32_bf16 v[112:115], a[232:235], a[112:115], v[112:115]
    ds_read_b64_tr_b16 a[218:219], v21 offset:35840
    v_mul_f32 v203, v203, v171
    v_mfma_f32_16x16x32_bf16 v[120:123], a[232:235], a[116:119], v[120:123]
    ds_read_b64_tr_b16 a[220:221], v22 offset:34816
    v_cvt_pk_bf16_f32 v101, v202, v203
    v_fma_f32 v32, v32, v27, v25
    v_mfma_f32_16x16x32_bf16 v[116:119], a[236:239], a[112:115], v[116:119]
    ds_read_b64_tr_b16 a[222:223], v22 offset:35840
    v_mul_f32 v32, v32, v172
    v_mfma_f32_16x16x32_bf16 v[124:127], a[236:239], a[116:119], v[124:127]
    s_waitcnt lgkmcnt(8)
    v_exp_f32 v32, v32
    v_mfma_f32_16x16x32_bf16 v[112:115], a[240:243], a[120:123], v[112:115]
    v_fma_f32 v32, v32, v252, v252
    v_mul_f32 v33, v173, v173
    v_mfma_f32_16x16x32_bf16 v[120:123], a[240:243], a[124:127], v[120:123]
    s_waitcnt lgkmcnt(0)
    s_barrier
    v_add_u32 v21, 36864, v21
    v_add_u32 v22, 36864, v22
    ds_read_b64_tr_b16 a[224:225], v21 offset:0
    ds_read_b64_tr_b16 a[226:227], v21 offset:1024
    v_mfma_f32_16x16x32_bf16 v[116:119], a[244:247], a[120:123], v[116:119]
    s_add_u32 m0, s34, 73728
    ds_read_b64_tr_b16 a[228:229], v22 offset:0
    ds_read_b64_tr_b16 a[230:231], v22 offset:1024
    v_rcp_f32 v32, v32
    v_mfma_f32_16x16x32_bf16 v[124:127], a[244:247], a[124:127], v[124:127]
    s_add_u32 s32, s42, 0
    ds_read_b64_tr_b16 a[232:233], v21 offset:2048
    buffer_load_dwordx4 v5, s[16:19], s32 offen offset:0 lds
    v_mul_f32 v172, v172, v32
    v_mfma_f32_16x16x32_bf16 v[112:115], a[248:251], a[128:131], v[112:115]
    ds_read_b64_tr_b16 a[234:235], v21 offset:3072
    v_mul_f32 v204, v204, v172
    v_fma_f32 v33, v33, v27, v25
    v_mfma_f32_16x16x32_bf16 v[120:123], a[248:251], a[132:135], v[120:123]
    ds_read_b64_tr_b16 a[236:237], v22 offset:2048
    v_mul_f32 v33, v33, v173
    v_mfma_f32_16x16x32_bf16 v[116:119], a[252:255], a[128:131], v[116:119]
    ds_read_b64_tr_b16 a[238:239], v22 offset:3072
    v_exp_f32 v33, v33
    v_mfma_f32_16x16x32_bf16 v[124:127], a[252:255], a[132:135], v[124:127]
    ds_read_b64_tr_b16 a[240:241], v21 offset:4096
    v_fma_f32 v33, v33, v252, v252
    v_mfma_f32_16x16x32_bf16 v[112:115], a[216:219], a[136:139], v[112:115]
    ds_read_b64_tr_b16 a[242:243], v21 offset:5120
    v_rcp_f32 v33, v33
    v_mfma_f32_16x16x32_bf16 v[120:123], a[216:219], a[140:143], v[120:123]
    ds_read_b64_tr_b16 a[244:245], v22 offset:4096
    v_mul_f32 v173, v173, v33
    v_mfma_f32_16x16x32_bf16 v[116:119], a[220:223], a[136:139], v[116:119]
    ds_read_b64_tr_b16 a[246:247], v22 offset:5120
    buffer_load_dwordx4 v6, s[16:19], s32 offen offset:1024 lds
    v_mul_f32 v205, v205, v173
    v_cvt_pk_bf16_f32 v102, v204, v205
    v_mfma_f32_16x16x32_bf16 v[124:127], a[220:223], a[140:143], v[124:127]
    s_waitcnt lgkmcnt(8)
    ds_read_b64_tr_b16 a[248:249], v21 offset:6144
    v_mul_f32 v34, v174, v174
    v_mfma_f32_16x16x32_bf16 v[128:131], a[224:227], a[0:3], 0
    ds_read_b64_tr_b16 a[250:251], v21 offset:7168
    v_fma_f32 v34, v34, v27, v25
    v_mul_f32 v34, v34, v174
    v_mfma_f32_16x16x32_bf16 v[136:139], a[224:227], a[4:7], 0
    ds_read_b64_tr_b16 a[252:253], v22 offset:6144
    v_exp_f32 v34, v34
    v_mfma_f32_16x16x32_bf16 v[132:135], a[228:231], a[0:3], 0
    ds_read_b64_tr_b16 a[254:255], v22 offset:7168
    v_fma_f32 v34, v34, v252, v252
    v_mfma_f32_16x16x32_bf16 v[140:143], a[228:231], a[4:7], 0
    s_waitcnt lgkmcnt(8)
    ds_read_b64_tr_b16 a[216:217], v21 offset:8192
    v_rcp_f32 v34, v34
    v_mfma_f32_16x16x32_bf16 v[128:131], a[232:235], a[8:11], v[128:131]
    ds_read_b64_tr_b16 a[218:219], v21 offset:9216
    v_mul_f32 v174, v174, v34
    v_mfma_f32_16x16x32_bf16 v[136:139], a[232:235], a[12:15], v[136:139]
    ds_read_b64_tr_b16 a[220:221], v22 offset:8192
    buffer_load_dwordx4 v7, s[16:19], s32 offen offset:2048 lds
    v_mul_f32 v206, v206, v174
    v_mfma_f32_16x16x32_bf16 v[132:135], a[236:239], a[8:11], v[132:135]
    ds_read_b64_tr_b16 a[222:223], v22 offset:9216
    v_mul_f32 v35, v175, v175
    v_mfma_f32_16x16x32_bf16 v[140:143], a[236:239], a[12:15], v[140:143]
    s_waitcnt lgkmcnt(8)
    ds_read_b64_tr_b16 a[224:225], v21 offset:10240
    v_fma_f32 v35, v35, v27, v25
    v_mul_f32 v35, v35, v175
    v_mfma_f32_16x16x32_bf16 v[128:131], a[240:243], a[16:19], v[128:131]
    ds_read_b64_tr_b16 a[226:227], v21 offset:11264
    v_exp_f32 v35, v35
    v_mfma_f32_16x16x32_bf16 v[136:139], a[240:243], a[20:23], v[136:139]
    ds_read_b64_tr_b16 a[228:229], v22 offset:10240
    v_fma_f32 v35, v35, v252, v252
    v_mfma_f32_16x16x32_bf16 v[132:135], a[244:247], a[16:19], v[132:135]
    ds_read_b64_tr_b16 a[230:231], v22 offset:11264
    v_rcp_f32 v35, v35
    v_mfma_f32_16x16x32_bf16 v[140:143], a[244:247], a[20:23], v[140:143]
    s_waitcnt lgkmcnt(8)
    ds_read_b64_tr_b16 a[232:233], v21 offset:12288
    v_mul_f32 v175, v175, v35
    v_mfma_f32_16x16x32_bf16 v[128:131], a[248:251], a[24:27], v[128:131]
    ds_read_b64_tr_b16 a[234:235], v21 offset:13312
    buffer_load_dwordx4 v8, s[16:19], s32 offen offset:3072 lds
    v_mul_f32 v207, v207, v175
    v_mfma_f32_16x16x32_bf16 v[136:139], a[248:251], a[28:31], v[136:139]
    s_add_u32 m0, s34, 77824
    ds_read_b64_tr_b16 a[236:237], v22 offset:12288
    v_cvt_pk_bf16_f32 v103, v206, v207
    v_mul_f32 v36, v112, v112
    v_mfma_f32_16x16x32_bf16 v[132:135], a[252:255], a[24:27], v[132:135]
    s_add_u32 s32, s42, 36864
    ds_read_b64_tr_b16 a[238:239], v22 offset:13312
    buffer_store_dwordx4 v[100:103], v23, s[20:23], s49 offen offset:3072 sc1
    v_fma_f32 v36, v36, v26, v24
    v_mfma_f32_16x16x32_bf16 v[140:143], a[252:255], a[28:31], v[140:143]
    s_waitcnt lgkmcnt(8)
    ds_read_b64_tr_b16 a[240:241], v21 offset:14336
    v_mul_f32 v36, v36, v112
    v_mul_f32 v37, v113, v113
    v_mfma_f32_16x16x32_bf16 v[128:131], a[216:219], a[32:35], v[128:131]
    s_add_u32 s49, s57, 16384
    ds_read_b64_tr_b16 a[242:243], v21 offset:15360
    v_exp_f32 v36, v36
    v_mfma_f32_16x16x32_bf16 v[136:139], a[216:219], a[36:39], v[136:139]
    ds_read_b64_tr_b16 a[244:245], v22 offset:14336
    v_fma_f32 v36, v36, v250, v250
    v_mfma_f32_16x16x32_bf16 v[132:135], a[220:223], a[32:35], v[132:135]
    ds_read_b64_tr_b16 a[246:247], v22 offset:15360
    v_rcp_f32 v36, v36
    v_mfma_f32_16x16x32_bf16 v[140:143], a[220:223], a[36:39], v[140:143]
    s_waitcnt lgkmcnt(8)
    ds_read_b64_tr_b16 a[248:249], v21 offset:16384
    buffer_load_dwordx4 v5, s[16:19], s32 offen offset:0 lds
    v_mfma_f32_16x16x32_bf16 v[128:131], a[224:227], a[40:43], v[128:131]
    ds_read_b64_tr_b16 a[250:251], v21 offset:17408
    v_mul_f32 v112, v112, v36
    v_fma_f32 v37, v37, v26, v24
    v_mfma_f32_16x16x32_bf16 v[136:139], a[224:227], a[44:47], v[136:139]
    ds_read_b64_tr_b16 a[252:253], v22 offset:16384
    v_mul_f32 v37, v37, v113
    v_mfma_f32_16x16x32_bf16 v[132:135], a[228:231], a[40:43], v[132:135]
    ds_read_b64_tr_b16 a[254:255], v22 offset:17408
    v_exp_f32 v37, v37
    v_mfma_f32_16x16x32_bf16 v[140:143], a[228:231], a[44:47], v[140:143]
    s_waitcnt lgkmcnt(8)
    ds_read_b64_tr_b16 a[216:217], v21 offset:18432
    v_fma_f32 v37, v37, v250, v250
    v_mfma_f32_16x16x32_bf16 v[128:131], a[232:235], a[48:51], v[128:131]
    ds_read_b64_tr_b16 a[218:219], v21 offset:19456
    v_rcp_f32 v37, v37
    v_mfma_f32_16x16x32_bf16 v[136:139], a[232:235], a[52:55], v[136:139]
    ds_read_b64_tr_b16 a[220:221], v22 offset:18432
    v_mul_f32 v113, v113, v37
    v_mfma_f32_16x16x32_bf16 v[132:135], a[236:239], a[48:51], v[132:135]
    ds_read_b64_tr_b16 a[222:223], v22 offset:19456
    buffer_load_dwordx4 v6, s[16:19], s32 offen offset:1024 lds
    v_mul_f32 v38, v114, v114
    v_fma_f32 v38, v38, v26, v24
    v_mfma_f32_16x16x32_bf16 v[140:143], a[236:239], a[52:55], v[140:143]
    s_waitcnt lgkmcnt(8)
    ds_read_b64_tr_b16 a[224:225], v21 offset:20480
    v_mul_f32 v38, v38, v114
    v_mfma_f32_16x16x32_bf16 v[128:131], a[240:243], a[56:59], v[128:131]
    ds_read_b64_tr_b16 a[226:227], v21 offset:21504
    v_exp_f32 v38, v38
    v_mfma_f32_16x16x32_bf16 v[136:139], a[240:243], a[60:63], v[136:139]
    ds_read_b64_tr_b16 a[228:229], v22 offset:20480
    v_fma_f32 v38, v38, v250, v250
    v_mfma_f32_16x16x32_bf16 v[132:135], a[244:247], a[56:59], v[132:135]
    ds_read_b64_tr_b16 a[230:231], v22 offset:21504
    v_rcp_f32 v38, v38
    v_mfma_f32_16x16x32_bf16 v[140:143], a[244:247], a[60:63], v[140:143]
    s_waitcnt lgkmcnt(8)
    ds_read_b64_tr_b16 a[232:233], v21 offset:22528
    v_mul_f32 v114, v114, v38
    v_mfma_f32_16x16x32_bf16 v[128:131], a[248:251], a[64:67], v[128:131]
    ds_read_b64_tr_b16 a[234:235], v21 offset:23552
    v_mul_f32 v39, v115, v115
    v_fma_f32 v39, v39, v26, v24
    v_mfma_f32_16x16x32_bf16 v[136:139], a[248:251], a[68:71], v[136:139]
    ds_read_b64_tr_b16 a[236:237], v22 offset:22528
    buffer_load_dwordx4 v7, s[16:19], s32 offen offset:2048 lds
    v_mul_f32 v39, v39, v115
    v_mfma_f32_16x16x32_bf16 v[132:135], a[252:255], a[64:67], v[132:135]
    ds_read_b64_tr_b16 a[238:239], v22 offset:23552
    v_exp_f32 v39, v39
    v_mfma_f32_16x16x32_bf16 v[140:143], a[252:255], a[68:71], v[140:143]
    s_waitcnt lgkmcnt(8)
    ds_read_b64_tr_b16 a[240:241], v21 offset:24576
    v_fma_f32 v39, v39, v250, v250
    v_mfma_f32_16x16x32_bf16 v[128:131], a[216:219], a[72:75], v[128:131]
    ds_read_b64_tr_b16 a[242:243], v21 offset:25600
    v_rcp_f32 v39, v39
    v_mfma_f32_16x16x32_bf16 v[136:139], a[216:219], a[76:79], v[136:139]
    ds_read_b64_tr_b16 a[244:245], v22 offset:24576
    v_mul_f32 v115, v115, v39
    v_mfma_f32_16x16x32_bf16 v[132:135], a[220:223], a[72:75], v[132:135]
    ds_read_b64_tr_b16 a[246:247], v22 offset:25600
    v_mul_f32 v28, v116, v116
    v_mfma_f32_16x16x32_bf16 v[140:143], a[220:223], a[76:79], v[140:143]
    s_waitcnt lgkmcnt(8)
    ds_read_b64_tr_b16 a[248:249], v21 offset:26624
    v_fma_f32 v28, v28, v26, v24
    v_mul_f32 v28, v28, v116
    v_mfma_f32_16x16x32_bf16 v[128:131], a[224:227], a[80:83], v[128:131]
    ds_read_b64_tr_b16 a[250:251], v21 offset:27648
    buffer_load_dwordx4 v8, s[16:19], s32 offen offset:3072 lds
    v_exp_f32 v28, v28
    v_mfma_f32_16x16x32_bf16 v[136:139], a[224:227], a[84:87], v[136:139]
    s_add_u32 m0, s35, 106496
    ds_read_b64_tr_b16 a[252:253], v22 offset:26624
    v_fma_f32 v28, v28, v250, v250
    v_mfma_f32_16x16x32_bf16 v[132:135], a[228:231], a[80:83], v[132:135]
    s_add_u32 s32, s43, 0
    ds_read_b64_tr_b16 a[254:255], v22 offset:27648
    v_rcp_f32 v28, v28
    v_mfma_f32_16x16x32_bf16 v[140:143], a[228:231], a[84:87], v[140:143]
    s_waitcnt lgkmcnt(8)
    ds_read_b64_tr_b16 a[216:217], v21 offset:28672
    v_mul_f32 v116, v116, v28
    v_mfma_f32_16x16x32_bf16 v[128:131], a[232:235], a[88:91], v[128:131]
    ds_read_b64_tr_b16 a[218:219], v21 offset:29696
    v_mul_f32 v29, v117, v117
    v_mfma_f32_16x16x32_bf16 v[136:139], a[232:235], a[92:95], v[136:139]
    ds_read_b64_tr_b16 a[220:221], v22 offset:28672
    v_fma_f32 v29, v29, v26, v24
    v_mul_f32 v29, v29, v117
    v_mfma_f32_16x16x32_bf16 v[132:135], a[236:239], a[88:91], v[132:135]
    ds_read_b64_tr_b16 a[222:223], v22 offset:29696
    v_exp_f32 v29, v29
    v_mfma_f32_16x16x32_bf16 v[140:143], a[236:239], a[92:95], v[140:143]
    s_waitcnt lgkmcnt(8)
    ds_read_b64_tr_b16 a[224:225], v21 offset:30720
    buffer_load_dwordx4 v5, s[16:19], s32 offen offset:0 lds
    v_mfma_f32_16x16x32_bf16 v[128:131], a[240:243], a[96:99], v[128:131]
    ds_read_b64_tr_b16 a[226:227], v21 offset:31744
    v_fma_f32 v29, v29, v250, v250
    v_mul_f32 v30, v118, v118
    v_mfma_f32_16x16x32_bf16 v[136:139], a[240:243], a[100:103], v[136:139]
    ds_read_b64_tr_b16 a[228:229], v22 offset:30720
    v_rcp_f32 v29, v29
    v_mfma_f32_16x16x32_bf16 v[132:135], a[244:247], a[96:99], v[132:135]
    ds_read_b64_tr_b16 a[230:231], v22 offset:31744
    v_mul_f32 v117, v117, v29
    v_mfma_f32_16x16x32_bf16 v[140:143], a[244:247], a[100:103], v[140:143]
    s_waitcnt lgkmcnt(8)
    ds_read_b64_tr_b16 a[232:233], v21 offset:32768
    v_fma_f32 v30, v30, v26, v24
    v_mfma_f32_16x16x32_bf16 v[128:131], a[248:251], a[104:107], v[128:131]
    ds_read_b64_tr_b16 a[234:235], v21 offset:33792
    v_mul_f32 v30, v30, v118
    v_mul_f32 v31, v119, v119
    v_mfma_f32_16x16x32_bf16 v[136:139], a[248:251], a[108:111], v[136:139]
    ds_read_b64_tr_b16 a[236:237], v22 offset:32768
    v_exp_f32 v30, v30
    v_mfma_f32_16x16x32_bf16 v[132:135], a[252:255], a[104:107], v[132:135]
    ds_read_b64_tr_b16 a[238:239], v22 offset:33792
    v_fma_f32 v30, v30, v250, v250
    v_mfma_f32_16x16x32_bf16 v[140:143], a[252:255], a[108:111], v[140:143]
    s_waitcnt lgkmcnt(8)
    ds_read_b64_tr_b16 a[240:241], v21 offset:34816
    v_rcp_f32 v30, v30
    v_mfma_f32_16x16x32_bf16 v[128:131], a[216:219], a[112:115], v[128:131]
    ds_read_b64_tr_b16 a[242:243], v21 offset:35840
    v_mul_f32 v118, v118, v30
    v_mfma_f32_16x16x32_bf16 v[136:139], a[216:219], a[116:119], v[136:139]
    ds_read_b64_tr_b16 a[244:245], v22 offset:34816
    v_fma_f32 v31, v31, v26, v24
    v_mfma_f32_16x16x32_bf16 v[132:135], a[220:223], a[112:115], v[132:135]
    ds_read_b64_tr_b16 a[246:247], v22 offset:35840
    v_mul_f32 v31, v31, v119
    v_mul_f32 v32, v120, v120
    v_mfma_f32_16x16x32_bf16 v[140:143], a[220:223], a[116:119], v[140:143]
    s_waitcnt lgkmcnt(8)
    v_exp_f32 v31, v31
    v_mfma_f32_16x16x32_bf16 v[128:131], a[224:227], a[120:123], v[128:131]
    v_fma_f32 v31, v31, v250, v250
    v_fma_f32 v32, v32, v27, v25
    v_mfma_f32_16x16x32_bf16 v[136:139], a[224:227], a[124:127], v[136:139]
    s_waitcnt vmcnt(26) lgkmcnt(0)
    s_barrier
    ds_read_b64_tr_b16 a[248:249], v9 offset:0
    ds_read_b64_tr_b16 a[250:251], v9 offset:2048
    v_mfma_f32_16x16x32_bf16 v[132:135], a[228:231], a[120:123], v[132:135]
    s_add_u32 m0, s34, 110592
    ds_read_b64_tr_b16 a[252:253], v10 offset:0
    ds_read_b64_tr_b16 a[254:255], v10 offset:2048
    v_rcp_f32 v31, v31
    v_mfma_f32_16x16x32_bf16 v[140:143], a[228:231], a[124:127], v[140:143]
    s_add_u32 s32, s42, 128
    ds_read_b64_tr_b16 a[216:217], v11 offset:0
    buffer_load_dwordx4 v5, s[16:19], s32 offen offset:0 lds
    v_mul_f32 v119, v119, v31
    v_mfma_f32_16x16x32_bf16 v[128:131], a[232:235], a[128:131], v[128:131]
    s_waitcnt vmcnt(6)
    ds_read_b64_tr_b16 a[218:219], v11 offset:2048
    buffer_store_dword v248, v245, s[20:23], s53 offen offset:384 sc1
    v_mul_f32 v32, v32, v120
    v_mfma_f32_16x16x32_bf16 v[136:139], a[232:235], a[132:135], v[136:139]
    ds_read_b64_tr_b16 a[220:221], v12 offset:0
    v_exp_f32 v32, v32
    v_mfma_f32_16x16x32_bf16 v[132:135], a[236:239], a[128:131], v[132:135]
    ds_read_b64_tr_b16 a[222:223], v12 offset:2048
    v_fma_f32 v32, v32, v252, v252
    v_mfma_f32_16x16x32_bf16 v[140:143], a[236:239], a[132:135], v[140:143]
    ds_read_b64_tr_b16 a[224:225], v9 offset:4096
    v_rcp_f32 v32, v32
    v_mfma_f32_16x16x32_bf16 v[128:131], a[240:243], a[136:139], v[128:131]
    ds_read_b64_tr_b16 a[226:227], v9 offset:6144
    v_mul_f32 v120, v120, v32
    v_mfma_f32_16x16x32_bf16 v[136:139], a[240:243], a[140:143], v[136:139]
    ds_read_b64_tr_b16 a[228:229], v10 offset:4096
    v_mul_f32 v33, v121, v121
    v_fma_f32 v33, v33, v27, v25
    v_mfma_f32_16x16x32_bf16 v[132:135], a[244:247], a[136:139], v[132:135]
    ds_read_b64_tr_b16 a[230:231], v10 offset:6144
    buffer_load_dwordx4 v6, s[16:19], s32 offen offset:1024 lds
    v_mul_f32 v33, v33, v121
    v_mfma_f32_16x16x32_bf16 v[140:143], a[244:247], a[140:143], v[140:143]
    s_waitcnt lgkmcnt(8)
    ds_read_b64_tr_b16 a[232:233], v11 offset:4096
    v_exp_f32 v33, v33
    v_mfma_f32_16x16x32_bf16 v[208:211], a[248:251], v[40:43], 0
    ds_read_b64_tr_b16 a[234:235], v11 offset:6144
    v_fma_f32 v33, v33, v252, v252
    v_mfma_f32_16x16x32_bf16 v[216:219], a[248:251], v[44:47], 0
    ds_read_b64_tr_b16 a[236:237], v12 offset:4096
    v_rcp_f32 v33, v33
    v_mfma_f32_16x16x32_bf16 v[212:215], a[252:255], v[40:43], 0
    ds_read_b64_tr_b16 a[238:239], v12 offset:6144
    v_mul_f32 v121, v121, v33
    v_mfma_f32_16x16x32_bf16 v[220:223], a[252:255], v[44:47], 0
    s_waitcnt lgkmcnt(8)
    ds_read_b64_tr_b16 a[240:241], v9 offset:8192
    v_mul_f32 v34, v122, v122
    v_fma_f32 v34, v34, v27, v25
    v_mfma_f32_16x16x32_bf16 v[224:227], a[216:219], v[40:43], 0
    ds_read_b64_tr_b16 a[242:243], v9 offset:10240
    buffer_load_dword v255, v246, s[20:23], s55 offen offset:512 sc1
    v_mul_f32 v128, v128, v112
    v_mfma_f32_16x16x32_bf16 v[232:235], a[216:219], v[44:47], 0
    ds_read_b64_tr_b16 a[244:245], v10 offset:8192
    buffer_load_dwordx4 v7, s[16:19], s32 offen offset:2048 lds
    v_mul_f32 v129, v129, v113
    v_cvt_pk_bf16_f32 v104, v128, v129
    v_mfma_f32_16x16x32_bf16 v[228:231], a[220:223], v[40:43], 0
    ds_read_b64_tr_b16 a[246:247], v10 offset:10240
    v_mul_f32 v130, v130, v114
    v_mfma_f32_16x16x32_bf16 v[236:239], a[220:223], v[44:47], 0
    s_waitcnt lgkmcnt(8)
    ds_read_b64_tr_b16 a[248:249], v11 offset:8192
    v_mul_f32 v131, v131, v115
    v_mfma_f32_16x16x32_bf16 v[208:211], a[224:227], v[48:51], v[208:211]
    ds_read_b64_tr_b16 a[250:251], v11 offset:10240
    v_cvt_pk_bf16_f32 v105, v130, v131
    v_mul_f32 v132, v132, v116
    v_mfma_f32_16x16x32_bf16 v[216:219], a[224:227], v[52:55], v[216:219]
    ds_read_b64_tr_b16 a[252:253], v12 offset:8192
    v_mul_f32 v133, v133, v117
    v_mfma_f32_16x16x32_bf16 v[212:215], a[228:231], v[48:51], v[212:215]
    ds_read_b64_tr_b16 a[254:255], v12 offset:10240
    v_cvt_pk_bf16_f32 v106, v132, v133
    v_mul_f32 v134, v134, v118
    v_mfma_f32_16x16x32_bf16 v[220:223], a[228:231], v[52:55], v[220:223]
    s_waitcnt lgkmcnt(8)
    ds_read_b64_tr_b16 a[216:217], v9 offset:12288
    v_mul_f32 v135, v135, v119
    v_mfma_f32_16x16x32_bf16 v[224:227], a[232:235], v[48:51], v[224:227]
    ds_read_b64_tr_b16 a[218:219], v9 offset:14336
    buffer_load_dwordx4 v8, s[16:19], s32 offen offset:3072 lds
    v_cvt_pk_bf16_f32 v107, v134, v135
    v_mul_f32 v136, v136, v120
    v_mfma_f32_16x16x32_bf16 v[232:235], a[232:235], v[52:55], v[232:235]
    s_add_u32 m0, s34, 114688
    ds_read_b64_tr_b16 a[220:221], v10 offset:12288
    buffer_store_dwordx4 v[104:107], v23, s[20:23], s49 offen offset:0 sc1
    v_mul_f32 v137, v137, v121
    v_mfma_f32_16x16x32_bf16 v[228:231], a[236:239], v[48:51], v[228:231]
    s_add_u32 s32, s42, 36992
    ds_read_b64_tr_b16 a[222:223], v10 offset:14336
    v_cvt_pk_bf16_f32 v108, v136, v137
    v_mul_f32 v34, v34, v122
    v_mfma_f32_16x16x32_bf16 v[236:239], a[236:239], v[52:55], v[236:239]
    s_waitcnt lgkmcnt(8)
    ds_read_b64_tr_b16 a[224:225], v11 offset:12288
    v_exp_f32 v34, v34
    v_mfma_f32_16x16x32_bf16 v[208:211], a[240:243], v[56:59], v[208:211]
    ds_read_b64_tr_b16 a[226:227], v11 offset:14336
    v_fma_f32 v34, v34, v252, v252
    v_mfma_f32_16x16x32_bf16 v[216:219], a[240:243], v[60:63], v[216:219]
    ds_read_b64_tr_b16 a[228:229], v12 offset:12288
    v_rcp_f32 v34, v34
    v_mfma_f32_16x16x32_bf16 v[212:215], a[244:247], v[56:59], v[212:215]
    ds_read_b64_tr_b16 a[230:231], v12 offset:14336
    v_mul_f32 v122, v122, v34
    v_mfma_f32_16x16x32_bf16 v[220:223], a[244:247], v[60:63], v[220:223]
    s_waitcnt lgkmcnt(8)
    ds_read_b64_tr_b16 a[232:233], v9 offset:16384
    buffer_load_dwordx4 v5, s[16:19], s32 offen offset:0 lds
    v_mul_f32 v138, v138, v122
    v_mfma_f32_16x16x32_bf16 v[224:227], a[248:251], v[56:59], v[224:227]
    ds_read_b64_tr_b16 a[234:235], v9 offset:18432
    v_mul_f32 v35, v123, v123
    v_mfma_f32_16x16x32_bf16 v[232:235], a[248:251], v[60:63], v[232:235]
    ds_read_b64_tr_b16 a[236:237], v10 offset:16384
    v_fma_f32 v35, v35, v27, v25
    v_mul_f32 v35, v35, v123
    v_mfma_f32_16x16x32_bf16 v[228:231], a[252:255], v[56:59], v[228:231]
    ds_read_b64_tr_b16 a[238:239], v10 offset:18432
    buffer_load_dword v254, off, s[20:23], s54 offset:384 sc1
    v_exp_f32 v35, v35
    v_mfma_f32_16x16x32_bf16 v[236:239], a[252:255], v[60:63], v[236:239]
    s_waitcnt lgkmcnt(8)
    ds_read_b64_tr_b16 a[240:241], v11 offset:16384
    v_fma_f32 v35, v35, v252, v252
    v_mfma_f32_16x16x32_bf16 v[208:211], a[216:219], v[64:67], v[208:211]
    ds_read_b64_tr_b16 a[242:243], v11 offset:18432
    v_rcp_f32 v35, v35
    v_mfma_f32_16x16x32_bf16 v[216:219], a[216:219], v[68:71], v[216:219]
    ds_read_b64_tr_b16 a[244:245], v12 offset:16384
    v_mul_f32 v123, v123, v35
    v_mfma_f32_16x16x32_bf16 v[212:215], a[220:223], v[64:67], v[212:215]
    ds_read_b64_tr_b16 a[246:247], v12 offset:18432
    buffer_load_dwordx4 v6, s[16:19], s32 offen offset:1024 lds
    v_mul_f32 v139, v139, v123
    v_mfma_f32_16x16x32_bf16 v[220:223], a[220:223], v[68:71], v[220:223]
    s_waitcnt lgkmcnt(8)
    ds_read_b64_tr_b16 a[248:249], v9 offset:20480
    v_cvt_pk_bf16_f32 v109, v138, v139
    v_mul_f32 v36, v124, v124
    v_mfma_f32_16x16x32_bf16 v[224:227], a[224:227], v[64:67], v[224:227]
    ds_read_b64_tr_b16 a[250:251], v9 offset:22528
    v_fma_f32 v36, v36, v27, v25
    v_mfma_f32_16x16x32_bf16 v[232:235], a[224:227], v[68:71], v[232:235]
    ds_read_b64_tr_b16 a[252:253], v10 offset:20480
    v_mul_f32 v36, v36, v124
    v_mul_f32 v37, v125, v125
    v_mfma_f32_16x16x32_bf16 v[228:231], a[228:231], v[64:67], v[228:231]
    ds_read_b64_tr_b16 a[254:255], v10 offset:22528
    v_exp_f32 v36, v36
    v_mfma_f32_16x16x32_bf16 v[236:239], a[228:231], v[68:71], v[236:239]
    s_waitcnt lgkmcnt(8)
    ds_read_b64_tr_b16 a[216:217], v11 offset:20480
    v_fma_f32 v36, v36, v252, v252
    v_mfma_f32_16x16x32_bf16 v[208:211], a[232:235], v[72:75], v[208:211]
    ds_read_b64_tr_b16 a[218:219], v11 offset:22528
    v_rcp_f32 v36, v36
    v_mfma_f32_16x16x32_bf16 v[216:219], a[232:235], v[76:79], v[216:219]
    ds_read_b64_tr_b16 a[220:221], v12 offset:20480
    buffer_load_dwordx4 v7, s[16:19], s32 offen offset:2048 lds
    v_mul_f32 v124, v124, v36
    v_mfma_f32_16x16x32_bf16 v[212:215], a[236:239], v[72:75], v[212:215]
    ds_read_b64_tr_b16 a[222:223], v12 offset:22528
    v_mul_f32 v140, v140, v124
    v_mfma_f32_16x16x32_bf16 v[220:223], a[236:239], v[76:79], v[220:223]
    s_waitcnt lgkmcnt(8)
    ds_read_b64_tr_b16 a[224:225], v9 offset:24576
    v_fma_f32 v37, v37, v27, v25
    v_mfma_f32_16x16x32_bf16 v[224:227], a[240:243], v[72:75], v[224:227]
    ds_read_b64_tr_b16 a[226:227], v9 offset:26624
    v_mul_f32 v37, v37, v125
    v_mul_f32 v38, v126, v126
    v_mfma_f32_16x16x32_bf16 v[232:235], a[240:243], v[76:79], v[232:235]
    ds_read_b64_tr_b16 a[228:229], v10 offset:24576
    v_exp_f32 v37, v37
    v_mfma_f32_16x16x32_bf16 v[228:231], a[244:247], v[72:75], v[228:231]
    ds_read_b64_tr_b16 a[230:231], v10 offset:26624
    v_fma_f32 v37, v37, v252, v252
    v_mfma_f32_16x16x32_bf16 v[236:239], a[244:247], v[76:79], v[236:239]
    s_waitcnt lgkmcnt(8)
    ds_read_b64_tr_b16 a[232:233], v11 offset:24576
    v_rcp_f32 v37, v37
    v_mfma_f32_16x16x32_bf16 v[208:211], a[248:251], v[80:83], v[208:211]
    ds_read_b64_tr_b16 a[234:235], v11 offset:26624
    buffer_load_dwordx4 v8, s[16:19], s32 offen offset:3072 lds
    v_mul_f32 v125, v125, v37
    v_mfma_f32_16x16x32_bf16 v[216:219], a[248:251], v[84:87], v[216:219]
    s_add_u32 m0, s35, 143360
    ds_read_b64_tr_b16 a[236:237], v12 offset:24576
    v_mul_f32 v141, v141, v125
    v_mfma_f32_16x16x32_bf16 v[212:215], a[252:255], v[80:83], v[212:215]
    s_add_u32 s32, s43, 128
    ds_read_b64_tr_b16 a[238:239], v12 offset:26624
    v_cvt_pk_bf16_f32 v110, v140, v141
    v_fma_f32 v38, v38, v27, v25
    v_mfma_f32_16x16x32_bf16 v[220:223], a[252:255], v[84:87], v[220:223]
    s_waitcnt lgkmcnt(8)
    ds_read_b64_tr_b16 a[240:241], v9 offset:28672
    v_mul_f32 v38, v38, v126
    v_mfma_f32_16x16x32_bf16 v[224:227], a[216:219], v[80:83], v[224:227]
    ds_read_b64_tr_b16 a[242:243], v9 offset:30720
    v_exp_f32 v38, v38
    v_mfma_f32_16x16x32_bf16 v[232:235], a[216:219], v[84:87], v[232:235]
    ds_read_b64_tr_b16 a[244:245], v10 offset:28672
    v_fma_f32 v38, v38, v252, v252
    v_mfma_f32_16x16x32_bf16 v[228:231], a[220:223], v[80:83], v[228:231]
    ds_read_b64_tr_b16 a[246:247], v10 offset:30720
    v_rcp_f32 v38, v38
    v_mfma_f32_16x16x32_bf16 v[236:239], a[220:223], v[84:87], v[236:239]
    s_waitcnt lgkmcnt(8)
    ds_read_b64_tr_b16 a[248:249], v11 offset:28672
    buffer_load_dwordx4 v5, s[16:19], s32 offen offset:0 lds
    v_mul_f32 v126, v126, v38
    v_mfma_f32_16x16x32_bf16 v[208:211], a[224:227], v[88:91], v[208:211]
    ds_read_b64_tr_b16 a[250:251], v11 offset:30720
    v_mul_f32 v142, v142, v126
    v_mul_f32 v39, v127, v127
    v_mfma_f32_16x16x32_bf16 v[216:219], a[224:227], v[92:95], v[216:219]
    ds_read_b64_tr_b16 a[252:253], v12 offset:28672
    v_fma_f32 v39, v39, v27, v25
    v_mfma_f32_16x16x32_bf16 v[212:215], a[228:231], v[88:91], v[212:215]
    ds_read_b64_tr_b16 a[254:255], v12 offset:30720
    v_mul_f32 v39, v39, v127
    v_mfma_f32_16x16x32_bf16 v[220:223], a[228:231], v[92:95], v[220:223]
    s_waitcnt lgkmcnt(8)
    ds_read_b64_tr_b16 a[216:217], v9 offset:32768
    v_exp_f32 v39, v39
    v_mfma_f32_16x16x32_bf16 v[224:227], a[232:235], v[88:91], v[224:227]
    ds_read_b64_tr_b16 a[218:219], v9 offset:34816
    v_fma_f32 v39, v39, v252, v252
    v_mfma_f32_16x16x32_bf16 v[232:235], a[232:235], v[92:95], v[232:235]
    ds_read_b64_tr_b16 a[220:221], v10 offset:32768
    v_rcp_f32 v39, v39
    v_mfma_f32_16x16x32_bf16 v[228:231], a[236:239], v[88:91], v[228:231]
    ds_read_b64_tr_b16 a[222:223], v10 offset:34816
    v_mul_f32 v127, v127, v39
    v_mul_f32 v143, v143, v127
    v_mfma_f32_16x16x32_bf16 v[236:239], a[236:239], v[92:95], v[236:239]
    s_waitcnt lgkmcnt(8)
    ds_read_b64_tr_b16 a[224:225], v11 offset:32768
    v_cvt_pk_bf16_f32 v111, v142, v143
    v_mfma_f32_16x16x32_bf16 v[208:211], a[240:243], v[96:99], v[208:211]
    s_lshl_b32 s51, s75, 5
    ds_read_b64_tr_b16 a[226:227], v11 offset:34816
    buffer_store_dwordx4 v[108:111], v23, s[20:23], s49 offen offset:1024 sc1
    v_mfma_f32_16x16x32_bf16 v[216:219], a[240:243], v[100:103], v[216:219]
    s_add_u32 s51, s51, s61
    ds_read_b64_tr_b16 a[228:229], v12 offset:32768
    buffer_load_dwordx2 v[28:29], v249, s[20:23], s51 offen sc1
    v_mfma_f32_16x16x32_bf16 v[212:215], a[244:247], v[96:99], v[212:215]
    s_waitcnt vmcnt(6)
    ds_read_b64_tr_b16 a[230:231], v12 offset:34816
    v_cmp_eq_u32 vcc, 0, v254
    v_mfma_f32_16x16x32_bf16 v[220:223], a[244:247], v[100:103], v[220:223]
    s_waitcnt lgkmcnt(8)
    v_lshrrev_b32 v25, 2, v23
    v_and_b32 v25, 12, v25
    v_mfma_f32_16x16x32_bf16 v[224:227], a[248:251], v[96:99], v[224:227]
    s_cbranch_vccnz L_ffn_kernel_spinh3
L_ffn_kernel_reth3:
    v_mfma_f32_16x16x32_bf16 v[232:235], a[248:251], v[100:103], v[232:235]
    s_waitcnt lgkmcnt(0)
    s_barrier
    ds_read_b64_tr_b16 a[232:233], v9 offset:36864
    ds_read_b64_tr_b16 a[234:235], v9 offset:38912
    v_mfma_f32_16x16x32_bf16 v[228:231], a[252:255], v[96:99], v[228:231]
    s_add_u32 m0, s34, 0
    ds_read_b64_tr_b16 a[236:237], v10 offset:36864
    ds_read_b64_tr_b16 a[238:239], v10 offset:38912
    v_mfma_f32_16x16x32_bf16 v[236:239], a[252:255], v[100:103], v[236:239]
    s_add_u32 s32, s40, 256
    ds_read_b64_tr_b16 a[240:241], v11 offset:36864
    buffer_load_dwordx4 v5, s[16:19], s32 offen offset:0 lds
    v_mfma_f32_16x16x32_bf16 v[208:211], a[216:219], v[104:107], v[208:211]
    s_add_u32 s52, s60, 12288
    ds_read_b64_tr_b16 a[242:243], v11 offset:38912
    v_mfma_f32_16x16x32_bf16 v[216:219], a[216:219], v[108:111], v[216:219]
    s_lshl_b32 s51, s75, 5
    ds_read_b64_tr_b16 a[244:245], v12 offset:36864
    buffer_load_dwordx4 a[192:195], v23, s[20:23], s52 offen offset:0 sc1
    v_mfma_f32_16x16x32_bf16 v[212:215], a[220:223], v[104:107], v[212:215]
    s_add_u32 s51, s51, s61
    ds_read_b64_tr_b16 a[246:247], v12 offset:38912
    buffer_load_dwordx4 a[196:199], v23, s[20:23], s52 offen offset:1024 sc1
    v_mfma_f32_16x16x32_bf16 v[220:223], a[220:223], v[108:111], v[220:223]
    s_add_u32 s51, s51, 4096
    ds_read_b64_tr_b16 a[248:249], v9 offset:40960
    buffer_load_dwordx4 a[200:203], v23, s[20:23], s52 offen offset:2048 sc1
    v_mfma_f32_16x16x32_bf16 v[224:227], a[224:227], v[104:107], v[224:227]
    ds_read_b64_tr_b16 a[250:251], v9 offset:43008
    buffer_load_dwordx4 a[204:207], v23, s[20:23], s52 offen offset:3072 sc1
    v_mfma_f32_16x16x32_bf16 v[232:235], a[224:227], v[108:111], v[232:235]
    ds_read_b64_tr_b16 a[252:253], v10 offset:40960
    buffer_load_dwordx2 v[30:31], v249, s[20:23], s51 offen sc1
    v_mfma_f32_16x16x32_bf16 v[228:231], a[228:231], v[104:107], v[228:231]
    s_lshl_b32 s51, s75, 5
    ds_read_b64_tr_b16 a[254:255], v10 offset:43008
    buffer_load_dwordx4 v6, s[16:19], s32 offen offset:1024 lds
    v_mfma_f32_16x16x32_bf16 v[236:239], a[228:231], v[108:111], v[236:239]
    s_waitcnt lgkmcnt(8)
    ds_read_b64_tr_b16 a[216:217], v11 offset:40960
    v_mfma_f32_16x16x32_bf16 v[144:147], a[232:235], v[40:43], 0
    s_add_u32 s51, s51, s61
    ds_read_b64_tr_b16 a[218:219], v11 offset:43008
    v_mfma_f32_16x16x32_bf16 v[152:155], a[232:235], v[44:47], 0
    s_add_u32 s51, s51, 8192
    ds_read_b64_tr_b16 a[220:221], v12 offset:40960
    buffer_load_dwordx2 v[32:33], v249, s[20:23], s51 offen sc1
    v_mfma_f32_16x16x32_bf16 v[148:151], a[236:239], v[40:43], 0
    s_lshl_b32 s51, s75, 5
    ds_read_b64_tr_b16 a[222:223], v12 offset:43008
    v_mfma_f32_16x16x32_bf16 v[156:159], a[236:239], v[44:47], 0
    s_waitcnt lgkmcnt(8)
    ds_read_b64_tr_b16 a[224:225], v9 offset:45056
    v_mfma_f32_16x16x32_bf16 v[160:163], a[240:243], v[40:43], 0
    s_add_u32 s51, s51, s61
    ds_read_b64_tr_b16 a[226:227], v9 offset:47104
    v_mfma_f32_16x16x32_bf16 v[168:171], a[240:243], v[44:47], 0
    s_add_u32 s51, s51, 12288
    ds_read_b64_tr_b16 a[228:229], v10 offset:45056
    buffer_load_dwordx4 v7, s[16:19], s32 offen offset:2048 lds
    v_mfma_f32_16x16x32_bf16 v[164:167], a[244:247], v[40:43], 0
    ds_read_b64_tr_b16 a[230:231], v10 offset:47104
    buffer_load_dwordx2 v[34:35], v249, s[20:23], s51 offen sc1
    v_mfma_f32_16x16x32_bf16 v[172:175], a[244:247], v[44:47], 0
    s_waitcnt lgkmcnt(8)
    ds_read_b64_tr_b16 a[232:233], v11 offset:45056
    v_mfma_f32_16x16x32_bf16 v[144:147], a[248:251], v[48:51], v[144:147]
    s_lshl_b32 s51, s76, 5
    ds_read_b64_tr_b16 a[234:235], v11 offset:47104
    v_mfma_f32_16x16x32_bf16 v[152:155], a[248:251], v[52:55], v[152:155]
    s_add_u32 s51, s51, s61
    ds_read_b64_tr_b16 a[236:237], v12 offset:45056
    buffer_load_dwordx2 v[36:37], v249, s[20:23], s51 offen sc1
    v_mfma_f32_16x16x32_bf16 v[148:151], a[252:255], v[48:51], v[148:151]
    ds_read_b64_tr_b16 a[238:239], v12 offset:47104
    buffer_load_dword v24, v25, s[20:23], s63 offen sc1
    v_mfma_f32_16x16x32_bf16 v[156:159], a[252:255], v[52:55], v[156:159]
    s_waitcnt lgkmcnt(8)
    ds_read_b64_tr_b16 a[240:241], v13 offset:0
    v_mfma_f32_16x16x32_bf16 v[160:163], a[216:219], v[48:51], v[160:163]
    ds_read_b64_tr_b16 a[242:243], v13 offset:2048
    buffer_load_dwordx4 v8, s[16:19], s32 offen offset:3072 lds
    v_mfma_f32_16x16x32_bf16 v[168:171], a[216:219], v[52:55], v[168:171]
    s_add_u32 m0, s34, 4096
    ds_read_b64_tr_b16 a[244:245], v14 offset:0
    v_mfma_f32_16x16x32_bf16 v[164:167], a[220:223], v[48:51], v[164:167]
    s_add_u32 s32, s40, 37120
    ds_read_b64_tr_b16 a[246:247], v14 offset:2048
    v_mfma_f32_16x16x32_bf16 v[172:175], a[220:223], v[52:55], v[172:175]
    s_waitcnt lgkmcnt(8)
    ds_read_b64_tr_b16 a[248:249], v15 offset:0
    v_mfma_f32_16x16x32_bf16 v[144:147], a[224:227], v[56:59], v[144:147]
    ds_read_b64_tr_b16 a[250:251], v15 offset:2048
    v_mfma_f32_16x16x32_bf16 v[152:155], a[224:227], v[60:63], v[152:155]
    ds_read_b64_tr_b16 a[252:253], v16 offset:0
    v_mfma_f32_16x16x32_bf16 v[148:151], a[228:231], v[56:59], v[148:151]
    ds_read_b64_tr_b16 a[254:255], v16 offset:2048
    v_mfma_f32_16x16x32_bf16 v[156:159], a[228:231], v[60:63], v[156:159]
    s_waitcnt lgkmcnt(8)
    ds_read_b64_tr_b16 a[216:217], v13 offset:4096
    buffer_load_dwordx4 v5, s[16:19], s32 offen offset:0 lds
    v_mfma_f32_16x16x32_bf16 v[160:163], a[232:235], v[56:59], v[160:163]
    ds_read_b64_tr_b16 a[218:219], v13 offset:6144
    v_mfma_f32_16x16x32_bf16 v[168:171], a[232:235], v[60:63], v[168:171]
    ds_read_b64_tr_b16 a[220:221], v14 offset:4096
    v_mfma_f32_16x16x32_bf16 v[164:167], a[236:239], v[56:59], v[164:167]
    ds_read_b64_tr_b16 a[222:223], v14 offset:6144
    v_mfma_f32_16x16x32_bf16 v[172:175], a[236:239], v[60:63], v[172:175]
    s_waitcnt lgkmcnt(8)
    ds_read_b64_tr_b16 a[224:225], v15 offset:4096
    v_mfma_f32_16x16x32_bf16 v[144:147], a[240:243], v[64:67], v[144:147]
    ds_read_b64_tr_b16 a[226:227], v15 offset:6144
    v_mfma_f32_16x16x32_bf16 v[152:155], a[240:243], v[68:71], v[152:155]
    ds_read_b64_tr_b16 a[228:229], v16 offset:4096
    v_mfma_f32_16x16x32_bf16 v[148:151], a[244:247], v[64:67], v[148:151]
    ds_read_b64_tr_b16 a[230:231], v16 offset:6144
    buffer_load_dwordx4 v6, s[16:19], s32 offen offset:1024 lds
    v_mfma_f32_16x16x32_bf16 v[156:159], a[244:247], v[68:71], v[156:159]
    s_waitcnt lgkmcnt(8)
    ds_read_b64_tr_b16 a[232:233], v13 offset:8192
    v_mfma_f32_16x16x32_bf16 v[160:163], a[248:251], v[64:67], v[160:163]
    ds_read_b64_tr_b16 a[234:235], v13 offset:10240
    v_mfma_f32_16x16x32_bf16 v[168:171], a[248:251], v[68:71], v[168:171]
    ds_read_b64_tr_b16 a[236:237], v14 offset:8192
    v_mfma_f32_16x16x32_bf16 v[164:167], a[252:255], v[64:67], v[164:167]
    ds_read_b64_tr_b16 a[238:239], v14 offset:10240
    v_mfma_f32_16x16x32_bf16 v[172:175], a[252:255], v[68:71], v[172:175]
    s_waitcnt lgkmcnt(8)
    ds_read_b64_tr_b16 a[240:241], v15 offset:8192
    v_mfma_f32_16x16x32_bf16 v[144:147], a[216:219], v[72:75], v[144:147]
    ds_read_b64_tr_b16 a[242:243], v15 offset:10240
    v_mfma_f32_16x16x32_bf16 v[152:155], a[216:219], v[76:79], v[152:155]
    ds_read_b64_tr_b16 a[244:245], v16 offset:8192
    buffer_load_dwordx4 v7, s[16:19], s32 offen offset:2048 lds
    v_mfma_f32_16x16x32_bf16 v[148:151], a[220:223], v[72:75], v[148:151]
    s_waitcnt vmcnt(17)
    ds_read_b64_tr_b16 a[246:247], v16 offset:10240
    buffer_store_dword v248, v245, s[20:23], s53 offen offset:512 sc1
    v_mfma_f32_16x16x32_bf16 v[156:159], a[220:223], v[76:79], v[156:159]
    s_waitcnt lgkmcnt(8)
    ds_read_b64_tr_b16 a[248:249], v13 offset:12288
    v_mfma_f32_16x16x32_bf16 v[160:163], a[224:227], v[72:75], v[160:163]
    ds_read_b64_tr_b16 a[250:251], v13 offset:14336
    v_mfma_f32_16x16x32_bf16 v[168:171], a[224:227], v[76:79], v[168:171]
    ds_read_b64_tr_b16 a[252:253], v14 offset:12288
    v_mfma_f32_16x16x32_bf16 v[164:167], a[228:231], v[72:75], v[164:167]
    ds_read_b64_tr_b16 a[254:255], v14 offset:14336
    v_mfma_f32_16x16x32_bf16 v[172:175], a[228:231], v[76:79], v[172:175]
    s_waitcnt lgkmcnt(8)
    ds_read_b64_tr_b16 a[216:217], v15 offset:12288
    v_mfma_f32_16x16x32_bf16 v[144:147], a[232:235], v[80:83], v[144:147]
    ds_read_b64_tr_b16 a[218:219], v15 offset:14336
    buffer_load_dwordx4 v8, s[16:19], s32 offen offset:3072 lds
    v_mfma_f32_16x16x32_bf16 v[152:155], a[232:235], v[84:87], v[152:155]
    s_add_u32 m0, s35, 32768
    ds_read_b64_tr_b16 a[220:221], v16 offset:12288
    v_mfma_f32_16x16x32_bf16 v[148:151], a[236:239], v[80:83], v[148:151]
    s_add_u32 s32, s41, 256
    ds_read_b64_tr_b16 a[222:223], v16 offset:14336
    v_mfma_f32_16x16x32_bf16 v[156:159], a[236:239], v[84:87], v[156:159]
    s_waitcnt lgkmcnt(8)
    ds_read_b64_tr_b16 a[224:225], v13 offset:16384
    v_mfma_f32_16x16x32_bf16 v[160:163], a[240:243], v[80:83], v[160:163]
    ds_read_b64_tr_b16 a[226:227], v13 offset:18432
    v_mfma_f32_16x16x32_bf16 v[168:171], a[240:243], v[84:87], v[168:171]
    ds_read_b64_tr_b16 a[228:229], v14 offset:16384
    v_mfma_f32_16x16x32_bf16 v[164:167], a[244:247], v[80:83], v[164:167]
    ds_read_b64_tr_b16 a[230:231], v14 offset:18432
    v_mfma_f32_16x16x32_bf16 v[172:175], a[244:247], v[84:87], v[172:175]
    s_waitcnt lgkmcnt(8)
    ds_read_b64_tr_b16 a[232:233], v15 offset:16384
    buffer_load_dwordx4 v5, s[16:19], s32 offen offset:0 lds
    v_mfma_f32_16x16x32_bf16 v[144:147], a[248:251], v[88:91], v[144:147]
    ds_read_b64_tr_b16 a[234:235], v15 offset:18432
    v_mfma_f32_16x16x32_bf16 v[152:155], a[248:251], v[92:95], v[152:155]
    ds_read_b64_tr_b16 a[236:237], v16 offset:16384
    v_mfma_f32_16x16x32_bf16 v[148:151], a[252:255], v[88:91], v[148:151]
    ds_read_b64_tr_b16 a[238:239], v16 offset:18432
    v_mfma_f32_16x16x32_bf16 v[156:159], a[252:255], v[92:95], v[156:159]
    s_waitcnt lgkmcnt(8)
    ds_read_b64_tr_b16 a[240:241], v13 offset:20480
    v_mfma_f32_16x16x32_bf16 v[160:163], a[216:219], v[88:91], v[160:163]
    ds_read_b64_tr_b16 a[242:243], v13 offset:22528
    v_mfma_f32_16x16x32_bf16 v[168:171], a[216:219], v[92:95], v[168:171]
    ds_read_b64_tr_b16 a[244:245], v14 offset:20480
    v_mfma_f32_16x16x32_bf16 v[164:167], a[220:223], v[88:91], v[164:167]
    ds_read_b64_tr_b16 a[246:247], v14 offset:22528
    v_mfma_f32_16x16x32_bf16 v[172:175], a[220:223], v[92:95], v[172:175]
    s_waitcnt lgkmcnt(8)
    ds_read_b64_tr_b16 a[248:249], v15 offset:20480
    v_mfma_f32_16x16x32_bf16 v[144:147], a[224:227], v[96:99], v[144:147]
    ds_read_b64_tr_b16 a[250:251], v15 offset:22528
    v_mfma_f32_16x16x32_bf16 v[152:155], a[224:227], v[100:103], v[152:155]
    ds_read_b64_tr_b16 a[252:253], v16 offset:20480
    v_mfma_f32_16x16x32_bf16 v[148:151], a[228:231], v[96:99], v[148:151]
    ds_read_b64_tr_b16 a[254:255], v16 offset:22528
    v_mfma_f32_16x16x32_bf16 v[156:159], a[228:231], v[100:103], v[156:159]
    s_waitcnt lgkmcnt(8)
    v_mfma_f32_16x16x32_bf16 v[160:163], a[232:235], v[96:99], v[160:163]
    v_mfma_f32_16x16x32_bf16 v[168:171], a[232:235], v[100:103], v[168:171]
    s_waitcnt lgkmcnt(0)
    s_barrier
    ds_read_b64_tr_b16 a[216:217], v13 offset:24576
    ds_read_b64_tr_b16 a[218:219], v13 offset:26624
    v_mfma_f32_16x16x32_bf16 v[164:167], a[236:239], v[96:99], v[164:167]
    s_add_u32 m0, s34, 36864
    ds_read_b64_tr_b16 a[220:221], v14 offset:24576
    ds_read_b64_tr_b16 a[222:223], v14 offset:26624
    v_mfma_f32_16x16x32_bf16 v[172:175], a[236:239], v[100:103], v[172:175]
    s_add_u32 s32, s42, 256
    ds_read_b64_tr_b16 a[224:225], v15 offset:24576
    buffer_load_dwordx4 v5, s[16:19], s32 offen offset:0 lds
    v_mfma_f32_16x16x32_bf16 v[144:147], a[240:243], v[104:107], v[144:147]
    ds_read_b64_tr_b16 a[226:227], v15 offset:26624
    buffer_load_dword v247, off, s[20:23], s54 offset:512 sc1
    v_mfma_f32_16x16x32_bf16 v[152:155], a[240:243], v[108:111], v[152:155]
    ds_read_b64_tr_b16 a[228:229], v16 offset:24576
    v_mfma_f32_16x16x32_bf16 v[148:151], a[244:247], v[104:107], v[148:151]
    ds_read_b64_tr_b16 a[230:231], v16 offset:26624
    v_mfma_f32_16x16x32_bf16 v[156:159], a[244:247], v[108:111], v[156:159]
    ds_read_b64_tr_b16 a[232:233], v13 offset:28672
    v_mfma_f32_16x16x32_bf16 v[160:163], a[248:251], v[104:107], v[160:163]
    ds_read_b64_tr_b16 a[234:235], v13 offset:30720
    v_mfma_f32_16x16x32_bf16 v[168:171], a[248:251], v[108:111], v[168:171]
    ds_read_b64_tr_b16 a[236:237], v14 offset:28672
    v_mfma_f32_16x16x32_bf16 v[164:167], a[252:255], v[104:107], v[164:167]
    ds_read_b64_tr_b16 a[238:239], v14 offset:30720
    buffer_load_dwordx4 v6, s[16:19], s32 offen offset:1024 lds
    v_mfma_f32_16x16x32_bf16 v[172:175], a[252:255], v[108:111], v[172:175]
    s_waitcnt lgkmcnt(8)
    ds_read_b64_tr_b16 a[240:241], v15 offset:28672
    v_mfma_f32_16x16x32_bf16 v[208:211], a[216:219], a[144:147], v[208:211]
    ds_read_b64_tr_b16 a[242:243], v15 offset:30720
    v_mfma_f32_16x16x32_bf16 v[216:219], a[216:219], a[148:151], v[216:219]
    ds_read_b64_tr_b16 a[244:245], v16 offset:28672
    v_mfma_f32_16x16x32_bf16 v[212:215], a[220:223], a[144:147], v[212:215]
    ds_read_b64_tr_b16 a[246:247], v16 offset:30720
    v_mfma_f32_16x16x32_bf16 v[220:223], a[220:223], a[148:151], v[220:223]
    s_waitcnt lgkmcnt(8)
    ds_read_b64_tr_b16 a[248:249], v13 offset:32768
    v_mfma_f32_16x16x32_bf16 v[224:227], a[224:227], a[144:147], v[224:227]
    ds_read_b64_tr_b16 a[250:251], v13 offset:34816
    v_mfma_f32_16x16x32_bf16 v[232:235], a[224:227], a[148:151], v[232:235]
    ds_read_b64_tr_b16 a[252:253], v14 offset:32768
    buffer_load_dwordx4 v7, s[16:19], s32 offen offset:2048 lds
    v_mfma_f32_16x16x32_bf16 v[228:231], a[228:231], a[144:147], v[228:231]
    ds_read_b64_tr_b16 a[254:255], v14 offset:34816
    v_mfma_f32_16x16x32_bf16 v[236:239], a[228:231], a[148:151], v[236:239]
    s_waitcnt lgkmcnt(8)
    ds_read_b64_tr_b16 a[216:217], v15 offset:32768
    v_mfma_f32_16x16x32_bf16 v[208:211], a[232:235], a[152:155], v[208:211]
    ds_read_b64_tr_b16 a[218:219], v15 offset:34816
    v_mfma_f32_16x16x32_bf16 v[216:219], a[232:235], a[156:159], v[216:219]
    ds_read_b64_tr_b16 a[220:221], v16 offset:32768
    v_mfma_f32_16x16x32_bf16 v[212:215], a[236:239], a[152:155], v[212:215]
    ds_read_b64_tr_b16 a[222:223], v16 offset:34816
    v_mfma_f32_16x16x32_bf16 v[220:223], a[236:239], a[156:159], v[220:223]
    s_waitcnt lgkmcnt(8)
    ds_read_b64_tr_b16 a[224:225], v13 offset:36864
    v_mfma_f32_16x16x32_bf16 v[224:227], a[240:243], a[152:155], v[224:227]
    ds_read_b64_tr_b16 a[226:227], v13 offset:38912
    buffer_load_dwordx4 v8, s[16:19], s32 offen offset:3072 lds
    v_mfma_f32_16x16x32_bf16 v[232:235], a[240:243], a[156:159], v[232:235]
    s_add_u32 m0, s34, 40960
    ds_read_b64_tr_b16 a[228:229], v14 offset:36864
    v_mfma_f32_16x16x32_bf16 v[228:231], a[244:247], a[152:155], v[228:231]
    s_add_u32 s32, s42, 37120
    ds_read_b64_tr_b16 a[230:231], v14 offset:38912
    v_mfma_f32_16x16x32_bf16 v[236:239], a[244:247], a[156:159], v[236:239]
    s_waitcnt lgkmcnt(8)
    ds_read_b64_tr_b16 a[232:233], v15 offset:36864
    v_mfma_f32_16x16x32_bf16 v[208:211], a[248:251], a[160:163], v[208:211]
    ds_read_b64_tr_b16 a[234:235], v15 offset:38912
    v_mfma_f32_16x16x32_bf16 v[216:219], a[248:251], a[164:167], v[216:219]
    ds_read_b64_tr_b16 a[236:237], v16 offset:36864
    v_mfma_f32_16x16x32_bf16 v[212:215], a[252:255], a[160:163], v[212:215]
    ds_read_b64_tr_b16 a[238:239], v16 offset:38912
    v_mfma_f32_16x16x32_bf16 v[220:223], a[252:255], a[164:167], v[220:223]
    s_waitcnt lgkmcnt(8)
    ds_read_b64_tr_b16 a[240:241], v13 offset:40960
    buffer_load_dwordx4 v5, s[16:19], s32 offen offset:0 lds
    v_mfma_f32_16x16x32_bf16 v[224:227], a[216:219], a[160:163], v[224:227]
    ds_read_b64_tr_b16 a[242:243], v13 offset:43008
    v_mfma_f32_16x16x32_bf16 v[232:235], a[216:219], a[164:167], v[232:235]
    ds_read_b64_tr_b16 a[244:245], v14 offset:40960
    v_mfma_f32_16x16x32_bf16 v[228:231], a[220:223], a[160:163], v[228:231]
    ds_read_b64_tr_b16 a[246:247], v14 offset:43008
    v_mfma_f32_16x16x32_bf16 v[236:239], a[220:223], a[164:167], v[236:239]
    s_waitcnt lgkmcnt(8)
    ds_read_b64_tr_b16 a[248:249], v15 offset:40960
    v_mfma_f32_16x16x32_bf16 v[208:211], a[224:227], a[168:171], v[208:211]
    ds_read_b64_tr_b16 a[250:251], v15 offset:43008
    v_mfma_f32_16x16x32_bf16 v[216:219], a[224:227], a[172:175], v[216:219]
    ds_read_b64_tr_b16 a[252:253], v16 offset:40960
    v_mfma_f32_16x16x32_bf16 v[212:215], a[228:231], a[168:171], v[212:215]
    ds_read_b64_tr_b16 a[254:255], v16 offset:43008
    buffer_load_dwordx4 v6, s[16:19], s32 offen offset:1024 lds
    v_mfma_f32_16x16x32_bf16 v[220:223], a[228:231], a[172:175], v[220:223]
    s_waitcnt lgkmcnt(8)
    ds_read_b64_tr_b16 a[216:217], v13 offset:45056
    v_mfma_f32_16x16x32_bf16 v[224:227], a[232:235], a[168:171], v[224:227]
    s_waitcnt vmcnt(5)
    ds_read_b64_tr_b16 a[218:219], v13 offset:47104
    v_cmp_eq_u32 vcc, 0, v247
    v_mfma_f32_16x16x32_bf16 v[232:235], a[232:235], a[172:175], v[232:235]
    s_cbranch_vccnz L_ffn_kernel_spinh4
L_ffn_kernel_reth4:
    ds_read_b64_tr_b16 a[220:221], v14 offset:45056
    v_mfma_f32_16x16x32_bf16 v[228:231], a[236:239], a[168:171], v[228:231]
    s_add_u32 s52, s60, 16384
    ds_read_b64_tr_b16 a[222:223], v14 offset:47104
    v_mfma_f32_16x16x32_bf16 v[236:239], a[236:239], a[172:175], v[236:239]
    s_waitcnt lgkmcnt(8)
    ds_read_b64_tr_b16 a[224:225], v15 offset:45056
    buffer_load_dwordx4 a[208:211], v23, s[20:23], s52 offen offset:0 sc1
    v_mfma_f32_16x16x32_bf16 v[208:211], a[240:243], a[176:179], v[208:211]
    ds_read_b64_tr_b16 a[226:227], v15 offset:47104
    buffer_load_dwordx4 a[212:215], v23, s[20:23], s52 offen offset:1024 sc1
    v_mfma_f32_16x16x32_bf16 v[216:219], a[240:243], a[180:183], v[216:219]
    ds_read_b64_tr_b16 a[228:229], v16 offset:45056
    buffer_load_dwordx4 v7, s[16:19], s32 offen offset:2048 lds
    v_mfma_f32_16x16x32_bf16 v[212:215], a[244:247], a[176:179], v[212:215]
    ds_read_b64_tr_b16 a[230:231], v16 offset:47104
    v_cmp_eq_u32 vcc, 0, v255
    v_mfma_f32_16x16x32_bf16 v[220:223], a[244:247], a[180:183], v[220:223]
    s_waitcnt lgkmcnt(8)
    ds_read_b64_tr_b16 a[232:233], v17 offset:0
    v_mfma_f32_16x16x32_bf16 v[224:227], a[248:251], a[176:179], v[224:227]
    s_cbranch_vccnz L_ffn_kernel_spinclr
L_ffn_kernel_retclr:
    ds_read_b64_tr_b16 a[234:235], v17 offset:2048
    v_mfma_f32_16x16x32_bf16 v[232:235], a[248:251], a[180:183], v[232:235]
    ds_read_b64_tr_b16 a[236:237], v18 offset:0
    v_mfma_f32_16x16x32_bf16 v[228:231], a[252:255], a[176:179], v[228:231]
    ds_read_b64_tr_b16 a[238:239], v18 offset:2048
    v_mfma_f32_16x16x32_bf16 v[236:239], a[252:255], a[180:183], v[236:239]
    s_waitcnt lgkmcnt(8)
    ds_read_b64_tr_b16 a[240:241], v19 offset:0
    v_mfma_f32_16x16x32_bf16 v[208:211], a[216:219], a[184:187], v[208:211]
    ds_read_b64_tr_b16 a[242:243], v19 offset:2048
    buffer_load_dwordx4 v8, s[16:19], s32 offen offset:3072 lds
    v_mfma_f32_16x16x32_bf16 v[216:219], a[216:219], a[188:191], v[216:219]
    s_add_u32 m0, s35, 69632
    ds_read_b64_tr_b16 a[244:245], v20 offset:0
    v_mfma_f32_16x16x32_bf16 v[212:215], a[220:223], a[184:187], v[212:215]
    s_add_u32 s32, s43, 256
    ds_read_b64_tr_b16 a[246:247], v20 offset:2048
    v_mfma_f32_16x16x32_bf16 v[220:223], a[220:223], a[188:191], v[220:223]
    s_waitcnt lgkmcnt(8)
    ds_read_b64_tr_b16 a[248:249], v17 offset:4096
    v_mfma_f32_16x16x32_bf16 v[224:227], a[224:227], a[184:187], v[224:227]
    ds_read_b64_tr_b16 a[250:251], v17 offset:6144
    v_mfma_f32_16x16x32_bf16 v[232:235], a[224:227], a[188:191], v[232:235]
    ds_read_b64_tr_b16 a[252:253], v18 offset:4096
    v_mfma_f32_16x16x32_bf16 v[228:231], a[228:231], a[184:187], v[228:231]
    ds_read_b64_tr_b16 a[254:255], v18 offset:6144
    v_mfma_f32_16x16x32_bf16 v[236:239], a[228:231], a[188:191], v[236:239]
    s_waitcnt lgkmcnt(8)
    ds_read_b64_tr_b16 a[216:217], v19 offset:4096
    buffer_load_dwordx4 v5, s[16:19], s32 offen offset:0 lds
    v_mfma_f32_16x16x32_bf16 v[208:211], a[232:235], a[192:195], v[208:211]
    ds_read_b64_tr_b16 a[218:219], v19 offset:6144
    v_mfma_f32_16x16x32_bf16 v[216:219], a[232:235], a[196:199], v[216:219]
    ds_read_b64_tr_b16 a[220:221], v20 offset:4096
    v_mfma_f32_16x16x32_bf16 v[212:215], a[236:239], a[192:195], v[212:215]
    ds_read_b64_tr_b16 a[222:223], v20 offset:6144
    v_mfma_f32_16x16x32_bf16 v[220:223], a[236:239], a[196:199], v[220:223]
    s_waitcnt lgkmcnt(8)
    ds_read_b64_tr_b16 a[224:225], v17 offset:8192
    v_mfma_f32_16x16x32_bf16 v[224:227], a[240:243], a[192:195], v[224:227]
    ds_read_b64_tr_b16 a[226:227], v17 offset:10240
    v_mfma_f32_16x16x32_bf16 v[232:235], a[240:243], a[196:199], v[232:235]
    ds_read_b64_tr_b16 a[228:229], v18 offset:8192
    v_mfma_f32_16x16x32_bf16 v[228:231], a[244:247], a[192:195], v[228:231]
    ds_read_b64_tr_b16 a[230:231], v18 offset:10240
    v_mfma_f32_16x16x32_bf16 v[236:239], a[244:247], a[196:199], v[236:239]
    s_waitcnt lgkmcnt(8)
    ds_read_b64_tr_b16 a[232:233], v19 offset:8192
    v_mfma_f32_16x16x32_bf16 v[208:211], a[248:251], a[200:203], v[208:211]
    ds_read_b64_tr_b16 a[234:235], v19 offset:10240
    v_mfma_f32_16x16x32_bf16 v[216:219], a[248:251], a[204:207], v[216:219]
    ds_read_b64_tr_b16 a[236:237], v20 offset:8192
    v_mfma_f32_16x16x32_bf16 v[212:215], a[252:255], a[200:203], v[212:215]
    ds_read_b64_tr_b16 a[238:239], v20 offset:10240
    v_mfma_f32_16x16x32_bf16 v[220:223], a[252:255], a[204:207], v[220:223]
    s_waitcnt lgkmcnt(8)
    v_mfma_f32_16x16x32_bf16 v[224:227], a[216:219], a[200:203], v[224:227]
    v_mfma_f32_16x16x32_bf16 v[232:235], a[216:219], a[204:207], v[232:235]
    s_waitcnt lgkmcnt(0)
    s_barrier
    ds_read_b64_tr_b16 a[240:241], v17 offset:12288
    ds_read_b64_tr_b16 a[242:243], v17 offset:14336
    v_mfma_f32_16x16x32_bf16 v[228:231], a[220:223], a[200:203], v[228:231]
    s_add_u32 m0, s34, 73728
    ds_read_b64_tr_b16 a[244:245], v18 offset:12288
    ds_read_b64_tr_b16 a[246:247], v18 offset:14336
    v_mfma_f32_16x16x32_bf16 v[236:239], a[220:223], a[204:207], v[236:239]
    s_waitcnt vmcnt(3)
    ds_read_b64_tr_b16 a[248:249], v17 offset:16384
    v_mfma_f32_16x16x32_bf16 v[208:211], a[224:227], a[208:211], v[208:211]
    s_add_u32 s32, s40, 384
    ds_read_b64_tr_b16 a[250:251], v17 offset:18432
    buffer_load_dwordx4 v5, s[16:19], s32 offen offset:0 lds
    v_mfma_f32_16x16x32_bf16 v[216:219], a[224:227], a[212:215], v[216:219]
    ds_read_b64_tr_b16 a[252:253], v18 offset:16384
    v_mfma_f32_16x16x32_bf16 v[212:215], a[228:231], a[208:211], v[212:215]
    ds_read_b64_tr_b16 a[254:255], v18 offset:18432
    v_mfma_f32_16x16x32_bf16 v[220:223], a[228:231], a[212:215], v[220:223]
    ds_read_b64_tr_b16 a[216:217], v17 offset:20480
    v_mfma_f32_16x16x32_bf16 v[224:227], a[232:235], a[208:211], v[224:227]
    ds_read_b64_tr_b16 a[218:219], v17 offset:22528
    v_mfma_f32_16x16x32_bf16 v[232:235], a[232:235], a[212:215], v[232:235]
    ds_read_b64_tr_b16 a[220:221], v18 offset:20480
    v_mfma_f32_16x16x32_bf16 v[228:231], a[236:239], a[208:211], v[228:231]
    ds_read_b64_tr_b16 a[222:223], v18 offset:22528
    v_mfma_f32_16x16x32_bf16 v[236:239], a[236:239], a[212:215], v[236:239]
    s_waitcnt lgkmcnt(8)
    ds_read_b64_tr_b16 a[224:225], v17 offset:24576
    buffer_load_dwordx4 v6, s[16:19], s32 offen offset:1024 lds
    v_mfma_f32_16x16x32_bf16 v[144:147], a[240:243], a[144:147], v[144:147]
    s_add_u32 s49, s47, 0
    ds_read_b64_tr_b16 a[226:227], v17 offset:26624
    v_cvt_pk_bf16_f32 v208, v208, v209
    v_mfma_f32_16x16x32_bf16 v[152:155], a[240:243], a[148:151], v[152:155]
    ds_read_b64_tr_b16 a[228:229], v18 offset:24576
    v_cvt_pk_bf16_f32 v209, v210, v211
    v_mfma_f32_16x16x32_bf16 v[148:151], a[244:247], a[144:147], v[148:151]
    ds_read_b64_tr_b16 a[230:231], v18 offset:26624
    v_cvt_pk_bf16_f32 v210, v212, v213
    v_mfma_f32_16x16x32_bf16 v[156:159], a[244:247], a[148:151], v[156:159]
    s_waitcnt lgkmcnt(8)
    ds_read_b64_tr_b16 a[232:233], v17 offset:28672
    v_cvt_pk_bf16_f32 v211, v214, v215
    v_mfma_f32_16x16x32_bf16 v[144:147], a[248:251], a[152:155], v[144:147]
    ds_read_b64_tr_b16 a[234:235], v17 offset:30720
    buffer_store_dwordx4 v[208:211], v244, s[20:23], s49 offen sc1
    v_mfma_f32_16x16x32_bf16 v[152:155], a[248:251], a[156:159], v[152:155]
    s_add_u32 s49, s47, 8192
    ds_read_b64_tr_b16 a[236:237], v18 offset:28672
    v_cvt_pk_bf16_f32 v212, v216, v217
    v_mfma_f32_16x16x32_bf16 v[148:151], a[252:255], a[152:155], v[148:151]
    ds_read_b64_tr_b16 a[238:239], v18 offset:30720
    buffer_load_dwordx4 v7, s[16:19], s32 offen offset:2048 lds
    v_mfma_f32_16x16x32_bf16 v[156:159], a[252:255], a[156:159], v[156:159]
    s_waitcnt lgkmcnt(8)
    ds_read_b64_tr_b16 a[240:241], v17 offset:32768
    v_cvt_pk_bf16_f32 v213, v218, v219
    v_mfma_f32_16x16x32_bf16 v[144:147], a[216:219], a[160:163], v[144:147]
    ds_read_b64_tr_b16 a[242:243], v17 offset:34816
    v_cvt_pk_bf16_f32 v214, v220, v221
    v_mfma_f32_16x16x32_bf16 v[152:155], a[216:219], a[164:167], v[152:155]
    ds_read_b64_tr_b16 a[244:245], v18 offset:32768
    v_cvt_pk_bf16_f32 v215, v222, v223
    v_mfma_f32_16x16x32_bf16 v[148:151], a[220:223], a[160:163], v[148:151]
    ds_read_b64_tr_b16 a[246:247], v18 offset:34816
    buffer_store_dwordx4 v[212:215], v244, s[20:23], s49 offen sc1
    v_mfma_f32_16x16x32_bf16 v[156:159], a[220:223], a[164:167], v[156:159]
    s_waitcnt lgkmcnt(8)
    ds_read_b64_tr_b16 a[248:249], v17 offset:36864
    v_cvt_pk_bf16_f32 v224, v224, v225
    v_mfma_f32_16x16x32_bf16 v[144:147], a[224:227], a[168:171], v[144:147]
    s_add_u32 s49, s47, 16384
    ds_read_b64_tr_b16 a[250:251], v17 offset:38912
    v_cvt_pk_bf16_f32 v225, v226, v227
    v_mfma_f32_16x16x32_bf16 v[152:155], a[224:227], a[172:175], v[152:155]
    ds_read_b64_tr_b16 a[252:253], v18 offset:36864
    buffer_load_dwordx4 v8, s[16:19], s32 offen offset:3072 lds
    v_mfma_f32_16x16x32_bf16 v[148:151], a[228:231], a[168:171], v[148:151]
    s_add_u32 m0, s34, 77824
    ds_read_b64_tr_b16 a[254:255], v18 offset:38912
    v_cvt_pk_bf16_f32 v226, v228, v229
    v_mfma_f32_16x16x32_bf16 v[156:159], a[228:231], a[172:175], v[156:159]
    s_waitcnt lgkmcnt(8)
    ds_read_b64_tr_b16 a[216:217], v17 offset:40960
    v_cvt_pk_bf16_f32 v227, v230, v231
    v_mfma_f32_16x16x32_bf16 v[144:147], a[232:235], a[176:179], v[144:147]
    s_add_u32 s32, s40, 37248
    ds_read_b64_tr_b16 a[218:219], v17 offset:43008
    buffer_store_dwordx4 v[224:227], v244, s[20:23], s49 offen sc1
    v_mfma_f32_16x16x32_bf16 v[152:155], a[232:235], a[180:183], v[152:155]
    s_add_u32 s49, s47, 24576
    ds_read_b64_tr_b16 a[220:221], v18 offset:40960
    v_cvt_pk_bf16_f32 v228, v232, v233
    v_mfma_f32_16x16x32_bf16 v[148:151], a[236:239], a[176:179], v[148:151]
    ds_read_b64_tr_b16 a[222:223], v18 offset:43008
    v_cvt_pk_bf16_f32 v229, v234, v235
    v_mfma_f32_16x16x32_bf16 v[156:159], a[236:239], a[180:183], v[156:159]
    s_waitcnt lgkmcnt(8)
    ds_read_b64_tr_b16 a[224:225], v17 offset:45056
    v_cvt_pk_bf16_f32 v230, v236, v237
    v_mfma_f32_16x16x32_bf16 v[144:147], a[240:243], a[184:187], v[144:147]
    ds_read_b64_tr_b16 a[226:227], v17 offset:47104
    buffer_load_dwordx4 v5, s[16:19], s32 offen offset:0 lds
    v_mfma_f32_16x16x32_bf16 v[152:155], a[240:243], a[188:191], v[152:155]
    ds_read_b64_tr_b16 a[228:229], v18 offset:45056
    v_cvt_pk_bf16_f32 v231, v238, v239
    v_mfma_f32_16x16x32_bf16 v[148:151], a[244:247], a[184:187], v[148:151]
    ds_read_b64_tr_b16 a[230:231], v18 offset:47104
    buffer_store_dwordx4 v[228:231], v244, s[20:23], s49 offen sc1
    v_mfma_f32_16x16x32_bf16 v[156:159], a[244:247], a[188:191], v[156:159]
    s_waitcnt lgkmcnt(8)
    ds_read_b64_tr_b16 a[232:233], v19 offset:12288
    v_mfma_f32_16x16x32_bf16 v[144:147], a[248:251], a[192:195], v[144:147]
    ds_read_b64_tr_b16 a[234:235], v19 offset:14336
    v_mfma_f32_16x16x32_bf16 v[152:155], a[248:251], a[196:199], v[152:155]
    ds_read_b64_tr_b16 a[236:237], v20 offset:12288
    v_mfma_f32_16x16x32_bf16 v[148:151], a[252:255], a[192:195], v[148:151]
    ds_read_b64_tr_b16 a[238:239], v20 offset:14336
    v_mfma_f32_16x16x32_bf16 v[156:159], a[252:255], a[196:199], v[156:159]
    s_waitcnt lgkmcnt(8)
    ds_read_b64_tr_b16 a[240:241], v19 offset:16384
    buffer_load_dwordx4 v6, s[16:19], s32 offen offset:1024 lds
    v_mfma_f32_16x16x32_bf16 v[144:147], a[216:219], a[200:203], v[144:147]
    ds_read_b64_tr_b16 a[242:243], v19 offset:18432
    v_mfma_f32_16x16x32_bf16 v[152:155], a[216:219], a[204:207], v[152:155]
    ds_read_b64_tr_b16 a[244:245], v20 offset:16384
    v_mfma_f32_16x16x32_bf16 v[148:151], a[220:223], a[200:203], v[148:151]
    ds_read_b64_tr_b16 a[246:247], v20 offset:18432
    v_mfma_f32_16x16x32_bf16 v[156:159], a[220:223], a[204:207], v[156:159]
    s_waitcnt lgkmcnt(8)
    ds_read_b64_tr_b16 a[248:249], v19 offset:20480
    v_mfma_f32_16x16x32_bf16 v[144:147], a[224:227], a[208:211], v[144:147]
    ds_read_b64_tr_b16 a[250:251], v19 offset:22528
    v_mfma_f32_16x16x32_bf16 v[152:155], a[224:227], a[212:215], v[152:155]
    ds_read_b64_tr_b16 a[252:253], v20 offset:20480
    v_mfma_f32_16x16x32_bf16 v[148:151], a[228:231], a[208:211], v[148:151]
    ds_read_b64_tr_b16 a[254:255], v20 offset:22528
    buffer_load_dwordx4 v7, s[16:19], s32 offen offset:2048 lds
    v_mfma_f32_16x16x32_bf16 v[156:159], a[228:231], a[212:215], v[156:159]
    s_waitcnt lgkmcnt(8)
    ds_read_b64_tr_b16 a[216:217], v19 offset:24576
    v_mfma_f32_16x16x32_bf16 v[160:163], a[232:235], a[144:147], v[160:163]
    ds_read_b64_tr_b16 a[218:219], v19 offset:26624
    v_mfma_f32_16x16x32_bf16 v[168:171], a[232:235], a[148:151], v[168:171]
    ds_read_b64_tr_b16 a[220:221], v20 offset:24576
    v_mfma_f32_16x16x32_bf16 v[164:167], a[236:239], a[144:147], v[164:167]
    ds_read_b64_tr_b16 a[222:223], v20 offset:26624
    v_mfma_f32_16x16x32_bf16 v[172:175], a[236:239], a[148:151], v[172:175]
    s_waitcnt lgkmcnt(8)
    ds_read_b64_tr_b16 a[224:225], v19 offset:28672
    v_mfma_f32_16x16x32_bf16 v[160:163], a[240:243], a[152:155], v[160:163]
    s_add_u32 s49, s47, 32768
    ds_read_b64_tr_b16 a[226:227], v19 offset:30720
    v_cvt_pk_bf16_f32 v144, v144, v145
    v_mfma_f32_16x16x32_bf16 v[168:171], a[240:243], a[156:159], v[168:171]
    ds_read_b64_tr_b16 a[228:229], v20 offset:28672
    buffer_load_dwordx4 v8, s[16:19], s32 offen offset:3072 lds
    v_mfma_f32_16x16x32_bf16 v[164:167], a[244:247], a[152:155], v[164:167]
    s_add_u32 m0, s35, 106496
    ds_read_b64_tr_b16 a[230:231], v20 offset:30720
    v_cvt_pk_bf16_f32 v145, v146, v147
    v_mfma_f32_16x16x32_bf16 v[172:175], a[244:247], a[156:159], v[172:175]
    s_waitcnt lgkmcnt(8)
    ds_read_b64_tr_b16 a[232:233], v19 offset:32768
    v_cvt_pk_bf16_f32 v146, v148, v149
    v_mfma_f32_16x16x32_bf16 v[160:163], a[248:251], a[160:163], v[160:163]
    s_add_u32 s32, s41, 384
    ds_read_b64_tr_b16 a[234:235], v19 offset:34816
    v_cvt_pk_bf16_f32 v147, v150, v151
    v_mfma_f32_16x16x32_bf16 v[168:171], a[248:251], a[164:167], v[168:171]
    ds_read_b64_tr_b16 a[236:237], v20 offset:32768
    buffer_store_dwordx4 v[144:147], v244, s[20:23], s49 offen sc1
    v_mfma_f32_16x16x32_bf16 v[164:167], a[252:255], a[160:163], v[164:167]
    s_add_u32 s49, s47, 40960
    ds_read_b64_tr_b16 a[238:239], v20 offset:34816
    v_cvt_pk_bf16_f32 v148, v152, v153
    v_mfma_f32_16x16x32_bf16 v[172:175], a[252:255], a[164:167], v[172:175]
    s_waitcnt lgkmcnt(8)
    ds_read_b64_tr_b16 a[240:241], v19 offset:36864
    v_cvt_pk_bf16_f32 v149, v154, v155
    v_mfma_f32_16x16x32_bf16 v[160:163], a[216:219], a[168:171], v[160:163]
    ds_read_b64_tr_b16 a[242:243], v19 offset:38912
    buffer_load_dwordx4 v5, s[16:19], s32 offen offset:0 lds
    v_mfma_f32_16x16x32_bf16 v[168:171], a[216:219], a[172:175], v[168:171]
    ds_read_b64_tr_b16 a[244:245], v20 offset:36864
    v_cvt_pk_bf16_f32 v150, v156, v157
    v_mfma_f32_16x16x32_bf16 v[164:167], a[220:223], a[168:171], v[164:167]
    ds_read_b64_tr_b16 a[246:247], v20 offset:38912
    v_cvt_pk_bf16_f32 v151, v158, v159
    v_mfma_f32_16x16x32_bf16 v[172:175], a[220:223], a[172:175], v[172:175]
    s_waitcnt lgkmcnt(8)
    ds_read_b64_tr_b16 a[248:249], v19 offset:40960
    buffer_store_dwordx4 v[148:151], v244, s[20:23], s49 offen sc1
    v_mfma_f32_16x16x32_bf16 v[160:163], a[224:227], a[176:179], v[160:163]
    ds_read_b64_tr_b16 a[250:251], v19 offset:43008
    v_mfma_f32_16x16x32_bf16 v[168:171], a[224:227], a[180:183], v[168:171]
    ds_read_b64_tr_b16 a[252:253], v20 offset:40960
    v_mfma_f32_16x16x32_bf16 v[164:167], a[228:231], a[176:179], v[164:167]
    ds_read_b64_tr_b16 a[254:255], v20 offset:43008
    v_mfma_f32_16x16x32_bf16 v[172:175], a[228:231], a[180:183], v[172:175]
    s_waitcnt lgkmcnt(8)
    ds_read_b64_tr_b16 a[216:217], v19 offset:45056
    v_mfma_f32_16x16x32_bf16 v[160:163], a[232:235], a[184:187], v[160:163]
    ds_read_b64_tr_b16 a[218:219], v19 offset:47104
    v_mfma_f32_16x16x32_bf16 v[168:171], a[232:235], a[188:191], v[168:171]
    ds_read_b64_tr_b16 a[220:221], v20 offset:45056
    v_mfma_f32_16x16x32_bf16 v[164:167], a[236:239], a[184:187], v[164:167]
    ds_read_b64_tr_b16 a[222:223], v20 offset:47104
    v_mfma_f32_16x16x32_bf16 v[172:175], a[236:239], a[188:191], v[172:175]
    s_waitcnt lgkmcnt(8)
    v_mfma_f32_16x16x32_bf16 v[160:163], a[240:243], a[192:195], v[160:163]
    v_mfma_f32_16x16x32_bf16 v[168:171], a[240:243], a[196:199], v[168:171]
    s_waitcnt lgkmcnt(0)
    s_barrier
    ds_read_b64_tr_b16 a[224:225], v9 offset:0
    ds_read_b64_tr_b16 a[226:227], v9 offset:2048
    v_mfma_f32_16x16x32_bf16 v[164:167], a[244:247], a[192:195], v[164:167]
    s_add_u32 m0, s34, 110592
    ds_read_b64_tr_b16 a[228:229], v10 offset:0
    ds_read_b64_tr_b16 a[230:231], v10 offset:2048
    v_mfma_f32_16x16x32_bf16 v[172:175], a[244:247], a[196:199], v[172:175]
    s_add_u32 s32, s42, 384
    ds_read_b64_tr_b16 a[232:233], v11 offset:0
    buffer_load_dwordx4 v5, s[16:19], s32 offen offset:0 lds
    v_mfma_f32_16x16x32_bf16 v[160:163], a[248:251], a[200:203], v[160:163]
    ds_read_b64_tr_b16 a[234:235], v11 offset:2048
    v_mfma_f32_16x16x32_bf16 v[168:171], a[248:251], a[204:207], v[168:171]
    ds_read_b64_tr_b16 a[236:237], v12 offset:0
    v_mfma_f32_16x16x32_bf16 v[164:167], a[252:255], a[200:203], v[164:167]
    ds_read_b64_tr_b16 a[238:239], v12 offset:2048
    v_mfma_f32_16x16x32_bf16 v[172:175], a[252:255], a[204:207], v[172:175]
    ds_read_b64_tr_b16 a[240:241], v9 offset:4096
    v_mfma_f32_16x16x32_bf16 v[160:163], a[216:219], a[208:211], v[160:163]
    ds_read_b64_tr_b16 a[242:243], v9 offset:6144
    v_mfma_f32_16x16x32_bf16 v[168:171], a[216:219], a[212:215], v[168:171]
    ds_read_b64_tr_b16 a[244:245], v10 offset:4096
    v_mfma_f32_16x16x32_bf16 v[164:167], a[220:223], a[208:211], v[164:167]
    ds_read_b64_tr_b16 a[246:247], v10 offset:6144
    buffer_load_dwordx4 v6, s[16:19], s32 offen offset:1024 lds
    v_mfma_f32_16x16x32_bf16 v[172:175], a[220:223], a[212:215], v[172:175]
    s_waitcnt lgkmcnt(8)
    ds_read_b64_tr_b16 a[248:249], v11 offset:4096
    v_mfma_f32_16x16x32_bf16 v[176:179], a[224:227], v[40:43], 0
    ds_read_b64_tr_b16 a[250:251], v11 offset:6144
    v_mfma_f32_16x16x32_bf16 v[184:187], a[224:227], v[44:47], 0
    ds_read_b64_tr_b16 a[252:253], v12 offset:4096
    v_mfma_f32_16x16x32_bf16 v[180:183], a[228:231], v[40:43], 0
    ds_read_b64_tr_b16 a[254:255], v12 offset:6144
    v_mfma_f32_16x16x32_bf16 v[188:191], a[228:231], v[44:47], 0
    s_waitcnt lgkmcnt(8)
    ds_read_b64_tr_b16 a[216:217], v9 offset:8192
    v_mfma_f32_16x16x32_bf16 v[192:195], a[232:235], v[40:43], 0
    s_add_u32 s49, s47, 49152
    ds_read_b64_tr_b16 a[218:219], v9 offset:10240
    v_cvt_pk_bf16_f32 v160, v160, v161
    v_mfma_f32_16x16x32_bf16 v[200:203], a[232:235], v[44:47], 0
    ds_read_b64_tr_b16 a[220:221], v10 offset:8192
    buffer_load_dwordx4 v7, s[16:19], s32 offen offset:2048 lds
    v_mfma_f32_16x16x32_bf16 v[196:199], a[236:239], v[40:43], 0
    ds_read_b64_tr_b16 a[222:223], v10 offset:10240
    v_cvt_pk_bf16_f32 v161, v162, v163
    v_mfma_f32_16x16x32_bf16 v[204:207], a[236:239], v[44:47], 0
    s_waitcnt lgkmcnt(8)
    ds_read_b64_tr_b16 a[224:225], v11 offset:8192
    v_cvt_pk_bf16_f32 v162, v164, v165
    v_mfma_f32_16x16x32_bf16 v[176:179], a[240:243], v[48:51], v[176:179]
    ds_read_b64_tr_b16 a[226:227], v11 offset:10240
    v_cvt_pk_bf16_f32 v163, v166, v167
    v_mfma_f32_16x16x32_bf16 v[184:187], a[240:243], v[52:55], v[184:187]
    ds_read_b64_tr_b16 a[228:229], v12 offset:8192
    buffer_store_dwordx4 v[160:163], v244, s[20:23], s49 offen sc1
    v_mfma_f32_16x16x32_bf16 v[180:183], a[244:247], v[48:51], v[180:183]
    s_add_u32 s49, s47, 57344
    ds_read_b64_tr_b16 a[230:231], v12 offset:10240
    v_cvt_pk_bf16_f32 v164, v168, v169
    v_mfma_f32_16x16x32_bf16 v[188:191], a[244:247], v[52:55], v[188:191]
    s_waitcnt lgkmcnt(8)
    ds_read_b64_tr_b16 a[232:233], v9 offset:12288
    v_cvt_pk_bf16_f32 v165, v170, v171
    v_mfma_f32_16x16x32_bf16 v[192:195], a[248:251], v[48:51], v[192:195]
    ds_read_b64_tr_b16 a[234:235], v9 offset:14336
    buffer_load_dwordx4 v8, s[16:19], s32 offen offset:3072 lds
    v_mfma_f32_16x16x32_bf16 v[200:203], a[248:251], v[52:55], v[200:203]
    s_add_u32 m0, s34, 114688
    ds_read_b64_tr_b16 a[236:237], v10 offset:12288
    v_cvt_pk_bf16_f32 v166, v172, v173
    v_mfma_f32_16x16x32_bf16 v[196:199], a[252:255], v[48:51], v[196:199]
    s_add_u32 s32, s42, 37248
    ds_read_b64_tr_b16 a[238:239], v10 offset:14336
    v_cvt_pk_bf16_f32 v167, v174, v175
    v_mfma_f32_16x16x32_bf16 v[204:207], a[252:255], v[52:55], v[204:207]
    s_waitcnt lgkmcnt(8)
    ds_read_b64_tr_b16 a[240:241], v11 offset:12288
    buffer_store_dwordx4 v[164:167], v244, s[20:23], s49 offen sc1
    v_mfma_f32_16x16x32_bf16 v[176:179], a[216:219], v[56:59], v[176:179]
    ds_read_b64_tr_b16 a[242:243], v11 offset:14336
    v_mfma_f32_16x16x32_bf16 v[184:187], a[216:219], v[60:63], v[184:187]
    ds_read_b64_tr_b16 a[244:245], v12 offset:12288
    v_mfma_f32_16x16x32_bf16 v[180:183], a[220:223], v[56:59], v[180:183]
    ds_read_b64_tr_b16 a[246:247], v12 offset:14336
    v_mfma_f32_16x16x32_bf16 v[188:191], a[220:223], v[60:63], v[188:191]
    s_waitcnt lgkmcnt(8)
    ds_read_b64_tr_b16 a[248:249], v9 offset:16384
    buffer_load_dwordx4 v5, s[16:19], s32 offen offset:0 lds
    v_mfma_f32_16x16x32_bf16 v[192:195], a[224:227], v[56:59], v[192:195]
    ds_read_b64_tr_b16 a[250:251], v9 offset:18432
    v_mfma_f32_16x16x32_bf16 v[200:203], a[224:227], v[60:63], v[200:203]
    ds_read_b64_tr_b16 a[252:253], v10 offset:16384
    v_mfma_f32_16x16x32_bf16 v[196:199], a[228:231], v[56:59], v[196:199]
    ds_read_b64_tr_b16 a[254:255], v10 offset:18432
    v_mfma_f32_16x16x32_bf16 v[204:207], a[228:231], v[60:63], v[204:207]
    s_waitcnt lgkmcnt(8)
    ds_read_b64_tr_b16 a[216:217], v11 offset:16384
    v_mfma_f32_16x16x32_bf16 v[176:179], a[232:235], v[64:67], v[176:179]
    ds_read_b64_tr_b16 a[218:219], v11 offset:18432
    v_mfma_f32_16x16x32_bf16 v[184:187], a[232:235], v[68:71], v[184:187]
    ds_read_b64_tr_b16 a[220:221], v12 offset:16384
    v_mfma_f32_16x16x32_bf16 v[180:183], a[236:239], v[64:67], v[180:183]
    ds_read_b64_tr_b16 a[222:223], v12 offset:18432
    buffer_load_dwordx4 v6, s[16:19], s32 offen offset:1024 lds
    v_mfma_f32_16x16x32_bf16 v[188:191], a[236:239], v[68:71], v[188:191]
    s_waitcnt lgkmcnt(8)
    ds_read_b64_tr_b16 a[224:225], v9 offset:20480
    v_mfma_f32_16x16x32_bf16 v[192:195], a[240:243], v[64:67], v[192:195]
    ds_read_b64_tr_b16 a[226:227], v9 offset:22528
    v_mfma_f32_16x16x32_bf16 v[200:203], a[240:243], v[68:71], v[200:203]
    ds_read_b64_tr_b16 a[228:229], v10 offset:20480
    v_mfma_f32_16x16x32_bf16 v[196:199], a[244:247], v[64:67], v[196:199]
    s_waitcnt vmcnt(14)
    ds_read_b64_tr_b16 a[230:231], v10 offset:22528
    buffer_store_dword v248, v245, s[20:23], s56 offen offset:0 sc1
    v_mfma_f32_16x16x32_bf16 v[204:207], a[244:247], v[68:71], v[204:207]
    s_waitcnt lgkmcnt(8)
    ds_read_b64_tr_b16 a[232:233], v11 offset:20480
    v_mfma_f32_16x16x32_bf16 v[176:179], a[248:251], v[72:75], v[176:179]
    ds_read_b64_tr_b16 a[234:235], v11 offset:22528
    v_mfma_f32_16x16x32_bf16 v[184:187], a[248:251], v[76:79], v[184:187]
    ds_read_b64_tr_b16 a[236:237], v12 offset:20480
    buffer_load_dwordx4 v7, s[16:19], s32 offen offset:2048 lds
    v_mfma_f32_16x16x32_bf16 v[180:183], a[252:255], v[72:75], v[180:183]
    ds_read_b64_tr_b16 a[238:239], v12 offset:22528
    v_mfma_f32_16x16x32_bf16 v[188:191], a[252:255], v[76:79], v[188:191]
    s_waitcnt lgkmcnt(8)
    ds_read_b64_tr_b16 a[240:241], v9 offset:24576
    v_mfma_f32_16x16x32_bf16 v[192:195], a[216:219], v[72:75], v[192:195]
    ds_read_b64_tr_b16 a[242:243], v9 offset:26624
    v_mfma_f32_16x16x32_bf16 v[200:203], a[216:219], v[76:79], v[200:203]
    ds_read_b64_tr_b16 a[244:245], v10 offset:24576
    v_mfma_f32_16x16x32_bf16 v[196:199], a[220:223], v[72:75], v[196:199]
    ds_read_b64_tr_b16 a[246:247], v10 offset:26624
    v_mfma_f32_16x16x32_bf16 v[204:207], a[220:223], v[76:79], v[204:207]
    s_waitcnt lgkmcnt(8)
    ds_read_b64_tr_b16 a[248:249], v11 offset:24576
    v_mfma_f32_16x16x32_bf16 v[176:179], a[224:227], v[80:83], v[176:179]
    ds_read_b64_tr_b16 a[250:251], v11 offset:26624
    buffer_load_dwordx4 v8, s[16:19], s32 offen offset:3072 lds
    v_mfma_f32_16x16x32_bf16 v[184:187], a[224:227], v[84:87], v[184:187]
    s_add_u32 m0, s35, 143360
    ds_read_b64_tr_b16 a[252:253], v12 offset:24576
    v_mfma_f32_16x16x32_bf16 v[180:183], a[228:231], v[80:83], v[180:183]
    s_add_u32 s32, s43, 384
    ds_read_b64_tr_b16 a[254:255], v12 offset:26624
    v_mfma_f32_16x16x32_bf16 v[188:191], a[228:231], v[84:87], v[188:191]
    s_waitcnt lgkmcnt(8)
    ds_read_b64_tr_b16 a[216:217], v9 offset:28672
    v_mfma_f32_16x16x32_bf16 v[192:195], a[232:235], v[80:83], v[192:195]
    ds_read_b64_tr_b16 a[218:219], v9 offset:30720
    v_mfma_f32_16x16x32_bf16 v[200:203], a[232:235], v[84:87], v[200:203]
    ds_read_b64_tr_b16 a[220:221], v10 offset:28672
    v_mfma_f32_16x16x32_bf16 v[196:199], a[236:239], v[80:83], v[196:199]
    ds_read_b64_tr_b16 a[222:223], v10 offset:30720
    v_mfma_f32_16x16x32_bf16 v[204:207], a[236:239], v[84:87], v[204:207]
    s_waitcnt lgkmcnt(8)
    ds_read_b64_tr_b16 a[224:225], v11 offset:28672
    buffer_load_dwordx4 v5, s[16:19], s32 offen offset:0 lds
    v_mfma_f32_16x16x32_bf16 v[176:179], a[240:243], v[88:91], v[176:179]
    ds_read_b64_tr_b16 a[226:227], v11 offset:30720
    v_mfma_f32_16x16x32_bf16 v[184:187], a[240:243], v[92:95], v[184:187]
    ds_read_b64_tr_b16 a[228:229], v12 offset:28672
    v_mfma_f32_16x16x32_bf16 v[180:183], a[244:247], v[88:91], v[180:183]
    ds_read_b64_tr_b16 a[230:231], v12 offset:30720
    v_mfma_f32_16x16x32_bf16 v[188:191], a[244:247], v[92:95], v[188:191]
    s_waitcnt lgkmcnt(8)
    ds_read_b64_tr_b16 a[232:233], v9 offset:32768
    v_mfma_f32_16x16x32_bf16 v[192:195], a[248:251], v[88:91], v[192:195]
    ds_read_b64_tr_b16 a[234:235], v9 offset:34816
    v_mfma_f32_16x16x32_bf16 v[200:203], a[248:251], v[92:95], v[200:203]
    ds_read_b64_tr_b16 a[236:237], v10 offset:32768
    v_mfma_f32_16x16x32_bf16 v[196:199], a[252:255], v[88:91], v[196:199]
    ds_read_b64_tr_b16 a[238:239], v10 offset:34816
    v_mfma_f32_16x16x32_bf16 v[204:207], a[252:255], v[92:95], v[204:207]
    s_waitcnt lgkmcnt(8)
    ds_read_b64_tr_b16 a[240:241], v11 offset:32768
    v_mfma_f32_16x16x32_bf16 v[176:179], a[216:219], v[96:99], v[176:179]
    ds_read_b64_tr_b16 a[242:243], v11 offset:34816
    v_mfma_f32_16x16x32_bf16 v[184:187], a[216:219], v[100:103], v[184:187]
    ds_read_b64_tr_b16 a[244:245], v12 offset:32768
    v_mfma_f32_16x16x32_bf16 v[180:183], a[220:223], v[96:99], v[180:183]
    ds_read_b64_tr_b16 a[246:247], v12 offset:34816
    v_mfma_f32_16x16x32_bf16 v[188:191], a[220:223], v[100:103], v[188:191]
    s_waitcnt lgkmcnt(8)
    v_mfma_f32_16x16x32_bf16 v[192:195], a[224:227], v[96:99], v[192:195]
    v_mfma_f32_16x16x32_bf16 v[200:203], a[224:227], v[100:103], v[200:203]
    s_waitcnt lgkmcnt(0)
    s_barrier
    ds_read_b64_tr_b16 a[248:249], v9 offset:36864
    ds_read_b64_tr_b16 a[250:251], v9 offset:38912
    v_mfma_f32_16x16x32_bf16 v[196:199], a[228:231], v[96:99], v[196:199]
    s_add_u32 m0, s36, 0
    ds_read_b64_tr_b16 a[252:253], v10 offset:36864
    ds_read_b64_tr_b16 a[254:255], v10 offset:38912
    v_mfma_f32_16x16x32_bf16 v[204:207], a[228:231], v[100:103], v[204:207]
    s_add_u32 s32, s44, 0
    ds_read_b64_tr_b16 a[216:217], v9 offset:40960
    buffer_load_dwordx4 v240, s[16:19], s32 offen offset:0 lds
    v_mfma_f32_16x16x32_bf16 v[176:179], a[232:235], v[104:107], v[176:179]
    ds_read_b64_tr_b16 a[218:219], v9 offset:43008
    v_mfma_f32_16x16x32_bf16 v[184:187], a[232:235], v[108:111], v[184:187]
    ds_read_b64_tr_b16 a[220:221], v10 offset:40960
    v_mfma_f32_16x16x32_bf16 v[180:183], a[236:239], v[104:107], v[180:183]
    ds_read_b64_tr_b16 a[222:223], v10 offset:43008
    v_mfma_f32_16x16x32_bf16 v[188:191], a[236:239], v[108:111], v[188:191]
    ds_read_b64_tr_b16 a[224:225], v9 offset:45056
    v_mfma_f32_16x16x32_bf16 v[192:195], a[240:243], v[104:107], v[192:195]
    ds_read_b64_tr_b16 a[226:227], v9 offset:47104
    v_mfma_f32_16x16x32_bf16 v[200:203], a[240:243], v[108:111], v[200:203]
    ds_read_b64_tr_b16 a[228:229], v10 offset:45056
    v_mfma_f32_16x16x32_bf16 v[196:199], a[244:247], v[104:107], v[196:199]
    ds_read_b64_tr_b16 a[230:231], v10 offset:47104
    buffer_load_dwordx4 v241, s[16:19], s32 offen offset:1024 lds
    v_mfma_f32_16x16x32_bf16 v[204:207], a[244:247], v[108:111], v[204:207]
    s_waitcnt lgkmcnt(8)
    ds_read_b64_tr_b16 a[232:233], v13 offset:0
    v_mfma_f32_16x16x32_bf16 v[176:179], a[248:251], a[144:147], v[176:179]
    ds_read_b64_tr_b16 a[234:235], v13 offset:2048
    v_mfma_f32_16x16x32_bf16 v[184:187], a[248:251], a[148:151], v[184:187]
    ds_read_b64_tr_b16 a[236:237], v14 offset:0
    v_mfma_f32_16x16x32_bf16 v[180:183], a[252:255], a[144:147], v[180:183]
    ds_read_b64_tr_b16 a[238:239], v14 offset:2048
    v_mfma_f32_16x16x32_bf16 v[188:191], a[252:255], a[148:151], v[188:191]
    s_waitcnt lgkmcnt(8)
    ds_read_b64_tr_b16 a[240:241], v13 offset:4096
    v_mfma_f32_16x16x32_bf16 v[176:179], a[216:219], a[152:155], v[176:179]
    ds_read_b64_tr_b16 a[242:243], v13 offset:6144
    v_mfma_f32_16x16x32_bf16 v[184:187], a[216:219], a[156:159], v[184:187]
    ds_read_b64_tr_b16 a[244:245], v14 offset:4096
    buffer_load_dwordx4 v242, s[16:19], s32 offen offset:2048 lds
    v_mfma_f32_16x16x32_bf16 v[180:183], a[220:223], a[152:155], v[180:183]
    ds_read_b64_tr_b16 a[246:247], v14 offset:6144
    v_mfma_f32_16x16x32_bf16 v[188:191], a[220:223], a[156:159], v[188:191]
    s_waitcnt lgkmcnt(8)
    ds_read_b64_tr_b16 a[248:249], v13 offset:8192
    v_mfma_f32_16x16x32_bf16 v[176:179], a[224:227], a[160:163], v[176:179]
    ds_read_b64_tr_b16 a[250:251], v13 offset:10240
    v_mfma_f32_16x16x32_bf16 v[184:187], a[224:227], a[164:167], v[184:187]
    ds_read_b64_tr_b16 a[252:253], v14 offset:8192
    v_mfma_f32_16x16x32_bf16 v[180:183], a[228:231], a[160:163], v[180:183]
    ds_read_b64_tr_b16 a[254:255], v14 offset:10240
    v_mfma_f32_16x16x32_bf16 v[188:191], a[228:231], a[164:167], v[188:191]
    s_waitcnt lgkmcnt(8)
    ds_read_b64_tr_b16 a[216:217], v13 offset:12288
    v_mfma_f32_16x16x32_bf16 v[176:179], a[232:235], a[168:171], v[176:179]
    ds_read_b64_tr_b16 a[218:219], v13 offset:14336
    buffer_load_dwordx4 v243, s[16:19], s32 offen offset:3072 lds
    v_mfma_f32_16x16x32_bf16 v[184:187], a[232:235], a[172:175], v[184:187]
    s_add_u32 m0, s36, 4096
    ds_read_b64_tr_b16 a[220:221], v14 offset:12288
    v_mfma_f32_16x16x32_bf16 v[180:183], a[236:239], a[168:171], v[180:183]
    s_add_u32 s32, s44, 73728
    ds_read_b64_tr_b16 a[222:223], v14 offset:14336
    v_mfma_f32_16x16x32_bf16 v[188:191], a[236:239], a[172:175], v[188:191]
    s_waitcnt lgkmcnt(8)
    ds_read_b64_tr_b16 a[224:225], v13 offset:16384
    v_mfma_f32_16x16x32_bf16 v[176:179], a[240:243], a[176:179], v[176:179]
    ds_read_b64_tr_b16 a[226:227], v13 offset:18432
    v_mfma_f32_16x16x32_bf16 v[184:187], a[240:243], a[180:183], v[184:187]
    ds_read_b64_tr_b16 a[228:229], v14 offset:16384
    v_mfma_f32_16x16x32_bf16 v[180:183], a[244:247], a[176:179], v[180:183]
    ds_read_b64_tr_b16 a[230:231], v14 offset:18432
    v_mfma_f32_16x16x32_bf16 v[188:191], a[244:247], a[180:183], v[188:191]
    s_waitcnt lgkmcnt(8)
    ds_read_b64_tr_b16 a[232:233], v13 offset:20480
    buffer_load_dwordx4 v240, s[16:19], s32 offen offset:0 lds
    v_mfma_f32_16x16x32_bf16 v[176:179], a[248:251], a[184:187], v[176:179]
    ds_read_b64_tr_b16 a[234:235], v13 offset:22528
    v_mfma_f32_16x16x32_bf16 v[184:187], a[248:251], a[188:191], v[184:187]
    ds_read_b64_tr_b16 a[236:237], v14 offset:20480
    v_mfma_f32_16x16x32_bf16 v[180:183], a[252:255], a[184:187], v[180:183]
    ds_read_b64_tr_b16 a[238:239], v14 offset:22528
    v_mfma_f32_16x16x32_bf16 v[188:191], a[252:255], a[188:191], v[188:191]
    s_waitcnt lgkmcnt(8)
    ds_read_b64_tr_b16 a[240:241], v11 offset:36864
    v_mfma_f32_16x16x32_bf16 v[176:179], a[216:219], a[192:195], v[176:179]
    s_waitcnt vmcnt(11)
    ds_read_b64_tr_b16 a[242:243], v11 offset:38912
    buffer_store_dword v248, v245, s[20:23], s56 offen offset:128 sc1
    v_mfma_f32_16x16x32_bf16 v[184:187], a[216:219], a[196:199], v[184:187]
    ds_read_b64_tr_b16 a[244:245], v12 offset:36864
    v_mfma_f32_16x16x32_bf16 v[180:183], a[220:223], a[192:195], v[180:183]
    ds_read_b64_tr_b16 a[246:247], v12 offset:38912
    buffer_load_dwordx4 v241, s[16:19], s32 offen offset:1024 lds
    v_mfma_f32_16x16x32_bf16 v[188:191], a[220:223], a[196:199], v[188:191]
    s_waitcnt lgkmcnt(8)
    ds_read_b64_tr_b16 a[248:249], v11 offset:40960
    v_mfma_f32_16x16x32_bf16 v[176:179], a[224:227], a[200:203], v[176:179]
    ds_read_b64_tr_b16 a[250:251], v11 offset:43008
    v_mfma_f32_16x16x32_bf16 v[184:187], a[224:227], a[204:207], v[184:187]
    ds_read_b64_tr_b16 a[252:253], v12 offset:40960
    v_mfma_f32_16x16x32_bf16 v[180:183], a[228:231], a[200:203], v[180:183]
    ds_read_b64_tr_b16 a[254:255], v12 offset:43008
    v_mfma_f32_16x16x32_bf16 v[188:191], a[228:231], a[204:207], v[188:191]
    s_waitcnt lgkmcnt(8)
    ds_read_b64_tr_b16 a[216:217], v11 offset:45056
    v_mfma_f32_16x16x32_bf16 v[176:179], a[232:235], a[208:211], v[176:179]
    ds_read_b64_tr_b16 a[218:219], v11 offset:47104
    v_mfma_f32_16x16x32_bf16 v[184:187], a[232:235], a[212:215], v[184:187]
    ds_read_b64_tr_b16 a[220:221], v12 offset:45056
    buffer_load_dwordx4 v242, s[16:19], s32 offen offset:2048 lds
    v_mfma_f32_16x16x32_bf16 v[180:183], a[236:239], a[208:211], v[180:183]
    ds_read_b64_tr_b16 a[222:223], v12 offset:47104
    v_mfma_f32_16x16x32_bf16 v[188:191], a[236:239], a[212:215], v[188:191]
    s_waitcnt lgkmcnt(8)
    ds_read_b64_tr_b16 a[224:225], v15 offset:0
    v_mfma_f32_16x16x32_bf16 v[192:195], a[240:243], a[144:147], v[192:195]
    ds_read_b64_tr_b16 a[226:227], v15 offset:2048
    v_mfma_f32_16x16x32_bf16 v[200:203], a[240:243], a[148:151], v[200:203]
    ds_read_b64_tr_b16 a[228:229], v16 offset:0
    v_mfma_f32_16x16x32_bf16 v[196:199], a[244:247], a[144:147], v[196:199]
    ds_read_b64_tr_b16 a[230:231], v16 offset:2048
    v_mfma_f32_16x16x32_bf16 v[204:207], a[244:247], a[148:151], v[204:207]
    s_waitcnt lgkmcnt(8)
    ds_read_b64_tr_b16 a[232:233], v15 offset:4096
    v_mfma_f32_16x16x32_bf16 v[192:195], a[248:251], a[152:155], v[192:195]
    s_add_u32 s49, s47, 65536
    ds_read_b64_tr_b16 a[234:235], v15 offset:6144
    buffer_load_dwordx4 v243, s[16:19], s32 offen offset:3072 lds
    v_mfma_f32_16x16x32_bf16 v[200:203], a[248:251], a[156:159], v[200:203]
    s_add_u32 m0, s37, 0
    ds_read_b64_tr_b16 a[236:237], v16 offset:4096
    v_cvt_pk_bf16_f32 v176, v176, v177
    v_mfma_f32_16x16x32_bf16 v[196:199], a[252:255], a[152:155], v[196:199]
    s_add_u32 s32, s45, 0
    ds_read_b64_tr_b16 a[238:239], v16 offset:6144
    v_cvt_pk_bf16_f32 v177, v178, v179
    v_mfma_f32_16x16x32_bf16 v[204:207], a[252:255], a[156:159], v[204:207]
    s_waitcnt lgkmcnt(8)
    ds_read_b64_tr_b16 a[240:241], v15 offset:8192
    v_cvt_pk_bf16_f32 v178, v180, v181
    v_mfma_f32_16x16x32_bf16 v[192:195], a[216:219], a[160:163], v[192:195]
    ds_read_b64_tr_b16 a[242:243], v15 offset:10240
    v_cvt_pk_bf16_f32 v179, v182, v183
    v_mfma_f32_16x16x32_bf16 v[200:203], a[216:219], a[164:167], v[200:203]
    ds_read_b64_tr_b16 a[244:245], v16 offset:8192
    buffer_store_dwordx4 v[176:179], v244, s[20:23], s49 offen sc1
    v_mfma_f32_16x16x32_bf16 v[196:199], a[220:223], a[160:163], v[196:199]
    s_add_u32 s49, s47, 73728
    ds_read_b64_tr_b16 a[246:247], v16 offset:10240
    v_cvt_pk_bf16_f32 v180, v184, v185
    v_mfma_f32_16x16x32_bf16 v[204:207], a[220:223], a[164:167], v[204:207]
    s_waitcnt lgkmcnt(8)
    ds_read_b64_tr_b16 a[248:249], v15 offset:12288
    buffer_load_dwordx4 v240, s[16:19], s32 offen offset:0 lds
    v_mfma_f32_16x16x32_bf16 v[192:195], a[224:227], a[168:171], v[192:195]
    ds_read_b64_tr_b16 a[250:251], v15 offset:14336
    v_cvt_pk_bf16_f32 v181, v186, v187
    v_mfma_f32_16x16x32_bf16 v[200:203], a[224:227], a[172:175], v[200:203]
    ds_read_b64_tr_b16 a[252:253], v16 offset:12288
    v_cvt_pk_bf16_f32 v182, v188, v189
    v_mfma_f32_16x16x32_bf16 v[196:199], a[228:231], a[168:171], v[196:199]
    ds_read_b64_tr_b16 a[254:255], v16 offset:14336
    v_cvt_pk_bf16_f32 v183, v190, v191
    v_mfma_f32_16x16x32_bf16 v[204:207], a[228:231], a[172:175], v[204:207]
    s_waitcnt lgkmcnt(8)
    ds_read_b64_tr_b16 a[216:217], v15 offset:16384
    buffer_store_dwordx4 v[180:183], v244, s[20:23], s49 offen sc1
    v_mfma_f32_16x16x32_bf16 v[192:195], a[232:235], a[176:179], v[192:195]
    ds_read_b64_tr_b16 a[218:219], v15 offset:18432
    v_mfma_f32_16x16x32_bf16 v[200:203], a[232:235], a[180:183], v[200:203]
    ds_read_b64_tr_b16 a[220:221], v16 offset:16384
    v_mfma_f32_16x16x32_bf16 v[196:199], a[236:239], a[176:179], v[196:199]
    ds_read_b64_tr_b16 a[222:223], v16 offset:18432
    v_mfma_f32_16x16x32_bf16 v[204:207], a[236:239], a[180:183], v[204:207]
    s_waitcnt lgkmcnt(8)
    ds_read_b64_tr_b16 a[224:225], v15 offset:20480
    v_mfma_f32_16x16x32_bf16 v[192:195], a[240:243], a[184:187], v[192:195]
    ds_read_b64_tr_b16 a[226:227], v15 offset:22528
    v_mfma_f32_16x16x32_bf16 v[200:203], a[240:243], a[188:191], v[200:203]
    ds_read_b64_tr_b16 a[228:229], v16 offset:20480
    v_mfma_f32_16x16x32_bf16 v[196:199], a[244:247], a[184:187], v[196:199]
    ds_read_b64_tr_b16 a[230:231], v16 offset:22528
    v_mfma_f32_16x16x32_bf16 v[204:207], a[244:247], a[188:191], v[204:207]
    s_waitcnt lgkmcnt(8)
    v_mfma_f32_16x16x32_bf16 v[192:195], a[248:251], a[192:195], v[192:195]
    v_mfma_f32_16x16x32_bf16 v[200:203], a[248:251], a[196:199], v[200:203]
    s_waitcnt lgkmcnt(0)
    s_barrier
    ds_read_b64_tr_b16 a[232:233], v13 offset:24576
    ds_read_b64_tr_b16 a[234:235], v13 offset:26624
    v_mfma_f32_16x16x32_bf16 v[196:199], a[252:255], a[192:195], v[196:199]
    ds_read_b64_tr_b16 a[236:237], v14 offset:24576
    ds_read_b64_tr_b16 a[238:239], v14 offset:26624
    v_mfma_f32_16x16x32_bf16 v[204:207], a[252:255], a[196:199], v[204:207]
    ds_read_b64_tr_b16 a[240:241], v15 offset:24576
    v_mfma_f32_16x16x32_bf16 v[192:195], a[216:219], a[200:203], v[192:195]
    ds_read_b64_tr_b16 a[242:243], v15 offset:26624
    v_mfma_f32_16x16x32_bf16 v[200:203], a[216:219], a[204:207], v[200:203]
    ds_read_b64_tr_b16 a[244:245], v16 offset:24576
    v_mfma_f32_16x16x32_bf16 v[196:199], a[220:223], a[200:203], v[196:199]
    ds_read_b64_tr_b16 a[246:247], v16 offset:26624
    v_mfma_f32_16x16x32_bf16 v[204:207], a[220:223], a[204:207], v[204:207]
    ds_read_b64_tr_b16 a[248:249], v13 offset:28672
    v_mfma_f32_16x16x32_bf16 v[192:195], a[224:227], a[208:211], v[192:195]
    ds_read_b64_tr_b16 a[250:251], v13 offset:30720
    v_mfma_f32_16x16x32_bf16 v[200:203], a[224:227], a[212:215], v[200:203]
    ds_read_b64_tr_b16 a[252:253], v14 offset:28672
    v_mfma_f32_16x16x32_bf16 v[196:199], a[228:231], a[208:211], v[196:199]
    ds_read_b64_tr_b16 a[254:255], v14 offset:30720
    v_mfma_f32_16x16x32_bf16 v[204:207], a[228:231], a[212:215], v[204:207]
    s_waitcnt lgkmcnt(8)
    ds_read_b64_tr_b16 a[216:217], v15 offset:28672
    v_mfma_f32_16x16x32_bf16 v[112:115], a[232:235], v[40:43], 0
    ds_read_b64_tr_b16 a[218:219], v15 offset:30720
    v_mfma_f32_16x16x32_bf16 v[120:123], a[232:235], v[44:47], 0
    ds_read_b64_tr_b16 a[220:221], v16 offset:28672
    v_mfma_f32_16x16x32_bf16 v[116:119], a[236:239], v[40:43], 0
    ds_read_b64_tr_b16 a[222:223], v16 offset:30720
    v_mfma_f32_16x16x32_bf16 v[124:127], a[236:239], v[44:47], 0
    s_waitcnt lgkmcnt(8)
    ds_read_b64_tr_b16 a[224:225], v13 offset:32768
    v_mfma_f32_16x16x32_bf16 v[128:131], a[240:243], v[40:43], 0
    s_add_u32 s49, s47, 81920
    ds_read_b64_tr_b16 a[226:227], v13 offset:34816
    v_cvt_pk_bf16_f32 v192, v192, v193
    v_mfma_f32_16x16x32_bf16 v[136:139], a[240:243], v[44:47], 0
    ds_read_b64_tr_b16 a[228:229], v14 offset:32768
    v_cvt_pk_bf16_f32 v193, v194, v195
    v_mfma_f32_16x16x32_bf16 v[132:135], a[244:247], v[40:43], 0
    ds_read_b64_tr_b16 a[230:231], v14 offset:34816
    v_cvt_pk_bf16_f32 v194, v196, v197
    v_mfma_f32_16x16x32_bf16 v[140:143], a[244:247], v[44:47], 0
    s_waitcnt lgkmcnt(8)
    ds_read_b64_tr_b16 a[232:233], v15 offset:32768
    v_cvt_pk_bf16_f32 v195, v198, v199
    v_mfma_f32_16x16x32_bf16 v[112:115], a[248:251], v[48:51], v[112:115]
    ds_read_b64_tr_b16 a[234:235], v15 offset:34816
    buffer_store_dwordx4 v[192:195], v244, s[20:23], s49 offen sc1
    v_mfma_f32_16x16x32_bf16 v[120:123], a[248:251], v[52:55], v[120:123]
    s_add_u32 s49, s47, 90112
    ds_read_b64_tr_b16 a[236:237], v16 offset:32768
    v_cvt_pk_bf16_f32 v196, v200, v201
    v_mfma_f32_16x16x32_bf16 v[116:119], a[252:255], v[48:51], v[116:119]
    ds_read_b64_tr_b16 a[238:239], v16 offset:34816
    v_cvt_pk_bf16_f32 v197, v202, v203
    v_mfma_f32_16x16x32_bf16 v[124:127], a[252:255], v[52:55], v[124:127]
    s_waitcnt lgkmcnt(8)
    ds_read_b64_tr_b16 a[240:241], v13 offset:36864
    v_cvt_pk_bf16_f32 v198, v204, v205
    v_mfma_f32_16x16x32_bf16 v[128:131], a[216:219], v[48:51], v[128:131]
    ds_read_b64_tr_b16 a[242:243], v13 offset:38912
    buffer_load_dword v247, v246, s[20:23], s55 offen offset:0 sc1
    v_mfma_f32_16x16x32_bf16 v[136:139], a[216:219], v[52:55], v[136:139]
    ds_read_b64_tr_b16 a[244:245], v14 offset:36864
    v_cvt_pk_bf16_f32 v199, v206, v207
    v_mfma_f32_16x16x32_bf16 v[132:135], a[220:223], v[48:51], v[132:135]
    ds_read_b64_tr_b16 a[246:247], v14 offset:38912
    buffer_store_dwordx4 v[196:199], v244, s[20:23], s49 offen sc1
    v_mfma_f32_16x16x32_bf16 v[140:143], a[220:223], v[52:55], v[140:143]
    s_waitcnt lgkmcnt(8)
    ds_read_b64_tr_b16 a[248:249], v15 offset:36864
    v_mfma_f32_16x16x32_bf16 v[112:115], a[224:227], v[56:59], v[112:115]
    ds_read_b64_tr_b16 a[250:251], v15 offset:38912
    v_mfma_f32_16x16x32_bf16 v[120:123], a[224:227], v[60:63], v[120:123]
    ds_read_b64_tr_b16 a[252:253], v16 offset:36864
    v_mfma_f32_16x16x32_bf16 v[116:119], a[228:231], v[56:59], v[116:119]
    ds_read_b64_tr_b16 a[254:255], v16 offset:38912
    v_mfma_f32_16x16x32_bf16 v[124:127], a[228:231], v[60:63], v[124:127]
    s_waitcnt lgkmcnt(8)
    ds_read_b64_tr_b16 a[216:217], v13 offset:40960
    v_mfma_f32_16x16x32_bf16 v[128:131], a[232:235], v[56:59], v[128:131]
    ds_read_b64_tr_b16 a[218:219], v13 offset:43008
    v_mfma_f32_16x16x32_bf16 v[136:139], a[232:235], v[60:63], v[136:139]
    ds_read_b64_tr_b16 a[220:221], v14 offset:40960
    v_mfma_f32_16x16x32_bf16 v[132:135], a[236:239], v[56:59], v[132:135]
    ds_read_b64_tr_b16 a[222:223], v14 offset:43008
    v_mfma_f32_16x16x32_bf16 v[140:143], a[236:239], v[60:63], v[140:143]
    s_waitcnt lgkmcnt(8)
    ds_read_b64_tr_b16 a[224:225], v15 offset:40960
    v_mfma_f32_16x16x32_bf16 v[112:115], a[240:243], v[64:67], v[112:115]
    ds_read_b64_tr_b16 a[226:227], v15 offset:43008
    v_mfma_f32_16x16x32_bf16 v[120:123], a[240:243], v[68:71], v[120:123]
    ds_read_b64_tr_b16 a[228:229], v16 offset:40960
    v_mfma_f32_16x16x32_bf16 v[116:119], a[244:247], v[64:67], v[116:119]
    ds_read_b64_tr_b16 a[230:231], v16 offset:43008
    v_mfma_f32_16x16x32_bf16 v[124:127], a[244:247], v[68:71], v[124:127]
    s_waitcnt lgkmcnt(8)
    ds_read_b64_tr_b16 a[232:233], v13 offset:45056
    v_mfma_f32_16x16x32_bf16 v[128:131], a[248:251], v[64:67], v[128:131]
    ds_read_b64_tr_b16 a[234:235], v13 offset:47104
    v_mfma_f32_16x16x32_bf16 v[136:139], a[248:251], v[68:71], v[136:139]
    ds_read_b64_tr_b16 a[236:237], v14 offset:45056
    v_mfma_f32_16x16x32_bf16 v[132:135], a[252:255], v[64:67], v[132:135]
    ds_read_b64_tr_b16 a[238:239], v14 offset:47104
    v_mfma_f32_16x16x32_bf16 v[140:143], a[252:255], v[68:71], v[140:143]
    s_waitcnt lgkmcnt(8)
    ds_read_b64_tr_b16 a[240:241], v15 offset:45056
    v_mfma_f32_16x16x32_bf16 v[112:115], a[216:219], v[72:75], v[112:115]
    ds_read_b64_tr_b16 a[242:243], v15 offset:47104
    v_mfma_f32_16x16x32_bf16 v[120:123], a[216:219], v[76:79], v[120:123]
    ds_read_b64_tr_b16 a[244:245], v16 offset:45056
    v_mfma_f32_16x16x32_bf16 v[116:119], a[220:223], v[72:75], v[116:119]
    ds_read_b64_tr_b16 a[246:247], v16 offset:47104
    v_mfma_f32_16x16x32_bf16 v[124:127], a[220:223], v[76:79], v[124:127]
    s_waitcnt lgkmcnt(8)
    ds_read_b64_tr_b16 a[248:249], v17 offset:0
    v_mfma_f32_16x16x32_bf16 v[128:131], a[224:227], v[72:75], v[128:131]
    ds_read_b64_tr_b16 a[250:251], v17 offset:2048
    v_mfma_f32_16x16x32_bf16 v[136:139], a[224:227], v[76:79], v[136:139]
    ds_read_b64_tr_b16 a[252:253], v18 offset:0
    v_mfma_f32_16x16x32_bf16 v[132:135], a[228:231], v[72:75], v[132:135]
    ds_read_b64_tr_b16 a[254:255], v18 offset:2048
    v_mfma_f32_16x16x32_bf16 v[140:143], a[228:231], v[76:79], v[140:143]
    s_waitcnt lgkmcnt(8)
    ds_read_b64_tr_b16 a[216:217], v19 offset:0
    v_mfma_f32_16x16x32_bf16 v[112:115], a[232:235], v[80:83], v[112:115]
    ds_read_b64_tr_b16 a[218:219], v19 offset:2048
    v_mfma_f32_16x16x32_bf16 v[120:123], a[232:235], v[84:87], v[120:123]
    ds_read_b64_tr_b16 a[220:221], v20 offset:0
    v_mfma_f32_16x16x32_bf16 v[116:119], a[236:239], v[80:83], v[116:119]
    ds_read_b64_tr_b16 a[222:223], v20 offset:2048
    v_mfma_f32_16x16x32_bf16 v[124:127], a[236:239], v[84:87], v[124:127]
    s_waitcnt lgkmcnt(8)
    ds_read_b64_tr_b16 a[224:225], v17 offset:4096
    v_mfma_f32_16x16x32_bf16 v[128:131], a[240:243], v[80:83], v[128:131]
    ds_read_b64_tr_b16 a[226:227], v17 offset:6144
    v_mfma_f32_16x16x32_bf16 v[136:139], a[240:243], v[84:87], v[136:139]
    ds_read_b64_tr_b16 a[228:229], v18 offset:4096
    v_mfma_f32_16x16x32_bf16 v[132:135], a[244:247], v[80:83], v[132:135]
    ds_read_b64_tr_b16 a[230:231], v18 offset:6144
    v_mfma_f32_16x16x32_bf16 v[140:143], a[244:247], v[84:87], v[140:143]
    s_waitcnt lgkmcnt(8)
    ds_read_b64_tr_b16 a[232:233], v19 offset:4096
    v_mfma_f32_16x16x32_bf16 v[112:115], a[248:251], v[88:91], v[112:115]
    ds_read_b64_tr_b16 a[234:235], v19 offset:6144
    v_mfma_f32_16x16x32_bf16 v[120:123], a[248:251], v[92:95], v[120:123]
    ds_read_b64_tr_b16 a[236:237], v20 offset:4096
    v_mfma_f32_16x16x32_bf16 v[116:119], a[252:255], v[88:91], v[116:119]
    ds_read_b64_tr_b16 a[238:239], v20 offset:6144
    v_mfma_f32_16x16x32_bf16 v[124:127], a[252:255], v[92:95], v[124:127]
    s_waitcnt lgkmcnt(8)
    ds_read_b64_tr_b16 a[240:241], v17 offset:8192
    v_mfma_f32_16x16x32_bf16 v[128:131], a[216:219], v[88:91], v[128:131]
    ds_read_b64_tr_b16 a[242:243], v17 offset:10240
    v_mfma_f32_16x16x32_bf16 v[136:139], a[216:219], v[92:95], v[136:139]
    ds_read_b64_tr_b16 a[244:245], v18 offset:8192
    v_mfma_f32_16x16x32_bf16 v[132:135], a[220:223], v[88:91], v[132:135]
    ds_read_b64_tr_b16 a[246:247], v18 offset:10240
    v_mfma_f32_16x16x32_bf16 v[140:143], a[220:223], v[92:95], v[140:143]
    s_waitcnt lgkmcnt(8)
    ds_read_b64_tr_b16 a[248:249], v19 offset:8192
    v_mfma_f32_16x16x32_bf16 v[112:115], a[224:227], v[96:99], v[112:115]
    ds_read_b64_tr_b16 a[250:251], v19 offset:10240
    v_mfma_f32_16x16x32_bf16 v[120:123], a[224:227], v[100:103], v[120:123]
    ds_read_b64_tr_b16 a[252:253], v20 offset:8192
    v_mfma_f32_16x16x32_bf16 v[116:119], a[228:231], v[96:99], v[116:119]
    ds_read_b64_tr_b16 a[254:255], v20 offset:10240
    v_mfma_f32_16x16x32_bf16 v[124:127], a[228:231], v[100:103], v[124:127]
    s_waitcnt lgkmcnt(8)
    v_mfma_f32_16x16x32_bf16 v[128:131], a[232:235], v[96:99], v[128:131]
    s_waitcnt vmcnt(1)
    v_cmp_eq_u32 vcc, 0, v247
    v_mfma_f32_16x16x32_bf16 v[136:139], a[232:235], v[100:103], v[136:139]
    s_waitcnt lgkmcnt(0)
    s_barrier
    ds_read_b64_tr_b16 a[216:217], v17 offset:12288
    ds_read_b64_tr_b16 a[218:219], v17 offset:14336
    v_mfma_f32_16x16x32_bf16 v[132:135], a[236:239], v[96:99], v[132:135]
    s_cbranch_vccnz L_ffn_kernel_spinr0
L_ffn_kernel_retr0:
    ds_read_b64_tr_b16 a[220:221], v18 offset:12288
    ds_read_b64_tr_b16 a[222:223], v18 offset:14336
    v_mfma_f32_16x16x32_bf16 v[140:143], a[236:239], v[100:103], v[140:143]
    s_add_u32 s52, s48, 0
    ds_read_b64_tr_b16 a[224:225], v17 offset:16384
    buffer_load_dword v254, v246, s[20:23], s55 offen offset:128 sc1
    v_mfma_f32_16x16x32_bf16 v[112:115], a[240:243], v[104:107], v[112:115]
    ds_read_b64_tr_b16 a[226:227], v17 offset:18432
    buffer_load_dwordx4 a[0:3], v23, s[20:23], s52 offen offset:0 sc1
    v_mfma_f32_16x16x32_bf16 v[120:123], a[240:243], v[108:111], v[120:123]
    ds_read_b64_tr_b16 a[228:229], v18 offset:16384
    buffer_load_dwordx4 a[4:7], v23, s[20:23], s52 offen offset:1024 sc1
    v_mfma_f32_16x16x32_bf16 v[116:119], a[244:247], v[104:107], v[116:119]
    s_add_u32 s52, s48, 16384
    ds_read_b64_tr_b16 a[230:231], v18 offset:18432
    v_mfma_f32_16x16x32_bf16 v[124:127], a[244:247], v[108:111], v[124:127]
    ds_read_b64_tr_b16 a[232:233], v17 offset:20480
    buffer_load_dwordx4 a[8:11], v23, s[20:23], s52 offen offset:0 sc1
    v_mfma_f32_16x16x32_bf16 v[128:131], a[248:251], v[104:107], v[128:131]
    ds_read_b64_tr_b16 a[234:235], v17 offset:22528
    buffer_load_dwordx4 a[12:15], v23, s[20:23], s52 offen offset:1024 sc1
    v_mfma_f32_16x16x32_bf16 v[136:139], a[248:251], v[108:111], v[136:139]
    ds_read_b64_tr_b16 a[236:237], v18 offset:20480
    v_mfma_f32_16x16x32_bf16 v[132:135], a[252:255], v[104:107], v[132:135]
    ds_read_b64_tr_b16 a[238:239], v18 offset:22528
    v_mfma_f32_16x16x32_bf16 v[140:143], a[252:255], v[108:111], v[140:143]
    s_waitcnt lgkmcnt(8)
    ds_read_b64_tr_b16 a[240:241], v17 offset:24576
    v_mfma_f32_16x16x32_bf16 v[112:115], a[216:219], a[144:147], v[112:115]
    ds_read_b64_tr_b16 a[242:243], v17 offset:26624
    v_mfma_f32_16x16x32_bf16 v[120:123], a[216:219], a[148:151], v[120:123]
    ds_read_b64_tr_b16 a[244:245], v18 offset:24576
    v_mfma_f32_16x16x32_bf16 v[116:119], a[220:223], a[144:147], v[116:119]
    ds_read_b64_tr_b16 a[246:247], v18 offset:26624
    v_mfma_f32_16x16x32_bf16 v[124:127], a[220:223], a[148:151], v[124:127]
    s_waitcnt lgkmcnt(8)
    ds_read_b64_tr_b16 a[248:249], v17 offset:28672
    v_mfma_f32_16x16x32_bf16 v[112:115], a[224:227], a[152:155], v[112:115]
    ds_read_b64_tr_b16 a[250:251], v17 offset:30720
    v_mfma_f32_16x16x32_bf16 v[120:123], a[224:227], a[156:159], v[120:123]
    ds_read_b64_tr_b16 a[252:253], v18 offset:28672
    v_mfma_f32_16x16x32_bf16 v[116:119], a[228:231], a[152:155], v[116:119]
    ds_read_b64_tr_b16 a[254:255], v18 offset:30720
    v_mfma_f32_16x16x32_bf16 v[124:127], a[228:231], a[156:159], v[124:127]
    s_waitcnt lgkmcnt(8)
    ds_read_b64_tr_b16 a[216:217], v17 offset:32768
    v_mfma_f32_16x16x32_bf16 v[112:115], a[232:235], a[160:163], v[112:115]
    ds_read_b64_tr_b16 a[218:219], v17 offset:34816
    v_mfma_f32_16x16x32_bf16 v[120:123], a[232:235], a[164:167], v[120:123]
    ds_read_b64_tr_b16 a[220:221], v18 offset:32768
    v_mfma_f32_16x16x32_bf16 v[116:119], a[236:239], a[160:163], v[116:119]
    ds_read_b64_tr_b16 a[222:223], v18 offset:34816
    v_mfma_f32_16x16x32_bf16 v[124:127], a[236:239], a[164:167], v[124:127]
    s_waitcnt lgkmcnt(8)
    ds_read_b64_tr_b16 a[224:225], v17 offset:36864
    v_mfma_f32_16x16x32_bf16 v[112:115], a[240:243], a[168:171], v[112:115]
    ds_read_b64_tr_b16 a[226:227], v17 offset:38912
    v_mfma_f32_16x16x32_bf16 v[120:123], a[240:243], a[172:175], v[120:123]
    ds_read_b64_tr_b16 a[228:229], v18 offset:36864
    v_mfma_f32_16x16x32_bf16 v[116:119], a[244:247], a[168:171], v[116:119]
    ds_read_b64_tr_b16 a[230:231], v18 offset:38912
    v_mfma_f32_16x16x32_bf16 v[124:127], a[244:247], a[172:175], v[124:127]
    s_waitcnt lgkmcnt(8)
    ds_read_b64_tr_b16 a[232:233], v17 offset:40960
    v_mfma_f32_16x16x32_bf16 v[112:115], a[248:251], a[176:179], v[112:115]
    ds_read_b64_tr_b16 a[234:235], v17 offset:43008
    v_mfma_f32_16x16x32_bf16 v[120:123], a[248:251], a[180:183], v[120:123]
    ds_read_b64_tr_b16 a[236:237], v18 offset:40960
    v_mfma_f32_16x16x32_bf16 v[116:119], a[252:255], a[176:179], v[116:119]
    ds_read_b64_tr_b16 a[238:239], v18 offset:43008
    v_mfma_f32_16x16x32_bf16 v[124:127], a[252:255], a[180:183], v[124:127]
    s_waitcnt lgkmcnt(8)
    ds_read_b64_tr_b16 a[240:241], v17 offset:45056
    v_mfma_f32_16x16x32_bf16 v[112:115], a[216:219], a[184:187], v[112:115]
    ds_read_b64_tr_b16 a[242:243], v17 offset:47104
    v_mfma_f32_16x16x32_bf16 v[120:123], a[216:219], a[188:191], v[120:123]
    ds_read_b64_tr_b16 a[244:245], v18 offset:45056
    v_mfma_f32_16x16x32_bf16 v[116:119], a[220:223], a[184:187], v[116:119]
    s_waitcnt vmcnt(5)
    ds_read_b64_tr_b16 a[246:247], v18 offset:47104
    buffer_store_dword v248, v245, s[20:23], s56 offen offset:256 sc1
    v_mfma_f32_16x16x32_bf16 v[124:127], a[220:223], a[188:191], v[124:127]
    s_waitcnt lgkmcnt(8)
    ds_read_b64_tr_b16 a[248:249], v19 offset:12288
    v_mfma_f32_16x16x32_bf16 v[112:115], a[224:227], a[192:195], v[112:115]
    ds_read_b64_tr_b16 a[250:251], v19 offset:14336
    v_mfma_f32_16x16x32_bf16 v[120:123], a[224:227], a[196:199], v[120:123]
    ds_read_b64_tr_b16 a[252:253], v20 offset:12288
    v_mfma_f32_16x16x32_bf16 v[116:119], a[228:231], a[192:195], v[116:119]
    ds_read_b64_tr_b16 a[254:255], v20 offset:14336
    v_mfma_f32_16x16x32_bf16 v[124:127], a[228:231], a[196:199], v[124:127]
    s_waitcnt lgkmcnt(8)
    ds_read_b64_tr_b16 a[216:217], v19 offset:16384
    v_mfma_f32_16x16x32_bf16 v[112:115], a[232:235], a[200:203], v[112:115]
    ds_read_b64_tr_b16 a[218:219], v19 offset:18432
    v_mfma_f32_16x16x32_bf16 v[120:123], a[232:235], a[204:207], v[120:123]
    ds_read_b64_tr_b16 a[220:221], v20 offset:16384
    v_mfma_f32_16x16x32_bf16 v[116:119], a[236:239], a[200:203], v[116:119]
    ds_read_b64_tr_b16 a[222:223], v20 offset:18432
    v_mfma_f32_16x16x32_bf16 v[124:127], a[236:239], a[204:207], v[124:127]
    s_waitcnt lgkmcnt(8)
    ds_read_b64_tr_b16 a[224:225], v19 offset:20480
    v_mfma_f32_16x16x32_bf16 v[112:115], a[240:243], a[208:211], v[112:115]
    ds_read_b64_tr_b16 a[226:227], v19 offset:22528
    v_mfma_f32_16x16x32_bf16 v[120:123], a[240:243], a[212:215], v[120:123]
    ds_read_b64_tr_b16 a[228:229], v20 offset:20480
    v_mfma_f32_16x16x32_bf16 v[116:119], a[244:247], a[208:211], v[116:119]
    ds_read_b64_tr_b16 a[230:231], v20 offset:22528
    v_mfma_f32_16x16x32_bf16 v[124:127], a[244:247], a[212:215], v[124:127]
    s_waitcnt lgkmcnt(8)
    ds_read_b64_tr_b16 a[232:233], v19 offset:24576
    v_mfma_f32_16x16x32_bf16 v[128:131], a[248:251], a[144:147], v[128:131]
    ds_read_b64_tr_b16 a[234:235], v19 offset:26624
    v_mfma_f32_16x16x32_bf16 v[136:139], a[248:251], a[148:151], v[136:139]
    ds_read_b64_tr_b16 a[236:237], v20 offset:24576
    v_mfma_f32_16x16x32_bf16 v[132:135], a[252:255], a[144:147], v[132:135]
    ds_read_b64_tr_b16 a[238:239], v20 offset:26624
    v_mfma_f32_16x16x32_bf16 v[140:143], a[252:255], a[148:151], v[140:143]
    s_waitcnt lgkmcnt(8)
    ds_read_b64_tr_b16 a[240:241], v19 offset:28672
    v_mfma_f32_16x16x32_bf16 v[128:131], a[216:219], a[152:155], v[128:131]
    s_waitcnt vmcnt(5)
    ds_read_b64_tr_b16 a[242:243], v19 offset:30720
    v_cmp_eq_u32 vcc, 0, v254
    v_mfma_f32_16x16x32_bf16 v[136:139], a[216:219], a[156:159], v[136:139]
    s_cbranch_vccnz L_ffn_kernel_spinr1
L_ffn_kernel_retr1:
    ds_read_b64_tr_b16 a[244:245], v20 offset:28672
    v_cvt_pk_bf16_f32 v112, v112, v113
    v_mfma_f32_16x16x32_bf16 v[132:135], a[220:223], a[152:155], v[132:135]
    s_add_u32 s52, s48, 32768
    ds_read_b64_tr_b16 a[246:247], v20 offset:30720
    v_cvt_pk_bf16_f32 v113, v114, v115
    v_mfma_f32_16x16x32_bf16 v[140:143], a[220:223], a[156:159], v[140:143]
    s_waitcnt lgkmcnt(8)
    ds_read_b64_tr_b16 a[248:249], v19 offset:32768
    buffer_load_dwordx4 a[16:19], v23, s[20:23], s52 offen offset:0 sc1
    v_mfma_f32_16x16x32_bf16 v[128:131], a[224:227], a[160:163], v[128:131]
    s_add_u32 s49, s47, 98304
    ds_read_b64_tr_b16 a[250:251], v19 offset:34816
    buffer_load_dwordx4 a[20:23], v23, s[20:23], s52 offen offset:1024 sc1
    v_mfma_f32_16x16x32_bf16 v[136:139], a[224:227], a[164:167], v[136:139]
    s_add_u32 s52, s48, 49152
    ds_read_b64_tr_b16 a[252:253], v20 offset:32768
    v_cvt_pk_bf16_f32 v114, v116, v117
    v_mfma_f32_16x16x32_bf16 v[132:135], a[228:231], a[160:163], v[132:135]
    ds_read_b64_tr_b16 a[254:255], v20 offset:34816
    buffer_load_dwordx4 a[24:27], v23, s[20:23], s52 offen offset:0 sc1
    v_mfma_f32_16x16x32_bf16 v[140:143], a[228:231], a[164:167], v[140:143]
    s_waitcnt lgkmcnt(8)
    ds_read_b64_tr_b16 a[216:217], v19 offset:36864
    buffer_load_dwordx4 a[28:31], v23, s[20:23], s52 offen offset:1024 sc1
    v_mfma_f32_16x16x32_bf16 v[128:131], a[232:235], a[168:171], v[128:131]
    ds_read_b64_tr_b16 a[218:219], v19 offset:38912
    v_cvt_pk_bf16_f32 v115, v118, v119
    v_mfma_f32_16x16x32_bf16 v[136:139], a[232:235], a[172:175], v[136:139]
    ds_read_b64_tr_b16 a[220:221], v20 offset:36864
    buffer_store_dwordx4 v[112:115], v244, s[20:23], s49 offen sc1
    v_mfma_f32_16x16x32_bf16 v[132:135], a[236:239], a[168:171], v[132:135]
    s_add_u32 s49, s47, 106496
    ds_read_b64_tr_b16 a[222:223], v20 offset:38912
    v_cvt_pk_bf16_f32 v116, v120, v121
    v_mfma_f32_16x16x32_bf16 v[140:143], a[236:239], a[172:175], v[140:143]
    s_waitcnt lgkmcnt(8)
    ds_read_b64_tr_b16 a[224:225], v19 offset:40960
    v_cvt_pk_bf16_f32 v117, v122, v123
    v_mfma_f32_16x16x32_bf16 v[128:131], a[240:243], a[176:179], v[128:131]
    ds_read_b64_tr_b16 a[226:227], v19 offset:43008
    v_cvt_pk_bf16_f32 v118, v124, v125
    v_mfma_f32_16x16x32_bf16 v[136:139], a[240:243], a[180:183], v[136:139]
    ds_read_b64_tr_b16 a[228:229], v20 offset:40960
    v_cvt_pk_bf16_f32 v119, v126, v127
    v_mfma_f32_16x16x32_bf16 v[132:135], a[244:247], a[176:179], v[132:135]
    ds_read_b64_tr_b16 a[230:231], v20 offset:43008
    buffer_store_dwordx4 v[116:119], v244, s[20:23], s49 offen sc1
    v_mfma_f32_16x16x32_bf16 v[140:143], a[244:247], a[180:183], v[140:143]
    s_waitcnt lgkmcnt(8)
    ds_read_b64_tr_b16 a[232:233], v19 offset:45056
    v_mfma_f32_16x16x32_bf16 v[128:131], a[248:251], a[184:187], v[128:131]
    ds_read_b64_tr_b16 a[234:235], v19 offset:47104
    v_mfma_f32_16x16x32_bf16 v[136:139], a[248:251], a[188:191], v[136:139]
    ds_read_b64_tr_b16 a[236:237], v20 offset:45056
    v_mfma_f32_16x16x32_bf16 v[132:135], a[252:255], a[184:187], v[132:135]
    ds_read_b64_tr_b16 a[238:239], v20 offset:47104
    v_mfma_f32_16x16x32_bf16 v[140:143], a[252:255], a[188:191], v[140:143]
    s_waitcnt lgkmcnt(8)
    v_mfma_f32_16x16x32_bf16 v[128:131], a[216:219], a[192:195], v[128:131]
    v_mfma_f32_16x16x32_bf16 v[136:139], a[216:219], a[196:199], v[136:139]
    s_waitcnt lgkmcnt(0)
    s_barrier
    v_add_u32 v21, 4294856704, v21
    v_add_u32 v22, 4294856704, v22
    ds_read_b64_tr_b16 a[240:241], v21 offset:0
    ds_read_b64_tr_b16 a[242:243], v21 offset:1024
    v_mfma_f32_16x16x32_bf16 v[132:135], a[220:223], a[192:195], v[132:135]
    ds_read_b64_tr_b16 a[244:245], v22 offset:0
    ds_read_b64_tr_b16 a[246:247], v22 offset:1024
    v_mfma_f32_16x16x32_bf16 v[140:143], a[220:223], a[196:199], v[140:143]
    ds_read_b64_tr_b16 a[248:249], v21 offset:2048
    v_mfma_f32_16x16x32_bf16 v[128:131], a[224:227], a[200:203], v[128:131]
    ds_read_b64_tr_b16 a[250:251], v21 offset:3072
    v_mfma_f32_16x16x32_bf16 v[136:139], a[224:227], a[204:207], v[136:139]
    ds_read_b64_tr_b16 a[252:253], v22 offset:2048
    v_mfma_f32_16x16x32_bf16 v[132:135], a[228:231], a[200:203], v[132:135]
    ds_read_b64_tr_b16 a[254:255], v22 offset:3072
    v_mfma_f32_16x16x32_bf16 v[140:143], a[228:231], a[204:207], v[140:143]
    ds_read_b64_tr_b16 a[216:217], v21 offset:4096
    v_mfma_f32_16x16x32_bf16 v[128:131], a[232:235], a[208:211], v[128:131]
    ds_read_b64_tr_b16 a[218:219], v21 offset:5120
    v_mfma_f32_16x16x32_bf16 v[136:139], a[232:235], a[212:215], v[136:139]
    ds_read_b64_tr_b16 a[220:221], v22 offset:4096
    v_mfma_f32_16x16x32_bf16 v[132:135], a[236:239], a[208:211], v[132:135]
    ds_read_b64_tr_b16 a[222:223], v22 offset:5120
    v_mfma_f32_16x16x32_bf16 v[140:143], a[236:239], a[212:215], v[140:143]
    s_waitcnt lgkmcnt(8)
    ds_read_b64_tr_b16 a[224:225], v21 offset:6144
    v_mfma_f32_16x16x32_bf16 v[208:211], a[240:243], v[40:43], 0
    ds_read_b64_tr_b16 a[226:227], v21 offset:7168
    v_mfma_f32_16x16x32_bf16 v[216:219], a[240:243], v[44:47], 0
    ds_read_b64_tr_b16 a[228:229], v22 offset:6144
    v_mfma_f32_16x16x32_bf16 v[212:215], a[244:247], v[40:43], 0
    ds_read_b64_tr_b16 a[230:231], v22 offset:7168
    v_mfma_f32_16x16x32_bf16 v[220:223], a[244:247], v[44:47], 0
    s_waitcnt lgkmcnt(8)
    ds_read_b64_tr_b16 a[232:233], v21 offset:8192
    v_mfma_f32_16x16x32_bf16 v[208:211], a[248:251], v[48:51], v[208:211]
    s_add_u32 s49, s47, 114688
    ds_read_b64_tr_b16 a[234:235], v21 offset:9216
    v_cvt_pk_bf16_f32 v128, v128, v129
    v_mfma_f32_16x16x32_bf16 v[216:219], a[248:251], v[52:55], v[216:219]
    ds_read_b64_tr_b16 a[236:237], v22 offset:8192
    v_cvt_pk_bf16_f32 v129, v130, v131
    v_mfma_f32_16x16x32_bf16 v[212:215], a[252:255], v[48:51], v[212:215]
    ds_read_b64_tr_b16 a[238:239], v22 offset:9216
    v_cvt_pk_bf16_f32 v130, v132, v133
    v_mfma_f32_16x16x32_bf16 v[220:223], a[252:255], v[52:55], v[220:223]
    s_waitcnt lgkmcnt(8)
    ds_read_b64_tr_b16 a[240:241], v21 offset:10240
    v_cvt_pk_bf16_f32 v131, v134, v135
    v_mfma_f32_16x16x32_bf16 v[208:211], a[216:219], v[56:59], v[208:211]
    ds_read_b64_tr_b16 a[242:243], v21 offset:11264
    buffer_store_dwordx4 v[128:131], v244, s[20:23], s49 offen sc1
    v_mfma_f32_16x16x32_bf16 v[216:219], a[216:219], v[60:63], v[216:219]
    s_add_u32 s49, s47, 122880
    ds_read_b64_tr_b16 a[244:245], v22 offset:10240
    v_cvt_pk_bf16_f32 v132, v136, v137
    v_mfma_f32_16x16x32_bf16 v[212:215], a[220:223], v[56:59], v[212:215]
    ds_read_b64_tr_b16 a[246:247], v22 offset:11264
    buffer_load_dword v255, v246, s[20:23], s55 offen offset:256 sc1
    v_mfma_f32_16x16x32_bf16 v[220:223], a[220:223], v[60:63], v[220:223]
    s_waitcnt lgkmcnt(8)
    ds_read_b64_tr_b16 a[248:249], v21 offset:12288
    v_cvt_pk_bf16_f32 v133, v138, v139
    v_mfma_f32_16x16x32_bf16 v[208:211], a[224:227], v[64:67], v[208:211]
    ds_read_b64_tr_b16 a[250:251], v21 offset:13312
    v_cvt_pk_bf16_f32 v134, v140, v141
    v_mfma_f32_16x16x32_bf16 v[216:219], a[224:227], v[68:71], v[216:219]
    ds_read_b64_tr_b16 a[252:253], v22 offset:12288
    v_cvt_pk_bf16_f32 v135, v142, v143
    v_mfma_f32_16x16x32_bf16 v[212:215], a[228:231], v[64:67], v[212:215]
    ds_read_b64_tr_b16 a[254:255], v22 offset:13312
    buffer_store_dwordx4 v[132:135], v244, s[20:23], s49 offen sc1
    v_mfma_f32_16x16x32_bf16 v[220:223], a[228:231], v[68:71], v[220:223]
    s_waitcnt lgkmcnt(8)
    ds_read_b64_tr_b16 a[216:217], v21 offset:14336
    v_mfma_f32_16x16x32_bf16 v[208:211], a[232:235], v[72:75], v[208:211]
    ds_read_b64_tr_b16 a[218:219], v21 offset:15360
    v_mfma_f32_16x16x32_bf16 v[216:219], a[232:235], v[76:79], v[216:219]
    ds_read_b64_tr_b16 a[220:221], v22 offset:14336
    v_mfma_f32_16x16x32_bf16 v[212:215], a[236:239], v[72:75], v[212:215]
    ds_read_b64_tr_b16 a[222:223], v22 offset:15360
    v_mfma_f32_16x16x32_bf16 v[220:223], a[236:239], v[76:79], v[220:223]
    s_waitcnt lgkmcnt(8)
    ds_read_b64_tr_b16 a[224:225], v21 offset:16384
    v_mfma_f32_16x16x32_bf16 v[208:211], a[240:243], v[80:83], v[208:211]
    ds_read_b64_tr_b16 a[226:227], v21 offset:17408
    v_mfma_f32_16x16x32_bf16 v[216:219], a[240:243], v[84:87], v[216:219]
    ds_read_b64_tr_b16 a[228:229], v22 offset:16384
    v_mfma_f32_16x16x32_bf16 v[212:215], a[244:247], v[80:83], v[212:215]
    ds_read_b64_tr_b16 a[230:231], v22 offset:17408
    v_mfma_f32_16x16x32_bf16 v[220:223], a[244:247], v[84:87], v[220:223]
    s_waitcnt lgkmcnt(8)
    ds_read_b64_tr_b16 a[232:233], v21 offset:18432
    v_mfma_f32_16x16x32_bf16 v[208:211], a[248:251], v[88:91], v[208:211]
    ds_read_b64_tr_b16 a[234:235], v21 offset:19456
    v_mfma_f32_16x16x32_bf16 v[216:219], a[248:251], v[92:95], v[216:219]
    ds_read_b64_tr_b16 a[236:237], v22 offset:18432
    v_mfma_f32_16x16x32_bf16 v[212:215], a[252:255], v[88:91], v[212:215]
    ds_read_b64_tr_b16 a[238:239], v22 offset:19456
    v_mfma_f32_16x16x32_bf16 v[220:223], a[252:255], v[92:95], v[220:223]
    s_waitcnt lgkmcnt(8)
    ds_read_b64_tr_b16 a[240:241], v21 offset:20480
    v_mfma_f32_16x16x32_bf16 v[208:211], a[216:219], v[96:99], v[208:211]
    ds_read_b64_tr_b16 a[242:243], v21 offset:21504
    v_mfma_f32_16x16x32_bf16 v[216:219], a[216:219], v[100:103], v[216:219]
    ds_read_b64_tr_b16 a[244:245], v22 offset:20480
    v_mfma_f32_16x16x32_bf16 v[212:215], a[220:223], v[96:99], v[212:215]
    ds_read_b64_tr_b16 a[246:247], v22 offset:21504
    v_mfma_f32_16x16x32_bf16 v[220:223], a[220:223], v[100:103], v[220:223]
    s_waitcnt lgkmcnt(8)
    ds_read_b64_tr_b16 a[248:249], v21 offset:22528
    v_mfma_f32_16x16x32_bf16 v[208:211], a[224:227], v[104:107], v[208:211]
    ds_read_b64_tr_b16 a[250:251], v21 offset:23552
    v_mfma_f32_16x16x32_bf16 v[216:219], a[224:227], v[108:111], v[216:219]
    ds_read_b64_tr_b16 a[252:253], v22 offset:22528
    v_mfma_f32_16x16x32_bf16 v[212:215], a[228:231], v[104:107], v[212:215]
    ds_read_b64_tr_b16 a[254:255], v22 offset:23552
    v_mfma_f32_16x16x32_bf16 v[220:223], a[228:231], v[108:111], v[220:223]
    s_waitcnt lgkmcnt(8)
    ds_read_b64_tr_b16 a[216:217], v21 offset:24576
    v_mfma_f32_16x16x32_bf16 v[208:211], a[232:235], a[144:147], v[208:211]
    ds_read_b64_tr_b16 a[218:219], v21 offset:25600
    v_mfma_f32_16x16x32_bf16 v[216:219], a[232:235], a[148:151], v[216:219]
    ds_read_b64_tr_b16 a[220:221], v22 offset:24576
    v_mfma_f32_16x16x32_bf16 v[212:215], a[236:239], a[144:147], v[212:215]
    ds_read_b64_tr_b16 a[222:223], v22 offset:25600
    v_mfma_f32_16x16x32_bf16 v[220:223], a[236:239], a[148:151], v[220:223]
    s_waitcnt lgkmcnt(8)
    ds_read_b64_tr_b16 a[224:225], v21 offset:26624
    v_mfma_f32_16x16x32_bf16 v[208:211], a[240:243], a[152:155], v[208:211]
    ds_read_b64_tr_b16 a[226:227], v21 offset:27648
    v_mfma_f32_16x16x32_bf16 v[216:219], a[240:243], a[156:159], v[216:219]
    ds_read_b64_tr_b16 a[228:229], v22 offset:26624
    v_mfma_f32_16x16x32_bf16 v[212:215], a[244:247], a[152:155], v[212:215]
    ds_read_b64_tr_b16 a[230:231], v22 offset:27648
    v_mfma_f32_16x16x32_bf16 v[220:223], a[244:247], a[156:159], v[220:223]
    s_waitcnt lgkmcnt(8)
    ds_read_b64_tr_b16 a[232:233], v21 offset:28672
    v_mfma_f32_16x16x32_bf16 v[208:211], a[248:251], a[160:163], v[208:211]
    ds_read_b64_tr_b16 a[234:235], v21 offset:29696
    v_mfma_f32_16x16x32_bf16 v[216:219], a[248:251], a[164:167], v[216:219]
    ds_read_b64_tr_b16 a[236:237], v22 offset:28672
    v_mfma_f32_16x16x32_bf16 v[212:215], a[252:255], a[160:163], v[212:215]
    ds_read_b64_tr_b16 a[238:239], v22 offset:29696
    v_mfma_f32_16x16x32_bf16 v[220:223], a[252:255], a[164:167], v[220:223]
    s_waitcnt lgkmcnt(8)
    ds_read_b64_tr_b16 a[240:241], v21 offset:30720
    v_mfma_f32_16x16x32_bf16 v[208:211], a[216:219], a[168:171], v[208:211]
    ds_read_b64_tr_b16 a[242:243], v21 offset:31744
    v_mfma_f32_16x16x32_bf16 v[216:219], a[216:219], a[172:175], v[216:219]
    ds_read_b64_tr_b16 a[244:245], v22 offset:30720
    v_mfma_f32_16x16x32_bf16 v[212:215], a[220:223], a[168:171], v[212:215]
    ds_read_b64_tr_b16 a[246:247], v22 offset:31744
    v_mfma_f32_16x16x32_bf16 v[220:223], a[220:223], a[172:175], v[220:223]
    s_waitcnt lgkmcnt(8)
    ds_read_b64_tr_b16 a[248:249], v21 offset:32768
    v_mfma_f32_16x16x32_bf16 v[208:211], a[224:227], a[176:179], v[208:211]
    ds_read_b64_tr_b16 a[250:251], v21 offset:33792
    v_mfma_f32_16x16x32_bf16 v[216:219], a[224:227], a[180:183], v[216:219]
    ds_read_b64_tr_b16 a[252:253], v22 offset:32768
    v_mfma_f32_16x16x32_bf16 v[212:215], a[228:231], a[176:179], v[212:215]
    ds_read_b64_tr_b16 a[254:255], v22 offset:33792
    v_mfma_f32_16x16x32_bf16 v[220:223], a[228:231], a[180:183], v[220:223]
    s_waitcnt lgkmcnt(8)
    ds_read_b64_tr_b16 a[216:217], v21 offset:34816
    v_mfma_f32_16x16x32_bf16 v[208:211], a[232:235], a[184:187], v[208:211]
    ds_read_b64_tr_b16 a[218:219], v21 offset:35840
    v_mfma_f32_16x16x32_bf16 v[216:219], a[232:235], a[188:191], v[216:219]
    ds_read_b64_tr_b16 a[220:221], v22 offset:34816
    v_mfma_f32_16x16x32_bf16 v[212:215], a[236:239], a[184:187], v[212:215]
    ds_read_b64_tr_b16 a[222:223], v22 offset:35840
    v_mfma_f32_16x16x32_bf16 v[220:223], a[236:239], a[188:191], v[220:223]
    s_waitcnt lgkmcnt(8)
    v_mfma_f32_16x16x32_bf16 v[208:211], a[240:243], a[192:195], v[208:211]
    v_mfma_f32_16x16x32_bf16 v[216:219], a[240:243], a[196:199], v[216:219]
    v_mfma_f32_16x16x32_bf16 v[212:215], a[244:247], a[192:195], v[212:215]
    v_mfma_f32_16x16x32_bf16 v[220:223], a[244:247], a[196:199], v[220:223]
    s_waitcnt lgkmcnt(4)
    v_mfma_f32_16x16x32_bf16 v[208:211], a[248:251], a[200:203], v[208:211]
    v_mfma_f32_16x16x32_bf16 v[216:219], a[248:251], a[204:207], v[216:219]
    v_mfma_f32_16x16x32_bf16 v[212:215], a[252:255], a[200:203], v[212:215]
    v_mfma_f32_16x16x32_bf16 v[220:223], a[252:255], a[204:207], v[220:223]
    s_waitcnt lgkmcnt(0)
    v_mfma_f32_16x16x32_bf16 v[208:211], a[216:219], a[208:211], v[208:211]
    v_mfma_f32_16x16x32_bf16 v[216:219], a[216:219], a[212:215], v[216:219]
    v_mfma_f32_16x16x32_bf16 v[212:215], a[220:223], a[208:211], v[212:215]
    v_mfma_f32_16x16x32_bf16 v[220:223], a[220:223], a[212:215], v[220:223]
    s_nop 7
    v_cvt_pk_bf16_f32 v208, v208, v209
    s_add_u32 s49, s47, 131072
    v_cvt_pk_bf16_f32 v209, v210, v211
    v_cvt_pk_bf16_f32 v210, v212, v213
    v_cvt_pk_bf16_f32 v211, v214, v215
    buffer_store_dwordx4 v[208:211], v244, s[20:23], s49 offen sc1
    v_cvt_pk_bf16_f32 v212, v216, v217
    s_add_u32 s49, s47, 139264
    v_cvt_pk_bf16_f32 v213, v218, v219
    v_cvt_pk_bf16_f32 v214, v220, v221
    v_cvt_pk_bf16_f32 v215, v222, v223
    buffer_store_dwordx4 v[212:215], v244, s[20:23], s49 offen sc1
    s_waitcnt vmcnt(3)
    v_cmp_eq_u32 vcc, 0, v255
    s_add_u32 s52, s48, 65536
    s_cbranch_vccnz L_ffn_kernel_spinr2
L_ffn_kernel_retr2:
    buffer_load_dwordx4 a[32:35], v23, s[20:23], s52 offen offset:0 sc1
    buffer_load_dwordx4 a[36:39], v23, s[20:23], s52 offen offset:1024 sc1
    s_add_u32 s52, s48, 81920
    buffer_load_dwordx4 a[40:43], v23, s[20:23], s52 offen offset:0 sc1
    buffer_load_dwordx4 a[44:47], v23, s[20:23], s52 offen offset:1024 sc1
    s_add_u32 s52, s48, 98304
    buffer_load_dwordx4 a[48:51], v23, s[20:23], s52 offen offset:0 sc1
    buffer_load_dwordx4 a[52:55], v23, s[20:23], s52 offen offset:1024 sc1
    s_add_u32 s52, s48, 114688
    buffer_load_dwordx4 a[56:59], v23, s[20:23], s52 offen offset:0 sc1
    buffer_load_dwordx4 a[60:63], v23, s[20:23], s52 offen offset:1024 sc1
    v_and_b32 v81, 3, v0
    v_mul_u32_u24 v80, 73728, v81
    v_bfe_u32 v81, v0, 2, 3
    v_lshl_add_u32 v80, v81, 3, v80
    v_lshrrev_b32 v70, 5, v0
    v_lshl_add_u32 v81, v70, 30, v80
    v_lshl_add_u32 v80, v70, 6, v80
    v_and_b32 v70, 1, v0
    v_lshlrev_b32 v70, 4, v70
    v_mov_b32 v71, 0x3f80
    v_lshlrev_b32 v71, v70, v71
    v_bfe_u32 v70, v0, 1, 3
    v_cmp_eq_u32 vcc, 0, v70
    s_nop 1
    v_cndmask_b32 v72, 0, v71, vcc
    v_cmp_eq_u32 vcc, 1, v70
    s_nop 1
    v_cndmask_b32 v73, 0, v71, vcc
    v_cmp_eq_u32 vcc, 2, v70
    s_nop 1
    v_cndmask_b32 v74, 0, v71, vcc
    v_cmp_eq_u32 vcc, 3, v70
    s_nop 1
    v_cndmask_b32 v75, 0, v71, vcc
    v_cmp_eq_u32 vcc, 4, v70
    s_nop 1
    v_cndmask_b32 v76, 0, v71, vcc
    v_cmp_eq_u32 vcc, 5, v70
    s_nop 1
    v_cndmask_b32 v77, 0, v71, vcc
    v_cmp_eq_u32 vcc, 6, v70
    s_nop 1
    v_cndmask_b32 v78, 0, v71, vcc
    v_cmp_eq_u32 vcc, 7, v70
    s_nop 1
    v_cndmask_b32 v79, 0, v71, vcc
    v_lshlrev_b32 v40, 16, v28
    v_and_b32 v41, 0xffff0000, v28
    v_lshlrev_b32 v42, 16, v29
    v_and_b32 v43, 0xffff0000, v29
    v_add_f32 v40, v40, v24
    v_add_f32 v41, v41, v24
    v_add_f32 v42, v42, v24
    v_add_f32 v43, v43, v24
    v_lshlrev_b32 v44, 16, v30
    v_and_b32 v45, 0xffff0000, v30
    v_lshlrev_b32 v46, 16, v31
    v_and_b32 v47, 0xffff0000, v31
    v_add_f32 v44, v44, v24
    v_add_f32 v45, v45, v24
    v_add_f32 v46, v46, v24
    v_add_f32 v47, v47, v24
    v_lshlrev_b32 v48, 16, v32
    v_and_b32 v49, 0xffff0000, v32
    v_lshlrev_b32 v50, 16, v33
    v_and_b32 v51, 0xffff0000, v33
    v_add_f32 v48, v48, v24
    v_add_f32 v49, v49, v24
    v_add_f32 v50, v50, v24
    v_add_f32 v51, v51, v24
    v_lshlrev_b32 v52, 16, v34
    v_and_b32 v53, 0xffff0000, v34
    v_lshlrev_b32 v54, 16, v35
    v_and_b32 v55, 0xffff0000, v35
    v_add_f32 v52, v52, v24
    v_add_f32 v53, v53, v24
    v_add_f32 v54, v54, v24
    v_add_f32 v55, v55, v24
    v_lshlrev_b32 v56, 16, v36
    v_and_b32 v57, 0xffff0000, v36
    v_lshlrev_b32 v58, 16, v37
    v_and_b32 v59, 0xffff0000, v37
    v_add_f32 v56, v56, v24
    v_add_f32 v57, v57, v24
    v_add_f32 v58, v58, v24
    v_add_f32 v59, v59, v24
    s_nop 1
    s_add_u32 s49, s62, s75
    s_add_u32 s50, s62, s76
    v_mfma_f32_16x16x32_bf16 v[40:43], v[72:75], a[0:3], v[40:43]
    v_mfma_f32_16x16x32_bf16 v[40:43], v[72:75], a[4:7], v[40:43]
    v_mfma_f32_16x16x32_bf16 v[40:43], v[76:79], a[8:11], v[40:43]
    v_mfma_f32_16x16x32_bf16 v[40:43], v[76:79], a[12:15], v[40:43]
    v_mfma_f32_16x16x32_bf16 v[44:47], v[72:75], a[16:19], v[44:47]
    v_mfma_f32_16x16x32_bf16 v[44:47], v[72:75], a[20:23], v[44:47]
    v_mfma_f32_16x16x32_bf16 v[44:47], v[76:79], a[24:27], v[44:47]
    v_mfma_f32_16x16x32_bf16 v[44:47], v[76:79], a[28:31], v[44:47]
    s_waitcnt vmcnt(8)
    s_add_u32 s52, s48, 131072
    buffer_load_dwordx4 a[64:67], v23, s[20:23], s52 offen offset:0 sc1
    buffer_load_dwordx4 a[68:71], v23, s[20:23], s52 offen offset:1024 sc1
    s_waitcnt vmcnt(6)
    v_mfma_f32_16x16x32_bf16 v[48:51], v[72:75], a[32:35], v[48:51]
    v_mfma_f32_16x16x32_bf16 v[48:51], v[72:75], a[36:39], v[48:51]
    v_mfma_f32_16x16x32_bf16 v[48:51], v[76:79], a[40:43], v[48:51]
    v_mfma_f32_16x16x32_bf16 v[48:51], v[76:79], a[44:47], v[48:51]
    s_nop 7
    v_cvt_pk_bf16_f32 v40, v40, v41
    v_cvt_pk_bf16_f32 v41, v42, v43
    buffer_store_dwordx2 v[40:41], v80, s[24:27], s49 offen offset:0
    v_cvt_pk_bf16_f32 v44, v44, v45
    v_cvt_pk_bf16_f32 v45, v46, v47
    buffer_store_dwordx2 v[44:45], v80, s[24:27], s49 offen offset:128
    v_cvt_pk_bf16_f32 v48, v48, v49
    v_cvt_pk_bf16_f32 v49, v50, v51
    buffer_store_dwordx2 v[48:49], v80, s[24:27], s49 offen offset:256
    s_waitcnt vmcnt(5)
    s_mov_b32 s64, 60000
L_ffn_kernel_sr3:
    v_mfma_f32_16x16x32_bf16 v[96:99], v[72:75], a[48:51], 0
    v_mfma_f32_16x16x32_bf16 v[96:99], v[72:75], a[52:55], v[96:99]
    v_mfma_f32_16x16x32_bf16 v[96:99], v[76:79], a[56:59], v[96:99]
    v_mfma_f32_16x16x32_bf16 v[96:99], v[76:79], a[60:63], v[96:99]
    s_sub_u32 s64, s64, 1
    s_nop 6
    v_cmp_u_f32 vcc, v96, v97
    v_cmp_u_f32 s[70:71], v98, v99
    s_nop 0
    s_or_b64 s[70:71], s[70:71], vcc
    s_cbranch_scc1 L_ffn_kernel_sx3
L_ffn_kernel_sd3:
    v_add_f32 v52, v52, v96
    v_add_f32 v53, v53, v97
    v_add_f32 v54, v54, v98
    v_add_f32 v55, v55, v99
    v_cvt_pk_bf16_f32 v52, v52, v53
    v_cvt_pk_bf16_f32 v53, v54, v55
    buffer_store_dwordx2 v[52:53], v80, s[24:27], s49 offen offset:384
    s_waitcnt vmcnt(4)
    s_mov_b32 s64, 60000
L_ffn_kernel_sr4:
    v_mfma_f32_16x16x32_bf16 v[100:103], v[72:75], a[64:67], 0
    v_mfma_f32_16x16x32_bf16 v[100:103], v[72:75], a[68:71], v[100:103]
    s_sub_u32 s64, s64, 1
    s_nop 6
    v_cmp_u_f32 vcc, v100, v101
    v_cmp_u_f32 s[70:71], v102, v103
    s_nop 0
    s_or_b64 s[70:71], s[70:71], vcc
    s_cbranch_scc1 L_ffn_kernel_sx4
L_ffn_kernel_sd4:
    v_add_f32 v56, v56, v100
    v_add_f32 v57, v57, v101
    v_add_f32 v58, v58, v102
    v_add_f32 v59, v59, v103
    v_cvt_pk_bf16_f32 v56, v56, v57
    v_cvt_pk_bf16_f32 v57, v58, v59
    buffer_store_dwordx2 v[56:57], v81, s[24:27], s50 offen
    s_nop 7
L_ffn_kernel_end:
    s_endpgm
L_ffn_kernel_spinh0:
    s_mov_b32 s64, 200000
L_ffn_kernel_spinlh0:
    buffer_load_dword v253, off, s[20:23], s54 offset:0 sc1
    s_sub_u32 s64, s64, 1
    s_waitcnt vmcnt(0)
    v_cmp_eq_u32 vcc, 0, v253
    s_cmp_eq_u32 s64, 0
    s_cbranch_scc1 L_ffn_kernel_reth0
    s_cbranch_vccnz L_ffn_kernel_spinlh0
    s_branch L_ffn_kernel_reth0
L_ffn_kernel_spinh1:
    s_mov_b32 s64, 200000
L_ffn_kernel_spinlh1:
    buffer_load_dword v253, off, s[20:23], s54 offset:128 sc1
    s_sub_u32 s64, s64, 1
    s_waitcnt vmcnt(0)
    v_cmp_eq_u32 vcc, 0, v253
    s_cmp_eq_u32 s64, 0
    s_cbranch_scc1 L_ffn_kernel_reth1
    s_cbranch_vccnz L_ffn_kernel_spinlh1
    s_branch L_ffn_kernel_reth1
L_ffn_kernel_spinh2:
    s_mov_b32 s64, 200000
L_ffn_kernel_spinlh2:
    buffer_load_dword v253, off, s[20:23], s54 offset:256 sc1
    s_sub_u32 s64, s64, 1
    s_waitcnt vmcnt(0)
    v_cmp_eq_u32 vcc, 0, v253
    s_cmp_eq_u32 s64, 0
    s_cbranch_scc1 L_ffn_kernel_reth2
    s_cbranch_vccnz L_ffn_kernel_spinlh2
    s_branch L_ffn_kernel_reth2
L_ffn_kernel_spinh3:
    s_mov_b32 s64, 200000
L_ffn_kernel_spinlh3:
    buffer_load_dword v253, off, s[20:23], s54 offset:384 sc1
    s_sub_u32 s64, s64, 1
    s_waitcnt vmcnt(0)
    v_cmp_eq_u32 vcc, 0, v253
    s_cmp_eq_u32 s64, 0
    s_cbranch_scc1 L_ffn_kernel_reth3
    s_cbranch_vccnz L_ffn_kernel_spinlh3
    s_branch L_ffn_kernel_reth3
L_ffn_kernel_spinh4:
    s_mov_b32 s64, 200000
L_ffn_kernel_spinlh4:
    buffer_load_dword v253, off, s[20:23], s54 offset:512 sc1
    s_sub_u32 s64, s64, 1
    s_waitcnt vmcnt(0)
    v_cmp_eq_u32 vcc, 0, v253
    s_cmp_eq_u32 s64, 0
    s_cbranch_scc1 L_ffn_kernel_reth4
    s_cbranch_vccnz L_ffn_kernel_spinlh4
    s_branch L_ffn_kernel_reth4
L_ffn_kernel_spinclr:
    s_mov_b32 s64, 200000
L_ffn_kernel_spinlclr:
    buffer_load_dword v253, v246, s[20:23], s55 offen offset:512 sc1
    s_sub_u32 s64, s64, 1
    s_waitcnt vmcnt(0)
    v_cmp_eq_u32 vcc, 0, v253
    s_cmp_eq_u32 s64, 0
    s_cbranch_scc1 L_ffn_kernel_retclr
    s_cbranch_vccnz L_ffn_kernel_spinlclr
    s_branch L_ffn_kernel_retclr
L_ffn_kernel_spinr0:
    s_mov_b32 s64, 200000
L_ffn_kernel_spinlr0:
    buffer_load_dword v253, v246, s[20:23], s55 offen offset:0 sc1
    s_sub_u32 s64, s64, 1
    s_waitcnt vmcnt(0)
    v_cmp_eq_u32 vcc, 0, v253
    s_cmp_eq_u32 s64, 0
    s_cbranch_scc1 L_ffn_kernel_retr0
    s_cbranch_vccnz L_ffn_kernel_spinlr0
    s_branch L_ffn_kernel_retr0
L_ffn_kernel_spinr1:
    s_mov_b32 s64, 200000
L_ffn_kernel_spinlr1:
    buffer_load_dword v253, v246, s[20:23], s55 offen offset:128 sc1
    s_sub_u32 s64, s64, 1
    s_waitcnt vmcnt(0)
    v_cmp_eq_u32 vcc, 0, v253
    s_cmp_eq_u32 s64, 0
    s_cbranch_scc1 L_ffn_kernel_retr1
    s_cbranch_vccnz L_ffn_kernel_spinlr1
    s_branch L_ffn_kernel_retr1
L_ffn_kernel_spinr2:
    s_mov_b32 s64, 200000
L_ffn_kernel_spinlr2:
    buffer_load_dword v253, v246, s[20:23], s55 offen offset:256 sc1
    s_sub_u32 s64, s64, 1
    s_waitcnt vmcnt(0)
    v_cmp_eq_u32 vcc, 0, v253
    s_cmp_eq_u32 s64, 0
    s_cbranch_scc1 L_ffn_kernel_retr2
    s_cbranch_vccnz L_ffn_kernel_spinlr2
    s_branch L_ffn_kernel_retr2
L_ffn_kernel_tf:
    s_branch L_ffn_kernel_join
L_ffn_kernel_in3:
    s_cmp_lg_u32 s28, 3
    s_cbranch_scc1 L_ffn_kernel_lb
    s_mov_b32 s99, 200000
    v_cmp_ne_u32 vcc, s100, v25
    s_cbranch_vccz L_ffn_kernel_lo
    s_branch L_ffn_kernel_lw
L_ffn_kernel_lg:
    buffer_load_dword v25, off, s[20:23], s57 sc1
    s_sub_u32 s99, s99, 1
    s_waitcnt vmcnt(0)
    v_cmp_ne_u32 vcc, s100, v25
    s_cmp_eq_u32 s99, 0
    s_cbranch_scc1 L_ffn_kernel_lo
    s_cbranch_vccz L_ffn_kernel_lw
    s_sleep 4
    s_branch L_ffn_kernel_lg
L_ffn_kernel_lw:
    buffer_load_dword v25, v26, s[20:23], s51 offen sc1
    s_sub_u32 s99, s99, 1
    s_waitcnt vmcnt(0)
    v_cmp_ne_u32 vcc, s100, v25
    s_cmp_eq_u32 s99, 0
    s_cbranch_scc1 L_ffn_kernel_lo
    s_cbranch_vccnz L_ffn_kernel_lw
L_ffn_kernel_lo:
    s_mov_b32 m0, 36864
    s_add_u32 s55, s54, 0
    buffer_load_dwordx4 v2, s[20:23], s55 offen offset:0 sc1 lds
    buffer_load_dwordx4 v2, s[20:23], s55 offen offset:1024 sc1 lds
    buffer_load_dwordx4 v2, s[20:23], s55 offen offset:2048 sc1 lds
    buffer_load_dwordx4 v2, s[20:23], s55 offen offset:3072 sc1 lds
    s_mov_b32 m0, 55296
    s_add_u32 s55, s54, 18432
    buffer_load_dwordx4 v2, s[20:23], s55 offen offset:0 sc1 lds
    buffer_load_dwordx4 v2, s[20:23], s55 offen offset:1024 sc1 lds
    buffer_load_dwordx4 v2, s[20:23], s55 offen offset:2048 sc1 lds
    buffer_load_dwordx4 v2, s[20:23], s55 offen offset:3072 sc1 lds
    s_waitcnt vmcnt(0)
L_ffn_kernel_lb:
    s_barrier
    s_branch L_ffn_kernel_join
L_ffn_kernel_sx3:
    s_cmp_eq_u32 s64, 0
    s_cbranch_scc1 L_ffn_kernel_sd3
    s_add_u32 s52, s48, 98304
    buffer_load_dwordx4 a[48:51], v23, s[20:23], s52 offen offset:0 sc1
    buffer_load_dwordx4 a[52:55], v23, s[20:23], s52 offen offset:1024 sc1
    s_add_u32 s52, s48, 114688
    buffer_load_dwordx4 a[56:59], v23, s[20:23], s52 offen offset:0 sc1
    buffer_load_dwordx4 a[60:63], v23, s[20:23], s52 offen offset:1024 sc1
    s_waitcnt vmcnt(0)
    s_branch L_ffn_kernel_sr3
L_ffn_kernel_sx4:
    s_cmp_eq_u32 s64, 0
    s_cbranch_scc1 L_ffn_kernel_sd4
    s_add_u32 s52, s48, 131072
    buffer_load_dwordx4 a[64:67], v23, s[20:23], s52 offen offset:0 sc1
    buffer_load_dwordx4 a[68:71], v23, s[20:23], s52 offen offset:1024 sc1
    s_waitcnt vmcnt(0)
    s_branch L_ffn_kernel_sr4
L_ffn_kernel_fin:

L_text_end:

.section .rodata,"a"
.p2align 6
.amdhsa_kernel sequential_preLN__spectral_gfnet__geglu_ffn__prompt_kernel
  .amdhsa_next_free_vgpr 512
  .amdhsa_next_free_sgpr 102
  .amdhsa_accum_offset 256
  .amdhsa_group_segment_fixed_size 0
  .amdhsa_kernarg_size 80
  .amdhsa_user_sgpr_count 2
  .amdhsa_user_sgpr_kernarg_segment_ptr 1
  .amdhsa_system_sgpr_workgroup_id_x 1
.end_amdhsa_kernel
```
